```python
import torch

def _softmax(x, axis=-1):
    return torch.softmax(x, dim=axis)

def _gelu(x):
    return torch.nn.functional.gelu(x, approximate='tanh')

def _silu(x):
    return torch.nn.functional.silu(x)

def _sigmoid(x):
    return torch.sigmoid(x)

def _layernorm(x, axis=-1, eps=1e-05):
    m = x.mean(dim=axis, keepdim=True)
    v = x.var(dim=axis, keepdim=True, unbiased=False)
    return (x - m) / torch.sqrt(v + eps)

def _scatter_add(tgt, idx, src, axis=0):
    return tgt.clone().index_add_(axis, idx, src)

def _segment_sum(src, seg, n):
    out = torch.zeros((n,) + src.shape[1:], dtype=src.dtype)
    return out.index_add_(0, seg, src)

def _pad(x, pw):
    flat = tuple((v for pair in reversed(pw) for v in pair))
    return torch.nn.functional.pad(x, flat)
kernel_name = 'gated_mix__memory_aug_recurrent_mem_tr__moe_arch_mod__prompt'

def setup_inputs():

    _w = lambda a: (lambda t: t.to(torch.bfloat16) if t.is_floating_point() else t)(torch.as_tensor(a))

    def _A_setup():
        B, S, Dm = (1, 2048, 640)
        H, Dh = (32, 192)
        M, seg = (8, 32)
        seg = min(seg, S)
        S = S // seg * seg
        return {'x': _w((lambda *s: torch.randn(*s, dtype=torch.bfloat16) * 0.05)(B, S, Dm)), 'mem0': _w((lambda *s: torch.randn(*s, dtype=torch.bfloat16) * 0.8)(B, M, Dm)), 'Wq': _w((lambda *s: torch.randn(*s, dtype=torch.bfloat16) * 3.2)(Dm, H, Dh) * Dm ** (-0.5)), 'Wk': _w((lambda *s: torch.randn(*s, dtype=torch.bfloat16) * 3.2)(Dm, H, Dh) * Dm ** (-0.5)), 'Wv': _w((lambda *s: torch.randn(*s, dtype=torch.bfloat16) * 0.8)(Dm, H, Dh) * Dm ** (-0.5)), 'Wo': _w((lambda *s: torch.randn(*s, dtype=torch.bfloat16) * 0.8)(H, Dh, Dm) * (H * Dh) ** (-0.5)), 'seg_len': seg}
    _A_in = _A_setup()

    def _B_setup():
        B, S, D, F, C = (1, 2048, 640, 1536, 8)
        return {'x': _w((lambda *s: torch.randn(*s, dtype=torch.bfloat16) * 0.05)(B, S, D)), 'w_r': _w((lambda *s: torch.randn(*s, dtype=torch.bfloat16) * 1.6)(D)), 'w_gate': _w((lambda *s: torch.randn(*s, dtype=torch.bfloat16) * 0.2)(D, F)), 'w_up': _w((lambda *s: torch.randn(*s, dtype=torch.bfloat16) * 0.2)(D, F)), 'w_down': _w((lambda *s: torch.randn(*s, dtype=torch.bfloat16) * 0.2)(F, D))}
    _B_in = _B_setup()
    return {'A_x': _A_in['x'], 'A_mem0': _A_in['mem0'], 'A_Wq': _A_in['Wq'], 'A_Wk': _A_in['Wk'], 'A_Wv': _A_in['Wv'], 'A_Wo': _A_in['Wo'], 'A_seg_len': _A_in['seg_len'], 'B_x': _B_in['x'], 'B_w_r': _B_in['w_r'], 'B_w_gate': _B_in['w_gate'], 'B_w_up': _B_in['w_up'], 'B_w_down': _B_in['w_down'], 'gate_w': _w((lambda *s: torch.randn(*s, dtype=torch.bfloat16) * 0.05)(640) * 16.0)}

def reference(A_x, A_mem0, A_Wq, A_Wk, A_Wv, A_Wo, A_seg_len, B_x, B_w_r, B_w_gate, B_w_up, B_w_down, gate_w):

    def _A_ref(x, mem0, Wq, Wk, Wv, Wo, seg_len):
        B, S, Dm = x.shape
        H, Dh = (Wq.shape[1], Wq.shape[2])
        M = mem0.shape[1]
        scale = Dh ** (-0.5)
        n_seg = S // seg_len
        L = M + seg_len
        idx = torch.arange(L)
        mask = (idx[:, None] < M) | (idx[:, None] >= idx[None, :])
        mem = mem0
        outs = []
        for s in range(n_seg):
            xs = x[:, s * seg_len:(s + 1) * seg_len, :].clone()
            h = torch.concatenate([mem, xs], axis=1)
            q = torch.einsum('btd,dhe->bhte', h, Wq)
            k = torch.einsum('btd,dhe->bhte', h, Wk)
            v = torch.einsum('btd,dhe->bhte', h, Wv)
            scores = torch.einsum('bhqe,bhke->bhqk', q, k) * scale
            scores = torch.where(mask[None, None], scores, -1000000000.0)
            p = _softmax(scores, axis=-1)
            o = torch.einsum('bhqk,bhke->bhqe', p, v)
            o = torch.einsum('bhte,hed->btd', o, Wo)
            mem = o[:, :M, :].clone()
            outs.append(o[:, M:, :])
        return torch.concatenate(outs, axis=1)

    def _B_ref(x, w_r, w_gate, w_up, w_down):
        B, S, D = x.shape
        C = 8
        r = x @ w_r
        idx = torch.argsort(-r, axis=-1)[:, :C]
        idx_e = (lambda x, n, axis: torch.repeat_interleave(x, n, dim=axis))(idx.reshape(B, C, 1), D, axis=2)
        x_sel = (lambda x, i, axis: torch.take_along_dim(x, i, dim=axis))(x, idx_e, axis=1)
        g = _silu(x_sel @ w_gate)
        u = x_sel @ w_up
        y = g * u @ w_down
        r_sel = _sigmoid((lambda x, i, axis: torch.take_along_dim(x, i, dim=axis))(r, idx, axis=1))
        y = y * r_sel.reshape(B, C, 1)
        b_off = (torch.arange(B) * S).reshape(B, 1)
        flat_idx = (idx + b_off).reshape(B * C)
        zero = (x * 0.0).reshape(B * S, D)
        upd = _scatter_add(zero, flat_idx, y.reshape(B * C, D), axis=0)
        return x + upd.reshape(B, S, D)
    x = A_x
    g = _sigmoid((x * gate_w).sum(-1, keepdims=True))
    a = _A_ref(x, A_mem0, A_Wq, A_Wk, A_Wv, A_Wo, A_seg_len)
    b = _B_ref(x, B_w_r, B_w_gate, B_w_up, B_w_down)
    return g * a + (1 - g) * b
```

```asm
; @launch kernel=gated_mix__memory_aug_recurrent_mem_tr__moe_arch_mod__prompt_kernel grid=(256,1,1) block=(256,1,1) lds=163840
.amdgcn_target "amdgcn-amd-amdhsa--gfx950"
.text
    .globl gated_mix__memory_aug_recurrent_mem_tr__moe_arch_mod__prompt_kernel
    .p2align 8
    .type gated_mix__memory_aug_recurrent_mem_tr__moe_arch_mod__prompt_kernel,@function
gated_mix__memory_aug_recurrent_mem_tr__moe_arch_mod__prompt_kernel:
    s_cmp_ge_u32 s2, 256
    s_cbranch_scc1 K2_EXIT
    s_load_dwordx16 s[16:31], s[0:1], 0
    s_load_dwordx16 s[32:47], s[0:1], 64
    v_lshrrev_b32 v1, 6, v0
    v_and_b32 v0, 63, v0
    s_getreg_b32 s72, hwreg(HW_REG_XCC_ID)
    v_readfirstlane_b32 s64, v1
    s_and_b32 s14, s72, 15
    s_bfe_u32 s72, s72, 0x10002
    s_waitcnt lgkmcnt(0)
    s_mov_b32 s68, s2
    s_mov_b32 s48, s46
    s_mov_b32 s49, s47
    s_mov_b32 s50, 0x10000000
    s_mov_b32 s51, 0x20000
    s_mov_b32 s60, s44
    s_mov_b32 s61, s45
    s_mov_b32 s62, 0x100
    s_mov_b32 s63, 0x20000
    s_lshl_b32 s75, s68, 2
    s_add_u32 s75, s75, s64
    s_cmp_lg_u32 s75, 3
    s_cbranch_scc1 L_noinit_10
    v_lshlrev_b32 v10, 4, v0
    v_mov_b32 v12, 0
    v_mov_b32 v13, 0
    v_mov_b32 v14, 0
    v_mov_b32 v15, 0
    s_mov_b32 s72, 6291456
    buffer_store_dwordx4 v[12:15], v10, s[48:51], s72 offen sc1
    s_mov_b32 s72, 6292480
    buffer_store_dwordx4 v[12:15], v10, s[48:51], s72 offen sc1
    s_mov_b32 s72, 6293504
    buffer_store_dwordx4 v[12:15], v10, s[48:51], s72 offen sc1
    s_mov_b32 s72, 6294528
    buffer_store_dwordx4 v[12:15], v10, s[48:51], s72 offen sc1
    s_mov_b32 s72, 6295552
    buffer_store_dwordx4 v[12:15], v10, s[48:51], s72 offen sc1
    s_mov_b32 s72, 6296576
    buffer_store_dwordx4 v[12:15], v10, s[48:51], s72 offen sc1
    s_mov_b32 s72, 6297600
    buffer_store_dwordx4 v[12:15], v10, s[48:51], s72 offen sc1
    s_mov_b32 s72, 6298624
    buffer_store_dwordx4 v[12:15], v10, s[48:51], s72 offen sc1
    s_mov_b32 s72, 6299648
    buffer_store_dwordx4 v[12:15], v10, s[48:51], s72 offen sc1
    s_mov_b32 s72, 6300672
    buffer_store_dwordx4 v[12:15], v10, s[48:51], s72 offen sc1
    s_mov_b32 s72, 6301696
    buffer_store_dwordx4 v[12:15], v10, s[48:51], s72 offen sc1
    s_mov_b32 s72, 6302720
    buffer_store_dwordx4 v[12:15], v10, s[48:51], s72 offen sc1
    s_mov_b32 s72, 6303744
    buffer_store_dwordx4 v[12:15], v10, s[48:51], s72 offen sc1
    s_mov_b32 s72, 6304768
    buffer_store_dwordx4 v[12:15], v10, s[48:51], s72 offen sc1
    s_mov_b32 s72, 6305792
    buffer_store_dwordx4 v[12:15], v10, s[48:51], s72 offen sc1
    s_mov_b32 s72, 6306816
    buffer_store_dwordx4 v[12:15], v10, s[48:51], s72 offen sc1
    s_mov_b32 s72, 6307840
    buffer_store_dwordx4 v[12:15], v10, s[48:51], s72 offen sc1
    s_mov_b32 s72, 6308864
    buffer_store_dwordx4 v[12:15], v10, s[48:51], s72 offen sc1
    s_mov_b32 s72, 6309888
    buffer_store_dwordx4 v[12:15], v10, s[48:51], s72 offen sc1
    s_mov_b32 s72, 6310912
    buffer_store_dwordx4 v[12:15], v10, s[48:51], s72 offen sc1
    s_mov_b32 s72, 6311936
    buffer_store_dwordx4 v[12:15], v10, s[48:51], s72 offen sc1
    s_mov_b32 s72, 6312960
    buffer_store_dwordx4 v[12:15], v10, s[48:51], s72 offen sc1
    s_mov_b32 s72, 6313984
    buffer_store_dwordx4 v[12:15], v10, s[48:51], s72 offen sc1
    s_mov_b32 s72, 6315008
    buffer_store_dwordx4 v[12:15], v10, s[48:51], s72 offen sc1
    s_mov_b32 s72, 6316032
    buffer_store_dwordx4 v[12:15], v10, s[48:51], s72 offen sc1
    s_mov_b32 s72, 6317056
    buffer_store_dwordx4 v[12:15], v10, s[48:51], s72 offen sc1
    s_mov_b32 s72, 6318080
    buffer_store_dwordx4 v[12:15], v10, s[48:51], s72 offen sc1
    s_mov_b32 s72, 6319104
    buffer_store_dwordx4 v[12:15], v10, s[48:51], s72 offen sc1
    s_mov_b64 exec, 0xffff
    s_mov_b32 s72, 6320128
    buffer_store_dwordx4 v[12:15], v10, s[48:51], s72 offen sc1
    s_mov_b64 exec, -1
    s_nop 0
    v_mov_b32 v12, 1
    v_mov_b32 v13, 160
    s_waitcnt vmcnt(0)
    s_mov_b64 exec, 1
    buffer_store_dword v12, v13, s[60:63], 0 offen sc1
    s_mov_b64 exec, -1
L_noinit_10:
    v_mov_b32 v3, 163832
    s_and_b32 s72, s14, 7
    s_mov_b32 s66, 0
    s_mov_b32 s67, 131072
    s_mov_b32 s98, 0
    s_mov_b32 s96, 0
    s_cmp_lg_u32 s64, 0
    s_cbranch_scc1 L_tk_1
    s_lshl_b32 s73, s72, 4
    v_mov_b32 v1, 1
    v_mov_b32 v2, s73
    s_mov_b64 exec, 1
    buffer_atomic_add v1, v2, s[60:63], 0 offen sc0 sc1
    s_waitcnt vmcnt(0)
    v_readfirstlane_b32 s73, v1
    s_cmp_ge_u32 s73, 32
    s_cbranch_scc1 L_ovf_2
    s_lshl_b32 s74, s72, 5
    s_add_u32 s73, s73, s74
    s_branch L_posok_3
L_ovf_2:
    v_mov_b32 v1, 1
    v_mov_b32 v2, 128
    buffer_atomic_add v1, v2, s[60:63], 0 offen sc0 sc1
    s_waitcnt vmcnt(0)
    v_readfirstlane_b32 s74, v1
    s_mov_b64 exec, 0xff
    v_lshlrev_b32 v2, 4, v0
L_ow_5:
    buffer_load_dword v1, v2, s[60:63], 0 offen sc1
    s_waitcnt vmcnt(0)
    s_mov_b32 s75, 0
    v_readlane_b32 s76, v1, 0
    s_nop 1
    s_add_u32 s75, s75, s76
    v_readlane_b32 s77, v1, 1
    s_nop 1
    s_add_u32 s75, s75, s77
    v_readlane_b32 s78, v1, 2
    s_nop 1
    s_add_u32 s75, s75, s78
    v_readlane_b32 s79, v1, 3
    s_nop 1
    s_add_u32 s75, s75, s79
    v_readlane_b32 s80, v1, 4
    s_nop 1
    s_add_u32 s75, s75, s80
    v_readlane_b32 s81, v1, 5
    s_nop 1
    s_add_u32 s75, s75, s81
    v_readlane_b32 s82, v1, 6
    s_nop 1
    s_add_u32 s75, s75, s82
    v_readlane_b32 s83, v1, 7
    s_nop 1
    s_add_u32 s75, s75, s83
    s_sub_u32 s67, s67, 1
    s_cbranch_scc1 K2_EXIT
    s_cmp_lt_u32 s75, 256
    s_cbranch_scc1 L_ow_5
    s_mov_b32 s73, 0
    s_min_u32 s76, s76, 32
    s_add_u32 s75, s76, s74
    s_add_u32 s84, s75, 0
    s_cmp_lt_u32 s75, 32
    s_cselect_b32 s73, s84, s73
    s_cbranch_scc1 L_ol_4
    s_sub_u32 s74, s75, 32
    s_min_u32 s77, s77, 32
    s_add_u32 s75, s77, s74
    s_add_u32 s84, s75, 32
    s_cmp_lt_u32 s75, 32
    s_cselect_b32 s73, s84, s73
    s_cbranch_scc1 L_ol_4
    s_sub_u32 s74, s75, 32
    s_min_u32 s78, s78, 32
    s_add_u32 s75, s78, s74
    s_add_u32 s84, s75, 64
    s_cmp_lt_u32 s75, 32
    s_cselect_b32 s73, s84, s73
    s_cbranch_scc1 L_ol_4
    s_sub_u32 s74, s75, 32
    s_min_u32 s79, s79, 32
    s_add_u32 s75, s79, s74
    s_add_u32 s84, s75, 96
    s_cmp_lt_u32 s75, 32
    s_cselect_b32 s73, s84, s73
    s_cbranch_scc1 L_ol_4
    s_sub_u32 s74, s75, 32
    s_min_u32 s80, s80, 32
    s_add_u32 s75, s80, s74
    s_add_u32 s84, s75, 128
    s_cmp_lt_u32 s75, 32
    s_cselect_b32 s73, s84, s73
    s_cbranch_scc1 L_ol_4
    s_sub_u32 s74, s75, 32
    s_min_u32 s81, s81, 32
    s_add_u32 s75, s81, s74
    s_add_u32 s84, s75, 160
    s_cmp_lt_u32 s75, 32
    s_cselect_b32 s73, s84, s73
    s_cbranch_scc1 L_ol_4
    s_sub_u32 s74, s75, 32
    s_min_u32 s82, s82, 32
    s_add_u32 s75, s82, s74
    s_add_u32 s84, s75, 192
    s_cmp_lt_u32 s75, 32
    s_cselect_b32 s73, s84, s73
    s_cbranch_scc1 L_ol_4
    s_sub_u32 s74, s75, 32
    s_min_u32 s83, s83, 32
    s_add_u32 s75, s83, s74
    s_add_u32 s84, s75, 224
    s_cmp_lt_u32 s75, 32
    s_cselect_b32 s73, s84, s73
    s_cbranch_scc1 L_ol_4
    s_sub_u32 s74, s75, 32
    s_movk_i32 s73, 256
L_ol_4:
    s_mov_b64 exec, 1
L_posok_3:
    v_mov_b32 v1, s73
    ds_write_b32 v3, v1
    s_mov_b64 exec, -1
L_tk_1:
    s_waitcnt lgkmcnt(0)
    s_barrier
    ds_read_b32 v1, v3
    s_waitcnt lgkmcnt(0)
    v_readfirstlane_b32 s73, v1
    s_cmp_ge_u32 s73, 256
    s_cbranch_scc1 K2_EXIT
    s_cmp_ge_u32 s73, 128
    s_cbranch_scc1 L_hi_6
    s_lshr_b32 s74, s73, 3
    s_and_b32 s75, s73, 7
    s_and_b32 s76, s75, 3
    s_cmp_eq_u32 s76, 0
    s_cbranch_scc1 L_ra_7
    s_lshr_b32 s76, s75, 2
    s_sub_u32 s76, s75, s76
    s_sub_u32 s76, s76, 1
    s_mul_i32 s13, s74, 6
    s_add_u32 s13, s13, s76
    s_mul_i32 s65, s74, 5
    s_cmp_eq_u32 s75, 7
    s_cselect_b32 s76, 80, s76
    s_add_u32 s65, s65, s76
    s_add_u32 s65, s65, 32
    s_branch L_rdone_9
L_ra_7:
    s_lshr_b32 s65, s73, 2
    s_branch L_rdone_9
L_hi_6:
    s_sub_u32 s74, s73, 128
    s_lshr_b32 s75, s74, 1
    s_add_u32 s13, s75, 96
    s_add_u32 s65, s75, 192
    s_bitcmp1_b32 s74, 0
    s_cbranch_scc1 L_rdone_9
    s_lshr_b32 s76, s75, 2
    s_add_u32 s65, s75, s76
    s_add_u32 s65, s65, 113
L_rdone_9:
    s_lshl_b32 s15, s65, 2
    s_add_u32 s15, s15, s64
    s_cmp_lt_u32 s65, 32
    s_cbranch_scc1 K2_A
    s_cmp_lt_u32 s65, 112
    s_cbranch_scc1 K2_B
    s_cmp_lt_u32 s65, 192
    s_cbranch_scc1 K2_G2
    s_cmp_ge_u32 s65, 256
    s_cbranch_scc1 K2_DONE
    s_sub_u32 s12, s65, 192
    s_lshr_b32 s12, s12, 1
    v_lshrrev_b32 v1, 3, v0
    v_and_b32 v2, 7, v0
    s_and_b32 s92, s64, 1
    s_lshl_b32 s93, s92, 2
    v_xor_b32 v3, s93, v1
    s_lshr_b32 s94, s64, 1
    s_lshl_b32 s94, s94, 4
    s_add_u32 s94, s94, s93
    v_bfe_u32 v4, v3, 1, 1
    v_lshlrev_b32 v4, 3, v4
    v_lshrrev_b32 v5, 2, v3
    v_lshl_add_u32 v4, v5, 1, v4
    v_and_b32 v5, 1, v3
    v_add3_u32 v4, v4, v5, s94
    s_mov_b32 s94, 12288
    v_mul_lo_u32 v4, v4, s94
    v_lshrrev_b32 v5, 1, v2
    v_bfe_u32 v6, v1, 1, 2
    v_xor_b32 v5, v5, v6
    v_lshl_add_u32 v4, v5, 5, v4
    v_and_b32 v5, 1, v2
    v_lshl_add_u32 v128, v5, 4, v4
    v_lshrrev_b32 v1, 4, v0
    v_bfe_u32 v2, v0, 2, 2
    v_lshl_add_u32 v2, v1, 3, v2
    v_and_b32 v1, 1, v1
    v_lshlrev_b32 v1, 2, v1
    v_xor_b32 v2, v2, v1
    v_bfe_u32 v3, v2, 1, 2
    v_and_b32 v4, 3, v0
    v_lshlrev_b32 v4, 3, v4
    v_lshl_add_u32 v4, v2, 7, v4
    v_lshl_add_u32 v129, v3, 5, v4
    v_xor_b32 v130, 0x240, v129
    s_mul_i32 s95, s64, 3
    s_add_u32 s92, s95, 0
    s_and_b32 s93, s92, 3
    s_lshl_b32 s93, s93, 5
    s_lshr_b32 s92, s92, 2
    s_lshl_b32 s92, s92, 12
    v_xor_b32 v131, s93, v129
    v_xor_b32 v132, s93, v130
    v_add_u32 v131, s92, v131
    v_add_u32 v132, s92, v132
    v_add_u32 v137, 73728, v131
    v_add_u32 v138, 73728, v132
    s_add_u32 s92, s95, 1
    s_and_b32 s93, s92, 3
    s_lshl_b32 s93, s93, 5
    s_lshr_b32 s92, s92, 2
    s_lshl_b32 s92, s92, 12
    v_xor_b32 v133, s93, v129
    v_xor_b32 v134, s93, v130
    v_add_u32 v133, s92, v133
    v_add_u32 v134, s92, v134
    v_add_u32 v139, 73728, v133
    v_add_u32 v140, 73728, v134
    s_add_u32 s92, s95, 2
    s_and_b32 s93, s92, 3
    s_lshl_b32 s93, s93, 5
    s_lshr_b32 s92, s92, 2
    s_lshl_b32 s92, s92, 12
    v_xor_b32 v135, s93, v129
    v_xor_b32 v136, s93, v130
    v_add_u32 v135, s92, v135
    v_add_u32 v136, s92, v136
    v_add_u32 v141, 73728, v135
    v_add_u32 v142, 73728, v136
    s_mul_i32 s10, s12, 384
    s_lshl_b32 s11, s64, 10
    s_bitcmp1_b32 s65, 0
    s_cselect_b32 s52, s22, s20
    s_cselect_b32 s53, s23, s21
    s_mov_b32 s54, 7864320
    s_mov_b32 s55, 0x20000
    s_add_u32 s92, s10, 0
    s_add_u32 m0, s11, 0
    s_nop 0
    buffer_load_dwordx4 v128, s[52:55], s92 offen lds
    s_add_u32 s92, s10, 128
    s_add_u32 m0, s11, 4096
    s_nop 0
    buffer_load_dwordx4 v128, s[52:55], s92 offen lds
    s_add_u32 s92, s10, 256
    s_add_u32 m0, s11, 8192
    s_nop 0
    buffer_load_dwordx4 v128, s[52:55], s92 offen lds
    s_add_u32 s92, s10, 393216
    s_add_u32 m0, s11, 12288
    s_nop 0
    buffer_load_dwordx4 v128, s[52:55], s92 offen lds
    s_add_u32 s92, s10, 393344
    s_add_u32 m0, s11, 16384
    s_nop 0
    buffer_load_dwordx4 v128, s[52:55], s92 offen lds
    s_add_u32 s92, s10, 393472
    s_add_u32 m0, s11, 20480
    s_nop 0
    buffer_load_dwordx4 v128, s[52:55], s92 offen lds
    s_add_u32 s92, s10, 786432
    s_add_u32 m0, s11, 24576
    s_nop 0
    buffer_load_dwordx4 v128, s[52:55], s92 offen lds
    s_add_u32 s92, s10, 786560
    s_add_u32 m0, s11, 28672
    s_nop 0
    buffer_load_dwordx4 v128, s[52:55], s92 offen lds
    s_add_u32 s92, s10, 786688
    s_add_u32 m0, s11, 32768
    s_nop 0
    buffer_load_dwordx4 v128, s[52:55], s92 offen lds
    s_add_u32 s92, s10, 1179648
    s_add_u32 m0, s11, 36864
    s_nop 0
    buffer_load_dwordx4 v128, s[52:55], s92 offen lds
    s_add_u32 s92, s10, 1179776
    s_add_u32 m0, s11, 40960
    s_nop 0
    buffer_load_dwordx4 v128, s[52:55], s92 offen lds
    s_add_u32 s92, s10, 1179904
    s_add_u32 m0, s11, 45056
    s_nop 0
    buffer_load_dwordx4 v128, s[52:55], s92 offen lds
    s_add_u32 s92, s10, 1572864
    s_add_u32 m0, s11, 49152
    s_nop 0
    buffer_load_dwordx4 v128, s[52:55], s92 offen lds
    s_add_u32 s92, s10, 1572992
    s_add_u32 m0, s11, 53248
    s_nop 0
    buffer_load_dwordx4 v128, s[52:55], s92 offen lds
    s_add_u32 s92, s10, 1573120
    s_add_u32 m0, s11, 57344
    s_nop 0
    buffer_load_dwordx4 v128, s[52:55], s92 offen lds
    s_add_u32 s92, s10, 1966080
    s_add_u32 m0, s11, 61440
    s_nop 0
    buffer_load_dwordx4 v128, s[52:55], s92 offen lds
    s_add_u32 s92, s10, 1966208
    s_add_u32 m0, s11, 65536
    s_nop 0
    buffer_load_dwordx4 v128, s[52:55], s92 offen lds
    s_add_u32 s92, s10, 1966336
    s_add_u32 m0, s11, 69632
    s_nop 0
    buffer_load_dwordx4 v128, s[52:55], s92 offen lds
    s_sub_u32 s70, s65, 192
    s_mov_b32 s52, s16
    s_mov_b32 s53, s17
    s_mov_b32 s54, 0x280000
    s_mov_b32 s55, 0x20000
    s_mov_b32 s56, s32
    s_mov_b32 s57, s33
    s_mov_b32 s58, 0x500
    s_mov_b32 s59, 0x20000
    v_and_b32 v1, 15, v0
    v_lshrrev_b32 v2, 4, v0
    v_lshrrev_b32 v3, 1, v2
    v_lshlrev_b32 v3, 5, v3
    v_and_b32 v2, 1, v2
    v_lshl_add_u32 v11, v2, 3, v3
    v_mul_u32_u24 v1, 1280, v1
    v_add_u32 v10, v1, v11
    s_mul_i32 s71, s64, 320
    s_mul_i32 s72, s70, 40960
    s_add_u32 s72, s72, s71
    s_add_u32 s73, s72, 20480
    buffer_load_dwordx2 v[72:73], v11, s[56:59], s71 offen offset:0
    buffer_load_dwordx2 v[74:75], v11, s[56:59], s71 offen offset:16
    buffer_load_dwordx2 v[76:77], v11, s[56:59], s71 offen offset:64
    buffer_load_dwordx2 v[78:79], v11, s[56:59], s71 offen offset:80
    buffer_load_dwordx2 v[80:81], v11, s[56:59], s71 offen offset:128
    buffer_load_dwordx2 v[82:83], v11, s[56:59], s71 offen offset:144
    buffer_load_dwordx2 v[84:85], v11, s[56:59], s71 offen offset:192
    buffer_load_dwordx2 v[86:87], v11, s[56:59], s71 offen offset:208
    buffer_load_dwordx2 v[88:89], v11, s[56:59], s71 offen offset:256
    buffer_load_dwordx2 v[90:91], v11, s[56:59], s71 offen offset:272
    buffer_load_dwordx2 v[32:33], v10, s[52:55], s72 offen offset:0
    buffer_load_dwordx2 v[34:35], v10, s[52:55], s72 offen offset:16
    buffer_load_dwordx2 v[36:37], v10, s[52:55], s72 offen offset:64
    buffer_load_dwordx2 v[38:39], v10, s[52:55], s72 offen offset:80
    buffer_load_dwordx2 v[40:41], v10, s[52:55], s72 offen offset:128
    buffer_load_dwordx2 v[42:43], v10, s[52:55], s72 offen offset:144
    buffer_load_dwordx2 v[44:45], v10, s[52:55], s72 offen offset:192
    buffer_load_dwordx2 v[46:47], v10, s[52:55], s72 offen offset:208
    buffer_load_dwordx2 v[48:49], v10, s[52:55], s72 offen offset:256
    buffer_load_dwordx2 v[50:51], v10, s[52:55], s72 offen offset:272
    buffer_load_dwordx2 v[52:53], v10, s[52:55], s73 offen offset:0
    buffer_load_dwordx2 v[54:55], v10, s[52:55], s73 offen offset:16
    buffer_load_dwordx2 v[56:57], v10, s[52:55], s73 offen offset:64
    buffer_load_dwordx2 v[58:59], v10, s[52:55], s73 offen offset:80
    buffer_load_dwordx2 v[60:61], v10, s[52:55], s73 offen offset:128
    buffer_load_dwordx2 v[62:63], v10, s[52:55], s73 offen offset:144
    buffer_load_dwordx2 v[64:65], v10, s[52:55], s73 offen offset:192
    buffer_load_dwordx2 v[66:67], v10, s[52:55], s73 offen offset:208
    buffer_load_dwordx2 v[68:69], v10, s[52:55], s73 offen offset:256
    buffer_load_dwordx2 v[70:71], v10, s[52:55], s73 offen offset:272
    s_mov_b32 s56, s40
    s_mov_b32 s57, s41
    s_mov_b32 s58, 0x500
    s_mov_b32 s59, 0x20000
    buffer_load_dwordx2 v[92:93], v11, s[56:59], s71 offen offset:0
    buffer_load_dwordx2 v[94:95], v11, s[56:59], s71 offen offset:16
    buffer_load_dwordx2 v[96:97], v11, s[56:59], s71 offen offset:64
    buffer_load_dwordx2 v[98:99], v11, s[56:59], s71 offen offset:80
    buffer_load_dwordx2 v[100:101], v11, s[56:59], s71 offen offset:128
    buffer_load_dwordx2 v[102:103], v11, s[56:59], s71 offen offset:144
    buffer_load_dwordx2 v[104:105], v11, s[56:59], s71 offen offset:192
    buffer_load_dwordx2 v[106:107], v11, s[56:59], s71 offen offset:208
    buffer_load_dwordx2 v[108:109], v11, s[56:59], s71 offen offset:256
    buffer_load_dwordx2 v[110:111], v11, s[56:59], s71 offen offset:272
    v_lshlrev_b32 v12, 4, v0
    s_mul_i32 s74, s70, 40960
    s_mul_i32 s75, s64, 5120
    s_add_u32 s74, s74, s75
    s_add_u32 s74, s74, 0x700000
    v_mov_b32 v14, 0
    v_mov_b32 v15, 0
    v_mov_b32 v16, 0
    v_mov_b32 v17, 0
    s_mov_b32 s76, 0x3f803f80
    s_waitcnt vmcnt(10)
    v_dot2_f32_bf16 v14, v32, v72, v14
    v_dot2_f32_bf16 v14, v33, v73, v14
    v_dot2_f32_bf16 v14, v34, v74, v14
    v_dot2_f32_bf16 v14, v35, v75, v14
    v_dot2_f32_bf16 v14, v36, v76, v14
    v_dot2_f32_bf16 v14, v37, v77, v14
    v_dot2_f32_bf16 v14, v38, v78, v14
    v_dot2_f32_bf16 v14, v39, v79, v14
    v_dot2_f32_bf16 v14, v40, v80, v14
    v_dot2_f32_bf16 v14, v41, v81, v14
    v_dot2_f32_bf16 v14, v42, v82, v14
    v_dot2_f32_bf16 v14, v43, v83, v14
    v_dot2_f32_bf16 v14, v44, v84, v14
    v_dot2_f32_bf16 v14, v45, v85, v14
    v_dot2_f32_bf16 v14, v46, v86, v14
    v_dot2_f32_bf16 v14, v47, v87, v14
    v_dot2_f32_bf16 v14, v48, v88, v14
    v_dot2_f32_bf16 v14, v49, v89, v14
    v_dot2_f32_bf16 v14, v50, v90, v14
    v_dot2_f32_bf16 v14, v51, v91, v14
    v_dot2_f32_bf16 v15, v52, v72, v15
    v_dot2_f32_bf16 v15, v53, v73, v15
    v_dot2_f32_bf16 v15, v54, v74, v15
    v_dot2_f32_bf16 v15, v55, v75, v15
    v_dot2_f32_bf16 v15, v56, v76, v15
    v_dot2_f32_bf16 v15, v57, v77, v15
    v_dot2_f32_bf16 v15, v58, v78, v15
    v_dot2_f32_bf16 v15, v59, v79, v15
    v_dot2_f32_bf16 v15, v60, v80, v15
    v_dot2_f32_bf16 v15, v61, v81, v15
    v_dot2_f32_bf16 v15, v62, v82, v15
    v_dot2_f32_bf16 v15, v63, v83, v15
    v_dot2_f32_bf16 v15, v64, v84, v15
    v_dot2_f32_bf16 v15, v65, v85, v15
    v_dot2_f32_bf16 v15, v66, v86, v15
    v_dot2_f32_bf16 v15, v67, v87, v15
    v_dot2_f32_bf16 v15, v68, v88, v15
    v_dot2_f32_bf16 v15, v69, v89, v15
    v_dot2_f32_bf16 v15, v70, v90, v15
    v_dot2_f32_bf16 v15, v71, v91, v15
    s_waitcnt vmcnt(0)
    v_lshlrev_b32 v112, 16, v92
    v_and_b32 v113, 0xffff0000, v92
    v_lshlrev_b32 v114, 16, v93
    v_and_b32 v115, 0xffff0000, v93
    v_lshlrev_b32 v116, 16, v94
    v_and_b32 v117, 0xffff0000, v94
    v_lshlrev_b32 v118, 16, v95
    v_and_b32 v119, 0xffff0000, v95
    v_lshlrev_b32 v20, 16, v32
    v_and_b32 v21, 0xffff0000, v32
    v_mul_f32 v20, v20, v112
    v_mul_f32 v21, v21, v113
    v_cvt_pk_bf16_f32 v20, v20, v21
    v_dot2_f32_bf16 v16, v20, s76, v16
    v_lshlrev_b32 v20, 16, v33
    v_and_b32 v21, 0xffff0000, v33
    v_mul_f32 v20, v20, v114
    v_mul_f32 v21, v21, v115
    v_cvt_pk_bf16_f32 v20, v20, v21
    v_dot2_f32_bf16 v16, v20, s76, v16
    v_lshlrev_b32 v20, 16, v34
    v_and_b32 v21, 0xffff0000, v34
    v_mul_f32 v20, v20, v116
    v_mul_f32 v21, v21, v117
    v_cvt_pk_bf16_f32 v20, v20, v21
    v_dot2_f32_bf16 v16, v20, s76, v16
    v_lshlrev_b32 v20, 16, v35
    v_and_b32 v21, 0xffff0000, v35
    v_mul_f32 v20, v20, v118
    v_mul_f32 v21, v21, v119
    v_cvt_pk_bf16_f32 v20, v20, v21
    v_dot2_f32_bf16 v16, v20, s76, v16
    v_lshlrev_b32 v20, 16, v52
    v_and_b32 v21, 0xffff0000, v52
    v_mul_f32 v20, v20, v112
    v_mul_f32 v21, v21, v113
    v_cvt_pk_bf16_f32 v20, v20, v21
    v_dot2_f32_bf16 v17, v20, s76, v17
    v_lshlrev_b32 v20, 16, v53
    v_and_b32 v21, 0xffff0000, v53
    v_mul_f32 v20, v20, v114
    v_mul_f32 v21, v21, v115
    v_cvt_pk_bf16_f32 v20, v20, v21
    v_dot2_f32_bf16 v17, v20, s76, v17
    v_lshlrev_b32 v20, 16, v54
    v_and_b32 v21, 0xffff0000, v54
    v_mul_f32 v20, v20, v116
    v_mul_f32 v21, v21, v117
    v_cvt_pk_bf16_f32 v20, v20, v21
    v_dot2_f32_bf16 v17, v20, s76, v17
    v_lshlrev_b32 v20, 16, v55
    v_and_b32 v21, 0xffff0000, v55
    v_mul_f32 v20, v20, v118
    v_mul_f32 v21, v21, v119
    v_cvt_pk_bf16_f32 v20, v20, v21
    v_dot2_f32_bf16 v17, v20, s76, v17
    v_lshlrev_b32 v112, 16, v96
    v_and_b32 v113, 0xffff0000, v96
    v_lshlrev_b32 v114, 16, v97
    v_and_b32 v115, 0xffff0000, v97
    v_lshlrev_b32 v116, 16, v98
    v_and_b32 v117, 0xffff0000, v98
    v_lshlrev_b32 v118, 16, v99
    v_and_b32 v119, 0xffff0000, v99
    v_lshlrev_b32 v20, 16, v36
    v_and_b32 v21, 0xffff0000, v36
    v_mul_f32 v20, v20, v112
    v_mul_f32 v21, v21, v113
    v_cvt_pk_bf16_f32 v20, v20, v21
    v_dot2_f32_bf16 v16, v20, s76, v16
    v_lshlrev_b32 v20, 16, v37
    v_and_b32 v21, 0xffff0000, v37
    v_mul_f32 v20, v20, v114
    v_mul_f32 v21, v21, v115
    v_cvt_pk_bf16_f32 v20, v20, v21
    v_dot2_f32_bf16 v16, v20, s76, v16
    v_lshlrev_b32 v20, 16, v38
    v_and_b32 v21, 0xffff0000, v38
    v_mul_f32 v20, v20, v116
    v_mul_f32 v21, v21, v117
    v_cvt_pk_bf16_f32 v20, v20, v21
    v_dot2_f32_bf16 v16, v20, s76, v16
    v_lshlrev_b32 v20, 16, v39
    v_and_b32 v21, 0xffff0000, v39
    v_mul_f32 v20, v20, v118
    v_mul_f32 v21, v21, v119
    v_cvt_pk_bf16_f32 v20, v20, v21
    v_dot2_f32_bf16 v16, v20, s76, v16
    v_lshlrev_b32 v20, 16, v56
    v_and_b32 v21, 0xffff0000, v56
    v_mul_f32 v20, v20, v112
    v_mul_f32 v21, v21, v113
    v_cvt_pk_bf16_f32 v20, v20, v21
    v_dot2_f32_bf16 v17, v20, s76, v17
    v_lshlrev_b32 v20, 16, v57
    v_and_b32 v21, 0xffff0000, v57
    v_mul_f32 v20, v20, v114
    v_mul_f32 v21, v21, v115
    v_cvt_pk_bf16_f32 v20, v20, v21
    v_dot2_f32_bf16 v17, v20, s76, v17
    v_lshlrev_b32 v20, 16, v58
    v_and_b32 v21, 0xffff0000, v58
    v_mul_f32 v20, v20, v116
    v_mul_f32 v21, v21, v117
    v_cvt_pk_bf16_f32 v20, v20, v21
    v_dot2_f32_bf16 v17, v20, s76, v17
    v_lshlrev_b32 v20, 16, v59
    v_and_b32 v21, 0xffff0000, v59
    v_mul_f32 v20, v20, v118
    v_mul_f32 v21, v21, v119
    v_cvt_pk_bf16_f32 v20, v20, v21
    v_dot2_f32_bf16 v17, v20, s76, v17
    v_lshlrev_b32 v112, 16, v100
    v_and_b32 v113, 0xffff0000, v100
    v_lshlrev_b32 v114, 16, v101
    v_and_b32 v115, 0xffff0000, v101
    v_lshlrev_b32 v116, 16, v102
    v_and_b32 v117, 0xffff0000, v102
    v_lshlrev_b32 v118, 16, v103
    v_and_b32 v119, 0xffff0000, v103
    v_lshlrev_b32 v20, 16, v40
    v_and_b32 v21, 0xffff0000, v40
    v_mul_f32 v20, v20, v112
    v_mul_f32 v21, v21, v113
    v_cvt_pk_bf16_f32 v20, v20, v21
    v_dot2_f32_bf16 v16, v20, s76, v16
    v_lshlrev_b32 v20, 16, v41
    v_and_b32 v21, 0xffff0000, v41
    v_mul_f32 v20, v20, v114
    v_mul_f32 v21, v21, v115
    v_cvt_pk_bf16_f32 v20, v20, v21
    v_dot2_f32_bf16 v16, v20, s76, v16
    v_lshlrev_b32 v20, 16, v42
    v_and_b32 v21, 0xffff0000, v42
    v_mul_f32 v20, v20, v116
    v_mul_f32 v21, v21, v117
    v_cvt_pk_bf16_f32 v20, v20, v21
    v_dot2_f32_bf16 v16, v20, s76, v16
    v_lshlrev_b32 v20, 16, v43
    v_and_b32 v21, 0xffff0000, v43
    v_mul_f32 v20, v20, v118
    v_mul_f32 v21, v21, v119
    v_cvt_pk_bf16_f32 v20, v20, v21
    v_dot2_f32_bf16 v16, v20, s76, v16
    v_lshlrev_b32 v20, 16, v60
    v_and_b32 v21, 0xffff0000, v60
    v_mul_f32 v20, v20, v112
    v_mul_f32 v21, v21, v113
    v_cvt_pk_bf16_f32 v20, v20, v21
    v_dot2_f32_bf16 v17, v20, s76, v17
    v_lshlrev_b32 v20, 16, v61
    v_and_b32 v21, 0xffff0000, v61
    v_mul_f32 v20, v20, v114
    v_mul_f32 v21, v21, v115
    v_cvt_pk_bf16_f32 v20, v20, v21
    v_dot2_f32_bf16 v17, v20, s76, v17
    v_lshlrev_b32 v20, 16, v62
    v_and_b32 v21, 0xffff0000, v62
    v_mul_f32 v20, v20, v116
    v_mul_f32 v21, v21, v117
    v_cvt_pk_bf16_f32 v20, v20, v21
    v_dot2_f32_bf16 v17, v20, s76, v17
    v_lshlrev_b32 v20, 16, v63
    v_and_b32 v21, 0xffff0000, v63
    v_mul_f32 v20, v20, v118
    v_mul_f32 v21, v21, v119
    v_cvt_pk_bf16_f32 v20, v20, v21
    v_dot2_f32_bf16 v17, v20, s76, v17
    v_lshlrev_b32 v112, 16, v104
    v_and_b32 v113, 0xffff0000, v104
    v_lshlrev_b32 v114, 16, v105
    v_and_b32 v115, 0xffff0000, v105
    v_lshlrev_b32 v116, 16, v106
    v_and_b32 v117, 0xffff0000, v106
    v_lshlrev_b32 v118, 16, v107
    v_and_b32 v119, 0xffff0000, v107
    v_lshlrev_b32 v20, 16, v44
    v_and_b32 v21, 0xffff0000, v44
    v_mul_f32 v20, v20, v112
    v_mul_f32 v21, v21, v113
    v_cvt_pk_bf16_f32 v20, v20, v21
    v_dot2_f32_bf16 v16, v20, s76, v16
    v_lshlrev_b32 v20, 16, v45
    v_and_b32 v21, 0xffff0000, v45
    v_mul_f32 v20, v20, v114
    v_mul_f32 v21, v21, v115
    v_cvt_pk_bf16_f32 v20, v20, v21
    v_dot2_f32_bf16 v16, v20, s76, v16
    v_lshlrev_b32 v20, 16, v46
    v_and_b32 v21, 0xffff0000, v46
    v_mul_f32 v20, v20, v116
    v_mul_f32 v21, v21, v117
    v_cvt_pk_bf16_f32 v20, v20, v21
    v_dot2_f32_bf16 v16, v20, s76, v16
    v_lshlrev_b32 v20, 16, v47
    v_and_b32 v21, 0xffff0000, v47
    v_mul_f32 v20, v20, v118
    v_mul_f32 v21, v21, v119
    v_cvt_pk_bf16_f32 v20, v20, v21
    v_dot2_f32_bf16 v16, v20, s76, v16
    v_lshlrev_b32 v20, 16, v64
    v_and_b32 v21, 0xffff0000, v64
    v_mul_f32 v20, v20, v112
    v_mul_f32 v21, v21, v113
    v_cvt_pk_bf16_f32 v20, v20, v21
    v_dot2_f32_bf16 v17, v20, s76, v17
    v_lshlrev_b32 v20, 16, v65
    v_and_b32 v21, 0xffff0000, v65
    v_mul_f32 v20, v20, v114
    v_mul_f32 v21, v21, v115
    v_cvt_pk_bf16_f32 v20, v20, v21
    v_dot2_f32_bf16 v17, v20, s76, v17
    v_lshlrev_b32 v20, 16, v66
    v_and_b32 v21, 0xffff0000, v66
    v_mul_f32 v20, v20, v116
    v_mul_f32 v21, v21, v117
    v_cvt_pk_bf16_f32 v20, v20, v21
    v_dot2_f32_bf16 v17, v20, s76, v17
    v_lshlrev_b32 v20, 16, v67
    v_and_b32 v21, 0xffff0000, v67
    v_mul_f32 v20, v20, v118
    v_mul_f32 v21, v21, v119
    v_cvt_pk_bf16_f32 v20, v20, v21
    v_dot2_f32_bf16 v17, v20, s76, v17
    v_lshlrev_b32 v112, 16, v108
    v_and_b32 v113, 0xffff0000, v108
    v_lshlrev_b32 v114, 16, v109
    v_and_b32 v115, 0xffff0000, v109
    v_lshlrev_b32 v116, 16, v110
    v_and_b32 v117, 0xffff0000, v110
    v_lshlrev_b32 v118, 16, v111
    v_and_b32 v119, 0xffff0000, v111
    v_lshlrev_b32 v20, 16, v48
    v_and_b32 v21, 0xffff0000, v48
    v_mul_f32 v20, v20, v112
    v_mul_f32 v21, v21, v113
    v_cvt_pk_bf16_f32 v20, v20, v21
    v_dot2_f32_bf16 v16, v20, s76, v16
    v_lshlrev_b32 v20, 16, v49
    v_and_b32 v21, 0xffff0000, v49
    v_mul_f32 v20, v20, v114
    v_mul_f32 v21, v21, v115
    v_cvt_pk_bf16_f32 v20, v20, v21
    v_dot2_f32_bf16 v16, v20, s76, v16
    v_lshlrev_b32 v20, 16, v50
    v_and_b32 v21, 0xffff0000, v50
    v_mul_f32 v20, v20, v116
    v_mul_f32 v21, v21, v117
    v_cvt_pk_bf16_f32 v20, v20, v21
    v_dot2_f32_bf16 v16, v20, s76, v16
    v_lshlrev_b32 v20, 16, v51
    v_and_b32 v21, 0xffff0000, v51
    v_mul_f32 v20, v20, v118
    v_mul_f32 v21, v21, v119
    v_cvt_pk_bf16_f32 v20, v20, v21
    v_dot2_f32_bf16 v16, v20, s76, v16
    v_lshlrev_b32 v20, 16, v68
    v_and_b32 v21, 0xffff0000, v68
    v_mul_f32 v20, v20, v112
    v_mul_f32 v21, v21, v113
    v_cvt_pk_bf16_f32 v20, v20, v21
    v_dot2_f32_bf16 v17, v20, s76, v17
    v_lshlrev_b32 v20, 16, v69
    v_and_b32 v21, 0xffff0000, v69
    v_mul_f32 v20, v20, v114
    v_mul_f32 v21, v21, v115
    v_cvt_pk_bf16_f32 v20, v20, v21
    v_dot2_f32_bf16 v17, v20, s76, v17
    v_lshlrev_b32 v20, 16, v70
    v_and_b32 v21, 0xffff0000, v70
    v_mul_f32 v20, v20, v116
    v_mul_f32 v21, v21, v117
    v_cvt_pk_bf16_f32 v20, v20, v21
    v_dot2_f32_bf16 v17, v20, s76, v17
    v_lshlrev_b32 v20, 16, v71
    v_and_b32 v21, 0xffff0000, v71
    v_mul_f32 v20, v20, v118
    v_mul_f32 v21, v21, v119
    v_cvt_pk_bf16_f32 v20, v20, v21
    v_dot2_f32_bf16 v17, v20, s76, v17
    s_add_u32 s75, s74, 0
    v_swap_b32 v33, v34
    buffer_store_dwordx4 v[32:35], v12, s[48:51], s75 offen offset:0 sc1
    v_swap_b32 v37, v38
    buffer_store_dwordx4 v[36:39], v12, s[48:51], s75 offen offset:1024 sc1
    v_swap_b32 v41, v42
    buffer_store_dwordx4 v[40:43], v12, s[48:51], s75 offen offset:2048 sc1
    v_swap_b32 v45, v46
    buffer_store_dwordx4 v[44:47], v12, s[48:51], s75 offen offset:3072 sc1
    v_swap_b32 v49, v50
    s_add_u32 s75, s75, 4096
    buffer_store_dwordx4 v[48:51], v12, s[48:51], s75 offen offset:0 sc1
    s_add_u32 s75, s74, 20480
    v_swap_b32 v53, v54
    buffer_store_dwordx4 v[52:55], v12, s[48:51], s75 offen offset:0 sc1
    v_swap_b32 v57, v58
    buffer_store_dwordx4 v[56:59], v12, s[48:51], s75 offen offset:1024 sc1
    v_swap_b32 v61, v62
    buffer_store_dwordx4 v[60:63], v12, s[48:51], s75 offen offset:2048 sc1
    v_swap_b32 v65, v66
    buffer_store_dwordx4 v[64:67], v12, s[48:51], s75 offen offset:3072 sc1
    v_swap_b32 v69, v70
    s_add_u32 s75, s75, 4096
    buffer_store_dwordx4 v[68:71], v12, s[48:51], s75 offen offset:0 sc1
    s_nop 2
    v_lshlrev_b32 v1, 2, v0
    s_lshl_b32 s75, s64, 8
    s_add_u32 s75, s75, 147456
    v_add_u32 v1, s75, v1
    ds_write_b32 v1, v14
    ds_write_b32 v1, v15 offset:1024
    ds_write_b32 v1, v16 offset:2048
    ds_write_b32 v1, v17 offset:3072
    s_waitcnt lgkmcnt(0)
    s_barrier
    s_cmp_lg_u32 s64, 0
    s_cbranch_scc1 L_xpskip_11
    v_lshrrev_b32 v1, 4, v0
    v_and_b32 v2, 15, v0
    v_lshlrev_b32 v2, 2, v2
    v_lshl_add_u32 v1, v1, 10, v2
    v_add_u32 v1, 147456, v1
    ds_read_b32 v32, v1 offset:0
    ds_read_b32 v33, v1 offset:64
    ds_read_b32 v34, v1 offset:128
    ds_read_b32 v35, v1 offset:192
    ds_read_b32 v36, v1 offset:256
    ds_read_b32 v37, v1 offset:320
    ds_read_b32 v38, v1 offset:384
    ds_read_b32 v39, v1 offset:448
    ds_read_b32 v40, v1 offset:512
    ds_read_b32 v41, v1 offset:576
    ds_read_b32 v42, v1 offset:640
    ds_read_b32 v43, v1 offset:704
    ds_read_b32 v44, v1 offset:768
    ds_read_b32 v45, v1 offset:832
    ds_read_b32 v46, v1 offset:896
    ds_read_b32 v47, v1 offset:960
    s_waitcnt lgkmcnt(0)
    v_add_f32 v32, v32, v40
    v_add_f32 v33, v33, v41
    v_add_f32 v34, v34, v42
    v_add_f32 v35, v35, v43
    v_add_f32 v36, v36, v44
    v_add_f32 v37, v37, v45
    v_add_f32 v38, v38, v46
    v_add_f32 v39, v39, v47
    v_add_f32 v32, v32, v36
    v_add_f32 v33, v33, v37
    v_add_f32 v34, v34, v38
    v_add_f32 v35, v35, v39
    v_add_f32 v32, v32, v34
    v_add_f32 v33, v33, v35
    v_add_f32 v32, v32, v33
    v_cvt_pk_bf16_f32 v32, v32, v32
    v_and_b32 v32, 0xffff0000, v32
    v_mul_f32 v34, 0xbfb8aa3b, v32
    v_exp_f32 v34, v34
    s_nop 0
    v_add_f32 v34, 1.0, v34
    v_rcp_f32 v33, v34
    s_nop 0
    v_cvt_pk_bf16_f32 v33, v33, v33
    v_and_b32 v33, 0xffff0000, v33
    v_cmp_gt_u32 vcc, 32, v0
    v_and_b32 v2, 31, v0
    v_lshlrev_b32 v2, 2, v2
    v_cndmask_b32 v32, v33, v32, vcc
    v_add_u32 v3, 8192, v2
    v_cndmask_b32 v2, v3, v2, vcc
    s_lshl_b32 s75, s70, 7
    s_add_u32 s75, s75, 0x608000
    buffer_store_dword v32, v2, s[48:51], s75 offen sc1
L_xpskip_11:
    s_cmp_lg_u32 s64, 1
    s_cbranch_scc1 L_waok_13
    v_min_u32 v3, 0, v0
    v_lshlrev_b32 v3, 2, v3
    v_add_u32 v3, 0xa0, v3
L_wa_12:
    buffer_load_dword v2, v3, s[60:63], 0 offen sc1
    s_waitcnt vmcnt(0)
    v_cmp_gt_u32 vcc, 1, v2
    s_cbranch_vccz L_waok_13
    s_sleep 12
    s_sub_u32 s67, s67, 1
    s_cbranch_scc1 K2_DONE
    s_branch L_wa_12
L_waok_13:
    s_barrier
    s_lshl_b32 s92, s70, 2
    s_add_u32 s92, s92, 0x603800
    s_mov_b32 s93, 1
    s_waitcnt vmcnt(0)
    s_barrier
    s_cmp_lg_u32 s64, 1
    s_cbranch_scc1 L_fs_14
    v_mov_b32 v2, s93
    v_mov_b32 v3, 0
    s_mov_b64 exec, 1
    buffer_store_dword v2, v3, s[48:51], s92 offen sc1
    s_mov_b64 exec, -1
L_fs_14:
    s_mul_i32 s10, s12, 384
    s_lshl_b32 s11, s64, 10
    s_bitcmp1_b32 s65, 0
    s_cselect_b32 s52, s22, s20
    s_cselect_b32 s53, s23, s21
    s_mov_b32 s54, 7864320
    s_mov_b32 s55, 0x20000
    s_waitcnt vmcnt(12) lgkmcnt(0)
    s_barrier
    s_add_u32 s92, s10, 2359296
    s_add_u32 m0, s11, 73728
    s_nop 0
    buffer_load_dwordx4 v128, s[52:55], s92 offen lds
    s_add_u32 s92, s10, 2359424
    s_add_u32 m0, s11, 77824
    s_nop 0
    buffer_load_dwordx4 v128, s[52:55], s92 offen lds
    s_add_u32 s92, s10, 2359552
    s_add_u32 m0, s11, 81920
    s_nop 0
    buffer_load_dwordx4 v128, s[52:55], s92 offen lds
    s_add_u32 s92, s10, 2752512
    s_add_u32 m0, s11, 86016
    s_nop 0
    buffer_load_dwordx4 v128, s[52:55], s92 offen lds
    s_add_u32 s92, s10, 2752640
    s_add_u32 m0, s11, 90112
    s_nop 0
    buffer_load_dwordx4 v128, s[52:55], s92 offen lds
    s_add_u32 s92, s10, 2752768
    s_add_u32 m0, s11, 94208
    s_nop 0
    buffer_load_dwordx4 v128, s[52:55], s92 offen lds
    ds_read_b64_tr_b16 a[0:1], v131 offset:0
    ds_read_b64_tr_b16 a[2:3], v132 offset:0
    ds_read_b64_tr_b16 a[4:5], v131 offset:12288
    ds_read_b64_tr_b16 a[6:7], v132 offset:12288
    ds_read_b64_tr_b16 a[80:81], v133 offset:0
    ds_read_b64_tr_b16 a[82:83], v134 offset:0
    ds_read_b64_tr_b16 a[84:85], v133 offset:12288
    ds_read_b64_tr_b16 a[86:87], v134 offset:12288
    ds_read_b64_tr_b16 a[160:161], v135 offset:0
    ds_read_b64_tr_b16 a[162:163], v136 offset:0
    ds_read_b64_tr_b16 a[164:165], v135 offset:12288
    ds_read_b64_tr_b16 a[166:167], v136 offset:12288
    s_waitcnt vmcnt(12) lgkmcnt(0)
    s_barrier
    s_add_u32 s92, s10, 3145728
    s_add_u32 m0, s11, 0
    s_nop 0
    buffer_load_dwordx4 v128, s[52:55], s92 offen lds
    s_add_u32 s92, s10, 3145856
    s_add_u32 m0, s11, 4096
    s_nop 0
    buffer_load_dwordx4 v128, s[52:55], s92 offen lds
    s_add_u32 s92, s10, 3145984
    s_add_u32 m0, s11, 8192
    s_nop 0
    buffer_load_dwordx4 v128, s[52:55], s92 offen lds
    s_add_u32 s92, s10, 3538944
    s_add_u32 m0, s11, 12288
    s_nop 0
    buffer_load_dwordx4 v128, s[52:55], s92 offen lds
    s_add_u32 s92, s10, 3539072
    s_add_u32 m0, s11, 16384
    s_nop 0
    buffer_load_dwordx4 v128, s[52:55], s92 offen lds
    s_add_u32 s92, s10, 3539200
    s_add_u32 m0, s11, 20480
    s_nop 0
    buffer_load_dwordx4 v128, s[52:55], s92 offen lds
    ds_read_b64_tr_b16 a[8:9], v131 offset:24576
    ds_read_b64_tr_b16 a[10:11], v132 offset:24576
    ds_read_b64_tr_b16 a[12:13], v131 offset:36864
    ds_read_b64_tr_b16 a[14:15], v132 offset:36864
    ds_read_b64_tr_b16 a[88:89], v133 offset:24576
    ds_read_b64_tr_b16 a[90:91], v134 offset:24576
    ds_read_b64_tr_b16 a[92:93], v133 offset:36864
    ds_read_b64_tr_b16 a[94:95], v134 offset:36864
    ds_read_b64_tr_b16 a[168:169], v135 offset:24576
    ds_read_b64_tr_b16 a[170:171], v136 offset:24576
    ds_read_b64_tr_b16 a[172:173], v135 offset:36864
    ds_read_b64_tr_b16 a[174:175], v136 offset:36864
    s_waitcnt vmcnt(12) lgkmcnt(0)
    s_barrier
    s_add_u32 s92, s10, 3932160
    s_add_u32 m0, s11, 24576
    s_nop 0
    buffer_load_dwordx4 v128, s[52:55], s92 offen lds
    s_add_u32 s92, s10, 3932288
    s_add_u32 m0, s11, 28672
    s_nop 0
    buffer_load_dwordx4 v128, s[52:55], s92 offen lds
    s_add_u32 s92, s10, 3932416
    s_add_u32 m0, s11, 32768
    s_nop 0
    buffer_load_dwordx4 v128, s[52:55], s92 offen lds
    s_add_u32 s92, s10, 4325376
    s_add_u32 m0, s11, 36864
    s_nop 0
    buffer_load_dwordx4 v128, s[52:55], s92 offen lds
    s_add_u32 s92, s10, 4325504
    s_add_u32 m0, s11, 40960
    s_nop 0
    buffer_load_dwordx4 v128, s[52:55], s92 offen lds
    s_add_u32 s92, s10, 4325632
    s_add_u32 m0, s11, 45056
    s_nop 0
    buffer_load_dwordx4 v128, s[52:55], s92 offen lds
    ds_read_b64_tr_b16 a[16:17], v131 offset:49152
    ds_read_b64_tr_b16 a[18:19], v132 offset:49152
    ds_read_b64_tr_b16 a[20:21], v131 offset:61440
    ds_read_b64_tr_b16 a[22:23], v132 offset:61440
    ds_read_b64_tr_b16 a[96:97], v133 offset:49152
    ds_read_b64_tr_b16 a[98:99], v134 offset:49152
    ds_read_b64_tr_b16 a[100:101], v133 offset:61440
    ds_read_b64_tr_b16 a[102:103], v134 offset:61440
    ds_read_b64_tr_b16 a[176:177], v135 offset:49152
    ds_read_b64_tr_b16 a[178:179], v136 offset:49152
    ds_read_b64_tr_b16 a[180:181], v135 offset:61440
    ds_read_b64_tr_b16 a[182:183], v136 offset:61440
    s_waitcnt vmcnt(12) lgkmcnt(0)
    s_barrier
    s_add_u32 s92, s10, 4718592
    s_add_u32 m0, s11, 49152
    s_nop 0
    buffer_load_dwordx4 v128, s[52:55], s92 offen lds
    s_add_u32 s92, s10, 4718720
    s_add_u32 m0, s11, 53248
    s_nop 0
    buffer_load_dwordx4 v128, s[52:55], s92 offen lds
    s_add_u32 s92, s10, 4718848
    s_add_u32 m0, s11, 57344
    s_nop 0
    buffer_load_dwordx4 v128, s[52:55], s92 offen lds
    s_add_u32 s92, s10, 5111808
    s_add_u32 m0, s11, 61440
    s_nop 0
    buffer_load_dwordx4 v128, s[52:55], s92 offen lds
    s_add_u32 s92, s10, 5111936
    s_add_u32 m0, s11, 65536
    s_nop 0
    buffer_load_dwordx4 v128, s[52:55], s92 offen lds
    s_add_u32 s92, s10, 5112064
    s_add_u32 m0, s11, 69632
    s_nop 0
    buffer_load_dwordx4 v128, s[52:55], s92 offen lds
    ds_read_b64_tr_b16 a[24:25], v137 offset:0
    ds_read_b64_tr_b16 a[26:27], v138 offset:0
    ds_read_b64_tr_b16 a[28:29], v137 offset:12288
    ds_read_b64_tr_b16 a[30:31], v138 offset:12288
    ds_read_b64_tr_b16 a[104:105], v139 offset:0
    ds_read_b64_tr_b16 a[106:107], v140 offset:0
    ds_read_b64_tr_b16 a[108:109], v139 offset:12288
    ds_read_b64_tr_b16 a[110:111], v140 offset:12288
    ds_read_b64_tr_b16 a[184:185], v141 offset:0
    ds_read_b64_tr_b16 a[186:187], v142 offset:0
    ds_read_b64_tr_b16 a[188:189], v141 offset:12288
    ds_read_b64_tr_b16 a[190:191], v142 offset:12288
    s_waitcnt vmcnt(12) lgkmcnt(0)
    s_barrier
    s_add_u32 s92, s10, 5505024
    s_add_u32 m0, s11, 73728
    s_nop 0
    buffer_load_dwordx4 v128, s[52:55], s92 offen lds
    s_add_u32 s92, s10, 5505152
    s_add_u32 m0, s11, 77824
    s_nop 0
    buffer_load_dwordx4 v128, s[52:55], s92 offen lds
    s_add_u32 s92, s10, 5505280
    s_add_u32 m0, s11, 81920
    s_nop 0
    buffer_load_dwordx4 v128, s[52:55], s92 offen lds
    s_add_u32 s92, s10, 5898240
    s_add_u32 m0, s11, 86016
    s_nop 0
    buffer_load_dwordx4 v128, s[52:55], s92 offen lds
    s_add_u32 s92, s10, 5898368
    s_add_u32 m0, s11, 90112
    s_nop 0
    buffer_load_dwordx4 v128, s[52:55], s92 offen lds
    s_add_u32 s92, s10, 5898496
    s_add_u32 m0, s11, 94208
    s_nop 0
    buffer_load_dwordx4 v128, s[52:55], s92 offen lds
    ds_read_b64_tr_b16 a[32:33], v131 offset:0
    ds_read_b64_tr_b16 a[34:35], v132 offset:0
    ds_read_b64_tr_b16 a[36:37], v131 offset:12288
    ds_read_b64_tr_b16 a[38:39], v132 offset:12288
    ds_read_b64_tr_b16 a[112:113], v133 offset:0
    ds_read_b64_tr_b16 a[114:115], v134 offset:0
    ds_read_b64_tr_b16 a[116:117], v133 offset:12288
    ds_read_b64_tr_b16 a[118:119], v134 offset:12288
    ds_read_b64_tr_b16 a[192:193], v135 offset:0
    ds_read_b64_tr_b16 a[194:195], v136 offset:0
    ds_read_b64_tr_b16 a[196:197], v135 offset:12288
    ds_read_b64_tr_b16 a[198:199], v136 offset:12288
    s_waitcnt vmcnt(12) lgkmcnt(0)
    s_barrier
    s_add_u32 s92, s10, 6291456
    s_add_u32 m0, s11, 0
    s_nop 0
    buffer_load_dwordx4 v128, s[52:55], s92 offen lds
    s_add_u32 s92, s10, 6291584
    s_add_u32 m0, s11, 4096
    s_nop 0
    buffer_load_dwordx4 v128, s[52:55], s92 offen lds
    s_add_u32 s92, s10, 6291712
    s_add_u32 m0, s11, 8192
    s_nop 0
    buffer_load_dwordx4 v128, s[52:55], s92 offen lds
    s_add_u32 s92, s10, 6684672
    s_add_u32 m0, s11, 12288
    s_nop 0
    buffer_load_dwordx4 v128, s[52:55], s92 offen lds
    s_add_u32 s92, s10, 6684800
    s_add_u32 m0, s11, 16384
    s_nop 0
    buffer_load_dwordx4 v128, s[52:55], s92 offen lds
    s_add_u32 s92, s10, 6684928
    s_add_u32 m0, s11, 20480
    s_nop 0
    buffer_load_dwordx4 v128, s[52:55], s92 offen lds
    ds_read_b64_tr_b16 a[40:41], v131 offset:24576
    ds_read_b64_tr_b16 a[42:43], v132 offset:24576
    ds_read_b64_tr_b16 a[44:45], v131 offset:36864
    ds_read_b64_tr_b16 a[46:47], v132 offset:36864
    ds_read_b64_tr_b16 a[120:121], v133 offset:24576
    ds_read_b64_tr_b16 a[122:123], v134 offset:24576
    ds_read_b64_tr_b16 a[124:125], v133 offset:36864
    ds_read_b64_tr_b16 a[126:127], v134 offset:36864
    ds_read_b64_tr_b16 a[200:201], v135 offset:24576
    ds_read_b64_tr_b16 a[202:203], v136 offset:24576
    ds_read_b64_tr_b16 a[204:205], v135 offset:36864
    ds_read_b64_tr_b16 a[206:207], v136 offset:36864
    s_waitcnt vmcnt(12) lgkmcnt(0)
    s_barrier
    s_add_u32 s92, s10, 7077888
    s_add_u32 m0, s11, 24576
    s_nop 0
    buffer_load_dwordx4 v128, s[52:55], s92 offen lds
    s_add_u32 s92, s10, 7078016
    s_add_u32 m0, s11, 28672
    s_nop 0
    buffer_load_dwordx4 v128, s[52:55], s92 offen lds
    s_add_u32 s92, s10, 7078144
    s_add_u32 m0, s11, 32768
    s_nop 0
    buffer_load_dwordx4 v128, s[52:55], s92 offen lds
    s_add_u32 s92, s10, 7471104
    s_add_u32 m0, s11, 36864
    s_nop 0
    buffer_load_dwordx4 v128, s[52:55], s92 offen lds
    s_add_u32 s92, s10, 7471232
    s_add_u32 m0, s11, 40960
    s_nop 0
    buffer_load_dwordx4 v128, s[52:55], s92 offen lds
    s_add_u32 s92, s10, 7471360
    s_add_u32 m0, s11, 45056
    s_nop 0
    buffer_load_dwordx4 v128, s[52:55], s92 offen lds
    ds_read_b64_tr_b16 a[48:49], v131 offset:49152
    ds_read_b64_tr_b16 a[50:51], v132 offset:49152
    ds_read_b64_tr_b16 a[52:53], v131 offset:61440
    ds_read_b64_tr_b16 a[54:55], v132 offset:61440
    ds_read_b64_tr_b16 a[128:129], v133 offset:49152
    ds_read_b64_tr_b16 a[130:131], v134 offset:49152
    ds_read_b64_tr_b16 a[132:133], v133 offset:61440
    ds_read_b64_tr_b16 a[134:135], v134 offset:61440
    ds_read_b64_tr_b16 a[208:209], v135 offset:49152
    ds_read_b64_tr_b16 a[210:211], v136 offset:49152
    ds_read_b64_tr_b16 a[212:213], v135 offset:61440
    ds_read_b64_tr_b16 a[214:215], v136 offset:61440
    s_waitcnt vmcnt(12) lgkmcnt(0)
    s_barrier
    ds_read_b64_tr_b16 a[56:57], v137 offset:0
    ds_read_b64_tr_b16 a[58:59], v138 offset:0
    ds_read_b64_tr_b16 a[60:61], v137 offset:12288
    ds_read_b64_tr_b16 a[62:63], v138 offset:12288
    ds_read_b64_tr_b16 a[136:137], v139 offset:0
    ds_read_b64_tr_b16 a[138:139], v140 offset:0
    ds_read_b64_tr_b16 a[140:141], v139 offset:12288
    ds_read_b64_tr_b16 a[142:143], v140 offset:12288
    ds_read_b64_tr_b16 a[216:217], v141 offset:0
    ds_read_b64_tr_b16 a[218:219], v142 offset:0
    ds_read_b64_tr_b16 a[220:221], v141 offset:12288
    ds_read_b64_tr_b16 a[222:223], v142 offset:12288
    s_waitcnt vmcnt(6) lgkmcnt(0)
    s_barrier
    ds_read_b64_tr_b16 a[64:65], v131 offset:0
    ds_read_b64_tr_b16 a[66:67], v132 offset:0
    ds_read_b64_tr_b16 a[68:69], v131 offset:12288
    ds_read_b64_tr_b16 a[70:71], v132 offset:12288
    ds_read_b64_tr_b16 a[144:145], v133 offset:0
    ds_read_b64_tr_b16 a[146:147], v134 offset:0
    ds_read_b64_tr_b16 a[148:149], v133 offset:12288
    ds_read_b64_tr_b16 a[150:151], v134 offset:12288
    ds_read_b64_tr_b16 a[224:225], v135 offset:0
    ds_read_b64_tr_b16 a[226:227], v136 offset:0
    ds_read_b64_tr_b16 a[228:229], v135 offset:12288
    ds_read_b64_tr_b16 a[230:231], v136 offset:12288
    s_waitcnt vmcnt(0) lgkmcnt(0)
    s_barrier
    ds_read_b64_tr_b16 a[72:73], v131 offset:24576
    ds_read_b64_tr_b16 a[74:75], v132 offset:24576
    ds_read_b64_tr_b16 a[76:77], v131 offset:36864
    ds_read_b64_tr_b16 a[78:79], v132 offset:36864
    ds_read_b64_tr_b16 a[152:153], v133 offset:24576
    ds_read_b64_tr_b16 a[154:155], v134 offset:24576
    ds_read_b64_tr_b16 a[156:157], v133 offset:36864
    ds_read_b64_tr_b16 a[158:159], v134 offset:36864
    ds_read_b64_tr_b16 a[232:233], v135 offset:24576
    ds_read_b64_tr_b16 a[234:235], v136 offset:24576
    ds_read_b64_tr_b16 a[236:237], v135 offset:36864
    ds_read_b64_tr_b16 a[238:239], v136 offset:36864
    s_waitcnt lgkmcnt(0)
    s_barrier
    s_cmp_lg_u32 s64, 1
    s_cbranch_scc1 L_waok_16
    v_min_u32 v3, 63, v0
    v_lshlrev_b32 v3, 2, v3
    v_add_u32 v3, 0x603800, v3
L_wa_15:
    buffer_load_dword v2, v3, s[48:51], 0 offen sc1
    s_waitcnt vmcnt(0)
    v_cmp_gt_u32 vcc, 1, v2
    s_cbranch_vccz L_waok_16
    s_sleep 12
    s_sub_u32 s67, s67, 1
    s_cbranch_scc1 K2_DONE
    s_branch L_wa_15
L_waok_16:
    s_barrier
    s_sub_u32 s4, s65, 192
    v_lshlrev_b32 v1, 4, v0
    v_mov_b32 v2, v1
    s_mul_i32 s6, s64, 10240
    s_add_u32 s5, s6, 0x700000
    s_add_u32 m0, s6, 0
    s_add_u32 s9, s5, 0
    buffer_load_dwordx4 v1, s[48:51], s9 offen offset:0 sc1 lds
    buffer_load_dwordx4 v1, s[48:51], s9 offen offset:1024 sc1 lds
    buffer_load_dwordx4 v1, s[48:51], s9 offen offset:2048 sc1 lds
    buffer_load_dwordx4 v1, s[48:51], s9 offen offset:3072 sc1 lds
    s_add_u32 m0, s6, 4096
    s_add_u32 s9, s5, 4096
    buffer_load_dwordx4 v1, s[48:51], s9 offen offset:0 sc1 lds
    buffer_load_dwordx4 v1, s[48:51], s9 offen offset:1024 sc1 lds
    buffer_load_dwordx4 v1, s[48:51], s9 offen offset:2048 sc1 lds
    buffer_load_dwordx4 v1, s[48:51], s9 offen offset:3072 sc1 lds
    s_add_u32 m0, s6, 8192
    s_add_u32 s9, s5, 8192
    buffer_load_dwordx4 v1, s[48:51], s9 offen offset:0 sc1 lds
    buffer_load_dwordx4 v1, s[48:51], s9 offen offset:1024 sc1 lds
    s_lshr_b32 s7, s4, 1
    s_lshl_b32 s7, s7, 7
    s_and_b32 s9, s4, 1
    s_lshl_b32 s9, s9, 2
    s_add_u32 s7, s7, s9
    s_add_u32 s7, s7, 0x600000
    s_lshr_b32 s8, s4, 1
    s_mul_i32 s8, s8, 0x181000
    s_and_b32 s9, s4, 1
    s_mul_i32 s9, s9, 3072
    s_add_u32 s8, s8, s9
    s_mul_i32 s9, s64, 6144
    s_add_u32 s8, s8, s9
    s_add_u32 s8, s8, 0x5000000
    s_waitcnt vmcnt(0)
    s_barrier
    s_add_u32 s5, s5, 40960
    s_mul_i32 s6, s64, 10240
    s_add_u32 s6, s6, 40960
    ds_read_b128 v[32:35], v2 offset:0
    ds_read_b128 v[36:39], v2 offset:20480
    ds_read_b128 v[40:43], v2 offset:1024
    ds_read_b128 v[44:47], v2 offset:21504
    ds_read_b128 v[48:51], v2 offset:2048
    ds_read_b128 v[52:55], v2 offset:22528
    s_waitcnt lgkmcnt(4)
    v_mfma_f32_16x16x32_bf16 v[8:11], a[0:3], v[32:35], 0
    v_mfma_f32_16x16x32_bf16 v[12:15], a[80:83], v[32:35], 0
    v_mfma_f32_16x16x32_bf16 v[16:19], a[160:163], v[32:35], 0
    v_mfma_f32_16x16x32_bf16 v[20:23], a[0:3], v[36:39], 0
    v_mfma_f32_16x16x32_bf16 v[24:27], a[80:83], v[36:39], 0
    v_mfma_f32_16x16x32_bf16 v[28:31], a[160:163], v[36:39], 0
    ds_read_b128 v[32:35], v2 offset:3072
    ds_read_b128 v[36:39], v2 offset:23552
    s_waitcnt lgkmcnt(4)
    v_mfma_f32_16x16x32_bf16 v[8:11], a[4:7], v[40:43], v[8:11]
    v_mfma_f32_16x16x32_bf16 v[12:15], a[84:87], v[40:43], v[12:15]
    v_mfma_f32_16x16x32_bf16 v[16:19], a[164:167], v[40:43], v[16:19]
    v_mfma_f32_16x16x32_bf16 v[20:23], a[4:7], v[44:47], v[20:23]
    v_mfma_f32_16x16x32_bf16 v[24:27], a[84:87], v[44:47], v[24:27]
    v_mfma_f32_16x16x32_bf16 v[28:31], a[164:167], v[44:47], v[28:31]
    ds_read_b128 v[40:43], v2 offset:4096
    ds_read_b128 v[44:47], v2 offset:24576
    s_waitcnt lgkmcnt(4)
    v_mfma_f32_16x16x32_bf16 v[8:11], a[8:11], v[48:51], v[8:11]
    v_mfma_f32_16x16x32_bf16 v[12:15], a[88:91], v[48:51], v[12:15]
    v_mfma_f32_16x16x32_bf16 v[16:19], a[168:171], v[48:51], v[16:19]
    v_mfma_f32_16x16x32_bf16 v[20:23], a[8:11], v[52:55], v[20:23]
    v_mfma_f32_16x16x32_bf16 v[24:27], a[88:91], v[52:55], v[24:27]
    v_mfma_f32_16x16x32_bf16 v[28:31], a[168:171], v[52:55], v[28:31]
    ds_read_b128 v[48:51], v2 offset:5120
    ds_read_b128 v[52:55], v2 offset:25600
    s_waitcnt lgkmcnt(4)
    v_mfma_f32_16x16x32_bf16 v[8:11], a[12:15], v[32:35], v[8:11]
    v_mfma_f32_16x16x32_bf16 v[12:15], a[92:95], v[32:35], v[12:15]
    v_mfma_f32_16x16x32_bf16 v[16:19], a[172:175], v[32:35], v[16:19]
    v_mfma_f32_16x16x32_bf16 v[20:23], a[12:15], v[36:39], v[20:23]
    v_mfma_f32_16x16x32_bf16 v[24:27], a[92:95], v[36:39], v[24:27]
    v_mfma_f32_16x16x32_bf16 v[28:31], a[172:175], v[36:39], v[28:31]
    ds_read_b128 v[32:35], v2 offset:6144
    ds_read_b128 v[36:39], v2 offset:26624
    s_waitcnt lgkmcnt(4)
    v_mfma_f32_16x16x32_bf16 v[8:11], a[16:19], v[40:43], v[8:11]
    v_mfma_f32_16x16x32_bf16 v[12:15], a[96:99], v[40:43], v[12:15]
    v_mfma_f32_16x16x32_bf16 v[16:19], a[176:179], v[40:43], v[16:19]
    v_mfma_f32_16x16x32_bf16 v[20:23], a[16:19], v[44:47], v[20:23]
    v_mfma_f32_16x16x32_bf16 v[24:27], a[96:99], v[44:47], v[24:27]
    v_mfma_f32_16x16x32_bf16 v[28:31], a[176:179], v[44:47], v[28:31]
    ds_read_b128 v[40:43], v2 offset:7168
    ds_read_b128 v[44:47], v2 offset:27648
    s_waitcnt lgkmcnt(4)
    v_mfma_f32_16x16x32_bf16 v[8:11], a[20:23], v[48:51], v[8:11]
    v_mfma_f32_16x16x32_bf16 v[12:15], a[100:103], v[48:51], v[12:15]
    v_mfma_f32_16x16x32_bf16 v[16:19], a[180:183], v[48:51], v[16:19]
    v_mfma_f32_16x16x32_bf16 v[20:23], a[20:23], v[52:55], v[20:23]
    v_mfma_f32_16x16x32_bf16 v[24:27], a[100:103], v[52:55], v[24:27]
    v_mfma_f32_16x16x32_bf16 v[28:31], a[180:183], v[52:55], v[28:31]
    ds_read_b128 v[48:51], v2 offset:8192
    ds_read_b128 v[52:55], v2 offset:28672
    s_waitcnt lgkmcnt(4)
    v_mfma_f32_16x16x32_bf16 v[8:11], a[24:27], v[32:35], v[8:11]
    v_mfma_f32_16x16x32_bf16 v[12:15], a[104:107], v[32:35], v[12:15]
    s_add_u32 m0, s6, 0
    s_add_u32 s9, s5, 0
    buffer_load_dwordx4 v1, s[48:51], s9 offen offset:0 sc1 lds
    v_mfma_f32_16x16x32_bf16 v[16:19], a[184:187], v[32:35], v[16:19]
    v_mfma_f32_16x16x32_bf16 v[20:23], a[24:27], v[36:39], v[20:23]
    v_mfma_f32_16x16x32_bf16 v[24:27], a[104:107], v[36:39], v[24:27]
    v_mfma_f32_16x16x32_bf16 v[28:31], a[184:187], v[36:39], v[28:31]
    ds_read_b128 v[32:35], v2 offset:9216
    ds_read_b128 v[36:39], v2 offset:29696
    s_waitcnt lgkmcnt(4)
    v_mfma_f32_16x16x32_bf16 v[8:11], a[28:31], v[40:43], v[8:11]
    v_mfma_f32_16x16x32_bf16 v[12:15], a[108:111], v[40:43], v[12:15]
    buffer_load_dwordx4 v1, s[48:51], s9 offen offset:1024 sc1 lds
    v_mfma_f32_16x16x32_bf16 v[16:19], a[188:191], v[40:43], v[16:19]
    v_mfma_f32_16x16x32_bf16 v[20:23], a[28:31], v[44:47], v[20:23]
    v_mfma_f32_16x16x32_bf16 v[24:27], a[108:111], v[44:47], v[24:27]
    v_mfma_f32_16x16x32_bf16 v[28:31], a[188:191], v[44:47], v[28:31]
    ds_read_b128 v[40:43], v2 offset:10240
    ds_read_b128 v[44:47], v2 offset:30720
    s_waitcnt lgkmcnt(4)
    v_mfma_f32_16x16x32_bf16 v[8:11], a[32:35], v[48:51], v[8:11]
    v_mfma_f32_16x16x32_bf16 v[12:15], a[112:115], v[48:51], v[12:15]
    buffer_load_dwordx4 v1, s[48:51], s9 offen offset:2048 sc1 lds
    v_mfma_f32_16x16x32_bf16 v[16:19], a[192:195], v[48:51], v[16:19]
    v_mfma_f32_16x16x32_bf16 v[20:23], a[32:35], v[52:55], v[20:23]
    v_mfma_f32_16x16x32_bf16 v[24:27], a[112:115], v[52:55], v[24:27]
    v_mfma_f32_16x16x32_bf16 v[28:31], a[192:195], v[52:55], v[28:31]
    ds_read_b128 v[48:51], v2 offset:11264
    ds_read_b128 v[52:55], v2 offset:31744
    s_waitcnt lgkmcnt(4)
    v_mfma_f32_16x16x32_bf16 v[8:11], a[36:39], v[32:35], v[8:11]
    v_mfma_f32_16x16x32_bf16 v[12:15], a[116:119], v[32:35], v[12:15]
    buffer_load_dwordx4 v1, s[48:51], s9 offen offset:3072 sc1 lds
    v_mfma_f32_16x16x32_bf16 v[16:19], a[196:199], v[32:35], v[16:19]
    v_mfma_f32_16x16x32_bf16 v[20:23], a[36:39], v[36:39], v[20:23]
    v_mfma_f32_16x16x32_bf16 v[24:27], a[116:119], v[36:39], v[24:27]
    v_mfma_f32_16x16x32_bf16 v[28:31], a[196:199], v[36:39], v[28:31]
    ds_read_b128 v[32:35], v2 offset:12288
    ds_read_b128 v[36:39], v2 offset:32768
    s_waitcnt lgkmcnt(4)
    v_mfma_f32_16x16x32_bf16 v[8:11], a[40:43], v[40:43], v[8:11]
    v_mfma_f32_16x16x32_bf16 v[12:15], a[120:123], v[40:43], v[12:15]
    s_add_u32 m0, s6, 4096
    s_add_u32 s9, s5, 4096
    buffer_load_dwordx4 v1, s[48:51], s9 offen offset:0 sc1 lds
    v_mfma_f32_16x16x32_bf16 v[16:19], a[200:203], v[40:43], v[16:19]
    v_mfma_f32_16x16x32_bf16 v[20:23], a[40:43], v[44:47], v[20:23]
    v_mfma_f32_16x16x32_bf16 v[24:27], a[120:123], v[44:47], v[24:27]
    v_mfma_f32_16x16x32_bf16 v[28:31], a[200:203], v[44:47], v[28:31]
    ds_read_b128 v[40:43], v2 offset:13312
    ds_read_b128 v[44:47], v2 offset:33792
    s_waitcnt lgkmcnt(4)
    v_mfma_f32_16x16x32_bf16 v[8:11], a[44:47], v[48:51], v[8:11]
    v_mfma_f32_16x16x32_bf16 v[12:15], a[124:127], v[48:51], v[12:15]
    buffer_load_dwordx4 v1, s[48:51], s9 offen offset:1024 sc1 lds
    v_mfma_f32_16x16x32_bf16 v[16:19], a[204:207], v[48:51], v[16:19]
    v_mfma_f32_16x16x32_bf16 v[20:23], a[44:47], v[52:55], v[20:23]
    v_mfma_f32_16x16x32_bf16 v[24:27], a[124:127], v[52:55], v[24:27]
    v_mfma_f32_16x16x32_bf16 v[28:31], a[204:207], v[52:55], v[28:31]
    ds_read_b128 v[48:51], v2 offset:14336
    ds_read_b128 v[52:55], v2 offset:34816
    s_waitcnt lgkmcnt(4)
    v_mfma_f32_16x16x32_bf16 v[8:11], a[48:51], v[32:35], v[8:11]
    v_mfma_f32_16x16x32_bf16 v[12:15], a[128:131], v[32:35], v[12:15]
    buffer_load_dwordx4 v1, s[48:51], s9 offen offset:2048 sc1 lds
    v_mfma_f32_16x16x32_bf16 v[16:19], a[208:211], v[32:35], v[16:19]
    v_mfma_f32_16x16x32_bf16 v[20:23], a[48:51], v[36:39], v[20:23]
    v_mfma_f32_16x16x32_bf16 v[24:27], a[128:131], v[36:39], v[24:27]
    v_mfma_f32_16x16x32_bf16 v[28:31], a[208:211], v[36:39], v[28:31]
    ds_read_b128 v[32:35], v2 offset:15360
    ds_read_b128 v[36:39], v2 offset:35840
    s_waitcnt lgkmcnt(4)
    v_mfma_f32_16x16x32_bf16 v[8:11], a[52:55], v[40:43], v[8:11]
    v_mfma_f32_16x16x32_bf16 v[12:15], a[132:135], v[40:43], v[12:15]
    buffer_load_dwordx4 v1, s[48:51], s9 offen offset:3072 sc1 lds
    v_mfma_f32_16x16x32_bf16 v[16:19], a[212:215], v[40:43], v[16:19]
    v_mfma_f32_16x16x32_bf16 v[20:23], a[52:55], v[44:47], v[20:23]
    v_mfma_f32_16x16x32_bf16 v[24:27], a[132:135], v[44:47], v[24:27]
    v_mfma_f32_16x16x32_bf16 v[28:31], a[212:215], v[44:47], v[28:31]
    ds_read_b128 v[40:43], v2 offset:16384
    ds_read_b128 v[44:47], v2 offset:36864
    s_waitcnt lgkmcnt(4)
    v_mfma_f32_16x16x32_bf16 v[8:11], a[56:59], v[48:51], v[8:11]
    v_mfma_f32_16x16x32_bf16 v[12:15], a[136:139], v[48:51], v[12:15]
    s_add_u32 m0, s6, 8192
    s_add_u32 s9, s5, 8192
    buffer_load_dwordx4 v1, s[48:51], s9 offen offset:0 sc1 lds
    v_mfma_f32_16x16x32_bf16 v[16:19], a[216:219], v[48:51], v[16:19]
    v_mfma_f32_16x16x32_bf16 v[20:23], a[56:59], v[52:55], v[20:23]
    v_mfma_f32_16x16x32_bf16 v[24:27], a[136:139], v[52:55], v[24:27]
    v_mfma_f32_16x16x32_bf16 v[28:31], a[216:219], v[52:55], v[28:31]
    ds_read_b128 v[48:51], v2 offset:17408
    ds_read_b128 v[52:55], v2 offset:37888
    s_waitcnt lgkmcnt(4)
    v_mfma_f32_16x16x32_bf16 v[8:11], a[60:63], v[32:35], v[8:11]
    v_mfma_f32_16x16x32_bf16 v[12:15], a[140:143], v[32:35], v[12:15]
    buffer_load_dwordx4 v1, s[48:51], s9 offen offset:1024 sc1 lds
    v_mfma_f32_16x16x32_bf16 v[16:19], a[220:223], v[32:35], v[16:19]
    v_mfma_f32_16x16x32_bf16 v[20:23], a[60:63], v[36:39], v[20:23]
    v_mfma_f32_16x16x32_bf16 v[24:27], a[140:143], v[36:39], v[24:27]
    v_mfma_f32_16x16x32_bf16 v[28:31], a[220:223], v[36:39], v[28:31]
    ds_read_b128 v[32:35], v2 offset:18432
    ds_read_b128 v[36:39], v2 offset:38912
    s_waitcnt lgkmcnt(4)
    v_mfma_f32_16x16x32_bf16 v[8:11], a[64:67], v[40:43], v[8:11]
    v_mfma_f32_16x16x32_bf16 v[12:15], a[144:147], v[40:43], v[12:15]
    v_mfma_f32_16x16x32_bf16 v[16:19], a[224:227], v[40:43], v[16:19]
    v_mfma_f32_16x16x32_bf16 v[20:23], a[64:67], v[44:47], v[20:23]
    v_mfma_f32_16x16x32_bf16 v[24:27], a[144:147], v[44:47], v[24:27]
    v_mfma_f32_16x16x32_bf16 v[28:31], a[224:227], v[44:47], v[28:31]
    ds_read_b128 v[40:43], v2 offset:19456
    ds_read_b128 v[44:47], v2 offset:39936
    s_waitcnt lgkmcnt(4)
    v_mfma_f32_16x16x32_bf16 v[8:11], a[68:71], v[48:51], v[8:11]
    v_mfma_f32_16x16x32_bf16 v[12:15], a[148:151], v[48:51], v[12:15]
    v_mfma_f32_16x16x32_bf16 v[16:19], a[228:231], v[48:51], v[16:19]
    v_mfma_f32_16x16x32_bf16 v[20:23], a[68:71], v[52:55], v[20:23]
    v_mfma_f32_16x16x32_bf16 v[24:27], a[148:151], v[52:55], v[24:27]
    v_mfma_f32_16x16x32_bf16 v[28:31], a[228:231], v[52:55], v[28:31]
    s_waitcnt lgkmcnt(2)
    v_mfma_f32_16x16x32_bf16 v[8:11], a[72:75], v[32:35], v[8:11]
    v_mfma_f32_16x16x32_bf16 v[12:15], a[152:155], v[32:35], v[12:15]
    v_mfma_f32_16x16x32_bf16 v[16:19], a[232:235], v[32:35], v[16:19]
    v_mfma_f32_16x16x32_bf16 v[20:23], a[72:75], v[36:39], v[20:23]
    v_mfma_f32_16x16x32_bf16 v[24:27], a[152:155], v[36:39], v[24:27]
    v_mfma_f32_16x16x32_bf16 v[28:31], a[232:235], v[36:39], v[28:31]
    s_waitcnt lgkmcnt(0)
    v_mfma_f32_16x16x32_bf16 v[8:11], a[76:79], v[40:43], v[8:11]
    v_mfma_f32_16x16x32_bf16 v[12:15], a[156:159], v[40:43], v[12:15]
    v_mfma_f32_16x16x32_bf16 v[16:19], a[236:239], v[40:43], v[16:19]
    v_mfma_f32_16x16x32_bf16 v[20:23], a[76:79], v[44:47], v[20:23]
    v_mfma_f32_16x16x32_bf16 v[24:27], a[156:159], v[44:47], v[24:27]
    v_mfma_f32_16x16x32_bf16 v[28:31], a[236:239], v[44:47], v[28:31]
    v_xor_b32 v2, 0xa000, v2
    s_nop 7
    v_cvt_pk_bf16_f32 v56, v8, v9
    v_cvt_pk_bf16_f32 v57, v10, v11
    v_cvt_pk_bf16_f32 v58, v12, v13
    v_cvt_pk_bf16_f32 v59, v14, v15
    buffer_store_dwordx4 v[56:59], v1, s[48:51], s8 offen offset:0 sc1
    v_cvt_pk_bf16_f32 v60, v20, v21
    v_cvt_pk_bf16_f32 v61, v22, v23
    v_cvt_pk_bf16_f32 v62, v24, v25
    v_cvt_pk_bf16_f32 v63, v26, v27
    buffer_store_dwordx4 v[60:63], v1, s[48:51], s8 offen offset:1024 sc1
    v_cvt_pk_bf16_f32 v64, v16, v17
    v_cvt_pk_bf16_f32 v65, v18, v19
    v_cvt_pk_bf16_f32 v66, v28, v29
    v_cvt_pk_bf16_f32 v67, v30, v31
    buffer_store_dwordx4 v[64:67], v1, s[48:51], s8 offen offset:2048 sc1
    s_add_u32 s8, s8, 24576
    s_add_u32 s66, s66, 1
    s_waitcnt vmcnt(0)
    s_barrier
    s_cmp_lg_u32 s64, 1
    s_cbranch_scc1 L_fs_19
    v_mov_b32 v68, s66
    v_mov_b32 v69, 0
    s_mov_b64 exec, 1
    buffer_store_dword v68, v69, s[48:51], s7 offen sc1
    s_mov_b64 exec, -1
L_fs_19:
    s_add_u32 s5, s5, 40960
    s_mul_i32 s6, s64, 10240
    s_add_u32 s6, s6, 0
    ds_read_b128 v[32:35], v2 offset:0
    ds_read_b128 v[36:39], v2 offset:20480
    ds_read_b128 v[40:43], v2 offset:1024
    ds_read_b128 v[44:47], v2 offset:21504
    ds_read_b128 v[48:51], v2 offset:2048
    ds_read_b128 v[52:55], v2 offset:22528
    s_waitcnt lgkmcnt(4)
    v_mfma_f32_16x16x32_bf16 v[80:83], a[0:3], v[32:35], 0
    v_mfma_f32_16x16x32_bf16 v[84:87], a[80:83], v[32:35], 0
    v_mfma_f32_16x16x32_bf16 v[88:91], a[160:163], v[32:35], 0
    v_mfma_f32_16x16x32_bf16 v[92:95], a[0:3], v[36:39], 0
    v_mfma_f32_16x16x32_bf16 v[96:99], a[80:83], v[36:39], 0
    v_mfma_f32_16x16x32_bf16 v[100:103], a[160:163], v[36:39], 0
    ds_read_b128 v[32:35], v2 offset:3072
    ds_read_b128 v[36:39], v2 offset:23552
    s_waitcnt lgkmcnt(4)
    v_mfma_f32_16x16x32_bf16 v[80:83], a[4:7], v[40:43], v[80:83]
    v_mfma_f32_16x16x32_bf16 v[84:87], a[84:87], v[40:43], v[84:87]
    v_mfma_f32_16x16x32_bf16 v[88:91], a[164:167], v[40:43], v[88:91]
    v_mfma_f32_16x16x32_bf16 v[92:95], a[4:7], v[44:47], v[92:95]
    v_mfma_f32_16x16x32_bf16 v[96:99], a[84:87], v[44:47], v[96:99]
    v_mfma_f32_16x16x32_bf16 v[100:103], a[164:167], v[44:47], v[100:103]
    ds_read_b128 v[40:43], v2 offset:4096
    ds_read_b128 v[44:47], v2 offset:24576
    s_waitcnt lgkmcnt(4)
    v_mfma_f32_16x16x32_bf16 v[80:83], a[8:11], v[48:51], v[80:83]
    v_mfma_f32_16x16x32_bf16 v[84:87], a[88:91], v[48:51], v[84:87]
    v_mfma_f32_16x16x32_bf16 v[88:91], a[168:171], v[48:51], v[88:91]
    v_mfma_f32_16x16x32_bf16 v[92:95], a[8:11], v[52:55], v[92:95]
    v_mfma_f32_16x16x32_bf16 v[96:99], a[88:91], v[52:55], v[96:99]
    v_mfma_f32_16x16x32_bf16 v[100:103], a[168:171], v[52:55], v[100:103]
    ds_read_b128 v[48:51], v2 offset:5120
    ds_read_b128 v[52:55], v2 offset:25600
    s_waitcnt lgkmcnt(4)
    v_mfma_f32_16x16x32_bf16 v[80:83], a[12:15], v[32:35], v[80:83]
    v_mfma_f32_16x16x32_bf16 v[84:87], a[92:95], v[32:35], v[84:87]
    v_mfma_f32_16x16x32_bf16 v[88:91], a[172:175], v[32:35], v[88:91]
    v_mfma_f32_16x16x32_bf16 v[92:95], a[12:15], v[36:39], v[92:95]
    v_mfma_f32_16x16x32_bf16 v[96:99], a[92:95], v[36:39], v[96:99]
    v_mfma_f32_16x16x32_bf16 v[100:103], a[172:175], v[36:39], v[100:103]
    ds_read_b128 v[32:35], v2 offset:6144
    ds_read_b128 v[36:39], v2 offset:26624
    s_waitcnt lgkmcnt(4)
    v_mfma_f32_16x16x32_bf16 v[80:83], a[16:19], v[40:43], v[80:83]
    v_mfma_f32_16x16x32_bf16 v[84:87], a[96:99], v[40:43], v[84:87]
    v_mfma_f32_16x16x32_bf16 v[88:91], a[176:179], v[40:43], v[88:91]
    v_mfma_f32_16x16x32_bf16 v[92:95], a[16:19], v[44:47], v[92:95]
    v_mfma_f32_16x16x32_bf16 v[96:99], a[96:99], v[44:47], v[96:99]
    v_mfma_f32_16x16x32_bf16 v[100:103], a[176:179], v[44:47], v[100:103]
    ds_read_b128 v[40:43], v2 offset:7168
    ds_read_b128 v[44:47], v2 offset:27648
    s_waitcnt lgkmcnt(4)
    v_mfma_f32_16x16x32_bf16 v[80:83], a[20:23], v[48:51], v[80:83]
    v_mfma_f32_16x16x32_bf16 v[84:87], a[100:103], v[48:51], v[84:87]
    v_mfma_f32_16x16x32_bf16 v[88:91], a[180:183], v[48:51], v[88:91]
    v_mfma_f32_16x16x32_bf16 v[92:95], a[20:23], v[52:55], v[92:95]
    v_mfma_f32_16x16x32_bf16 v[96:99], a[100:103], v[52:55], v[96:99]
    v_mfma_f32_16x16x32_bf16 v[100:103], a[180:183], v[52:55], v[100:103]
    ds_read_b128 v[48:51], v2 offset:8192
    ds_read_b128 v[52:55], v2 offset:28672
    s_waitcnt lgkmcnt(4)
    v_mfma_f32_16x16x32_bf16 v[80:83], a[24:27], v[32:35], v[80:83]
    v_mfma_f32_16x16x32_bf16 v[84:87], a[104:107], v[32:35], v[84:87]
    s_add_u32 m0, s6, 0
    s_add_u32 s9, s5, 0
    buffer_load_dwordx4 v1, s[48:51], s9 offen offset:0 sc1 lds
    v_mfma_f32_16x16x32_bf16 v[88:91], a[184:187], v[32:35], v[88:91]
    v_mfma_f32_16x16x32_bf16 v[92:95], a[24:27], v[36:39], v[92:95]
    v_mfma_f32_16x16x32_bf16 v[96:99], a[104:107], v[36:39], v[96:99]
    v_mfma_f32_16x16x32_bf16 v[100:103], a[184:187], v[36:39], v[100:103]
    ds_read_b128 v[32:35], v2 offset:9216
    ds_read_b128 v[36:39], v2 offset:29696
    s_waitcnt lgkmcnt(4)
    v_mfma_f32_16x16x32_bf16 v[80:83], a[28:31], v[40:43], v[80:83]
    v_mfma_f32_16x16x32_bf16 v[84:87], a[108:111], v[40:43], v[84:87]
    buffer_load_dwordx4 v1, s[48:51], s9 offen offset:1024 sc1 lds
    v_mfma_f32_16x16x32_bf16 v[88:91], a[188:191], v[40:43], v[88:91]
    v_mfma_f32_16x16x32_bf16 v[92:95], a[28:31], v[44:47], v[92:95]
    v_mfma_f32_16x16x32_bf16 v[96:99], a[108:111], v[44:47], v[96:99]
    v_mfma_f32_16x16x32_bf16 v[100:103], a[188:191], v[44:47], v[100:103]
    ds_read_b128 v[40:43], v2 offset:10240
    ds_read_b128 v[44:47], v2 offset:30720
    s_waitcnt lgkmcnt(4)
    v_mfma_f32_16x16x32_bf16 v[80:83], a[32:35], v[48:51], v[80:83]
    v_mfma_f32_16x16x32_bf16 v[84:87], a[112:115], v[48:51], v[84:87]
    buffer_load_dwordx4 v1, s[48:51], s9 offen offset:2048 sc1 lds
    v_mfma_f32_16x16x32_bf16 v[88:91], a[192:195], v[48:51], v[88:91]
    v_mfma_f32_16x16x32_bf16 v[92:95], a[32:35], v[52:55], v[92:95]
    v_mfma_f32_16x16x32_bf16 v[96:99], a[112:115], v[52:55], v[96:99]
    v_mfma_f32_16x16x32_bf16 v[100:103], a[192:195], v[52:55], v[100:103]
    ds_read_b128 v[48:51], v2 offset:11264
    ds_read_b128 v[52:55], v2 offset:31744
    s_waitcnt lgkmcnt(4)
    v_mfma_f32_16x16x32_bf16 v[80:83], a[36:39], v[32:35], v[80:83]
    v_mfma_f32_16x16x32_bf16 v[84:87], a[116:119], v[32:35], v[84:87]
    buffer_load_dwordx4 v1, s[48:51], s9 offen offset:3072 sc1 lds
    v_mfma_f32_16x16x32_bf16 v[88:91], a[196:199], v[32:35], v[88:91]
    v_mfma_f32_16x16x32_bf16 v[92:95], a[36:39], v[36:39], v[92:95]
    v_mfma_f32_16x16x32_bf16 v[96:99], a[116:119], v[36:39], v[96:99]
    v_mfma_f32_16x16x32_bf16 v[100:103], a[196:199], v[36:39], v[100:103]
    ds_read_b128 v[32:35], v2 offset:12288
    ds_read_b128 v[36:39], v2 offset:32768
    s_waitcnt lgkmcnt(4)
    v_mfma_f32_16x16x32_bf16 v[80:83], a[40:43], v[40:43], v[80:83]
    v_mfma_f32_16x16x32_bf16 v[84:87], a[120:123], v[40:43], v[84:87]
    s_add_u32 m0, s6, 4096
    s_add_u32 s9, s5, 4096
    buffer_load_dwordx4 v1, s[48:51], s9 offen offset:0 sc1 lds
    v_mfma_f32_16x16x32_bf16 v[88:91], a[200:203], v[40:43], v[88:91]
    v_mfma_f32_16x16x32_bf16 v[92:95], a[40:43], v[44:47], v[92:95]
    v_mfma_f32_16x16x32_bf16 v[96:99], a[120:123], v[44:47], v[96:99]
    v_mfma_f32_16x16x32_bf16 v[100:103], a[200:203], v[44:47], v[100:103]
    ds_read_b128 v[40:43], v2 offset:13312
    ds_read_b128 v[44:47], v2 offset:33792
    s_waitcnt lgkmcnt(4)
    v_mfma_f32_16x16x32_bf16 v[80:83], a[44:47], v[48:51], v[80:83]
    v_mfma_f32_16x16x32_bf16 v[84:87], a[124:127], v[48:51], v[84:87]
    buffer_load_dwordx4 v1, s[48:51], s9 offen offset:1024 sc1 lds
    v_mfma_f32_16x16x32_bf16 v[88:91], a[204:207], v[48:51], v[88:91]
    v_mfma_f32_16x16x32_bf16 v[92:95], a[44:47], v[52:55], v[92:95]
    v_mfma_f32_16x16x32_bf16 v[96:99], a[124:127], v[52:55], v[96:99]
    v_mfma_f32_16x16x32_bf16 v[100:103], a[204:207], v[52:55], v[100:103]
    ds_read_b128 v[48:51], v2 offset:14336
    ds_read_b128 v[52:55], v2 offset:34816
    s_waitcnt lgkmcnt(4)
    v_mfma_f32_16x16x32_bf16 v[80:83], a[48:51], v[32:35], v[80:83]
    v_mfma_f32_16x16x32_bf16 v[84:87], a[128:131], v[32:35], v[84:87]
    buffer_load_dwordx4 v1, s[48:51], s9 offen offset:2048 sc1 lds
    v_mfma_f32_16x16x32_bf16 v[88:91], a[208:211], v[32:35], v[88:91]
    v_mfma_f32_16x16x32_bf16 v[92:95], a[48:51], v[36:39], v[92:95]
    v_mfma_f32_16x16x32_bf16 v[96:99], a[128:131], v[36:39], v[96:99]
    v_mfma_f32_16x16x32_bf16 v[100:103], a[208:211], v[36:39], v[100:103]
    ds_read_b128 v[32:35], v2 offset:15360
    ds_read_b128 v[36:39], v2 offset:35840
    s_waitcnt lgkmcnt(4)
    v_mfma_f32_16x16x32_bf16 v[80:83], a[52:55], v[40:43], v[80:83]
    v_mfma_f32_16x16x32_bf16 v[84:87], a[132:135], v[40:43], v[84:87]
    buffer_load_dwordx4 v1, s[48:51], s9 offen offset:3072 sc1 lds
    v_mfma_f32_16x16x32_bf16 v[88:91], a[212:215], v[40:43], v[88:91]
    v_mfma_f32_16x16x32_bf16 v[92:95], a[52:55], v[44:47], v[92:95]
    v_mfma_f32_16x16x32_bf16 v[96:99], a[132:135], v[44:47], v[96:99]
    v_mfma_f32_16x16x32_bf16 v[100:103], a[212:215], v[44:47], v[100:103]
    ds_read_b128 v[40:43], v2 offset:16384
    ds_read_b128 v[44:47], v2 offset:36864
    s_waitcnt lgkmcnt(4)
    v_mfma_f32_16x16x32_bf16 v[80:83], a[56:59], v[48:51], v[80:83]
    v_mfma_f32_16x16x32_bf16 v[84:87], a[136:139], v[48:51], v[84:87]
    s_add_u32 m0, s6, 8192
    s_add_u32 s9, s5, 8192
    buffer_load_dwordx4 v1, s[48:51], s9 offen offset:0 sc1 lds
    v_mfma_f32_16x16x32_bf16 v[88:91], a[216:219], v[48:51], v[88:91]
    v_mfma_f32_16x16x32_bf16 v[92:95], a[56:59], v[52:55], v[92:95]
    v_mfma_f32_16x16x32_bf16 v[96:99], a[136:139], v[52:55], v[96:99]
    v_mfma_f32_16x16x32_bf16 v[100:103], a[216:219], v[52:55], v[100:103]
    ds_read_b128 v[48:51], v2 offset:17408
    ds_read_b128 v[52:55], v2 offset:37888
    s_waitcnt lgkmcnt(4)
    v_mfma_f32_16x16x32_bf16 v[80:83], a[60:63], v[32:35], v[80:83]
    v_mfma_f32_16x16x32_bf16 v[84:87], a[140:143], v[32:35], v[84:87]
    buffer_load_dwordx4 v1, s[48:51], s9 offen offset:1024 sc1 lds
    v_mfma_f32_16x16x32_bf16 v[88:91], a[220:223], v[32:35], v[88:91]
    v_mfma_f32_16x16x32_bf16 v[92:95], a[60:63], v[36:39], v[92:95]
    v_mfma_f32_16x16x32_bf16 v[96:99], a[140:143], v[36:39], v[96:99]
    v_mfma_f32_16x16x32_bf16 v[100:103], a[220:223], v[36:39], v[100:103]
    ds_read_b128 v[32:35], v2 offset:18432
    ds_read_b128 v[36:39], v2 offset:38912
    s_waitcnt lgkmcnt(4)
    v_mfma_f32_16x16x32_bf16 v[80:83], a[64:67], v[40:43], v[80:83]
    v_mfma_f32_16x16x32_bf16 v[84:87], a[144:147], v[40:43], v[84:87]
    v_mfma_f32_16x16x32_bf16 v[88:91], a[224:227], v[40:43], v[88:91]
    v_mfma_f32_16x16x32_bf16 v[92:95], a[64:67], v[44:47], v[92:95]
    v_mfma_f32_16x16x32_bf16 v[96:99], a[144:147], v[44:47], v[96:99]
    v_mfma_f32_16x16x32_bf16 v[100:103], a[224:227], v[44:47], v[100:103]
    ds_read_b128 v[40:43], v2 offset:19456
    ds_read_b128 v[44:47], v2 offset:39936
    s_waitcnt lgkmcnt(4)
    v_mfma_f32_16x16x32_bf16 v[80:83], a[68:71], v[48:51], v[80:83]
    v_mfma_f32_16x16x32_bf16 v[84:87], a[148:151], v[48:51], v[84:87]
    v_mfma_f32_16x16x32_bf16 v[88:91], a[228:231], v[48:51], v[88:91]
    v_mfma_f32_16x16x32_bf16 v[92:95], a[68:71], v[52:55], v[92:95]
    v_mfma_f32_16x16x32_bf16 v[96:99], a[148:151], v[52:55], v[96:99]
    v_mfma_f32_16x16x32_bf16 v[100:103], a[228:231], v[52:55], v[100:103]
    s_waitcnt lgkmcnt(2)
    v_mfma_f32_16x16x32_bf16 v[80:83], a[72:75], v[32:35], v[80:83]
    v_mfma_f32_16x16x32_bf16 v[84:87], a[152:155], v[32:35], v[84:87]
    v_mfma_f32_16x16x32_bf16 v[88:91], a[232:235], v[32:35], v[88:91]
    v_mfma_f32_16x16x32_bf16 v[92:95], a[72:75], v[36:39], v[92:95]
    v_mfma_f32_16x16x32_bf16 v[96:99], a[152:155], v[36:39], v[96:99]
    v_mfma_f32_16x16x32_bf16 v[100:103], a[232:235], v[36:39], v[100:103]
    s_waitcnt lgkmcnt(0)
    v_mfma_f32_16x16x32_bf16 v[80:83], a[76:79], v[40:43], v[80:83]
    v_mfma_f32_16x16x32_bf16 v[84:87], a[156:159], v[40:43], v[84:87]
    v_mfma_f32_16x16x32_bf16 v[88:91], a[236:239], v[40:43], v[88:91]
    v_mfma_f32_16x16x32_bf16 v[92:95], a[76:79], v[44:47], v[92:95]
    v_mfma_f32_16x16x32_bf16 v[96:99], a[156:159], v[44:47], v[96:99]
    v_mfma_f32_16x16x32_bf16 v[100:103], a[236:239], v[44:47], v[100:103]
    v_xor_b32 v2, 0xa000, v2
    s_nop 7
    v_cvt_pk_bf16_f32 v56, v80, v81
    v_cvt_pk_bf16_f32 v57, v82, v83
    v_cvt_pk_bf16_f32 v58, v84, v85
    v_cvt_pk_bf16_f32 v59, v86, v87
    buffer_store_dwordx4 v[56:59], v1, s[48:51], s8 offen offset:0 sc1
    v_cvt_pk_bf16_f32 v60, v92, v93
    v_cvt_pk_bf16_f32 v61, v94, v95
    v_cvt_pk_bf16_f32 v62, v96, v97
    v_cvt_pk_bf16_f32 v63, v98, v99
    buffer_store_dwordx4 v[60:63], v1, s[48:51], s8 offen offset:1024 sc1
    v_cvt_pk_bf16_f32 v64, v88, v89
    v_cvt_pk_bf16_f32 v65, v90, v91
    v_cvt_pk_bf16_f32 v66, v100, v101
    v_cvt_pk_bf16_f32 v67, v102, v103
    buffer_store_dwordx4 v[64:67], v1, s[48:51], s8 offen offset:2048 sc1
    s_add_u32 s8, s8, 24576
    s_add_u32 s66, s66, 1
    s_waitcnt vmcnt(0)
    s_barrier
    s_cmp_lg_u32 s64, 1
    s_cbranch_scc1 L_fs_20
    v_mov_b32 v68, s66
    v_mov_b32 v69, 0
    s_mov_b64 exec, 1
    buffer_store_dword v68, v69, s[48:51], s7 offen sc1
    s_mov_b64 exec, -1
L_fs_20:
    s_mov_b32 s12, 15
L_g_res_18:
    s_add_u32 s5, s5, 40960
    s_mul_i32 s6, s64, 10240
    s_add_u32 s6, s6, 40960
    ds_read_b128 v[32:35], v2 offset:0
    ds_read_b128 v[36:39], v2 offset:20480
    ds_read_b128 v[40:43], v2 offset:1024
    ds_read_b128 v[44:47], v2 offset:21504
    ds_read_b128 v[48:51], v2 offset:2048
    ds_read_b128 v[52:55], v2 offset:22528
    s_waitcnt lgkmcnt(4)
    v_mfma_f32_16x16x32_bf16 v[8:11], a[0:3], v[32:35], 0
    v_mfma_f32_16x16x32_bf16 v[12:15], a[80:83], v[32:35], 0
    v_mfma_f32_16x16x32_bf16 v[16:19], a[160:163], v[32:35], 0
    v_mfma_f32_16x16x32_bf16 v[20:23], a[0:3], v[36:39], 0
    v_mfma_f32_16x16x32_bf16 v[24:27], a[80:83], v[36:39], 0
    v_mfma_f32_16x16x32_bf16 v[28:31], a[160:163], v[36:39], 0
    ds_read_b128 v[32:35], v2 offset:3072
    ds_read_b128 v[36:39], v2 offset:23552
    s_waitcnt lgkmcnt(4)
    v_mfma_f32_16x16x32_bf16 v[8:11], a[4:7], v[40:43], v[8:11]
    v_mfma_f32_16x16x32_bf16 v[12:15], a[84:87], v[40:43], v[12:15]
    v_mfma_f32_16x16x32_bf16 v[16:19], a[164:167], v[40:43], v[16:19]
    v_mfma_f32_16x16x32_bf16 v[20:23], a[4:7], v[44:47], v[20:23]
    v_mfma_f32_16x16x32_bf16 v[24:27], a[84:87], v[44:47], v[24:27]
    v_mfma_f32_16x16x32_bf16 v[28:31], a[164:167], v[44:47], v[28:31]
    ds_read_b128 v[40:43], v2 offset:4096
    ds_read_b128 v[44:47], v2 offset:24576
    s_waitcnt lgkmcnt(4)
    v_mfma_f32_16x16x32_bf16 v[8:11], a[8:11], v[48:51], v[8:11]
    v_mfma_f32_16x16x32_bf16 v[12:15], a[88:91], v[48:51], v[12:15]
    v_mfma_f32_16x16x32_bf16 v[16:19], a[168:171], v[48:51], v[16:19]
    v_mfma_f32_16x16x32_bf16 v[20:23], a[8:11], v[52:55], v[20:23]
    v_mfma_f32_16x16x32_bf16 v[24:27], a[88:91], v[52:55], v[24:27]
    v_mfma_f32_16x16x32_bf16 v[28:31], a[168:171], v[52:55], v[28:31]
    ds_read_b128 v[48:51], v2 offset:5120
    ds_read_b128 v[52:55], v2 offset:25600
    s_waitcnt lgkmcnt(4)
    v_mfma_f32_16x16x32_bf16 v[8:11], a[12:15], v[32:35], v[8:11]
    v_mfma_f32_16x16x32_bf16 v[12:15], a[92:95], v[32:35], v[12:15]
    v_mfma_f32_16x16x32_bf16 v[16:19], a[172:175], v[32:35], v[16:19]
    v_mfma_f32_16x16x32_bf16 v[20:23], a[12:15], v[36:39], v[20:23]
    v_mfma_f32_16x16x32_bf16 v[24:27], a[92:95], v[36:39], v[24:27]
    v_mfma_f32_16x16x32_bf16 v[28:31], a[172:175], v[36:39], v[28:31]
    ds_read_b128 v[32:35], v2 offset:6144
    ds_read_b128 v[36:39], v2 offset:26624
    s_waitcnt lgkmcnt(4)
    v_mfma_f32_16x16x32_bf16 v[8:11], a[16:19], v[40:43], v[8:11]
    v_mfma_f32_16x16x32_bf16 v[12:15], a[96:99], v[40:43], v[12:15]
    v_mfma_f32_16x16x32_bf16 v[16:19], a[176:179], v[40:43], v[16:19]
    v_mfma_f32_16x16x32_bf16 v[20:23], a[16:19], v[44:47], v[20:23]
    v_mfma_f32_16x16x32_bf16 v[24:27], a[96:99], v[44:47], v[24:27]
    v_mfma_f32_16x16x32_bf16 v[28:31], a[176:179], v[44:47], v[28:31]
    ds_read_b128 v[40:43], v2 offset:7168
    ds_read_b128 v[44:47], v2 offset:27648
    s_waitcnt lgkmcnt(4)
    v_mfma_f32_16x16x32_bf16 v[8:11], a[20:23], v[48:51], v[8:11]
    v_mfma_f32_16x16x32_bf16 v[12:15], a[100:103], v[48:51], v[12:15]
    v_mfma_f32_16x16x32_bf16 v[16:19], a[180:183], v[48:51], v[16:19]
    v_mfma_f32_16x16x32_bf16 v[20:23], a[20:23], v[52:55], v[20:23]
    v_mfma_f32_16x16x32_bf16 v[24:27], a[100:103], v[52:55], v[24:27]
    v_mfma_f32_16x16x32_bf16 v[28:31], a[180:183], v[52:55], v[28:31]
    ds_read_b128 v[48:51], v2 offset:8192
    ds_read_b128 v[52:55], v2 offset:28672
    s_waitcnt lgkmcnt(4)
    v_mfma_f32_16x16x32_bf16 v[8:11], a[24:27], v[32:35], v[8:11]
    v_mfma_f32_16x16x32_bf16 v[12:15], a[104:107], v[32:35], v[12:15]
    s_add_u32 m0, s6, 0
    s_add_u32 s9, s5, 0
    buffer_load_dwordx4 v1, s[48:51], s9 offen offset:0 sc1 lds
    v_mfma_f32_16x16x32_bf16 v[16:19], a[184:187], v[32:35], v[16:19]
    v_mfma_f32_16x16x32_bf16 v[20:23], a[24:27], v[36:39], v[20:23]
    v_mfma_f32_16x16x32_bf16 v[24:27], a[104:107], v[36:39], v[24:27]
    v_mfma_f32_16x16x32_bf16 v[28:31], a[184:187], v[36:39], v[28:31]
    ds_read_b128 v[32:35], v2 offset:9216
    ds_read_b128 v[36:39], v2 offset:29696
    s_waitcnt lgkmcnt(4)
    v_mfma_f32_16x16x32_bf16 v[8:11], a[28:31], v[40:43], v[8:11]
    v_mfma_f32_16x16x32_bf16 v[12:15], a[108:111], v[40:43], v[12:15]
    buffer_load_dwordx4 v1, s[48:51], s9 offen offset:1024 sc1 lds
    v_mfma_f32_16x16x32_bf16 v[16:19], a[188:191], v[40:43], v[16:19]
    v_mfma_f32_16x16x32_bf16 v[20:23], a[28:31], v[44:47], v[20:23]
    v_mfma_f32_16x16x32_bf16 v[24:27], a[108:111], v[44:47], v[24:27]
    v_mfma_f32_16x16x32_bf16 v[28:31], a[188:191], v[44:47], v[28:31]
    ds_read_b128 v[40:43], v2 offset:10240
    ds_read_b128 v[44:47], v2 offset:30720
    s_waitcnt lgkmcnt(4)
    v_mfma_f32_16x16x32_bf16 v[8:11], a[32:35], v[48:51], v[8:11]
    v_mfma_f32_16x16x32_bf16 v[12:15], a[112:115], v[48:51], v[12:15]
    buffer_load_dwordx4 v1, s[48:51], s9 offen offset:2048 sc1 lds
    v_mfma_f32_16x16x32_bf16 v[16:19], a[192:195], v[48:51], v[16:19]
    v_mfma_f32_16x16x32_bf16 v[20:23], a[32:35], v[52:55], v[20:23]
    v_mfma_f32_16x16x32_bf16 v[24:27], a[112:115], v[52:55], v[24:27]
    v_mfma_f32_16x16x32_bf16 v[28:31], a[192:195], v[52:55], v[28:31]
    ds_read_b128 v[48:51], v2 offset:11264
    ds_read_b128 v[52:55], v2 offset:31744
    s_waitcnt lgkmcnt(4)
    v_mfma_f32_16x16x32_bf16 v[8:11], a[36:39], v[32:35], v[8:11]
    v_mfma_f32_16x16x32_bf16 v[12:15], a[116:119], v[32:35], v[12:15]
    buffer_load_dwordx4 v1, s[48:51], s9 offen offset:3072 sc1 lds
    v_mfma_f32_16x16x32_bf16 v[16:19], a[196:199], v[32:35], v[16:19]
    v_mfma_f32_16x16x32_bf16 v[20:23], a[36:39], v[36:39], v[20:23]
    v_mfma_f32_16x16x32_bf16 v[24:27], a[116:119], v[36:39], v[24:27]
    v_mfma_f32_16x16x32_bf16 v[28:31], a[196:199], v[36:39], v[28:31]
    ds_read_b128 v[32:35], v2 offset:12288
    ds_read_b128 v[36:39], v2 offset:32768
    s_waitcnt lgkmcnt(4)
    v_mfma_f32_16x16x32_bf16 v[8:11], a[40:43], v[40:43], v[8:11]
    v_mfma_f32_16x16x32_bf16 v[12:15], a[120:123], v[40:43], v[12:15]
    s_add_u32 m0, s6, 4096
    s_add_u32 s9, s5, 4096
    buffer_load_dwordx4 v1, s[48:51], s9 offen offset:0 sc1 lds
    v_mfma_f32_16x16x32_bf16 v[16:19], a[200:203], v[40:43], v[16:19]
    v_mfma_f32_16x16x32_bf16 v[20:23], a[40:43], v[44:47], v[20:23]
    v_mfma_f32_16x16x32_bf16 v[24:27], a[120:123], v[44:47], v[24:27]
    v_mfma_f32_16x16x32_bf16 v[28:31], a[200:203], v[44:47], v[28:31]
    ds_read_b128 v[40:43], v2 offset:13312
    ds_read_b128 v[44:47], v2 offset:33792
    s_waitcnt lgkmcnt(4)
    v_mfma_f32_16x16x32_bf16 v[8:11], a[44:47], v[48:51], v[8:11]
    v_mfma_f32_16x16x32_bf16 v[12:15], a[124:127], v[48:51], v[12:15]
    buffer_load_dwordx4 v1, s[48:51], s9 offen offset:1024 sc1 lds
    v_mfma_f32_16x16x32_bf16 v[16:19], a[204:207], v[48:51], v[16:19]
    v_mfma_f32_16x16x32_bf16 v[20:23], a[44:47], v[52:55], v[20:23]
    v_mfma_f32_16x16x32_bf16 v[24:27], a[124:127], v[52:55], v[24:27]
    v_mfma_f32_16x16x32_bf16 v[28:31], a[204:207], v[52:55], v[28:31]
    ds_read_b128 v[48:51], v2 offset:14336
    ds_read_b128 v[52:55], v2 offset:34816
    s_waitcnt lgkmcnt(4)
    v_mfma_f32_16x16x32_bf16 v[8:11], a[48:51], v[32:35], v[8:11]
    v_mfma_f32_16x16x32_bf16 v[12:15], a[128:131], v[32:35], v[12:15]
    buffer_load_dwordx4 v1, s[48:51], s9 offen offset:2048 sc1 lds
    v_mfma_f32_16x16x32_bf16 v[16:19], a[208:211], v[32:35], v[16:19]
    v_mfma_f32_16x16x32_bf16 v[20:23], a[48:51], v[36:39], v[20:23]
    v_mfma_f32_16x16x32_bf16 v[24:27], a[128:131], v[36:39], v[24:27]
    v_mfma_f32_16x16x32_bf16 v[28:31], a[208:211], v[36:39], v[28:31]
    ds_read_b128 v[32:35], v2 offset:15360
    ds_read_b128 v[36:39], v2 offset:35840
    s_waitcnt lgkmcnt(4)
    v_mfma_f32_16x16x32_bf16 v[8:11], a[52:55], v[40:43], v[8:11]
    v_mfma_f32_16x16x32_bf16 v[12:15], a[132:135], v[40:43], v[12:15]
    buffer_load_dwordx4 v1, s[48:51], s9 offen offset:3072 sc1 lds
    v_mfma_f32_16x16x32_bf16 v[16:19], a[212:215], v[40:43], v[16:19]
    v_mfma_f32_16x16x32_bf16 v[20:23], a[52:55], v[44:47], v[20:23]
    v_mfma_f32_16x16x32_bf16 v[24:27], a[132:135], v[44:47], v[24:27]
    v_mfma_f32_16x16x32_bf16 v[28:31], a[212:215], v[44:47], v[28:31]
    ds_read_b128 v[40:43], v2 offset:16384
    ds_read_b128 v[44:47], v2 offset:36864
    s_waitcnt lgkmcnt(4)
    v_mfma_f32_16x16x32_bf16 v[8:11], a[56:59], v[48:51], v[8:11]
    v_mfma_f32_16x16x32_bf16 v[12:15], a[136:139], v[48:51], v[12:15]
    s_add_u32 m0, s6, 8192
    s_add_u32 s9, s5, 8192
    buffer_load_dwordx4 v1, s[48:51], s9 offen offset:0 sc1 lds
    v_mfma_f32_16x16x32_bf16 v[16:19], a[216:219], v[48:51], v[16:19]
    v_mfma_f32_16x16x32_bf16 v[20:23], a[56:59], v[52:55], v[20:23]
    v_mfma_f32_16x16x32_bf16 v[24:27], a[136:139], v[52:55], v[24:27]
    v_mfma_f32_16x16x32_bf16 v[28:31], a[216:219], v[52:55], v[28:31]
    ds_read_b128 v[48:51], v2 offset:17408
    ds_read_b128 v[52:55], v2 offset:37888
    s_waitcnt lgkmcnt(4)
    v_mfma_f32_16x16x32_bf16 v[8:11], a[60:63], v[32:35], v[8:11]
    v_mfma_f32_16x16x32_bf16 v[12:15], a[140:143], v[32:35], v[12:15]
    buffer_load_dwordx4 v1, s[48:51], s9 offen offset:1024 sc1 lds
    v_mfma_f32_16x16x32_bf16 v[16:19], a[220:223], v[32:35], v[16:19]
    v_mfma_f32_16x16x32_bf16 v[20:23], a[60:63], v[36:39], v[20:23]
    v_mfma_f32_16x16x32_bf16 v[24:27], a[140:143], v[36:39], v[24:27]
    v_mfma_f32_16x16x32_bf16 v[28:31], a[220:223], v[36:39], v[28:31]
    ds_read_b128 v[32:35], v2 offset:18432
    ds_read_b128 v[36:39], v2 offset:38912
    s_waitcnt lgkmcnt(4)
    v_mfma_f32_16x16x32_bf16 v[8:11], a[64:67], v[40:43], v[8:11]
    v_mfma_f32_16x16x32_bf16 v[12:15], a[144:147], v[40:43], v[12:15]
    v_mfma_f32_16x16x32_bf16 v[16:19], a[224:227], v[40:43], v[16:19]
    v_mfma_f32_16x16x32_bf16 v[20:23], a[64:67], v[44:47], v[20:23]
    v_mfma_f32_16x16x32_bf16 v[24:27], a[144:147], v[44:47], v[24:27]
    v_mfma_f32_16x16x32_bf16 v[28:31], a[224:227], v[44:47], v[28:31]
    ds_read_b128 v[40:43], v2 offset:19456
    ds_read_b128 v[44:47], v2 offset:39936
    s_waitcnt lgkmcnt(4)
    v_mfma_f32_16x16x32_bf16 v[8:11], a[68:71], v[48:51], v[8:11]
    v_mfma_f32_16x16x32_bf16 v[12:15], a[148:151], v[48:51], v[12:15]
    v_mfma_f32_16x16x32_bf16 v[16:19], a[228:231], v[48:51], v[16:19]
    v_mfma_f32_16x16x32_bf16 v[20:23], a[68:71], v[52:55], v[20:23]
    v_mfma_f32_16x16x32_bf16 v[24:27], a[148:151], v[52:55], v[24:27]
    v_mfma_f32_16x16x32_bf16 v[28:31], a[228:231], v[52:55], v[28:31]
    s_waitcnt lgkmcnt(2)
    v_mfma_f32_16x16x32_bf16 v[8:11], a[72:75], v[32:35], v[8:11]
    v_mfma_f32_16x16x32_bf16 v[12:15], a[152:155], v[32:35], v[12:15]
    v_mfma_f32_16x16x32_bf16 v[16:19], a[232:235], v[32:35], v[16:19]
    v_mfma_f32_16x16x32_bf16 v[20:23], a[72:75], v[36:39], v[20:23]
    v_mfma_f32_16x16x32_bf16 v[24:27], a[152:155], v[36:39], v[24:27]
    v_mfma_f32_16x16x32_bf16 v[28:31], a[232:235], v[36:39], v[28:31]
    s_waitcnt lgkmcnt(0)
    v_mfma_f32_16x16x32_bf16 v[8:11], a[76:79], v[40:43], v[8:11]
    v_mfma_f32_16x16x32_bf16 v[12:15], a[156:159], v[40:43], v[12:15]
    v_mfma_f32_16x16x32_bf16 v[16:19], a[236:239], v[40:43], v[16:19]
    v_mfma_f32_16x16x32_bf16 v[20:23], a[76:79], v[44:47], v[20:23]
    v_mfma_f32_16x16x32_bf16 v[24:27], a[156:159], v[44:47], v[24:27]
    v_mfma_f32_16x16x32_bf16 v[28:31], a[236:239], v[44:47], v[28:31]
    v_xor_b32 v2, 0xa000, v2
L_g_top_17:
    s_waitcnt vmcnt(0)
    s_barrier
    s_cmp_lg_u32 s64, 1
    s_cbranch_scc1 L_fs_21
    v_mov_b32 v68, s66
    v_mov_b32 v69, 0
    s_mov_b64 exec, 1
    buffer_store_dword v68, v69, s[48:51], s7 offen sc1
    s_mov_b64 exec, -1
L_fs_21:
    s_add_u32 s5, s5, 40960
    s_mul_i32 s6, s64, 10240
    s_add_u32 s6, s6, 0
    ds_read_b128 v[32:35], v2 offset:0
    ds_read_b128 v[36:39], v2 offset:20480
    ds_read_b128 v[40:43], v2 offset:1024
    ds_read_b128 v[44:47], v2 offset:21504
    ds_read_b128 v[48:51], v2 offset:2048
    ds_read_b128 v[52:55], v2 offset:22528
    s_waitcnt lgkmcnt(4)
    v_mfma_f32_16x16x32_bf16 v[80:83], a[0:3], v[32:35], 0
    v_mfma_f32_16x16x32_bf16 v[84:87], a[80:83], v[32:35], 0
    v_mfma_f32_16x16x32_bf16 v[88:91], a[160:163], v[32:35], 0
    v_mfma_f32_16x16x32_bf16 v[92:95], a[0:3], v[36:39], 0
    v_mfma_f32_16x16x32_bf16 v[96:99], a[80:83], v[36:39], 0
    v_mfma_f32_16x16x32_bf16 v[100:103], a[160:163], v[36:39], 0
    ds_read_b128 v[32:35], v2 offset:3072
    ds_read_b128 v[36:39], v2 offset:23552
    s_waitcnt lgkmcnt(4)
    v_mfma_f32_16x16x32_bf16 v[80:83], a[4:7], v[40:43], v[80:83]
    v_cvt_pk_bf16_f32 v56, v8, v9
    v_mfma_f32_16x16x32_bf16 v[84:87], a[84:87], v[40:43], v[84:87]
    v_cvt_pk_bf16_f32 v57, v10, v11
    v_mfma_f32_16x16x32_bf16 v[88:91], a[164:167], v[40:43], v[88:91]
    v_cvt_pk_bf16_f32 v58, v12, v13
    v_mfma_f32_16x16x32_bf16 v[92:95], a[4:7], v[44:47], v[92:95]
    v_cvt_pk_bf16_f32 v59, v14, v15
    v_mfma_f32_16x16x32_bf16 v[96:99], a[84:87], v[44:47], v[96:99]
    buffer_store_dwordx4 v[56:59], v1, s[48:51], s8 offen offset:0 sc1
    v_mfma_f32_16x16x32_bf16 v[100:103], a[164:167], v[44:47], v[100:103]
    v_cvt_pk_bf16_f32 v60, v20, v21
    ds_read_b128 v[40:43], v2 offset:4096
    ds_read_b128 v[44:47], v2 offset:24576
    s_waitcnt lgkmcnt(4)
    v_mfma_f32_16x16x32_bf16 v[80:83], a[8:11], v[48:51], v[80:83]
    v_cvt_pk_bf16_f32 v61, v22, v23
    v_mfma_f32_16x16x32_bf16 v[84:87], a[88:91], v[48:51], v[84:87]
    v_cvt_pk_bf16_f32 v62, v24, v25
    v_mfma_f32_16x16x32_bf16 v[88:91], a[168:171], v[48:51], v[88:91]
    v_cvt_pk_bf16_f32 v63, v26, v27
    v_mfma_f32_16x16x32_bf16 v[92:95], a[8:11], v[52:55], v[92:95]
    buffer_store_dwordx4 v[60:63], v1, s[48:51], s8 offen offset:1024 sc1
    v_mfma_f32_16x16x32_bf16 v[96:99], a[88:91], v[52:55], v[96:99]
    v_cvt_pk_bf16_f32 v64, v16, v17
    v_mfma_f32_16x16x32_bf16 v[100:103], a[168:171], v[52:55], v[100:103]
    v_cvt_pk_bf16_f32 v65, v18, v19
    ds_read_b128 v[48:51], v2 offset:5120
    ds_read_b128 v[52:55], v2 offset:25600
    s_waitcnt lgkmcnt(4)
    v_mfma_f32_16x16x32_bf16 v[80:83], a[12:15], v[32:35], v[80:83]
    v_cvt_pk_bf16_f32 v66, v28, v29
    v_mfma_f32_16x16x32_bf16 v[84:87], a[92:95], v[32:35], v[84:87]
    v_cvt_pk_bf16_f32 v67, v30, v31
    v_mfma_f32_16x16x32_bf16 v[88:91], a[172:175], v[32:35], v[88:91]
    buffer_store_dwordx4 v[64:67], v1, s[48:51], s8 offen offset:2048 sc1
    s_add_u32 s8, s8, 24576
    v_mfma_f32_16x16x32_bf16 v[92:95], a[12:15], v[36:39], v[92:95]
    v_mfma_f32_16x16x32_bf16 v[96:99], a[92:95], v[36:39], v[96:99]
    v_mfma_f32_16x16x32_bf16 v[100:103], a[172:175], v[36:39], v[100:103]
    ds_read_b128 v[32:35], v2 offset:6144
    ds_read_b128 v[36:39], v2 offset:26624
    s_waitcnt lgkmcnt(4)
    v_mfma_f32_16x16x32_bf16 v[80:83], a[16:19], v[40:43], v[80:83]
    v_mfma_f32_16x16x32_bf16 v[84:87], a[96:99], v[40:43], v[84:87]
    v_mfma_f32_16x16x32_bf16 v[88:91], a[176:179], v[40:43], v[88:91]
    v_mfma_f32_16x16x32_bf16 v[92:95], a[16:19], v[44:47], v[92:95]
    v_mfma_f32_16x16x32_bf16 v[96:99], a[96:99], v[44:47], v[96:99]
    v_mfma_f32_16x16x32_bf16 v[100:103], a[176:179], v[44:47], v[100:103]
    ds_read_b128 v[40:43], v2 offset:7168
    ds_read_b128 v[44:47], v2 offset:27648
    s_waitcnt lgkmcnt(4)
    v_mfma_f32_16x16x32_bf16 v[80:83], a[20:23], v[48:51], v[80:83]
    v_mfma_f32_16x16x32_bf16 v[84:87], a[100:103], v[48:51], v[84:87]
    v_mfma_f32_16x16x32_bf16 v[88:91], a[180:183], v[48:51], v[88:91]
    v_mfma_f32_16x16x32_bf16 v[92:95], a[20:23], v[52:55], v[92:95]
    v_mfma_f32_16x16x32_bf16 v[96:99], a[100:103], v[52:55], v[96:99]
    v_mfma_f32_16x16x32_bf16 v[100:103], a[180:183], v[52:55], v[100:103]
    ds_read_b128 v[48:51], v2 offset:8192
    ds_read_b128 v[52:55], v2 offset:28672
    s_waitcnt lgkmcnt(4)
    v_mfma_f32_16x16x32_bf16 v[80:83], a[24:27], v[32:35], v[80:83]
    v_mfma_f32_16x16x32_bf16 v[84:87], a[104:107], v[32:35], v[84:87]
    s_add_u32 m0, s6, 0
    s_add_u32 s9, s5, 0
    buffer_load_dwordx4 v1, s[48:51], s9 offen offset:0 sc1 lds
    v_mfma_f32_16x16x32_bf16 v[88:91], a[184:187], v[32:35], v[88:91]
    v_mfma_f32_16x16x32_bf16 v[92:95], a[24:27], v[36:39], v[92:95]
    v_mfma_f32_16x16x32_bf16 v[96:99], a[104:107], v[36:39], v[96:99]
    v_mfma_f32_16x16x32_bf16 v[100:103], a[184:187], v[36:39], v[100:103]
    ds_read_b128 v[32:35], v2 offset:9216
    ds_read_b128 v[36:39], v2 offset:29696
    s_waitcnt lgkmcnt(4)
    v_mfma_f32_16x16x32_bf16 v[80:83], a[28:31], v[40:43], v[80:83]
    v_mfma_f32_16x16x32_bf16 v[84:87], a[108:111], v[40:43], v[84:87]
    buffer_load_dwordx4 v1, s[48:51], s9 offen offset:1024 sc1 lds
    v_mfma_f32_16x16x32_bf16 v[88:91], a[188:191], v[40:43], v[88:91]
    v_mfma_f32_16x16x32_bf16 v[92:95], a[28:31], v[44:47], v[92:95]
    v_mfma_f32_16x16x32_bf16 v[96:99], a[108:111], v[44:47], v[96:99]
    v_mfma_f32_16x16x32_bf16 v[100:103], a[188:191], v[44:47], v[100:103]
    ds_read_b128 v[40:43], v2 offset:10240
    ds_read_b128 v[44:47], v2 offset:30720
    s_waitcnt lgkmcnt(4)
    v_mfma_f32_16x16x32_bf16 v[80:83], a[32:35], v[48:51], v[80:83]
    v_mfma_f32_16x16x32_bf16 v[84:87], a[112:115], v[48:51], v[84:87]
    buffer_load_dwordx4 v1, s[48:51], s9 offen offset:2048 sc1 lds
    v_mfma_f32_16x16x32_bf16 v[88:91], a[192:195], v[48:51], v[88:91]
    v_mfma_f32_16x16x32_bf16 v[92:95], a[32:35], v[52:55], v[92:95]
    v_mfma_f32_16x16x32_bf16 v[96:99], a[112:115], v[52:55], v[96:99]
    v_mfma_f32_16x16x32_bf16 v[100:103], a[192:195], v[52:55], v[100:103]
    ds_read_b128 v[48:51], v2 offset:11264
    ds_read_b128 v[52:55], v2 offset:31744
    s_waitcnt lgkmcnt(4)
    v_mfma_f32_16x16x32_bf16 v[80:83], a[36:39], v[32:35], v[80:83]
    v_mfma_f32_16x16x32_bf16 v[84:87], a[116:119], v[32:35], v[84:87]
    buffer_load_dwordx4 v1, s[48:51], s9 offen offset:3072 sc1 lds
    v_mfma_f32_16x16x32_bf16 v[88:91], a[196:199], v[32:35], v[88:91]
    v_mfma_f32_16x16x32_bf16 v[92:95], a[36:39], v[36:39], v[92:95]
    v_mfma_f32_16x16x32_bf16 v[96:99], a[116:119], v[36:39], v[96:99]
    v_mfma_f32_16x16x32_bf16 v[100:103], a[196:199], v[36:39], v[100:103]
    ds_read_b128 v[32:35], v2 offset:12288
    ds_read_b128 v[36:39], v2 offset:32768
    s_waitcnt lgkmcnt(4)
    v_mfma_f32_16x16x32_bf16 v[80:83], a[40:43], v[40:43], v[80:83]
    v_mfma_f32_16x16x32_bf16 v[84:87], a[120:123], v[40:43], v[84:87]
    s_add_u32 m0, s6, 4096
    s_add_u32 s9, s5, 4096
    buffer_load_dwordx4 v1, s[48:51], s9 offen offset:0 sc1 lds
    v_mfma_f32_16x16x32_bf16 v[88:91], a[200:203], v[40:43], v[88:91]
    v_mfma_f32_16x16x32_bf16 v[92:95], a[40:43], v[44:47], v[92:95]
    v_mfma_f32_16x16x32_bf16 v[96:99], a[120:123], v[44:47], v[96:99]
    v_mfma_f32_16x16x32_bf16 v[100:103], a[200:203], v[44:47], v[100:103]
    ds_read_b128 v[40:43], v2 offset:13312
    ds_read_b128 v[44:47], v2 offset:33792
    s_waitcnt lgkmcnt(4)
    v_mfma_f32_16x16x32_bf16 v[80:83], a[44:47], v[48:51], v[80:83]
    v_mfma_f32_16x16x32_bf16 v[84:87], a[124:127], v[48:51], v[84:87]
    buffer_load_dwordx4 v1, s[48:51], s9 offen offset:1024 sc1 lds
    v_mfma_f32_16x16x32_bf16 v[88:91], a[204:207], v[48:51], v[88:91]
    v_mfma_f32_16x16x32_bf16 v[92:95], a[44:47], v[52:55], v[92:95]
    v_mfma_f32_16x16x32_bf16 v[96:99], a[124:127], v[52:55], v[96:99]
    v_mfma_f32_16x16x32_bf16 v[100:103], a[204:207], v[52:55], v[100:103]
    ds_read_b128 v[48:51], v2 offset:14336
    ds_read_b128 v[52:55], v2 offset:34816
    s_waitcnt lgkmcnt(4)
    v_mfma_f32_16x16x32_bf16 v[80:83], a[48:51], v[32:35], v[80:83]
    v_mfma_f32_16x16x32_bf16 v[84:87], a[128:131], v[32:35], v[84:87]
    buffer_load_dwordx4 v1, s[48:51], s9 offen offset:2048 sc1 lds
    v_mfma_f32_16x16x32_bf16 v[88:91], a[208:211], v[32:35], v[88:91]
    v_mfma_f32_16x16x32_bf16 v[92:95], a[48:51], v[36:39], v[92:95]
    v_mfma_f32_16x16x32_bf16 v[96:99], a[128:131], v[36:39], v[96:99]
    v_mfma_f32_16x16x32_bf16 v[100:103], a[208:211], v[36:39], v[100:103]
    ds_read_b128 v[32:35], v2 offset:15360
    ds_read_b128 v[36:39], v2 offset:35840
    s_waitcnt lgkmcnt(4)
    v_mfma_f32_16x16x32_bf16 v[80:83], a[52:55], v[40:43], v[80:83]
    v_mfma_f32_16x16x32_bf16 v[84:87], a[132:135], v[40:43], v[84:87]
    buffer_load_dwordx4 v1, s[48:51], s9 offen offset:3072 sc1 lds
    v_mfma_f32_16x16x32_bf16 v[88:91], a[212:215], v[40:43], v[88:91]
    v_mfma_f32_16x16x32_bf16 v[92:95], a[52:55], v[44:47], v[92:95]
    v_mfma_f32_16x16x32_bf16 v[96:99], a[132:135], v[44:47], v[96:99]
    v_mfma_f32_16x16x32_bf16 v[100:103], a[212:215], v[44:47], v[100:103]
    ds_read_b128 v[40:43], v2 offset:16384
    ds_read_b128 v[44:47], v2 offset:36864
    s_waitcnt lgkmcnt(4)
    v_mfma_f32_16x16x32_bf16 v[80:83], a[56:59], v[48:51], v[80:83]
    v_mfma_f32_16x16x32_bf16 v[84:87], a[136:139], v[48:51], v[84:87]
    s_add_u32 m0, s6, 8192
    s_add_u32 s9, s5, 8192
    buffer_load_dwordx4 v1, s[48:51], s9 offen offset:0 sc1 lds
    v_mfma_f32_16x16x32_bf16 v[88:91], a[216:219], v[48:51], v[88:91]
    v_mfma_f32_16x16x32_bf16 v[92:95], a[56:59], v[52:55], v[92:95]
    v_mfma_f32_16x16x32_bf16 v[96:99], a[136:139], v[52:55], v[96:99]
    v_mfma_f32_16x16x32_bf16 v[100:103], a[216:219], v[52:55], v[100:103]
    ds_read_b128 v[48:51], v2 offset:17408
    ds_read_b128 v[52:55], v2 offset:37888
    s_waitcnt lgkmcnt(4)
    v_mfma_f32_16x16x32_bf16 v[80:83], a[60:63], v[32:35], v[80:83]
    v_mfma_f32_16x16x32_bf16 v[84:87], a[140:143], v[32:35], v[84:87]
    buffer_load_dwordx4 v1, s[48:51], s9 offen offset:1024 sc1 lds
    v_mfma_f32_16x16x32_bf16 v[88:91], a[220:223], v[32:35], v[88:91]
    v_mfma_f32_16x16x32_bf16 v[92:95], a[60:63], v[36:39], v[92:95]
    v_mfma_f32_16x16x32_bf16 v[96:99], a[140:143], v[36:39], v[96:99]
    v_mfma_f32_16x16x32_bf16 v[100:103], a[220:223], v[36:39], v[100:103]
    ds_read_b128 v[32:35], v2 offset:18432
    ds_read_b128 v[36:39], v2 offset:38912
    s_waitcnt lgkmcnt(4)
    v_mfma_f32_16x16x32_bf16 v[80:83], a[64:67], v[40:43], v[80:83]
    v_mfma_f32_16x16x32_bf16 v[84:87], a[144:147], v[40:43], v[84:87]
    v_mfma_f32_16x16x32_bf16 v[88:91], a[224:227], v[40:43], v[88:91]
    v_mfma_f32_16x16x32_bf16 v[92:95], a[64:67], v[44:47], v[92:95]
    v_mfma_f32_16x16x32_bf16 v[96:99], a[144:147], v[44:47], v[96:99]
    v_mfma_f32_16x16x32_bf16 v[100:103], a[224:227], v[44:47], v[100:103]
    ds_read_b128 v[40:43], v2 offset:19456
    ds_read_b128 v[44:47], v2 offset:39936
    s_waitcnt lgkmcnt(4)
    v_mfma_f32_16x16x32_bf16 v[80:83], a[68:71], v[48:51], v[80:83]
    v_mfma_f32_16x16x32_bf16 v[84:87], a[148:151], v[48:51], v[84:87]
    v_mfma_f32_16x16x32_bf16 v[88:91], a[228:231], v[48:51], v[88:91]
    v_mfma_f32_16x16x32_bf16 v[92:95], a[68:71], v[52:55], v[92:95]
    v_mfma_f32_16x16x32_bf16 v[96:99], a[148:151], v[52:55], v[96:99]
    v_mfma_f32_16x16x32_bf16 v[100:103], a[228:231], v[52:55], v[100:103]
    s_waitcnt lgkmcnt(2)
    v_mfma_f32_16x16x32_bf16 v[80:83], a[72:75], v[32:35], v[80:83]
    v_mfma_f32_16x16x32_bf16 v[84:87], a[152:155], v[32:35], v[84:87]
    v_mfma_f32_16x16x32_bf16 v[88:91], a[232:235], v[32:35], v[88:91]
    v_mfma_f32_16x16x32_bf16 v[92:95], a[72:75], v[36:39], v[92:95]
    v_mfma_f32_16x16x32_bf16 v[96:99], a[152:155], v[36:39], v[96:99]
    v_mfma_f32_16x16x32_bf16 v[100:103], a[232:235], v[36:39], v[100:103]
    s_waitcnt lgkmcnt(0)
    v_mfma_f32_16x16x32_bf16 v[80:83], a[76:79], v[40:43], v[80:83]
    v_mfma_f32_16x16x32_bf16 v[84:87], a[156:159], v[40:43], v[84:87]
    v_mfma_f32_16x16x32_bf16 v[88:91], a[236:239], v[40:43], v[88:91]
    v_mfma_f32_16x16x32_bf16 v[92:95], a[76:79], v[44:47], v[92:95]
    v_mfma_f32_16x16x32_bf16 v[96:99], a[156:159], v[44:47], v[96:99]
    v_mfma_f32_16x16x32_bf16 v[100:103], a[236:239], v[44:47], v[100:103]
    v_xor_b32 v2, 0xa000, v2
    s_add_u32 s66, s66, 1
    s_cmp_eq_u32 s66, s12
    s_cbranch_scc1 L_g_end_22
    s_waitcnt vmcnt(0)
    s_barrier
    s_cmp_lg_u32 s64, 1
    s_cbranch_scc1 L_fs_23
    v_mov_b32 v68, s66
    v_mov_b32 v69, 0
    s_mov_b64 exec, 1
    buffer_store_dword v68, v69, s[48:51], s7 offen sc1
    s_mov_b64 exec, -1
L_fs_23:
    s_add_u32 s5, s5, 40960
    s_mul_i32 s6, s64, 10240
    s_add_u32 s6, s6, 40960
    ds_read_b128 v[32:35], v2 offset:0
    ds_read_b128 v[36:39], v2 offset:20480
    ds_read_b128 v[40:43], v2 offset:1024
    ds_read_b128 v[44:47], v2 offset:21504
    ds_read_b128 v[48:51], v2 offset:2048
    ds_read_b128 v[52:55], v2 offset:22528
    s_waitcnt lgkmcnt(4)
    v_mfma_f32_16x16x32_bf16 v[8:11], a[0:3], v[32:35], 0
    v_mfma_f32_16x16x32_bf16 v[12:15], a[80:83], v[32:35], 0
    v_mfma_f32_16x16x32_bf16 v[16:19], a[160:163], v[32:35], 0
    v_mfma_f32_16x16x32_bf16 v[20:23], a[0:3], v[36:39], 0
    v_mfma_f32_16x16x32_bf16 v[24:27], a[80:83], v[36:39], 0
    v_mfma_f32_16x16x32_bf16 v[28:31], a[160:163], v[36:39], 0
    ds_read_b128 v[32:35], v2 offset:3072
    ds_read_b128 v[36:39], v2 offset:23552
    s_waitcnt lgkmcnt(4)
    v_mfma_f32_16x16x32_bf16 v[8:11], a[4:7], v[40:43], v[8:11]
    v_cvt_pk_bf16_f32 v56, v80, v81
    v_mfma_f32_16x16x32_bf16 v[12:15], a[84:87], v[40:43], v[12:15]
    v_cvt_pk_bf16_f32 v57, v82, v83
    v_mfma_f32_16x16x32_bf16 v[16:19], a[164:167], v[40:43], v[16:19]
    v_cvt_pk_bf16_f32 v58, v84, v85
    v_mfma_f32_16x16x32_bf16 v[20:23], a[4:7], v[44:47], v[20:23]
    v_cvt_pk_bf16_f32 v59, v86, v87
    v_mfma_f32_16x16x32_bf16 v[24:27], a[84:87], v[44:47], v[24:27]
    buffer_store_dwordx4 v[56:59], v1, s[48:51], s8 offen offset:0 sc1
    v_mfma_f32_16x16x32_bf16 v[28:31], a[164:167], v[44:47], v[28:31]
    v_cvt_pk_bf16_f32 v60, v92, v93
    ds_read_b128 v[40:43], v2 offset:4096
    ds_read_b128 v[44:47], v2 offset:24576
    s_waitcnt lgkmcnt(4)
    v_mfma_f32_16x16x32_bf16 v[8:11], a[8:11], v[48:51], v[8:11]
    v_cvt_pk_bf16_f32 v61, v94, v95
    v_mfma_f32_16x16x32_bf16 v[12:15], a[88:91], v[48:51], v[12:15]
    v_cvt_pk_bf16_f32 v62, v96, v97
    v_mfma_f32_16x16x32_bf16 v[16:19], a[168:171], v[48:51], v[16:19]
    v_cvt_pk_bf16_f32 v63, v98, v99
    v_mfma_f32_16x16x32_bf16 v[20:23], a[8:11], v[52:55], v[20:23]
    buffer_store_dwordx4 v[60:63], v1, s[48:51], s8 offen offset:1024 sc1
    v_mfma_f32_16x16x32_bf16 v[24:27], a[88:91], v[52:55], v[24:27]
    v_cvt_pk_bf16_f32 v64, v88, v89
    v_mfma_f32_16x16x32_bf16 v[28:31], a[168:171], v[52:55], v[28:31]
    v_cvt_pk_bf16_f32 v65, v90, v91
    ds_read_b128 v[48:51], v2 offset:5120
    ds_read_b128 v[52:55], v2 offset:25600
    s_waitcnt lgkmcnt(4)
    v_mfma_f32_16x16x32_bf16 v[8:11], a[12:15], v[32:35], v[8:11]
    v_cvt_pk_bf16_f32 v66, v100, v101
    v_mfma_f32_16x16x32_bf16 v[12:15], a[92:95], v[32:35], v[12:15]
    v_cvt_pk_bf16_f32 v67, v102, v103
    v_mfma_f32_16x16x32_bf16 v[16:19], a[172:175], v[32:35], v[16:19]
    buffer_store_dwordx4 v[64:67], v1, s[48:51], s8 offen offset:2048 sc1
    s_add_u32 s8, s8, 24576
    v_mfma_f32_16x16x32_bf16 v[20:23], a[12:15], v[36:39], v[20:23]
    v_mfma_f32_16x16x32_bf16 v[24:27], a[92:95], v[36:39], v[24:27]
    v_mfma_f32_16x16x32_bf16 v[28:31], a[172:175], v[36:39], v[28:31]
    ds_read_b128 v[32:35], v2 offset:6144
    ds_read_b128 v[36:39], v2 offset:26624
    s_waitcnt lgkmcnt(4)
    v_mfma_f32_16x16x32_bf16 v[8:11], a[16:19], v[40:43], v[8:11]
    v_mfma_f32_16x16x32_bf16 v[12:15], a[96:99], v[40:43], v[12:15]
    v_mfma_f32_16x16x32_bf16 v[16:19], a[176:179], v[40:43], v[16:19]
    v_mfma_f32_16x16x32_bf16 v[20:23], a[16:19], v[44:47], v[20:23]
    v_mfma_f32_16x16x32_bf16 v[24:27], a[96:99], v[44:47], v[24:27]
    v_mfma_f32_16x16x32_bf16 v[28:31], a[176:179], v[44:47], v[28:31]
    ds_read_b128 v[40:43], v2 offset:7168
    ds_read_b128 v[44:47], v2 offset:27648
    s_waitcnt lgkmcnt(4)
    v_mfma_f32_16x16x32_bf16 v[8:11], a[20:23], v[48:51], v[8:11]
    v_mfma_f32_16x16x32_bf16 v[12:15], a[100:103], v[48:51], v[12:15]
    v_mfma_f32_16x16x32_bf16 v[16:19], a[180:183], v[48:51], v[16:19]
    v_mfma_f32_16x16x32_bf16 v[20:23], a[20:23], v[52:55], v[20:23]
    v_mfma_f32_16x16x32_bf16 v[24:27], a[100:103], v[52:55], v[24:27]
    v_mfma_f32_16x16x32_bf16 v[28:31], a[180:183], v[52:55], v[28:31]
    ds_read_b128 v[48:51], v2 offset:8192
    ds_read_b128 v[52:55], v2 offset:28672
    s_waitcnt lgkmcnt(4)
    v_mfma_f32_16x16x32_bf16 v[8:11], a[24:27], v[32:35], v[8:11]
    v_mfma_f32_16x16x32_bf16 v[12:15], a[104:107], v[32:35], v[12:15]
    s_add_u32 m0, s6, 0
    s_add_u32 s9, s5, 0
    buffer_load_dwordx4 v1, s[48:51], s9 offen offset:0 sc1 lds
    v_mfma_f32_16x16x32_bf16 v[16:19], a[184:187], v[32:35], v[16:19]
    v_mfma_f32_16x16x32_bf16 v[20:23], a[24:27], v[36:39], v[20:23]
    v_mfma_f32_16x16x32_bf16 v[24:27], a[104:107], v[36:39], v[24:27]
    v_mfma_f32_16x16x32_bf16 v[28:31], a[184:187], v[36:39], v[28:31]
    ds_read_b128 v[32:35], v2 offset:9216
    ds_read_b128 v[36:39], v2 offset:29696
    s_waitcnt lgkmcnt(4)
    v_mfma_f32_16x16x32_bf16 v[8:11], a[28:31], v[40:43], v[8:11]
    v_mfma_f32_16x16x32_bf16 v[12:15], a[108:111], v[40:43], v[12:15]
    buffer_load_dwordx4 v1, s[48:51], s9 offen offset:1024 sc1 lds
    v_mfma_f32_16x16x32_bf16 v[16:19], a[188:191], v[40:43], v[16:19]
    v_mfma_f32_16x16x32_bf16 v[20:23], a[28:31], v[44:47], v[20:23]
    v_mfma_f32_16x16x32_bf16 v[24:27], a[108:111], v[44:47], v[24:27]
    v_mfma_f32_16x16x32_bf16 v[28:31], a[188:191], v[44:47], v[28:31]
    ds_read_b128 v[40:43], v2 offset:10240
    ds_read_b128 v[44:47], v2 offset:30720
    s_waitcnt lgkmcnt(4)
    v_mfma_f32_16x16x32_bf16 v[8:11], a[32:35], v[48:51], v[8:11]
    v_mfma_f32_16x16x32_bf16 v[12:15], a[112:115], v[48:51], v[12:15]
    buffer_load_dwordx4 v1, s[48:51], s9 offen offset:2048 sc1 lds
    v_mfma_f32_16x16x32_bf16 v[16:19], a[192:195], v[48:51], v[16:19]
    v_mfma_f32_16x16x32_bf16 v[20:23], a[32:35], v[52:55], v[20:23]
    v_mfma_f32_16x16x32_bf16 v[24:27], a[112:115], v[52:55], v[24:27]
    v_mfma_f32_16x16x32_bf16 v[28:31], a[192:195], v[52:55], v[28:31]
    ds_read_b128 v[48:51], v2 offset:11264
    ds_read_b128 v[52:55], v2 offset:31744
    s_waitcnt lgkmcnt(4)
    v_mfma_f32_16x16x32_bf16 v[8:11], a[36:39], v[32:35], v[8:11]
    v_mfma_f32_16x16x32_bf16 v[12:15], a[116:119], v[32:35], v[12:15]
    buffer_load_dwordx4 v1, s[48:51], s9 offen offset:3072 sc1 lds
    v_mfma_f32_16x16x32_bf16 v[16:19], a[196:199], v[32:35], v[16:19]
    v_mfma_f32_16x16x32_bf16 v[20:23], a[36:39], v[36:39], v[20:23]
    v_mfma_f32_16x16x32_bf16 v[24:27], a[116:119], v[36:39], v[24:27]
    v_mfma_f32_16x16x32_bf16 v[28:31], a[196:199], v[36:39], v[28:31]
    ds_read_b128 v[32:35], v2 offset:12288
    ds_read_b128 v[36:39], v2 offset:32768
    s_waitcnt lgkmcnt(4)
    v_mfma_f32_16x16x32_bf16 v[8:11], a[40:43], v[40:43], v[8:11]
    v_mfma_f32_16x16x32_bf16 v[12:15], a[120:123], v[40:43], v[12:15]
    s_add_u32 m0, s6, 4096
    s_add_u32 s9, s5, 4096
    buffer_load_dwordx4 v1, s[48:51], s9 offen offset:0 sc1 lds
    v_mfma_f32_16x16x32_bf16 v[16:19], a[200:203], v[40:43], v[16:19]
    v_mfma_f32_16x16x32_bf16 v[20:23], a[40:43], v[44:47], v[20:23]
    v_mfma_f32_16x16x32_bf16 v[24:27], a[120:123], v[44:47], v[24:27]
    v_mfma_f32_16x16x32_bf16 v[28:31], a[200:203], v[44:47], v[28:31]
    ds_read_b128 v[40:43], v2 offset:13312
    ds_read_b128 v[44:47], v2 offset:33792
    s_waitcnt lgkmcnt(4)
    v_mfma_f32_16x16x32_bf16 v[8:11], a[44:47], v[48:51], v[8:11]
    v_mfma_f32_16x16x32_bf16 v[12:15], a[124:127], v[48:51], v[12:15]
    buffer_load_dwordx4 v1, s[48:51], s9 offen offset:1024 sc1 lds
    v_mfma_f32_16x16x32_bf16 v[16:19], a[204:207], v[48:51], v[16:19]
    v_mfma_f32_16x16x32_bf16 v[20:23], a[44:47], v[52:55], v[20:23]
    v_mfma_f32_16x16x32_bf16 v[24:27], a[124:127], v[52:55], v[24:27]
    v_mfma_f32_16x16x32_bf16 v[28:31], a[204:207], v[52:55], v[28:31]
    ds_read_b128 v[48:51], v2 offset:14336
    ds_read_b128 v[52:55], v2 offset:34816
    s_waitcnt lgkmcnt(4)
    v_mfma_f32_16x16x32_bf16 v[8:11], a[48:51], v[32:35], v[8:11]
    v_mfma_f32_16x16x32_bf16 v[12:15], a[128:131], v[32:35], v[12:15]
    buffer_load_dwordx4 v1, s[48:51], s9 offen offset:2048 sc1 lds
    v_mfma_f32_16x16x32_bf16 v[16:19], a[208:211], v[32:35], v[16:19]
    v_mfma_f32_16x16x32_bf16 v[20:23], a[48:51], v[36:39], v[20:23]
    v_mfma_f32_16x16x32_bf16 v[24:27], a[128:131], v[36:39], v[24:27]
    v_mfma_f32_16x16x32_bf16 v[28:31], a[208:211], v[36:39], v[28:31]
    ds_read_b128 v[32:35], v2 offset:15360
    ds_read_b128 v[36:39], v2 offset:35840
    s_waitcnt lgkmcnt(4)
    v_mfma_f32_16x16x32_bf16 v[8:11], a[52:55], v[40:43], v[8:11]
    v_mfma_f32_16x16x32_bf16 v[12:15], a[132:135], v[40:43], v[12:15]
    buffer_load_dwordx4 v1, s[48:51], s9 offen offset:3072 sc1 lds
    v_mfma_f32_16x16x32_bf16 v[16:19], a[212:215], v[40:43], v[16:19]
    v_mfma_f32_16x16x32_bf16 v[20:23], a[52:55], v[44:47], v[20:23]
    v_mfma_f32_16x16x32_bf16 v[24:27], a[132:135], v[44:47], v[24:27]
    v_mfma_f32_16x16x32_bf16 v[28:31], a[212:215], v[44:47], v[28:31]
    ds_read_b128 v[40:43], v2 offset:16384
    ds_read_b128 v[44:47], v2 offset:36864
    s_waitcnt lgkmcnt(4)
    v_mfma_f32_16x16x32_bf16 v[8:11], a[56:59], v[48:51], v[8:11]
    v_mfma_f32_16x16x32_bf16 v[12:15], a[136:139], v[48:51], v[12:15]
    s_add_u32 m0, s6, 8192
    s_add_u32 s9, s5, 8192
    buffer_load_dwordx4 v1, s[48:51], s9 offen offset:0 sc1 lds
    v_mfma_f32_16x16x32_bf16 v[16:19], a[216:219], v[48:51], v[16:19]
    v_mfma_f32_16x16x32_bf16 v[20:23], a[56:59], v[52:55], v[20:23]
    v_mfma_f32_16x16x32_bf16 v[24:27], a[136:139], v[52:55], v[24:27]
    v_mfma_f32_16x16x32_bf16 v[28:31], a[216:219], v[52:55], v[28:31]
    ds_read_b128 v[48:51], v2 offset:17408
    ds_read_b128 v[52:55], v2 offset:37888
    s_waitcnt lgkmcnt(4)
    v_mfma_f32_16x16x32_bf16 v[8:11], a[60:63], v[32:35], v[8:11]
    v_mfma_f32_16x16x32_bf16 v[12:15], a[140:143], v[32:35], v[12:15]
    buffer_load_dwordx4 v1, s[48:51], s9 offen offset:1024 sc1 lds
    v_mfma_f32_16x16x32_bf16 v[16:19], a[220:223], v[32:35], v[16:19]
    v_mfma_f32_16x16x32_bf16 v[20:23], a[60:63], v[36:39], v[20:23]
    v_mfma_f32_16x16x32_bf16 v[24:27], a[140:143], v[36:39], v[24:27]
    v_mfma_f32_16x16x32_bf16 v[28:31], a[220:223], v[36:39], v[28:31]
    ds_read_b128 v[32:35], v2 offset:18432
    ds_read_b128 v[36:39], v2 offset:38912
    s_waitcnt lgkmcnt(4)
    v_mfma_f32_16x16x32_bf16 v[8:11], a[64:67], v[40:43], v[8:11]
    v_mfma_f32_16x16x32_bf16 v[12:15], a[144:147], v[40:43], v[12:15]
    v_mfma_f32_16x16x32_bf16 v[16:19], a[224:227], v[40:43], v[16:19]
    v_mfma_f32_16x16x32_bf16 v[20:23], a[64:67], v[44:47], v[20:23]
    v_mfma_f32_16x16x32_bf16 v[24:27], a[144:147], v[44:47], v[24:27]
    v_mfma_f32_16x16x32_bf16 v[28:31], a[224:227], v[44:47], v[28:31]
    ds_read_b128 v[40:43], v2 offset:19456
    ds_read_b128 v[44:47], v2 offset:39936
    s_waitcnt lgkmcnt(4)
    v_mfma_f32_16x16x32_bf16 v[8:11], a[68:71], v[48:51], v[8:11]
    v_mfma_f32_16x16x32_bf16 v[12:15], a[148:151], v[48:51], v[12:15]
    v_mfma_f32_16x16x32_bf16 v[16:19], a[228:231], v[48:51], v[16:19]
    v_mfma_f32_16x16x32_bf16 v[20:23], a[68:71], v[52:55], v[20:23]
    v_mfma_f32_16x16x32_bf16 v[24:27], a[148:151], v[52:55], v[24:27]
    v_mfma_f32_16x16x32_bf16 v[28:31], a[228:231], v[52:55], v[28:31]
    s_waitcnt lgkmcnt(2)
    v_mfma_f32_16x16x32_bf16 v[8:11], a[72:75], v[32:35], v[8:11]
    v_mfma_f32_16x16x32_bf16 v[12:15], a[152:155], v[32:35], v[12:15]
    v_mfma_f32_16x16x32_bf16 v[16:19], a[232:235], v[32:35], v[16:19]
    v_mfma_f32_16x16x32_bf16 v[20:23], a[72:75], v[36:39], v[20:23]
    v_mfma_f32_16x16x32_bf16 v[24:27], a[152:155], v[36:39], v[24:27]
    v_mfma_f32_16x16x32_bf16 v[28:31], a[232:235], v[36:39], v[28:31]
    s_waitcnt lgkmcnt(0)
    v_mfma_f32_16x16x32_bf16 v[8:11], a[76:79], v[40:43], v[8:11]
    v_mfma_f32_16x16x32_bf16 v[12:15], a[156:159], v[40:43], v[12:15]
    v_mfma_f32_16x16x32_bf16 v[16:19], a[236:239], v[40:43], v[16:19]
    v_mfma_f32_16x16x32_bf16 v[20:23], a[76:79], v[44:47], v[20:23]
    v_mfma_f32_16x16x32_bf16 v[24:27], a[156:159], v[44:47], v[24:27]
    v_mfma_f32_16x16x32_bf16 v[28:31], a[236:239], v[44:47], v[28:31]
    v_xor_b32 v2, 0xa000, v2
    s_add_u32 s66, s66, 1
    s_branch L_g_top_17
L_g_end_22:
    s_nop 7
    v_cvt_pk_bf16_f32 v56, v80, v81
    v_cvt_pk_bf16_f32 v57, v82, v83
    v_cvt_pk_bf16_f32 v58, v84, v85
    v_cvt_pk_bf16_f32 v59, v86, v87
    buffer_store_dwordx4 v[56:59], v1, s[48:51], s8 offen offset:0 sc1
    v_cvt_pk_bf16_f32 v60, v92, v93
    v_cvt_pk_bf16_f32 v61, v94, v95
    v_cvt_pk_bf16_f32 v62, v96, v97
    v_cvt_pk_bf16_f32 v63, v98, v99
    buffer_store_dwordx4 v[60:63], v1, s[48:51], s8 offen offset:1024 sc1
    v_cvt_pk_bf16_f32 v64, v88, v89
    v_cvt_pk_bf16_f32 v65, v90, v91
    v_cvt_pk_bf16_f32 v66, v100, v101
    v_cvt_pk_bf16_f32 v67, v102, v103
    buffer_store_dwordx4 v[64:67], v1, s[48:51], s8 offen offset:2048 sc1
    s_add_u32 s8, s8, 24576
    s_add_u32 s66, s66, 1
    s_waitcnt vmcnt(0)
    s_barrier
    s_cmp_lg_u32 s64, 1
    s_cbranch_scc1 L_fs_24
    v_mov_b32 v68, s66
    v_mov_b32 v69, 0
    s_mov_b64 exec, 1
    buffer_store_dword v68, v69, s[48:51], s7 offen sc1
    s_mov_b64 exec, -1
L_fs_24:
    s_cmp_eq_u32 s66, 64
    s_cbranch_scc1 L_g_fin_25
    s_cmp_ge_u32 s4, 44
    s_cbranch_scc1 L_moe_end_27
    s_cmp_ge_u32 s4, 24
    s_cbranch_scc1 L_moe_dn_26
    s_mov_b32 s70, s4
    s_mov_b32 s52, s34
    s_mov_b32 s53, s35
    s_mov_b32 s54, 0x1e0000
    s_mov_b32 s55, 0x20000
    s_mov_b32 s56, s36
    s_mov_b32 s57, s37
    s_mov_b32 s58, 0x1e0000
    s_mov_b32 s59, 0x20000
    v_lshrrev_b32 v1, 4, v0
    v_mul_u32_u24 v1, 24576, v1
    v_and_b32 v2, 15, v0
    v_lshl_add_u32 v10, v2, 3, v1
    s_mul_i32 s71, s64, 491520
    s_lshl_b32 s72, s70, 7
    s_add_u32 s71, s71, s72
    s_add_u32 s72, s71, 0
    buffer_load_dwordx2 v[80:81], v10, s[52:55], s72 offen offset:0
    buffer_load_dwordx2 v[82:83], v10, s[52:55], s72 offen offset:3072
    s_add_u32 s72, s71, 6144
    buffer_load_dwordx2 v[84:85], v10, s[52:55], s72 offen offset:0
    buffer_load_dwordx2 v[86:87], v10, s[52:55], s72 offen offset:3072
    s_add_u32 s72, s71, 12288
    buffer_load_dwordx2 v[88:89], v10, s[52:55], s72 offen offset:0
    buffer_load_dwordx2 v[90:91], v10, s[52:55], s72 offen offset:3072
    s_add_u32 s72, s71, 18432
    buffer_load_dwordx2 v[92:93], v10, s[52:55], s72 offen offset:0
    buffer_load_dwordx2 v[94:95], v10, s[52:55], s72 offen offset:3072
    s_add_u32 s72, s71, 0
    buffer_load_dwordx2 v[96:97], v10, s[56:59], s72 offen offset:0
    buffer_load_dwordx2 v[98:99], v10, s[56:59], s72 offen offset:3072
    s_add_u32 s72, s71, 6144
    buffer_load_dwordx2 v[100:101], v10, s[56:59], s72 offen offset:0
    buffer_load_dwordx2 v[102:103], v10, s[56:59], s72 offen offset:3072
    s_add_u32 s72, s71, 12288
    buffer_load_dwordx2 v[104:105], v10, s[56:59], s72 offen offset:0
    buffer_load_dwordx2 v[106:107], v10, s[56:59], s72 offen offset:3072
    s_add_u32 s72, s71, 18432
    buffer_load_dwordx2 v[108:109], v10, s[56:59], s72 offen offset:0
    buffer_load_dwordx2 v[110:111], v10, s[56:59], s72 offen offset:3072
    s_add_u32 s72, s71, 98304
    buffer_load_dwordx2 v[112:113], v10, s[52:55], s72 offen offset:0
    buffer_load_dwordx2 v[114:115], v10, s[52:55], s72 offen offset:3072
    s_add_u32 s72, s71, 104448
    buffer_load_dwordx2 v[116:117], v10, s[52:55], s72 offen offset:0
    buffer_load_dwordx2 v[118:119], v10, s[52:55], s72 offen offset:3072
    s_add_u32 s72, s71, 110592
    buffer_load_dwordx2 v[120:121], v10, s[52:55], s72 offen offset:0
    buffer_load_dwordx2 v[122:123], v10, s[52:55], s72 offen offset:3072
    s_add_u32 s72, s71, 116736
    buffer_load_dwordx2 v[124:125], v10, s[52:55], s72 offen offset:0
    buffer_load_dwordx2 v[126:127], v10, s[52:55], s72 offen offset:3072
    s_add_u32 s72, s71, 98304
    buffer_load_dwordx2 v[128:129], v10, s[56:59], s72 offen offset:0
    buffer_load_dwordx2 v[130:131], v10, s[56:59], s72 offen offset:3072
    s_add_u32 s72, s71, 104448
    buffer_load_dwordx2 v[132:133], v10, s[56:59], s72 offen offset:0
    buffer_load_dwordx2 v[134:135], v10, s[56:59], s72 offen offset:3072
    s_add_u32 s72, s71, 110592
    buffer_load_dwordx2 v[136:137], v10, s[56:59], s72 offen offset:0
    buffer_load_dwordx2 v[138:139], v10, s[56:59], s72 offen offset:3072
    s_add_u32 s72, s71, 116736
    buffer_load_dwordx2 v[140:141], v10, s[56:59], s72 offen offset:0
    buffer_load_dwordx2 v[142:143], v10, s[56:59], s72 offen offset:3072
    s_add_u32 s72, s71, 196608
    buffer_load_dwordx2 v[144:145], v10, s[52:55], s72 offen offset:0
    buffer_load_dwordx2 v[146:147], v10, s[52:55], s72 offen offset:3072
    s_add_u32 s72, s71, 202752
    buffer_load_dwordx2 v[148:149], v10, s[52:55], s72 offen offset:0
    buffer_load_dwordx2 v[150:151], v10, s[52:55], s72 offen offset:3072
    s_add_u32 s72, s71, 208896
    buffer_load_dwordx2 v[152:153], v10, s[52:55], s72 offen offset:0
    buffer_load_dwordx2 v[154:155], v10, s[52:55], s72 offen offset:3072
    s_add_u32 s72, s71, 215040
    buffer_load_dwordx2 v[156:157], v10, s[52:55], s72 offen offset:0
    buffer_load_dwordx2 v[158:159], v10, s[52:55], s72 offen offset:3072
    s_add_u32 s72, s71, 196608
    buffer_load_dwordx2 v[160:161], v10, s[56:59], s72 offen offset:0
    buffer_load_dwordx2 v[162:163], v10, s[56:59], s72 offen offset:3072
    s_add_u32 s72, s71, 202752
    buffer_load_dwordx2 v[164:165], v10, s[56:59], s72 offen offset:0
    buffer_load_dwordx2 v[166:167], v10, s[56:59], s72 offen offset:3072
    s_add_u32 s72, s71, 208896
    buffer_load_dwordx2 v[168:169], v10, s[56:59], s72 offen offset:0
    buffer_load_dwordx2 v[170:171], v10, s[56:59], s72 offen offset:3072
    s_add_u32 s72, s71, 215040
    buffer_load_dwordx2 v[172:173], v10, s[56:59], s72 offen offset:0
    buffer_load_dwordx2 v[174:175], v10, s[56:59], s72 offen offset:3072
    s_waitcnt vmcnt(24)
    s_add_u32 s72, s71, 294912
    buffer_load_dwordx2 v[176:177], v10, s[52:55], s72 offen offset:0
    buffer_load_dwordx2 v[178:179], v10, s[52:55], s72 offen offset:3072
    s_add_u32 s72, s71, 301056
    buffer_load_dwordx2 v[180:181], v10, s[52:55], s72 offen offset:0
    buffer_load_dwordx2 v[182:183], v10, s[52:55], s72 offen offset:3072
    s_add_u32 s72, s71, 307200
    buffer_load_dwordx2 v[184:185], v10, s[52:55], s72 offen offset:0
    buffer_load_dwordx2 v[186:187], v10, s[52:55], s72 offen offset:3072
    s_add_u32 s72, s71, 313344
    buffer_load_dwordx2 v[188:189], v10, s[52:55], s72 offen offset:0
    buffer_load_dwordx2 v[190:191], v10, s[52:55], s72 offen offset:3072
    s_add_u32 s72, s71, 294912
    buffer_load_dwordx2 v[192:193], v10, s[56:59], s72 offen offset:0
    buffer_load_dwordx2 v[194:195], v10, s[56:59], s72 offen offset:3072
    s_add_u32 s72, s71, 301056
    buffer_load_dwordx2 v[196:197], v10, s[56:59], s72 offen offset:0
    buffer_load_dwordx2 v[198:199], v10, s[56:59], s72 offen offset:3072
    s_add_u32 s72, s71, 307200
    buffer_load_dwordx2 v[200:201], v10, s[56:59], s72 offen offset:0
    buffer_load_dwordx2 v[202:203], v10, s[56:59], s72 offen offset:3072
    s_add_u32 s72, s71, 313344
    buffer_load_dwordx2 v[204:205], v10, s[56:59], s72 offen offset:0
    buffer_load_dwordx2 v[206:207], v10, s[56:59], s72 offen offset:3072
    s_add_u32 s72, s71, 393216
    buffer_load_dwordx2 v[208:209], v10, s[52:55], s72 offen offset:0
    buffer_load_dwordx2 v[210:211], v10, s[52:55], s72 offen offset:3072
    s_add_u32 s72, s71, 399360
    buffer_load_dwordx2 v[212:213], v10, s[52:55], s72 offen offset:0
    buffer_load_dwordx2 v[214:215], v10, s[52:55], s72 offen offset:3072
    s_add_u32 s72, s71, 405504
    buffer_load_dwordx2 v[216:217], v10, s[52:55], s72 offen offset:0
    buffer_load_dwordx2 v[218:219], v10, s[52:55], s72 offen offset:3072
    s_add_u32 s72, s71, 411648
    buffer_load_dwordx2 v[220:221], v10, s[52:55], s72 offen offset:0
    buffer_load_dwordx2 v[222:223], v10, s[52:55], s72 offen offset:3072
    s_add_u32 s72, s71, 393216
    buffer_load_dwordx2 v[224:225], v10, s[56:59], s72 offen offset:0
    buffer_load_dwordx2 v[226:227], v10, s[56:59], s72 offen offset:3072
    s_add_u32 s72, s71, 399360
    buffer_load_dwordx2 v[228:229], v10, s[56:59], s72 offen offset:0
    buffer_load_dwordx2 v[230:231], v10, s[56:59], s72 offen offset:3072
    s_add_u32 s72, s71, 405504
    buffer_load_dwordx2 v[232:233], v10, s[56:59], s72 offen offset:0
    buffer_load_dwordx2 v[234:235], v10, s[56:59], s72 offen offset:3072
    s_add_u32 s72, s71, 411648
    buffer_load_dwordx2 v[236:237], v10, s[56:59], s72 offen offset:0
    buffer_load_dwordx2 v[238:239], v10, s[56:59], s72 offen offset:3072
    s_mov_b32 s73, 0x05040100
    s_mov_b32 s74, 0x07060302
    s_waitcnt vmcnt(63)
    v_perm_b32 v64, v82, v80, s73
    v_perm_b32 v65, v86, v84, s73
    v_perm_b32 v66, v90, v88, s73
    v_perm_b32 v67, v94, v92, s73
    v_perm_b32 v68, v82, v80, s74
    v_perm_b32 v69, v86, v84, s74
    v_perm_b32 v70, v90, v88, s74
    v_perm_b32 v71, v94, v92, s74
    v_perm_b32 v72, v83, v81, s73
    v_perm_b32 v73, v87, v85, s73
    v_perm_b32 v74, v91, v89, s73
    v_perm_b32 v75, v95, v93, s73
    v_perm_b32 v76, v83, v81, s74
    v_perm_b32 v77, v87, v85, s74
    v_perm_b32 v78, v91, v89, s74
    v_perm_b32 v79, v95, v93, s74
    s_waitcnt vmcnt(63)
    v_perm_b32 v80, v98, v96, s73
    v_perm_b32 v81, v102, v100, s73
    v_perm_b32 v82, v106, v104, s73
    v_perm_b32 v83, v110, v108, s73
    v_perm_b32 v84, v98, v96, s74
    v_perm_b32 v85, v102, v100, s74
    v_perm_b32 v86, v106, v104, s74
    v_perm_b32 v87, v110, v108, s74
    v_perm_b32 v88, v99, v97, s73
    v_perm_b32 v89, v103, v101, s73
    v_perm_b32 v90, v107, v105, s73
    v_perm_b32 v91, v111, v109, s73
    v_perm_b32 v92, v99, v97, s74
    v_perm_b32 v93, v103, v101, s74
    v_perm_b32 v94, v107, v105, s74
    v_perm_b32 v95, v111, v109, s74
    s_waitcnt vmcnt(56)
    v_perm_b32 v96, v114, v112, s73
    v_perm_b32 v97, v118, v116, s73
    v_perm_b32 v98, v122, v120, s73
    v_perm_b32 v99, v126, v124, s73
    v_perm_b32 v100, v114, v112, s74
    v_perm_b32 v101, v118, v116, s74
    v_perm_b32 v102, v122, v120, s74
    v_perm_b32 v103, v126, v124, s74
    v_perm_b32 v104, v115, v113, s73
    v_perm_b32 v105, v119, v117, s73
    v_perm_b32 v106, v123, v121, s73
    v_perm_b32 v107, v127, v125, s73
    v_perm_b32 v108, v115, v113, s74
    v_perm_b32 v109, v119, v117, s74
    v_perm_b32 v110, v123, v121, s74
    v_perm_b32 v111, v127, v125, s74
    s_waitcnt vmcnt(48)
    v_perm_b32 v112, v130, v128, s73
    v_perm_b32 v113, v134, v132, s73
    v_perm_b32 v114, v138, v136, s73
    v_perm_b32 v115, v142, v140, s73
    v_perm_b32 v116, v130, v128, s74
    v_perm_b32 v117, v134, v132, s74
    v_perm_b32 v118, v138, v136, s74
    v_perm_b32 v119, v142, v140, s74
    v_perm_b32 v120, v131, v129, s73
    v_perm_b32 v121, v135, v133, s73
    v_perm_b32 v122, v139, v137, s73
    v_perm_b32 v123, v143, v141, s73
    v_perm_b32 v124, v131, v129, s74
    v_perm_b32 v125, v135, v133, s74
    v_perm_b32 v126, v139, v137, s74
    v_perm_b32 v127, v143, v141, s74
    s_waitcnt vmcnt(40)
    v_perm_b32 v128, v146, v144, s73
    v_perm_b32 v129, v150, v148, s73
    v_perm_b32 v130, v154, v152, s73
    v_perm_b32 v131, v158, v156, s73
    v_perm_b32 v132, v146, v144, s74
    v_perm_b32 v133, v150, v148, s74
    v_perm_b32 v134, v154, v152, s74
    v_perm_b32 v135, v158, v156, s74
    v_perm_b32 v136, v147, v145, s73
    v_perm_b32 v137, v151, v149, s73
    v_perm_b32 v138, v155, v153, s73
    v_perm_b32 v139, v159, v157, s73
    v_perm_b32 v140, v147, v145, s74
    v_perm_b32 v141, v151, v149, s74
    v_perm_b32 v142, v155, v153, s74
    v_perm_b32 v143, v159, v157, s74
    s_waitcnt vmcnt(32)
    v_perm_b32 v144, v162, v160, s73
    v_perm_b32 v145, v166, v164, s73
    v_perm_b32 v146, v170, v168, s73
    v_perm_b32 v147, v174, v172, s73
    v_perm_b32 v148, v162, v160, s74
    v_perm_b32 v149, v166, v164, s74
    v_perm_b32 v150, v170, v168, s74
    v_perm_b32 v151, v174, v172, s74
    v_perm_b32 v152, v163, v161, s73
    v_perm_b32 v153, v167, v165, s73
    v_perm_b32 v154, v171, v169, s73
    v_perm_b32 v155, v175, v173, s73
    v_perm_b32 v156, v163, v161, s74
    v_perm_b32 v157, v167, v165, s74
    v_perm_b32 v158, v171, v169, s74
    v_perm_b32 v159, v175, v173, s74
    s_waitcnt vmcnt(24)
    v_perm_b32 v160, v178, v176, s73
    v_perm_b32 v161, v182, v180, s73
    v_perm_b32 v162, v186, v184, s73
    v_perm_b32 v163, v190, v188, s73
    v_perm_b32 v164, v178, v176, s74
    v_perm_b32 v165, v182, v180, s74
    v_perm_b32 v166, v186, v184, s74
    v_perm_b32 v167, v190, v188, s74
    v_perm_b32 v168, v179, v177, s73
    v_perm_b32 v169, v183, v181, s73
    v_perm_b32 v170, v187, v185, s73
    v_perm_b32 v171, v191, v189, s73
    v_perm_b32 v172, v179, v177, s74
    v_perm_b32 v173, v183, v181, s74
    v_perm_b32 v174, v187, v185, s74
    v_perm_b32 v175, v191, v189, s74
    s_waitcnt vmcnt(16)
    v_perm_b32 v176, v194, v192, s73
    v_perm_b32 v177, v198, v196, s73
    v_perm_b32 v178, v202, v200, s73
    v_perm_b32 v179, v206, v204, s73
    v_perm_b32 v180, v194, v192, s74
    v_perm_b32 v181, v198, v196, s74
    v_perm_b32 v182, v202, v200, s74
    v_perm_b32 v183, v206, v204, s74
    v_perm_b32 v184, v195, v193, s73
    v_perm_b32 v185, v199, v197, s73
    v_perm_b32 v186, v203, v201, s73
    v_perm_b32 v187, v207, v205, s73
    v_perm_b32 v188, v195, v193, s74
    v_perm_b32 v189, v199, v197, s74
    v_perm_b32 v190, v203, v201, s74
    v_perm_b32 v191, v207, v205, s74
    s_waitcnt vmcnt(8)
    v_perm_b32 v192, v210, v208, s73
    v_perm_b32 v193, v214, v212, s73
    v_perm_b32 v194, v218, v216, s73
    v_perm_b32 v195, v222, v220, s73
    v_perm_b32 v196, v210, v208, s74
    v_perm_b32 v197, v214, v212, s74
    v_perm_b32 v198, v218, v216, s74
    v_perm_b32 v199, v222, v220, s74
    v_perm_b32 v200, v211, v209, s73
    v_perm_b32 v201, v215, v213, s73
    v_perm_b32 v202, v219, v217, s73
    v_perm_b32 v203, v223, v221, s73
    v_perm_b32 v204, v211, v209, s74
    v_perm_b32 v205, v215, v213, s74
    v_perm_b32 v206, v219, v217, s74
    v_perm_b32 v207, v223, v221, s74
    s_waitcnt vmcnt(0)
    v_perm_b32 v208, v226, v224, s73
    v_perm_b32 v209, v230, v228, s73
    v_perm_b32 v210, v234, v232, s73
    v_perm_b32 v211, v238, v236, s73
    v_perm_b32 v212, v226, v224, s74
    v_perm_b32 v213, v230, v228, s74
    v_perm_b32 v214, v234, v232, s74
    v_perm_b32 v215, v238, v236, s74
    v_perm_b32 v216, v227, v225, s73
    v_perm_b32 v217, v231, v229, s73
    v_perm_b32 v218, v235, v233, s73
    v_perm_b32 v219, v239, v237, s73
    v_perm_b32 v220, v227, v225, s74
    v_perm_b32 v221, v231, v229, s74
    v_perm_b32 v222, v235, v233, s74
    v_perm_b32 v223, v239, v237, s74
    s_lshl_b32 s75, s64, 6
    v_add_u32 v1, s75, v0
    v_lshlrev_b32 v2, 5, v1
    s_mov_b32 s76, 0x608000
    buffer_load_dwordx4 v[32:35], v2, s[48:51], s76 offen sc1
    buffer_load_dwordx4 v[36:39], v2, s[48:51], s76 offen offset:16 sc1
    v_lshlrev_b32 v1, 3, v1
    v_sub_u32 v1, 0xffff, v1
    s_brev_b32 s77, 1
    s_waitcnt vmcnt(0)
    v_ashrrev_i32 v3, 31, v32
    v_or_b32 v3, s77, v3
    v_xor_b32 v32, v3, v32
    v_and_b32 v32, 0xffff0000, v32
    v_subrev_u32 v3, 0, v1
    v_or_b32 v32, v32, v3
    v_ashrrev_i32 v3, 31, v33
    v_or_b32 v3, s77, v3
    v_xor_b32 v33, v3, v33
    v_and_b32 v33, 0xffff0000, v33
    v_subrev_u32 v3, 1, v1
    v_or_b32 v33, v33, v3
    v_ashrrev_i32 v3, 31, v34
    v_or_b32 v3, s77, v3
    v_xor_b32 v34, v3, v34
    v_and_b32 v34, 0xffff0000, v34
    v_subrev_u32 v3, 2, v1
    v_or_b32 v34, v34, v3
    v_ashrrev_i32 v3, 31, v35
    v_or_b32 v3, s77, v3
    v_xor_b32 v35, v3, v35
    v_and_b32 v35, 0xffff0000, v35
    v_subrev_u32 v3, 3, v1
    v_or_b32 v35, v35, v3
    v_ashrrev_i32 v3, 31, v36
    v_or_b32 v3, s77, v3
    v_xor_b32 v36, v3, v36
    v_and_b32 v36, 0xffff0000, v36
    v_subrev_u32 v3, 4, v1
    v_or_b32 v36, v36, v3
    v_ashrrev_i32 v3, 31, v37
    v_or_b32 v3, s77, v3
    v_xor_b32 v37, v3, v37
    v_and_b32 v37, 0xffff0000, v37
    v_subrev_u32 v3, 5, v1
    v_or_b32 v37, v37, v3
    v_ashrrev_i32 v3, 31, v38
    v_or_b32 v3, s77, v3
    v_xor_b32 v38, v3, v38
    v_and_b32 v38, 0xffff0000, v38
    v_subrev_u32 v3, 6, v1
    v_or_b32 v38, v38, v3
    v_ashrrev_i32 v3, 31, v39
    v_or_b32 v3, s77, v3
    v_xor_b32 v39, v3, v39
    v_and_b32 v39, 0xffff0000, v39
    v_subrev_u32 v3, 7, v1
    v_or_b32 v39, v39, v3
    s_mov_b32 s78, 0
    v_mov_b32 v41, 0
    v_max3_u32 v40, v32, v33, v34
    v_max3_u32 v42, v35, v36, v37
    v_max3_u32 v40, v40, v38, v39
    v_max_u32 v40, v40, v42
    s_nop 1
    v_max_u32_dpp v40, v40, v40 quad_perm:[1,0,3,2] row_mask:0xf bank_mask:0xf
    s_nop 1
    v_max_u32_dpp v40, v40, v40 quad_perm:[2,3,0,1] row_mask:0xf bank_mask:0xf
    s_nop 1
    v_max_u32_dpp v40, v40, v40 row_half_mirror row_mask:0xf bank_mask:0xf
    s_nop 1
    v_max_u32_dpp v40, v40, v40 row_mirror row_mask:0xf bank_mask:0xf
    s_nop 0
    v_readlane_b32 s79, v40, 0
    v_readlane_b32 s80, v40, 16
    v_readlane_b32 s81, v40, 32
    v_readlane_b32 s82, v40, 48
    s_nop 1
    s_max_u32 s79, s79, s80
    s_max_u32 s81, s81, s82
    s_max_u32 s79, s79, s81
    s_add_u32 s78, s78, s79
    v_writelane_b32 v41, s78, 0
    v_subrev_u32 v32, s79, v32
    v_subrev_u32 v33, s79, v33
    v_subrev_u32 v34, s79, v34
    v_subrev_u32 v35, s79, v35
    v_subrev_u32 v36, s79, v36
    v_subrev_u32 v37, s79, v37
    v_subrev_u32 v38, s79, v38
    v_subrev_u32 v39, s79, v39
    v_max3_u32 v40, v32, v33, v34
    v_max3_u32 v42, v35, v36, v37
    v_max3_u32 v40, v40, v38, v39
    v_max_u32 v40, v40, v42
    s_nop 1
    v_max_u32_dpp v40, v40, v40 quad_perm:[1,0,3,2] row_mask:0xf bank_mask:0xf
    s_nop 1
    v_max_u32_dpp v40, v40, v40 quad_perm:[2,3,0,1] row_mask:0xf bank_mask:0xf
    s_nop 1
    v_max_u32_dpp v40, v40, v40 row_half_mirror row_mask:0xf bank_mask:0xf
    s_nop 1
    v_max_u32_dpp v40, v40, v40 row_mirror row_mask:0xf bank_mask:0xf
    s_nop 0
    v_readlane_b32 s79, v40, 0
    v_readlane_b32 s80, v40, 16
    v_readlane_b32 s81, v40, 32
    v_readlane_b32 s82, v40, 48
    s_nop 1
    s_max_u32 s79, s79, s80
    s_max_u32 s81, s81, s82
    s_max_u32 s79, s79, s81
    s_add_u32 s78, s78, s79
    v_writelane_b32 v41, s78, 1
    v_subrev_u32 v32, s79, v32
    v_subrev_u32 v33, s79, v33
    v_subrev_u32 v34, s79, v34
    v_subrev_u32 v35, s79, v35
    v_subrev_u32 v36, s79, v36
    v_subrev_u32 v37, s79, v37
    v_subrev_u32 v38, s79, v38
    v_subrev_u32 v39, s79, v39
    v_max3_u32 v40, v32, v33, v34
    v_max3_u32 v42, v35, v36, v37
    v_max3_u32 v40, v40, v38, v39
    v_max_u32 v40, v40, v42
    s_nop 1
    v_max_u32_dpp v40, v40, v40 quad_perm:[1,0,3,2] row_mask:0xf bank_mask:0xf
    s_nop 1
    v_max_u32_dpp v40, v40, v40 quad_perm:[2,3,0,1] row_mask:0xf bank_mask:0xf
    s_nop 1
    v_max_u32_dpp v40, v40, v40 row_half_mirror row_mask:0xf bank_mask:0xf
    s_nop 1
    v_max_u32_dpp v40, v40, v40 row_mirror row_mask:0xf bank_mask:0xf
    s_nop 0
    v_readlane_b32 s79, v40, 0
    v_readlane_b32 s80, v40, 16
    v_readlane_b32 s81, v40, 32
    v_readlane_b32 s82, v40, 48
    s_nop 1
    s_max_u32 s79, s79, s80
    s_max_u32 s81, s81, s82
    s_max_u32 s79, s79, s81
    s_add_u32 s78, s78, s79
    v_writelane_b32 v41, s78, 2
    v_subrev_u32 v32, s79, v32
    v_subrev_u32 v33, s79, v33
    v_subrev_u32 v34, s79, v34
    v_subrev_u32 v35, s79, v35
    v_subrev_u32 v36, s79, v36
    v_subrev_u32 v37, s79, v37
    v_subrev_u32 v38, s79, v38
    v_subrev_u32 v39, s79, v39
    v_max3_u32 v40, v32, v33, v34
    v_max3_u32 v42, v35, v36, v37
    v_max3_u32 v40, v40, v38, v39
    v_max_u32 v40, v40, v42
    s_nop 1
    v_max_u32_dpp v40, v40, v40 quad_perm:[1,0,3,2] row_mask:0xf bank_mask:0xf
    s_nop 1
    v_max_u32_dpp v40, v40, v40 quad_perm:[2,3,0,1] row_mask:0xf bank_mask:0xf
    s_nop 1
    v_max_u32_dpp v40, v40, v40 row_half_mirror row_mask:0xf bank_mask:0xf
    s_nop 1
    v_max_u32_dpp v40, v40, v40 row_mirror row_mask:0xf bank_mask:0xf
    s_nop 0
    v_readlane_b32 s79, v40, 0
    v_readlane_b32 s80, v40, 16
    v_readlane_b32 s81, v40, 32
    v_readlane_b32 s82, v40, 48
    s_nop 1
    s_max_u32 s79, s79, s80
    s_max_u32 s81, s81, s82
    s_max_u32 s79, s79, s81
    s_add_u32 s78, s78, s79
    v_writelane_b32 v41, s78, 3
    v_subrev_u32 v32, s79, v32
    v_subrev_u32 v33, s79, v33
    v_subrev_u32 v34, s79, v34
    v_subrev_u32 v35, s79, v35
    v_subrev_u32 v36, s79, v36
    v_subrev_u32 v37, s79, v37
    v_subrev_u32 v38, s79, v38
    v_subrev_u32 v39, s79, v39
    v_max3_u32 v40, v32, v33, v34
    v_max3_u32 v42, v35, v36, v37
    v_max3_u32 v40, v40, v38, v39
    v_max_u32 v40, v40, v42
    s_nop 1
    v_max_u32_dpp v40, v40, v40 quad_perm:[1,0,3,2] row_mask:0xf bank_mask:0xf
    s_nop 1
    v_max_u32_dpp v40, v40, v40 quad_perm:[2,3,0,1] row_mask:0xf bank_mask:0xf
    s_nop 1
    v_max_u32_dpp v40, v40, v40 row_half_mirror row_mask:0xf bank_mask:0xf
    s_nop 1
    v_max_u32_dpp v40, v40, v40 row_mirror row_mask:0xf bank_mask:0xf
    s_nop 0
    v_readlane_b32 s79, v40, 0
    v_readlane_b32 s80, v40, 16
    v_readlane_b32 s81, v40, 32
    v_readlane_b32 s82, v40, 48
    s_nop 1
    s_max_u32 s79, s79, s80
    s_max_u32 s81, s81, s82
    s_max_u32 s79, s79, s81
    s_add_u32 s78, s78, s79
    v_writelane_b32 v41, s78, 4
    v_subrev_u32 v32, s79, v32
    v_subrev_u32 v33, s79, v33
    v_subrev_u32 v34, s79, v34
    v_subrev_u32 v35, s79, v35
    v_subrev_u32 v36, s79, v36
    v_subrev_u32 v37, s79, v37
    v_subrev_u32 v38, s79, v38
    v_subrev_u32 v39, s79, v39
    v_max3_u32 v40, v32, v33, v34
    v_max3_u32 v42, v35, v36, v37
    v_max3_u32 v40, v40, v38, v39
    v_max_u32 v40, v40, v42
    s_nop 1
    v_max_u32_dpp v40, v40, v40 quad_perm:[1,0,3,2] row_mask:0xf bank_mask:0xf
    s_nop 1
    v_max_u32_dpp v40, v40, v40 quad_perm:[2,3,0,1] row_mask:0xf bank_mask:0xf
    s_nop 1
    v_max_u32_dpp v40, v40, v40 row_half_mirror row_mask:0xf bank_mask:0xf
    s_nop 1
    v_max_u32_dpp v40, v40, v40 row_mirror row_mask:0xf bank_mask:0xf
    s_nop 0
    v_readlane_b32 s79, v40, 0
    v_readlane_b32 s80, v40, 16
    v_readlane_b32 s81, v40, 32
    v_readlane_b32 s82, v40, 48
    s_nop 1
    s_max_u32 s79, s79, s80
    s_max_u32 s81, s81, s82
    s_max_u32 s79, s79, s81
    s_add_u32 s78, s78, s79
    v_writelane_b32 v41, s78, 5
    v_subrev_u32 v32, s79, v32
    v_subrev_u32 v33, s79, v33
    v_subrev_u32 v34, s79, v34
    v_subrev_u32 v35, s79, v35
    v_subrev_u32 v36, s79, v36
    v_subrev_u32 v37, s79, v37
    v_subrev_u32 v38, s79, v38
    v_subrev_u32 v39, s79, v39
    v_max3_u32 v40, v32, v33, v34
    v_max3_u32 v42, v35, v36, v37
    v_max3_u32 v40, v40, v38, v39
    v_max_u32 v40, v40, v42
    s_nop 1
    v_max_u32_dpp v40, v40, v40 quad_perm:[1,0,3,2] row_mask:0xf bank_mask:0xf
    s_nop 1
    v_max_u32_dpp v40, v40, v40 quad_perm:[2,3,0,1] row_mask:0xf bank_mask:0xf
    s_nop 1
    v_max_u32_dpp v40, v40, v40 row_half_mirror row_mask:0xf bank_mask:0xf
    s_nop 1
    v_max_u32_dpp v40, v40, v40 row_mirror row_mask:0xf bank_mask:0xf
    s_nop 0
    v_readlane_b32 s79, v40, 0
    v_readlane_b32 s80, v40, 16
    v_readlane_b32 s81, v40, 32
    v_readlane_b32 s82, v40, 48
    s_nop 1
    s_max_u32 s79, s79, s80
    s_max_u32 s81, s81, s82
    s_max_u32 s79, s79, s81
    s_add_u32 s78, s78, s79
    v_writelane_b32 v41, s78, 6
    v_subrev_u32 v32, s79, v32
    v_subrev_u32 v33, s79, v33
    v_subrev_u32 v34, s79, v34
    v_subrev_u32 v35, s79, v35
    v_subrev_u32 v36, s79, v36
    v_subrev_u32 v37, s79, v37
    v_subrev_u32 v38, s79, v38
    v_subrev_u32 v39, s79, v39
    v_max3_u32 v40, v32, v33, v34
    v_max3_u32 v42, v35, v36, v37
    v_max3_u32 v40, v40, v38, v39
    v_max_u32 v40, v40, v42
    s_nop 1
    v_max_u32_dpp v40, v40, v40 quad_perm:[1,0,3,2] row_mask:0xf bank_mask:0xf
    s_nop 1
    v_max_u32_dpp v40, v40, v40 quad_perm:[2,3,0,1] row_mask:0xf bank_mask:0xf
    s_nop 1
    v_max_u32_dpp v40, v40, v40 row_half_mirror row_mask:0xf bank_mask:0xf
    s_nop 1
    v_max_u32_dpp v40, v40, v40 row_mirror row_mask:0xf bank_mask:0xf
    s_nop 0
    v_readlane_b32 s79, v40, 0
    v_readlane_b32 s80, v40, 16
    v_readlane_b32 s81, v40, 32
    v_readlane_b32 s82, v40, 48
    s_nop 1
    s_max_u32 s79, s79, s80
    s_max_u32 s81, s81, s82
    s_max_u32 s79, s79, s81
    s_add_u32 s78, s78, s79
    v_writelane_b32 v41, s78, 7
    v_lshlrev_b32 v1, 2, v0
    s_lshl_b32 s75, s64, 5
    v_add_u32 v2, s75, v1
    v_add_u32 v2, 81920, v2
    s_mov_b64 exec, 0xff
    ds_write_b32 v2, v41
    s_mov_b64 exec, -1
    s_waitcnt lgkmcnt(0)
    s_barrier
    v_and_b32 v1, 0x7c, v1
    v_add_u32 v1, 81920, v1
    ds_read_b32 v32, v1
    s_mov_b32 s78, 0
    v_mov_b32 v41, 0
    s_waitcnt lgkmcnt(0)
    v_mov_b32 v40, v32
    s_nop 1
    v_max_u32_dpp v40, v40, v40 quad_perm:[1,0,3,2] row_mask:0xf bank_mask:0xf
    s_nop 1
    v_max_u32_dpp v40, v40, v40 quad_perm:[2,3,0,1] row_mask:0xf bank_mask:0xf
    s_nop 1
    v_max_u32_dpp v40, v40, v40 row_half_mirror row_mask:0xf bank_mask:0xf
    s_nop 1
    v_max_u32_dpp v40, v40, v40 row_mirror row_mask:0xf bank_mask:0xf
    s_nop 0
    v_readlane_b32 s79, v40, 0
    v_readlane_b32 s80, v40, 16
    v_readlane_b32 s81, v40, 32
    v_readlane_b32 s82, v40, 48
    s_nop 1
    s_max_u32 s79, s79, s80
    s_max_u32 s81, s81, s82
    s_max_u32 s79, s79, s81
    s_add_u32 s78, s78, s79
    v_writelane_b32 v41, s78, 0
    v_subrev_u32 v32, s79, v32
    v_mov_b32 v40, v32
    s_nop 1
    v_max_u32_dpp v40, v40, v40 quad_perm:[1,0,3,2] row_mask:0xf bank_mask:0xf
    s_nop 1
    v_max_u32_dpp v40, v40, v40 quad_perm:[2,3,0,1] row_mask:0xf bank_mask:0xf
    s_nop 1
    v_max_u32_dpp v40, v40, v40 row_half_mirror row_mask:0xf bank_mask:0xf
    s_nop 1
    v_max_u32_dpp v40, v40, v40 row_mirror row_mask:0xf bank_mask:0xf
    s_nop 0
    v_readlane_b32 s79, v40, 0
    v_readlane_b32 s80, v40, 16
    v_readlane_b32 s81, v40, 32
    v_readlane_b32 s82, v40, 48
    s_nop 1
    s_max_u32 s79, s79, s80
    s_max_u32 s81, s81, s82
    s_max_u32 s79, s79, s81
    s_add_u32 s78, s78, s79
    v_writelane_b32 v41, s78, 1
    v_subrev_u32 v32, s79, v32
    v_mov_b32 v40, v32
    s_nop 1
    v_max_u32_dpp v40, v40, v40 quad_perm:[1,0,3,2] row_mask:0xf bank_mask:0xf
    s_nop 1
    v_max_u32_dpp v40, v40, v40 quad_perm:[2,3,0,1] row_mask:0xf bank_mask:0xf
    s_nop 1
    v_max_u32_dpp v40, v40, v40 row_half_mirror row_mask:0xf bank_mask:0xf
    s_nop 1
    v_max_u32_dpp v40, v40, v40 row_mirror row_mask:0xf bank_mask:0xf
    s_nop 0
    v_readlane_b32 s79, v40, 0
    v_readlane_b32 s80, v40, 16
    v_readlane_b32 s81, v40, 32
    v_readlane_b32 s82, v40, 48
    s_nop 1
    s_max_u32 s79, s79, s80
    s_max_u32 s81, s81, s82
    s_max_u32 s79, s79, s81
    s_add_u32 s78, s78, s79
    v_writelane_b32 v41, s78, 2
    v_subrev_u32 v32, s79, v32
    v_mov_b32 v40, v32
    s_nop 1
    v_max_u32_dpp v40, v40, v40 quad_perm:[1,0,3,2] row_mask:0xf bank_mask:0xf
    s_nop 1
    v_max_u32_dpp v40, v40, v40 quad_perm:[2,3,0,1] row_mask:0xf bank_mask:0xf
    s_nop 1
    v_max_u32_dpp v40, v40, v40 row_half_mirror row_mask:0xf bank_mask:0xf
    s_nop 1
    v_max_u32_dpp v40, v40, v40 row_mirror row_mask:0xf bank_mask:0xf
    s_nop 0
    v_readlane_b32 s79, v40, 0
    v_readlane_b32 s80, v40, 16
    v_readlane_b32 s81, v40, 32
    v_readlane_b32 s82, v40, 48
    s_nop 1
    s_max_u32 s79, s79, s80
    s_max_u32 s81, s81, s82
    s_max_u32 s79, s79, s81
    s_add_u32 s78, s78, s79
    v_writelane_b32 v41, s78, 3
    v_subrev_u32 v32, s79, v32
    v_mov_b32 v40, v32
    s_nop 1
    v_max_u32_dpp v40, v40, v40 quad_perm:[1,0,3,2] row_mask:0xf bank_mask:0xf
    s_nop 1
    v_max_u32_dpp v40, v40, v40 quad_perm:[2,3,0,1] row_mask:0xf bank_mask:0xf
    s_nop 1
    v_max_u32_dpp v40, v40, v40 row_half_mirror row_mask:0xf bank_mask:0xf
    s_nop 1
    v_max_u32_dpp v40, v40, v40 row_mirror row_mask:0xf bank_mask:0xf
    s_nop 0
    v_readlane_b32 s79, v40, 0
    v_readlane_b32 s80, v40, 16
    v_readlane_b32 s81, v40, 32
    v_readlane_b32 s82, v40, 48
    s_nop 1
    s_max_u32 s79, s79, s80
    s_max_u32 s81, s81, s82
    s_max_u32 s79, s79, s81
    s_add_u32 s78, s78, s79
    v_writelane_b32 v41, s78, 4
    v_subrev_u32 v32, s79, v32
    v_mov_b32 v40, v32
    s_nop 1
    v_max_u32_dpp v40, v40, v40 quad_perm:[1,0,3,2] row_mask:0xf bank_mask:0xf
    s_nop 1
    v_max_u32_dpp v40, v40, v40 quad_perm:[2,3,0,1] row_mask:0xf bank_mask:0xf
    s_nop 1
    v_max_u32_dpp v40, v40, v40 row_half_mirror row_mask:0xf bank_mask:0xf
    s_nop 1
    v_max_u32_dpp v40, v40, v40 row_mirror row_mask:0xf bank_mask:0xf
    s_nop 0
    v_readlane_b32 s79, v40, 0
    v_readlane_b32 s80, v40, 16
    v_readlane_b32 s81, v40, 32
    v_readlane_b32 s82, v40, 48
    s_nop 1
    s_max_u32 s79, s79, s80
    s_max_u32 s81, s81, s82
    s_max_u32 s79, s79, s81
    s_add_u32 s78, s78, s79
    v_writelane_b32 v41, s78, 5
    v_subrev_u32 v32, s79, v32
    v_mov_b32 v40, v32
    s_nop 1
    v_max_u32_dpp v40, v40, v40 quad_perm:[1,0,3,2] row_mask:0xf bank_mask:0xf
    s_nop 1
    v_max_u32_dpp v40, v40, v40 quad_perm:[2,3,0,1] row_mask:0xf bank_mask:0xf
    s_nop 1
    v_max_u32_dpp v40, v40, v40 row_half_mirror row_mask:0xf bank_mask:0xf
    s_nop 1
    v_max_u32_dpp v40, v40, v40 row_mirror row_mask:0xf bank_mask:0xf
    s_nop 0
    v_readlane_b32 s79, v40, 0
    v_readlane_b32 s80, v40, 16
    v_readlane_b32 s81, v40, 32
    v_readlane_b32 s82, v40, 48
    s_nop 1
    s_max_u32 s79, s79, s80
    s_max_u32 s81, s81, s82
    s_max_u32 s79, s79, s81
    s_add_u32 s78, s78, s79
    v_writelane_b32 v41, s78, 6
    v_subrev_u32 v32, s79, v32
    v_mov_b32 v40, v32
    s_nop 1
    v_max_u32_dpp v40, v40, v40 quad_perm:[1,0,3,2] row_mask:0xf bank_mask:0xf
    s_nop 1
    v_max_u32_dpp v40, v40, v40 quad_perm:[2,3,0,1] row_mask:0xf bank_mask:0xf
    s_nop 1
    v_max_u32_dpp v40, v40, v40 row_half_mirror row_mask:0xf bank_mask:0xf
    s_nop 1
    v_max_u32_dpp v40, v40, v40 row_mirror row_mask:0xf bank_mask:0xf
    s_nop 0
    v_readlane_b32 s79, v40, 0
    v_readlane_b32 s80, v40, 16
    v_readlane_b32 s81, v40, 32
    v_readlane_b32 s82, v40, 48
    s_nop 1
    s_max_u32 s79, s79, s80
    s_max_u32 s81, s81, s82
    s_max_u32 s79, s79, s81
    s_add_u32 s78, s78, s79
    v_writelane_b32 v41, s78, 7
    v_and_b32 v1, 7, v0
    v_lshlrev_b32 v1, 2, v1
    ds_bpermute_b32 v42, v1, v41
    s_waitcnt lgkmcnt(0)
    v_and_b32 v43, 0xffff, v42
    v_sub_u32 v43, 0xffff, v43
    s_mov_b32 s52, s16
    s_mov_b32 s53, s17
    s_mov_b32 s54, 0x280000
    s_mov_b32 s55, 0x20000
    v_mul_u32_u24 v1, 1280, v43
    v_lshrrev_b32 v2, 4, v0
    v_lshl_add_u32 v1, v2, 4, v1
    s_mul_i32 s75, s64, 320
    buffer_load_dwordx4 v[44:47], v1, s[52:55], s75 offen offset:0
    buffer_load_dwordx4 v[48:51], v1, s[52:55], s75 offen offset:64
    buffer_load_dwordx4 v[52:55], v1, s[52:55], s75 offen offset:128
    buffer_load_dwordx4 v[56:59], v1, s[52:55], s75 offen offset:192
    buffer_load_dwordx4 v[60:63], v1, s[52:55], s75 offen offset:256
    s_or_b32 s76, s70, s64
    s_cmp_lg_u32 s76, 0
    s_cbranch_scc1 L_gu_pub_28
    v_and_b32 v3, 0xffff0000, v42
    v_not_b32 v4, v3
    v_ashrrev_i32 v5, 31, v4
    v_or_b32 v5, s77, v5
    v_xor_b32 v3, v5, v3
    v_and_b32 v3, 0xffff0000, v3
    v_mul_f32 v5, 0xbfb8aa3b, v3
    v_exp_f32 v5, v5
    s_nop 0
    v_add_f32 v5, 1.0, v5
    v_rcp_f32 v4, v5
    s_nop 0
    v_cvt_pk_bf16_f32 v4, v4, v4
    v_and_b32 v4, 0xffff0000, v4
    v_lshlrev_b32 v5, 2, v0
    s_mov_b32 s76, 0x607200
    s_mov_b64 exec, 0xff
    buffer_store_dword v43, v5, s[48:51], s76 offen sc1
    buffer_store_dword v4, v5, s[48:51], s76 offen offset:64 sc1
    s_mov_b64 exec, -1
L_gu_pub_28:
    s_waitcnt vmcnt(0)
    v_mfma_f32_16x16x32_bf16 v[224:227], v[44:47], v[64:67], 0
    v_mfma_f32_16x16x32_bf16 v[228:231], v[44:47], v[68:71], 0
    v_mfma_f32_16x16x32_bf16 v[232:235], v[44:47], v[72:75], 0
    v_mfma_f32_16x16x32_bf16 v[236:239], v[44:47], v[76:79], 0
    v_mfma_f32_16x16x32_bf16 v[240:243], v[44:47], v[80:83], 0
    v_mfma_f32_16x16x32_bf16 v[244:247], v[44:47], v[84:87], 0
    v_mfma_f32_16x16x32_bf16 v[248:251], v[44:47], v[88:91], 0
    v_mfma_f32_16x16x32_bf16 v[252:255], v[44:47], v[92:95], 0
    v_mfma_f32_16x16x32_bf16 v[224:227], v[48:51], v[96:99], v[224:227]
    v_mfma_f32_16x16x32_bf16 v[228:231], v[48:51], v[100:103], v[228:231]
    v_mfma_f32_16x16x32_bf16 v[232:235], v[48:51], v[104:107], v[232:235]
    v_mfma_f32_16x16x32_bf16 v[236:239], v[48:51], v[108:111], v[236:239]
    v_mfma_f32_16x16x32_bf16 v[240:243], v[48:51], v[112:115], v[240:243]
    v_mfma_f32_16x16x32_bf16 v[244:247], v[48:51], v[116:119], v[244:247]
    v_mfma_f32_16x16x32_bf16 v[248:251], v[48:51], v[120:123], v[248:251]
    v_mfma_f32_16x16x32_bf16 v[252:255], v[48:51], v[124:127], v[252:255]
    v_mfma_f32_16x16x32_bf16 v[224:227], v[52:55], v[128:131], v[224:227]
    v_mfma_f32_16x16x32_bf16 v[228:231], v[52:55], v[132:135], v[228:231]
    v_mfma_f32_16x16x32_bf16 v[232:235], v[52:55], v[136:139], v[232:235]
    v_mfma_f32_16x16x32_bf16 v[236:239], v[52:55], v[140:143], v[236:239]
    v_mfma_f32_16x16x32_bf16 v[240:243], v[52:55], v[144:147], v[240:243]
    v_mfma_f32_16x16x32_bf16 v[244:247], v[52:55], v[148:151], v[244:247]
    v_mfma_f32_16x16x32_bf16 v[248:251], v[52:55], v[152:155], v[248:251]
    v_mfma_f32_16x16x32_bf16 v[252:255], v[52:55], v[156:159], v[252:255]
    v_mfma_f32_16x16x32_bf16 v[224:227], v[56:59], v[160:163], v[224:227]
    v_mfma_f32_16x16x32_bf16 v[228:231], v[56:59], v[164:167], v[228:231]
    v_mfma_f32_16x16x32_bf16 v[232:235], v[56:59], v[168:171], v[232:235]
    v_mfma_f32_16x16x32_bf16 v[236:239], v[56:59], v[172:175], v[236:239]
    v_mfma_f32_16x16x32_bf16 v[240:243], v[56:59], v[176:179], v[240:243]
    v_mfma_f32_16x16x32_bf16 v[244:247], v[56:59], v[180:183], v[244:247]
    v_mfma_f32_16x16x32_bf16 v[248:251], v[56:59], v[184:187], v[248:251]
    v_mfma_f32_16x16x32_bf16 v[252:255], v[56:59], v[188:191], v[252:255]
    v_mfma_f32_16x16x32_bf16 v[224:227], v[60:63], v[192:195], v[224:227]
    v_mfma_f32_16x16x32_bf16 v[228:231], v[60:63], v[196:199], v[228:231]
    v_mfma_f32_16x16x32_bf16 v[232:235], v[60:63], v[200:203], v[232:235]
    v_mfma_f32_16x16x32_bf16 v[236:239], v[60:63], v[204:207], v[236:239]
    v_mfma_f32_16x16x32_bf16 v[240:243], v[60:63], v[208:211], v[240:243]
    v_mfma_f32_16x16x32_bf16 v[244:247], v[60:63], v[212:215], v[244:247]
    v_mfma_f32_16x16x32_bf16 v[248:251], v[60:63], v[216:219], v[248:251]
    v_mfma_f32_16x16x32_bf16 v[252:255], v[60:63], v[220:223], v[252:255]
    v_lshlrev_b32 v1, 4, v0
    v_add_u32 v1, 81920, v1
    s_lshl_b32 s75, s64, 12
    v_add_u32 v2, s75, v1
    s_nop 4
    s_mov_b32 exec_hi, 0
    ds_write_b128 v2, v[224:227] offset:1024
    ds_write_b128 v2, v[228:231] offset:1536
    ds_write_b128 v2, v[232:235] offset:2048
    ds_write_b128 v2, v[236:239] offset:2560
    ds_write_b128 v2, v[240:243] offset:3072
    ds_write_b128 v2, v[244:247] offset:3584
    ds_write_b128 v2, v[248:251] offset:4096
    ds_write_b128 v2, v[252:255] offset:4608
    s_waitcnt lgkmcnt(0)
    s_barrier
    s_lshl_b32 s75, s64, 9
    v_add_u32 v2, s75, v1
    ds_read_b128 v[64:67], v2 offset:1024
    ds_read_b128 v[68:71], v2 offset:5120
    ds_read_b128 v[72:75], v2 offset:9216
    ds_read_b128 v[76:79], v2 offset:13312
    ds_read_b128 v[80:83], v2 offset:3072
    ds_read_b128 v[84:87], v2 offset:7168
    ds_read_b128 v[88:91], v2 offset:11264
    ds_read_b128 v[92:95], v2 offset:15360
    s_waitcnt lgkmcnt(0)
    v_add_f32 v64, v64, v68
    v_add_f32 v72, v72, v76
    v_add_f32 v64, v64, v72
    v_cvt_pk_bf16_f32 v64, v64, v64
    v_and_b32 v64, 0xffff0000, v64
    v_add_f32 v65, v65, v69
    v_add_f32 v73, v73, v77
    v_add_f32 v65, v65, v73
    v_cvt_pk_bf16_f32 v65, v65, v65
    v_and_b32 v65, 0xffff0000, v65
    v_add_f32 v66, v66, v70
    v_add_f32 v74, v74, v78
    v_add_f32 v66, v66, v74
    v_cvt_pk_bf16_f32 v66, v66, v66
    v_and_b32 v66, 0xffff0000, v66
    v_add_f32 v67, v67, v71
    v_add_f32 v75, v75, v79
    v_add_f32 v67, v67, v75
    v_cvt_pk_bf16_f32 v67, v67, v67
    v_and_b32 v67, 0xffff0000, v67
    v_add_f32 v80, v80, v84
    v_add_f32 v88, v88, v92
    v_add_f32 v80, v80, v88
    v_cvt_pk_bf16_f32 v80, v80, v80
    v_and_b32 v80, 0xffff0000, v80
    v_add_f32 v81, v81, v85
    v_add_f32 v89, v89, v93
    v_add_f32 v81, v81, v89
    v_cvt_pk_bf16_f32 v81, v81, v81
    v_and_b32 v81, 0xffff0000, v81
    v_add_f32 v82, v82, v86
    v_add_f32 v90, v90, v94
    v_add_f32 v82, v82, v90
    v_cvt_pk_bf16_f32 v82, v82, v82
    v_and_b32 v82, 0xffff0000, v82
    v_add_f32 v83, v83, v87
    v_add_f32 v91, v91, v95
    v_add_f32 v83, v83, v91
    v_cvt_pk_bf16_f32 v83, v83, v83
    v_and_b32 v83, 0xffff0000, v83
    v_and_b32 v1, 15, v0
    v_lshlrev_b32 v1, 3, v1
    v_lshrrev_b32 v2, 4, v0
    v_lshl_add_u32 v1, v2, 9, v1
    s_lshl_b32 s75, s64, 1
    s_add_u32 s75, s75, 81920
    v_add_u32 v1, s75, v1
    v_mul_f32 v101, 0xbfb8aa3b, v64
    v_exp_f32 v101, v101
    s_nop 0
    v_add_f32 v101, 1.0, v101
    v_rcp_f32 v100, v101
    s_nop 0
    v_mul_f32 v100, v100, v64
    v_cvt_pk_bf16_f32 v100, v100, v100
    v_and_b32 v100, 0xffff0000, v100
    v_mul_f32 v100, v100, v80
    v_cvt_pk_bf16_f32 v102, v100, v100
    ds_write_b16 v1, v102 offset:20480
    v_mul_f32 v101, 0xbfb8aa3b, v65
    v_exp_f32 v101, v101
    s_nop 0
    v_add_f32 v101, 1.0, v101
    v_rcp_f32 v100, v101
    s_nop 0
    v_mul_f32 v100, v100, v65
    v_cvt_pk_bf16_f32 v100, v100, v100
    v_and_b32 v100, 0xffff0000, v100
    v_mul_f32 v100, v100, v81
    v_cvt_pk_bf16_f32 v103, v100, v100
    ds_write_b16 v1, v103 offset:20608
    v_mul_f32 v101, 0xbfb8aa3b, v66
    v_exp_f32 v101, v101
    s_nop 0
    v_add_f32 v101, 1.0, v101
    v_rcp_f32 v100, v101
    s_nop 0
    v_mul_f32 v100, v100, v66
    v_cvt_pk_bf16_f32 v100, v100, v100
    v_and_b32 v100, 0xffff0000, v100
    v_mul_f32 v100, v100, v82
    v_cvt_pk_bf16_f32 v104, v100, v100
    ds_write_b16 v1, v104 offset:20736
    v_mul_f32 v101, 0xbfb8aa3b, v67
    v_exp_f32 v101, v101
    s_nop 0
    v_add_f32 v101, 1.0, v101
    v_rcp_f32 v100, v101
    s_nop 0
    v_mul_f32 v100, v100, v67
    v_cvt_pk_bf16_f32 v100, v100, v100
    v_and_b32 v100, 0xffff0000, v100
    v_mul_f32 v100, v100, v83
    v_cvt_pk_bf16_f32 v105, v100, v100
    ds_write_b16 v1, v105 offset:20864
    s_mov_b64 exec, -1
    s_waitcnt lgkmcnt(0)
    s_barrier
    s_cmp_lg_u32 s64, 0
    s_cbranch_scc1 L_gu_st_29
    v_lshlrev_b32 v1, 4, v0
    v_add_u32 v1, 81920, v1
    ds_read_b128 v[64:67], v1 offset:20480
    v_lshrrev_b32 v2, 3, v0
    v_mul_u32_u24 v2, 3072, v2
    v_and_b32 v3, 7, v0
    v_lshl_add_u32 v2, v3, 4, v2
    s_lshl_b32 s75, s70, 7
    s_add_u32 s75, s75, 0x60c000
    s_waitcnt lgkmcnt(0)
    buffer_store_dwordx4 v[64:67], v2, s[48:51], s75 offen sc1
L_gu_st_29:
    s_lshl_b32 s92, s70, 2
    s_add_u32 s92, s92, 0x603d00
    s_mov_b32 s93, 1
    s_waitcnt vmcnt(0)
    s_barrier
    s_cmp_lg_u32 s64, 1
    s_cbranch_scc1 L_fs_30
    v_mov_b32 v2, s93
    v_mov_b32 v3, 0
    s_mov_b64 exec, 1
    buffer_store_dword v2, v3, s[48:51], s92 offen sc1
    s_mov_b64 exec, -1
L_fs_30:
    s_branch L_moe_end_27
L_moe_dn_26:
    s_sub_u32 s70, s4, 24
    s_mov_b32 s52, s38
    s_mov_b32 s53, s39
    s_mov_b32 s54, 0x1e0000
    s_mov_b32 s55, 0x20000
    s_mov_b32 s56, s16
    s_mov_b32 s57, s17
    s_mov_b32 s58, 0x280000
    s_mov_b32 s59, 0x20000
    v_lshrrev_b32 v1, 4, v0
    v_mul_u32_u24 v1, 10240, v1
    v_and_b32 v2, 15, v0
    v_lshl_add_u32 v10, v2, 2, v1
    s_mul_i32 s71, s64, 491520
    s_lshl_b32 s72, s70, 6
    s_add_u32 s71, s71, s72
    s_add_u32 s72, s71, 0
    buffer_load_dword v72, v10, s[52:55], s72 offen offset:0
    buffer_load_dword v73, v10, s[52:55], s72 offen offset:1280
    buffer_load_dword v74, v10, s[52:55], s72 offen offset:2560
    buffer_load_dword v75, v10, s[52:55], s72 offen offset:3840
    s_add_u32 s72, s71, 5120
    buffer_load_dword v76, v10, s[52:55], s72 offen offset:0
    buffer_load_dword v77, v10, s[52:55], s72 offen offset:1280
    buffer_load_dword v78, v10, s[52:55], s72 offen offset:2560
    buffer_load_dword v79, v10, s[52:55], s72 offen offset:3840
    s_add_u32 s72, s71, 40960
    buffer_load_dword v80, v10, s[52:55], s72 offen offset:0
    buffer_load_dword v81, v10, s[52:55], s72 offen offset:1280
    buffer_load_dword v82, v10, s[52:55], s72 offen offset:2560
    buffer_load_dword v83, v10, s[52:55], s72 offen offset:3840
    s_add_u32 s72, s71, 46080
    buffer_load_dword v84, v10, s[52:55], s72 offen offset:0
    buffer_load_dword v85, v10, s[52:55], s72 offen offset:1280
    buffer_load_dword v86, v10, s[52:55], s72 offen offset:2560
    buffer_load_dword v87, v10, s[52:55], s72 offen offset:3840
    s_add_u32 s72, s71, 81920
    buffer_load_dword v88, v10, s[52:55], s72 offen offset:0
    buffer_load_dword v89, v10, s[52:55], s72 offen offset:1280
    buffer_load_dword v90, v10, s[52:55], s72 offen offset:2560
    buffer_load_dword v91, v10, s[52:55], s72 offen offset:3840
    s_add_u32 s72, s71, 87040
    buffer_load_dword v92, v10, s[52:55], s72 offen offset:0
    buffer_load_dword v93, v10, s[52:55], s72 offen offset:1280
    buffer_load_dword v94, v10, s[52:55], s72 offen offset:2560
    buffer_load_dword v95, v10, s[52:55], s72 offen offset:3840
    s_add_u32 s72, s71, 122880
    buffer_load_dword v96, v10, s[52:55], s72 offen offset:0
    buffer_load_dword v97, v10, s[52:55], s72 offen offset:1280
    buffer_load_dword v98, v10, s[52:55], s72 offen offset:2560
    buffer_load_dword v99, v10, s[52:55], s72 offen offset:3840
    s_add_u32 s72, s71, 128000
    buffer_load_dword v100, v10, s[52:55], s72 offen offset:0
    buffer_load_dword v101, v10, s[52:55], s72 offen offset:1280
    buffer_load_dword v102, v10, s[52:55], s72 offen offset:2560
    buffer_load_dword v103, v10, s[52:55], s72 offen offset:3840
    s_add_u32 s72, s71, 163840
    buffer_load_dword v104, v10, s[52:55], s72 offen offset:0
    buffer_load_dword v105, v10, s[52:55], s72 offen offset:1280
    buffer_load_dword v106, v10, s[52:55], s72 offen offset:2560
    buffer_load_dword v107, v10, s[52:55], s72 offen offset:3840
    s_add_u32 s72, s71, 168960
    buffer_load_dword v108, v10, s[52:55], s72 offen offset:0
    buffer_load_dword v109, v10, s[52:55], s72 offen offset:1280
    buffer_load_dword v110, v10, s[52:55], s72 offen offset:2560
    buffer_load_dword v111, v10, s[52:55], s72 offen offset:3840
    s_add_u32 s72, s71, 204800
    buffer_load_dword v112, v10, s[52:55], s72 offen offset:0
    buffer_load_dword v113, v10, s[52:55], s72 offen offset:1280
    buffer_load_dword v114, v10, s[52:55], s72 offen offset:2560
    buffer_load_dword v115, v10, s[52:55], s72 offen offset:3840
    s_add_u32 s72, s71, 209920
    buffer_load_dword v116, v10, s[52:55], s72 offen offset:0
    buffer_load_dword v117, v10, s[52:55], s72 offen offset:1280
    buffer_load_dword v118, v10, s[52:55], s72 offen offset:2560
    buffer_load_dword v119, v10, s[52:55], s72 offen offset:3840
    s_waitcnt vmcnt(8)
    s_add_u32 s72, s71, 245760
    buffer_load_dword v120, v10, s[52:55], s72 offen offset:0
    buffer_load_dword v121, v10, s[52:55], s72 offen offset:1280
    buffer_load_dword v122, v10, s[52:55], s72 offen offset:2560
    buffer_load_dword v123, v10, s[52:55], s72 offen offset:3840
    s_add_u32 s72, s71, 250880
    buffer_load_dword v124, v10, s[52:55], s72 offen offset:0
    buffer_load_dword v125, v10, s[52:55], s72 offen offset:1280
    buffer_load_dword v126, v10, s[52:55], s72 offen offset:2560
    buffer_load_dword v127, v10, s[52:55], s72 offen offset:3840
    s_add_u32 s72, s71, 286720
    buffer_load_dword v128, v10, s[52:55], s72 offen offset:0
    buffer_load_dword v129, v10, s[52:55], s72 offen offset:1280
    buffer_load_dword v130, v10, s[52:55], s72 offen offset:2560
    buffer_load_dword v131, v10, s[52:55], s72 offen offset:3840
    s_add_u32 s72, s71, 291840
    buffer_load_dword v132, v10, s[52:55], s72 offen offset:0
    buffer_load_dword v133, v10, s[52:55], s72 offen offset:1280
    buffer_load_dword v134, v10, s[52:55], s72 offen offset:2560
    buffer_load_dword v135, v10, s[52:55], s72 offen offset:3840
    s_add_u32 s72, s71, 327680
    buffer_load_dword v136, v10, s[52:55], s72 offen offset:0
    buffer_load_dword v137, v10, s[52:55], s72 offen offset:1280
    buffer_load_dword v138, v10, s[52:55], s72 offen offset:2560
    buffer_load_dword v139, v10, s[52:55], s72 offen offset:3840
    s_add_u32 s72, s71, 332800
    buffer_load_dword v140, v10, s[52:55], s72 offen offset:0
    buffer_load_dword v141, v10, s[52:55], s72 offen offset:1280
    buffer_load_dword v142, v10, s[52:55], s72 offen offset:2560
    buffer_load_dword v143, v10, s[52:55], s72 offen offset:3840
    s_add_u32 s72, s71, 368640
    buffer_load_dword v144, v10, s[52:55], s72 offen offset:0
    buffer_load_dword v145, v10, s[52:55], s72 offen offset:1280
    buffer_load_dword v146, v10, s[52:55], s72 offen offset:2560
    buffer_load_dword v147, v10, s[52:55], s72 offen offset:3840
    s_add_u32 s72, s71, 373760
    buffer_load_dword v148, v10, s[52:55], s72 offen offset:0
    buffer_load_dword v149, v10, s[52:55], s72 offen offset:1280
    buffer_load_dword v150, v10, s[52:55], s72 offen offset:2560
    buffer_load_dword v151, v10, s[52:55], s72 offen offset:3840
    s_add_u32 s72, s71, 409600
    buffer_load_dword v152, v10, s[52:55], s72 offen offset:0
    buffer_load_dword v153, v10, s[52:55], s72 offen offset:1280
    buffer_load_dword v154, v10, s[52:55], s72 offen offset:2560
    buffer_load_dword v155, v10, s[52:55], s72 offen offset:3840
    s_add_u32 s72, s71, 414720
    buffer_load_dword v156, v10, s[52:55], s72 offen offset:0
    buffer_load_dword v157, v10, s[52:55], s72 offen offset:1280
    buffer_load_dword v158, v10, s[52:55], s72 offen offset:2560
    buffer_load_dword v159, v10, s[52:55], s72 offen offset:3840
    s_add_u32 s72, s71, 450560
    buffer_load_dword v160, v10, s[52:55], s72 offen offset:0
    buffer_load_dword v161, v10, s[52:55], s72 offen offset:1280
    buffer_load_dword v162, v10, s[52:55], s72 offen offset:2560
    buffer_load_dword v163, v10, s[52:55], s72 offen offset:3840
    s_add_u32 s72, s71, 455680
    buffer_load_dword v164, v10, s[52:55], s72 offen offset:0
    buffer_load_dword v165, v10, s[52:55], s72 offen offset:1280
    buffer_load_dword v166, v10, s[52:55], s72 offen offset:2560
    buffer_load_dword v167, v10, s[52:55], s72 offen offset:3840
    s_mov_b32 s73, 0x05040100
    s_mov_b32 s74, 0x07060302
    s_waitcnt vmcnt(63)
    v_perm_b32 v64, v73, v72, s73
    v_perm_b32 v65, v75, v74, s73
    v_perm_b32 v66, v77, v76, s73
    v_perm_b32 v67, v79, v78, s73
    v_perm_b32 v68, v73, v72, s74
    v_perm_b32 v69, v75, v74, s74
    v_perm_b32 v70, v77, v76, s74
    v_perm_b32 v71, v79, v78, s74
    s_waitcnt vmcnt(63)
    v_perm_b32 v72, v81, v80, s73
    v_perm_b32 v73, v83, v82, s73
    v_perm_b32 v74, v85, v84, s73
    v_perm_b32 v75, v87, v86, s73
    v_perm_b32 v76, v81, v80, s74
    v_perm_b32 v77, v83, v82, s74
    v_perm_b32 v78, v85, v84, s74
    v_perm_b32 v79, v87, v86, s74
    s_waitcnt vmcnt(63)
    v_perm_b32 v80, v89, v88, s73
    v_perm_b32 v81, v91, v90, s73
    v_perm_b32 v82, v93, v92, s73
    v_perm_b32 v83, v95, v94, s73
    v_perm_b32 v84, v89, v88, s74
    v_perm_b32 v85, v91, v90, s74
    v_perm_b32 v86, v93, v92, s74
    v_perm_b32 v87, v95, v94, s74
    s_waitcnt vmcnt(63)
    v_perm_b32 v88, v97, v96, s73
    v_perm_b32 v89, v99, v98, s73
    v_perm_b32 v90, v101, v100, s73
    v_perm_b32 v91, v103, v102, s73
    v_perm_b32 v92, v97, v96, s74
    v_perm_b32 v93, v99, v98, s74
    v_perm_b32 v94, v101, v100, s74
    v_perm_b32 v95, v103, v102, s74
    s_waitcnt vmcnt(56)
    v_perm_b32 v96, v105, v104, s73
    v_perm_b32 v97, v107, v106, s73
    v_perm_b32 v98, v109, v108, s73
    v_perm_b32 v99, v111, v110, s73
    v_perm_b32 v100, v105, v104, s74
    v_perm_b32 v101, v107, v106, s74
    v_perm_b32 v102, v109, v108, s74
    v_perm_b32 v103, v111, v110, s74
    s_waitcnt vmcnt(48)
    v_perm_b32 v104, v113, v112, s73
    v_perm_b32 v105, v115, v114, s73
    v_perm_b32 v106, v117, v116, s73
    v_perm_b32 v107, v119, v118, s73
    v_perm_b32 v108, v113, v112, s74
    v_perm_b32 v109, v115, v114, s74
    v_perm_b32 v110, v117, v116, s74
    v_perm_b32 v111, v119, v118, s74
    s_waitcnt vmcnt(40)
    v_perm_b32 v112, v121, v120, s73
    v_perm_b32 v113, v123, v122, s73
    v_perm_b32 v114, v125, v124, s73
    v_perm_b32 v115, v127, v126, s73
    v_perm_b32 v116, v121, v120, s74
    v_perm_b32 v117, v123, v122, s74
    v_perm_b32 v118, v125, v124, s74
    v_perm_b32 v119, v127, v126, s74
    s_waitcnt vmcnt(32)
    v_perm_b32 v120, v129, v128, s73
    v_perm_b32 v121, v131, v130, s73
    v_perm_b32 v122, v133, v132, s73
    v_perm_b32 v123, v135, v134, s73
    v_perm_b32 v124, v129, v128, s74
    v_perm_b32 v125, v131, v130, s74
    v_perm_b32 v126, v133, v132, s74
    v_perm_b32 v127, v135, v134, s74
    s_waitcnt vmcnt(24)
    v_perm_b32 v128, v137, v136, s73
    v_perm_b32 v129, v139, v138, s73
    v_perm_b32 v130, v141, v140, s73
    v_perm_b32 v131, v143, v142, s73
    v_perm_b32 v132, v137, v136, s74
    v_perm_b32 v133, v139, v138, s74
    v_perm_b32 v134, v141, v140, s74
    v_perm_b32 v135, v143, v142, s74
    s_waitcnt vmcnt(16)
    v_perm_b32 v136, v145, v144, s73
    v_perm_b32 v137, v147, v146, s73
    v_perm_b32 v138, v149, v148, s73
    v_perm_b32 v139, v151, v150, s73
    v_perm_b32 v140, v145, v144, s74
    v_perm_b32 v141, v147, v146, s74
    v_perm_b32 v142, v149, v148, s74
    v_perm_b32 v143, v151, v150, s74
    s_waitcnt vmcnt(8)
    v_perm_b32 v144, v153, v152, s73
    v_perm_b32 v145, v155, v154, s73
    v_perm_b32 v146, v157, v156, s73
    v_perm_b32 v147, v159, v158, s73
    v_perm_b32 v148, v153, v152, s74
    v_perm_b32 v149, v155, v154, s74
    v_perm_b32 v150, v157, v156, s74
    v_perm_b32 v151, v159, v158, s74
    s_waitcnt vmcnt(0)
    v_perm_b32 v152, v161, v160, s73
    v_perm_b32 v153, v163, v162, s73
    v_perm_b32 v154, v165, v164, s73
    v_perm_b32 v155, v167, v166, s73
    v_perm_b32 v156, v161, v160, s74
    v_perm_b32 v157, v163, v162, s74
    v_perm_b32 v158, v165, v164, s74
    v_perm_b32 v159, v167, v166, s74
    s_cmp_lg_u32 s64, 1
    s_cbranch_scc1 L_waok_32
    v_min_u32 v2, 23, v0
    v_lshlrev_b32 v2, 2, v2
    v_add_u32 v2, 0x603d00, v2
L_wa_31:
    buffer_load_dword v1, v2, s[48:51], 0 offen sc1
    s_waitcnt vmcnt(0)
    v_cmp_gt_u32 vcc, 1, v1
    s_cbranch_vccz L_waok_32
    s_sleep 32
    s_sub_u32 s67, s67, 1
    s_cbranch_scc1 K2_DONE
    s_branch L_wa_31
L_waok_32:
    s_barrier
    v_and_b32 v1, 7, v0
    v_mul_u32_u24 v1, 3072, v1
    v_lshrrev_b32 v2, 4, v0
    v_lshl_add_u32 v1, v2, 4, v1
    s_mul_i32 s75, s64, 768
    s_add_u32 s75, s75, 0x60c000
    buffer_load_dwordx4 v[176:179], v1, s[48:51], s75 offen offset:0 sc1
    buffer_load_dwordx4 v[180:183], v1, s[48:51], s75 offen offset:64 sc1
    buffer_load_dwordx4 v[184:187], v1, s[48:51], s75 offen offset:128 sc1
    buffer_load_dwordx4 v[188:191], v1, s[48:51], s75 offen offset:192 sc1
    buffer_load_dwordx4 v[192:195], v1, s[48:51], s75 offen offset:256 sc1
    buffer_load_dwordx4 v[196:199], v1, s[48:51], s75 offen offset:320 sc1
    buffer_load_dwordx4 v[200:203], v1, s[48:51], s75 offen offset:384 sc1
    buffer_load_dwordx4 v[204:207], v1, s[48:51], s75 offen offset:448 sc1
    buffer_load_dwordx4 v[208:211], v1, s[48:51], s75 offen offset:512 sc1
    buffer_load_dwordx4 v[212:215], v1, s[48:51], s75 offen offset:576 sc1
    buffer_load_dwordx4 v[216:219], v1, s[48:51], s75 offen offset:640 sc1
    buffer_load_dwordx4 v[220:223], v1, s[48:51], s75 offen offset:704 sc1
    v_lshrrev_b32 v2, 5, v0
    s_lshl_b32 s76, s64, 1
    v_add_u32 v11, s76, v2
    v_lshlrev_b32 v2, 2, v11
    s_mov_b32 s76, 0x607200
    buffer_load_dword v12, v2, s[48:51], s76 offen sc1
    buffer_load_dword v13, v2, s[48:51], s76 offen offset:64 sc1
    s_waitcnt vmcnt(13)
    v_mfma_f32_16x16x32_bf16 v[232:235], v[176:179], v[64:67], 0
    v_mfma_f32_16x16x32_bf16 v[236:239], v[176:179], v[68:71], 0
    s_waitcnt vmcnt(12)
    v_mfma_f32_16x16x32_bf16 v[232:235], v[180:183], v[72:75], v[232:235]
    v_mfma_f32_16x16x32_bf16 v[236:239], v[180:183], v[76:79], v[236:239]
    s_waitcnt vmcnt(11)
    v_mfma_f32_16x16x32_bf16 v[232:235], v[184:187], v[80:83], v[232:235]
    v_mfma_f32_16x16x32_bf16 v[236:239], v[184:187], v[84:87], v[236:239]
    s_waitcnt vmcnt(10)
    v_mfma_f32_16x16x32_bf16 v[232:235], v[188:191], v[88:91], v[232:235]
    v_mfma_f32_16x16x32_bf16 v[236:239], v[188:191], v[92:95], v[236:239]
    s_waitcnt vmcnt(9)
    v_mfma_f32_16x16x32_bf16 v[232:235], v[192:195], v[96:99], v[232:235]
    v_mfma_f32_16x16x32_bf16 v[236:239], v[192:195], v[100:103], v[236:239]
    s_waitcnt vmcnt(8)
    v_mfma_f32_16x16x32_bf16 v[232:235], v[196:199], v[104:107], v[232:235]
    v_mfma_f32_16x16x32_bf16 v[236:239], v[196:199], v[108:111], v[236:239]
    s_waitcnt vmcnt(7)
    v_mfma_f32_16x16x32_bf16 v[232:235], v[200:203], v[112:115], v[232:235]
    v_mfma_f32_16x16x32_bf16 v[236:239], v[200:203], v[116:119], v[236:239]
    s_waitcnt vmcnt(6)
    v_mfma_f32_16x16x32_bf16 v[232:235], v[204:207], v[120:123], v[232:235]
    v_mfma_f32_16x16x32_bf16 v[236:239], v[204:207], v[124:127], v[236:239]
    s_waitcnt vmcnt(5)
    v_mfma_f32_16x16x32_bf16 v[232:235], v[208:211], v[128:131], v[232:235]
    v_mfma_f32_16x16x32_bf16 v[236:239], v[208:211], v[132:135], v[236:239]
    s_waitcnt vmcnt(4)
    v_mfma_f32_16x16x32_bf16 v[232:235], v[212:215], v[136:139], v[232:235]
    v_mfma_f32_16x16x32_bf16 v[236:239], v[212:215], v[140:143], v[236:239]
    s_waitcnt vmcnt(3)
    v_mfma_f32_16x16x32_bf16 v[232:235], v[216:219], v[144:147], v[232:235]
    v_mfma_f32_16x16x32_bf16 v[236:239], v[216:219], v[148:151], v[236:239]
    s_waitcnt vmcnt(2)
    v_mfma_f32_16x16x32_bf16 v[232:235], v[220:223], v[152:155], v[232:235]
    v_mfma_f32_16x16x32_bf16 v[236:239], v[220:223], v[156:159], v[236:239]
    s_waitcnt vmcnt(0)
    v_and_b32 v14, 31, v0
    v_mul_u32_u24 v12, 1280, v12
    v_lshl_add_u32 v12, v14, 1, v12
    s_lshl_b32 s76, s70, 6
    buffer_load_ushort v15, v12, s[56:59], s76 offen
    v_lshlrev_b32 v1, 4, v0
    s_lshl_b32 s75, s64, 10
    s_add_u32 s75, s75, 81920
    v_add_u32 v2, s75, v1
    s_mov_b32 exec_hi, 0
    ds_write_b128 v2, v[232:235]
    ds_write_b128 v2, v[236:239] offset:512
    s_mov_b64 exec, -1
    s_waitcnt lgkmcnt(0)
    s_barrier
    v_and_b32 v1, 1, v14
    v_lshlrev_b32 v1, 9, v1
    v_lshrrev_b32 v2, 1, v14
    v_lshl_add_u32 v1, v2, 4, v1
    v_lshrrev_b32 v2, 2, v11
    v_lshl_add_u32 v1, v2, 8, v1
    v_and_b32 v2, 3, v11
    v_lshl_add_u32 v1, v2, 2, v1
    v_add_u32 v1, 81920, v1
    ds_read_b32 v20, v1 offset:0
    ds_read_b32 v21, v1 offset:1024
    ds_read_b32 v22, v1 offset:2048
    ds_read_b32 v23, v1 offset:3072
    s_waitcnt lgkmcnt(0)
    v_add_f32 v20, v20, v21
    v_add_f32 v22, v22, v23
    v_add_f32 v20, v20, v22
    v_cvt_pk_bf16_f32 v20, v20, v20
    v_and_b32 v20, 0xffff0000, v20
    v_mul_f32 v20, v20, v13
    v_cvt_pk_bf16_f32 v20, v20, v20
    v_and_b32 v20, 0xffff0000, v20
    s_waitcnt vmcnt(0)
    v_lshlrev_b32 v15, 16, v15
    v_add_f32 v20, v20, v15
    v_cvt_pk_bf16_f32 v20, v20, v20
    v_mul_u32_u24 v1, 1280, v11
    v_lshl_add_u32 v1, v14, 1, v1
    s_add_u32 s76, s76, 0x612000
    buffer_store_short v20, v1, s[48:51], s76 offen sc1
    s_lshl_b32 s92, s70, 2
    s_add_u32 s92, s92, 0x603e00
    s_mov_b32 s93, 1
    s_waitcnt vmcnt(0)
    s_barrier
    s_cmp_lg_u32 s64, 1
    s_cbranch_scc1 L_fs_33
    v_mov_b32 v2, s93
    v_mov_b32 v3, 0
    s_mov_b64 exec, 1
    buffer_store_dword v2, v3, s[48:51], s92 offen sc1
    s_mov_b64 exec, -1
L_fs_33:
L_moe_end_27:
    s_sub_u32 s4, s65, 192
    v_lshlrev_b32 v1, 4, v0
    v_mov_b32 v2, v1
    s_mov_b32 s12, 63
    s_branch L_g_res_18
L_g_fin_25:
    s_and_b32 s84, s4, 15
    s_lshr_b32 s83, s4, 4
    s_sub_u32 s83, 3, s83
    s_mul_i32 s84, s84, 5
    s_mov_b32 s10, 4
    s_mov_b32 s11, 61
    s_mov_b32 s12, 34
K2_PR5:
    s_mov_b32 s52, s16
    s_mov_b32 s53, s17
    s_mov_b32 s54, 0x280000
    s_mov_b32 s55, 0x20000
    s_mov_b32 s56, s42
    s_mov_b32 s57, s43
    s_mov_b32 s58, 0x280000
    s_mov_b32 s59, 0x20000
    s_cmp_lg_u32 s64, 1
    s_cbranch_scc1 L_waok_35
    v_min_u32 v9, 19, v0
    v_lshlrev_b32 v9, 2, v9
    v_add_u32 v9, 0x603e00, v9
L_wa_34:
    buffer_load_dword v8, v9, s[48:51], 0 offen sc1
    s_waitcnt vmcnt(0)
    v_cmp_gt_u32 vcc, 1, v8
    s_cbranch_vccz L_waok_35
    s_sleep 12
    s_sub_u32 s67, s67, 1
    s_cbranch_scc1 K2_DONE
    s_branch L_wa_34
L_waok_35:
    s_barrier
    s_mov_b32 s82, s83
    s_mov_b32 s80, 0x607200
    v_and_b32 v8, 7, v0
    v_lshlrev_b32 v8, 2, v8
    buffer_load_dword v9, v8, s[48:51], s80 offen sc1
    s_waitcnt vmcnt(0)
    v_readlane_b32 s20, v9, 0
    v_readlane_b32 s21, v9, 1
    v_readlane_b32 s22, v9, 2
    v_readlane_b32 s23, v9, 3
    v_readlane_b32 s24, v9, 4
    v_readlane_b32 s25, v9, 5
    v_readlane_b32 s26, v9, 6
    v_readlane_b32 s27, v9, 7
    v_and_b32 v8, 7, v0
    v_bfe_u32 v9, v0, 3, 1
    v_lshrrev_b32 v10, 4, v0
    v_mul_u32_u24 v11, 640, v9
    v_lshl_add_u32 v12, v8, 4, v11
    v_lshl_add_u32 v2, v10, 7, v12
    v_lshrrev_b32 v12, 1, v10
    v_mul_u32_u24 v12, 1280, v12
    v_add3_u32 v12, v12, v11, 0
    v_lshl_add_u32 v12, v8, 4, v12
    v_and_b32 v13, 1, v10
    v_lshl_add_u32 v12, v13, 3, v12
    v_add_u32 v3, 512, v12
    v_lshlrev_b32 v13, 2, v13
    v_add_u32 v13, s64, v13
    v_xor_b32 v13, v13, v8
    v_lshl_add_u32 v13, v8, 3, v13
    v_lshlrev_b32 v13, 4, v13
    v_lshl_add_u32 v13, v9, 10, v13
    v_add_u32 v4, 81920, v13
    v_lshrrev_b32 v8, 3, v0
    v_xor_b32 v5, v8, v0
    v_lshlrev_b32 v5, 4, v5
    v_add_u32 v5, 81920, v5
    s_lshl_b32 s80, s64, 11
    v_add_u32 v5, s80, v5
    v_mul_u32_u24 v10, 1280, v8
    v_bfe_u32 v9, v0, 2, 1
    v_lshl_add_u32 v6, v9, 3, v10
    v_lshlrev_b32 v7, 2, v8
    v_and_b32 v8, 7, v0
    v_min_u32 v8, 4, v8
    v_add_u32 v8, s84, v8
    v_lshlrev_b32 v8, 7, v8
    v_add_u32 v9, 0x604000, v8
    v_add_u32 v8, 0x601000, v8
    v_cmp_gt_u32 vcc, 48, v0
    v_lshlrev_b32 v10, 2, v0
    v_add_u32 v10, 0x607000, v10
    v_cndmask_b32 v8, v8, v9, vcc
    v_cmp_gt_u32 vcc, 32, v0
    s_mov_b32 s78, 0
    s_mov_b64 s[8:9], 0
    v_cndmask_b32 v203, v8, v10, vcc
    v_mov_b32 v216, v8
    s_mov_b32 s4, 0xff00ff
    s_mov_b32 s5, 0xff00ff00
    s_mov_b32 s6, 0x1010101
    s_mov_b32 s7, 0x1010101
    s_add_u32 s32, s65, 0
    s_and_b32 s32, s32, 3
    s_lshl_b32 s32, s32, 11
    s_add_u32 s33, s65, 1
    s_and_b32 s33, s33, 3
    s_lshl_b32 s33, s33, 11
    s_add_u32 s34, s65, 2
    s_and_b32 s34, s34, 3
    s_lshl_b32 s34, s34, 11
    s_add_u32 s35, s65, 3
    s_and_b32 s35, s35, 3
    s_lshl_b32 s35, s35, 11
    s_waitcnt lgkmcnt(0)
    s_lshr_b32 s80, s20, 5
    s_bitset1_b64 s[8:9], s80
    s_lshr_b32 s80, s21, 5
    s_bitset1_b64 s[8:9], s80
    s_lshr_b32 s80, s22, 5
    s_bitset1_b64 s[8:9], s80
    s_lshr_b32 s80, s23, 5
    s_bitset1_b64 s[8:9], s80
    s_lshr_b32 s80, s24, 5
    s_bitset1_b64 s[8:9], s80
    s_lshr_b32 s80, s25, 5
    s_bitset1_b64 s[8:9], s80
    s_lshr_b32 s80, s26, 5
    s_bitset1_b64 s[8:9], s80
    s_lshr_b32 s80, s27, 5
    s_bitset1_b64 s[8:9], s80
    s_cmp_ge_u32 s82, s11
    s_cbranch_scc1 K2_PR5E
    s_mul_i32 s73, s84, 0x101000
    s_lshl_b32 s80, s82, 2
    s_add_u32 s80, s80, s64
    s_lshl_b32 s81, s80, 12
    s_add_u32 s73, s73, s81
    s_add_u32 s73, s73, 0x8100000
    s_mul_i32 s74, s84, 0x41000
    s_lshl_b32 s81, s80, 10
    s_add_u32 s74, s74, s81
    s_add_u32 s74, s74, 0x3a00000
    s_mul_i32 s76, s80, 10240
    s_lshl_b32 s81, s84, 4
    s_add_u32 s76, s76, s81
    s_lshl_b32 s77, s80, 5
    s_add_u32 s77, s77, 0x60a000
    s_mul_i32 s75, s82, 81920
    s_mul_i32 s81, s64, 5120
    s_add_u32 s75, s75, s81
    s_add_u32 s75, s75, 0xa00000
    s_add_u32 s79, s82, 1
    s_min_u32 s79, s79, 63
    s_mov_b32 s30, 0
    v_mov_b32 v217, v216
    buffer_load_dwordx2 v[204:205], v6, s[52:55], s76 offen offset:0
    buffer_load_dwordx2 v[206:207], v6, s[52:55], s76 offen offset:16
    buffer_load_dwordx2 v[208:209], v6, s[52:55], s76 offen offset:32
    buffer_load_dwordx2 v[210:211], v6, s[52:55], s76 offen offset:48
    buffer_load_dwordx2 v[212:213], v6, s[52:55], s76 offen offset:64
    buffer_load_dword v214, v7, s[48:51], s77 offen sc1
    s_cmp_lg_u32 s64, 1
    s_cbranch_scc1 L_pr_ok_41
    s_cmp_ge_u32 s78, s79
    s_cbranch_scc1 L_pr_hit_43
L_pr_fp_40:
    buffer_load_dword v12, v217, s[48:51], 0 offen sc1
    s_waitcnt vmcnt(0)
    s_nop 1
    v_min_u32_dpp v12, v12, v12 quad_perm:[1,0,3,2] row_mask:0xf bank_mask:0xf
    s_nop 1
    v_min_u32_dpp v12, v12, v12 quad_perm:[2,3,0,1] row_mask:0xf bank_mask:0xf
    s_nop 1
    v_min_u32_dpp v12, v12, v12 row_half_mirror row_mask:0xf bank_mask:0xf
    s_nop 1
    v_min_u32_dpp v12, v12, v12 row_mirror row_mask:0xf bank_mask:0xf
    s_nop 0
    v_readlane_b32 s78, v12, 0
    v_readlane_b32 s80, v12, 16
    v_readlane_b32 s81, v12, 32
    v_readlane_b32 s31, v12, 48
    s_min_u32 s78, s78, s80
    s_min_u32 s81, s81, s31
    s_min_u32 s78, s78, s81
    s_cmp_ge_u32 s78, s79
    s_cbranch_scc1 L_pr_hit_43
    s_sleep 4
    s_add_u32 s80, s78, 1
    s_cmp_ge_u32 s80, s79
    s_cbranch_scc1 L_pr_far_42
    s_sleep 64
L_pr_far_42:
    s_sub_u32 s67, s67, 1
    s_cbranch_scc1 K2_DONE
    s_branch L_pr_fp_40
L_pr_hit_43:
    s_cmp_lt_u32 s82, 62
    s_cbranch_scc1 L_pr_ok_41
    s_cmp_lg_u32 s30, 0
    s_cbranch_scc1 L_pr_ok_41
    s_mov_b32 s30, 1
    s_add_u32 s79, s82, 1
    v_mov_b32 v217, v203
    s_branch L_pr_fp_40
L_pr_ok_41:
    s_barrier
    s_mul_i32 s81, s32, 10
    s_add_u32 s81, s81, s75
    buffer_load_dwordx4 v[32:35], v2, s[48:51], s81 offen offset:0 sc1
    buffer_load_dwordx4 v[36:39], v2, s[48:51], s81 offen offset:1280 sc1
    buffer_load_dwordx4 v[40:43], v2, s[48:51], s81 offen offset:2560 sc1
    buffer_load_dwordx4 v[44:47], v2, s[48:51], s81 offen offset:3840 sc1
    buffer_load_dwordx2 v[48:49], v3, s[48:51], s81 offen sc1
    buffer_load_dwordx2 v[50:51], v3, s[48:51], s81 offen offset:2560 sc1
    s_mul_i32 s81, s33, 10
    s_add_u32 s81, s81, s75
    buffer_load_dwordx4 v[52:55], v2, s[48:51], s81 offen offset:0 sc1
    buffer_load_dwordx4 v[56:59], v2, s[48:51], s81 offen offset:1280 sc1
    buffer_load_dwordx4 v[60:63], v2, s[48:51], s81 offen offset:2560 sc1
    buffer_load_dwordx4 v[64:67], v2, s[48:51], s81 offen offset:3840 sc1
    buffer_load_dwordx2 v[68:69], v3, s[48:51], s81 offen sc1
    buffer_load_dwordx2 v[70:71], v3, s[48:51], s81 offen offset:2560 sc1
    s_mul_i32 s81, s34, 10
    s_add_u32 s81, s81, s75
    buffer_load_dwordx4 v[72:75], v2, s[48:51], s81 offen offset:0 sc1
    buffer_load_dwordx4 v[76:79], v2, s[48:51], s81 offen offset:1280 sc1
    buffer_load_dwordx4 v[80:83], v2, s[48:51], s81 offen offset:2560 sc1
    buffer_load_dwordx4 v[84:87], v2, s[48:51], s81 offen offset:3840 sc1
    buffer_load_dwordx2 v[88:89], v3, s[48:51], s81 offen sc1
    buffer_load_dwordx2 v[90:91], v3, s[48:51], s81 offen offset:2560 sc1
    s_mul_i32 s81, s35, 10
    s_add_u32 s81, s81, s75
    buffer_load_dwordx4 v[92:95], v2, s[48:51], s81 offen offset:0 sc1
    buffer_load_dwordx4 v[96:99], v2, s[48:51], s81 offen offset:1280 sc1
    buffer_load_dwordx4 v[100:103], v2, s[48:51], s81 offen offset:2560 sc1
    buffer_load_dwordx4 v[104:107], v2, s[48:51], s81 offen offset:3840 sc1
    buffer_load_dwordx2 v[108:109], v3, s[48:51], s81 offen sc1
    buffer_load_dwordx2 v[110:111], v3, s[48:51], s81 offen offset:2560 sc1
    s_add_u32 s81, s74, 0x0
    buffer_load_dwordx4 a[16:19], v1, s[48:51], s81 offen sc1
    s_add_u32 s81, s74, 0x41000
    buffer_load_dwordx4 a[36:39], v1, s[48:51], s81 offen sc1
    s_add_u32 s81, s74, 0x82000
    buffer_load_dwordx4 a[56:59], v1, s[48:51], s81 offen sc1
    s_add_u32 s81, s74, 0xc3000
    buffer_load_dwordx4 a[76:79], v1, s[48:51], s81 offen sc1
    s_add_u32 s81, s74, 0x104000
    buffer_load_dwordx4 a[96:99], v1, s[48:51], s81 offen sc1
    s_add_u32 s81, s73, 0x0
    buffer_load_dwordx4 a[0:3], v1, s[48:51], s81 offen offset:0 sc1
    buffer_load_dwordx4 a[4:7], v1, s[48:51], s81 offen offset:1024 sc1
    buffer_load_dwordx4 a[8:11], v1, s[48:51], s81 offen offset:2048 sc1
    buffer_load_dwordx4 a[12:15], v1, s[48:51], s81 offen offset:3072 sc1
    s_add_u32 s81, s73, 0x101000
    buffer_load_dwordx4 a[20:23], v1, s[48:51], s81 offen offset:0 sc1
    buffer_load_dwordx4 a[24:27], v1, s[48:51], s81 offen offset:1024 sc1
    buffer_load_dwordx4 a[28:31], v1, s[48:51], s81 offen offset:2048 sc1
    buffer_load_dwordx4 a[32:35], v1, s[48:51], s81 offen offset:3072 sc1
    s_add_u32 s81, s73, 0x202000
    buffer_load_dwordx4 a[40:43], v1, s[48:51], s81 offen offset:0 sc1
    buffer_load_dwordx4 a[44:47], v1, s[48:51], s81 offen offset:1024 sc1
    buffer_load_dwordx4 a[48:51], v1, s[48:51], s81 offen offset:2048 sc1
    buffer_load_dwordx4 a[52:55], v1, s[48:51], s81 offen offset:3072 sc1
    s_add_u32 s81, s73, 0x303000
    buffer_load_dwordx4 a[60:63], v1, s[48:51], s81 offen offset:0 sc1
    buffer_load_dwordx4 a[64:67], v1, s[48:51], s81 offen offset:1024 sc1
    buffer_load_dwordx4 a[68:71], v1, s[48:51], s81 offen offset:2048 sc1
    buffer_load_dwordx4 a[72:75], v1, s[48:51], s81 offen offset:3072 sc1
    s_add_u32 s81, s73, 0x404000
    buffer_load_dwordx4 a[80:83], v1, s[48:51], s81 offen offset:0 sc1
    buffer_load_dwordx4 a[84:87], v1, s[48:51], s81 offen offset:1024 sc1
    buffer_load_dwordx4 a[88:91], v1, s[48:51], s81 offen offset:2048 sc1
    buffer_load_dwordx4 a[92:95], v1, s[48:51], s81 offen offset:3072 sc1
    buffer_load_dword v215, v7, s[48:51], s77 offen
    buffer_load_dword v215, v7, s[48:51], s77 offen
    buffer_load_dword v215, v7, s[48:51], s77 offen
    buffer_load_dword v215, v7, s[48:51], s77 offen
    buffer_load_dword v215, v7, s[48:51], s77 offen
L_pr_top_36:
    v_add_u32 v8, s32, v4
    v_add_u32 v9, s33, v4
    v_add_u32 v10, s34, v4
    v_add_u32 v11, s35, v4
    s_waitcnt vmcnt(21)
    v_mov_b32 v192, v204
    v_mov_b32 v193, v205
    v_mov_b32 v194, v206
    v_mov_b32 v195, v207
    v_mov_b32 v196, v208
    v_mov_b32 v197, v209
    v_mov_b32 v198, v210
    v_mov_b32 v199, v211
    v_mov_b32 v200, v212
    v_mov_b32 v201, v213
    v_mov_b32 v202, v214
    s_mov_b32 s86, s76
    s_mov_b32 s87, s82
    s_add_u32 s82, s82, s10
    s_cmp_ge_u32 s82, s12
    s_cselect_b32 s80, 24, 0
    s_cselect_b32 s12, 999, s12
    s_add_u32 s82, s82, s80
    v_mfma_f32_16x16x32_bf16 v[112:115], a[0:3], v[32:35], 0
    v_mfma_f32_16x16x32_bf16 v[116:119], a[0:3], v[52:55], 0
    v_mfma_f32_16x16x32_bf16 v[120:123], a[0:3], v[72:75], 0
    v_mfma_f32_16x16x32_bf16 v[124:127], a[0:3], v[92:95], 0
    v_mfma_f32_16x16x32_bf16 v[112:115], a[4:7], v[36:39], v[112:115]
    v_mfma_f32_16x16x32_bf16 v[116:119], a[4:7], v[56:59], v[116:119]
    v_mfma_f32_16x16x32_bf16 v[120:123], a[4:7], v[76:79], v[120:123]
    v_mfma_f32_16x16x32_bf16 v[124:127], a[4:7], v[96:99], v[124:127]
    v_mfma_f32_16x16x32_bf16 v[112:115], a[8:11], v[40:43], v[112:115]
    v_mfma_f32_16x16x32_bf16 v[116:119], a[8:11], v[60:63], v[116:119]
    v_mfma_f32_16x16x32_bf16 v[120:123], a[8:11], v[80:83], v[120:123]
    v_mfma_f32_16x16x32_bf16 v[124:127], a[8:11], v[100:103], v[124:127]
    v_mfma_f32_16x16x32_bf16 v[112:115], a[12:15], v[44:47], v[112:115]
    v_mfma_f32_16x16x32_bf16 v[116:119], a[12:15], v[64:67], v[116:119]
    v_mfma_f32_16x16x32_bf16 v[120:123], a[12:15], v[84:87], v[120:123]
    v_mfma_f32_16x16x32_bf16 v[124:127], a[12:15], v[104:107], v[124:127]
    v_mfma_f32_16x16x32_bf16 v[112:115], a[16:19], v[48:51], v[112:115]
    v_mfma_f32_16x16x32_bf16 v[116:119], a[16:19], v[68:71], v[116:119]
    v_mfma_f32_16x16x32_bf16 v[120:123], a[16:19], v[88:91], v[120:123]
    v_mfma_f32_16x16x32_bf16 v[124:127], a[16:19], v[108:111], v[124:127]
    s_waitcnt vmcnt(17)
    v_mfma_f32_16x16x32_bf16 v[128:131], a[20:23], v[32:35], 0
    v_mfma_f32_16x16x32_bf16 v[132:135], a[20:23], v[52:55], 0
    v_mfma_f32_16x16x32_bf16 v[136:139], a[20:23], v[72:75], 0
    v_mfma_f32_16x16x32_bf16 v[140:143], a[20:23], v[92:95], 0
    v_mfma_f32_16x16x32_bf16 v[128:131], a[24:27], v[36:39], v[128:131]
    v_mfma_f32_16x16x32_bf16 v[132:135], a[24:27], v[56:59], v[132:135]
    v_mfma_f32_16x16x32_bf16 v[136:139], a[24:27], v[76:79], v[136:139]
    v_mfma_f32_16x16x32_bf16 v[140:143], a[24:27], v[96:99], v[140:143]
    v_mfma_f32_16x16x32_bf16 v[128:131], a[28:31], v[40:43], v[128:131]
    v_mfma_f32_16x16x32_bf16 v[132:135], a[28:31], v[60:63], v[132:135]
    v_mfma_f32_16x16x32_bf16 v[136:139], a[28:31], v[80:83], v[136:139]
    v_mfma_f32_16x16x32_bf16 v[140:143], a[28:31], v[100:103], v[140:143]
    v_mfma_f32_16x16x32_bf16 v[128:131], a[32:35], v[44:47], v[128:131]
    v_mfma_f32_16x16x32_bf16 v[132:135], a[32:35], v[64:67], v[132:135]
    v_mfma_f32_16x16x32_bf16 v[136:139], a[32:35], v[84:87], v[136:139]
    v_mfma_f32_16x16x32_bf16 v[140:143], a[32:35], v[104:107], v[140:143]
    v_mfma_f32_16x16x32_bf16 v[128:131], a[36:39], v[48:51], v[128:131]
    v_mfma_f32_16x16x32_bf16 v[132:135], a[36:39], v[68:71], v[132:135]
    v_mfma_f32_16x16x32_bf16 v[136:139], a[36:39], v[88:91], v[136:139]
    v_mfma_f32_16x16x32_bf16 v[140:143], a[36:39], v[108:111], v[140:143]
    s_waitcnt vmcnt(13)
    v_mfma_f32_16x16x32_bf16 v[144:147], a[40:43], v[32:35], 0
    v_mfma_f32_16x16x32_bf16 v[148:151], a[40:43], v[52:55], 0
    v_mfma_f32_16x16x32_bf16 v[152:155], a[40:43], v[72:75], 0
    v_mfma_f32_16x16x32_bf16 v[156:159], a[40:43], v[92:95], 0
    v_mfma_f32_16x16x32_bf16 v[144:147], a[44:47], v[36:39], v[144:147]
    v_mfma_f32_16x16x32_bf16 v[148:151], a[44:47], v[56:59], v[148:151]
    v_mfma_f32_16x16x32_bf16 v[152:155], a[44:47], v[76:79], v[152:155]
    v_mfma_f32_16x16x32_bf16 v[156:159], a[44:47], v[96:99], v[156:159]
    v_mfma_f32_16x16x32_bf16 v[144:147], a[48:51], v[40:43], v[144:147]
    v_mfma_f32_16x16x32_bf16 v[148:151], a[48:51], v[60:63], v[148:151]
    v_mfma_f32_16x16x32_bf16 v[152:155], a[48:51], v[80:83], v[152:155]
    v_mfma_f32_16x16x32_bf16 v[156:159], a[48:51], v[100:103], v[156:159]
    v_mfma_f32_16x16x32_bf16 v[144:147], a[52:55], v[44:47], v[144:147]
    v_mfma_f32_16x16x32_bf16 v[148:151], a[52:55], v[64:67], v[148:151]
    v_mfma_f32_16x16x32_bf16 v[152:155], a[52:55], v[84:87], v[152:155]
    v_mfma_f32_16x16x32_bf16 v[156:159], a[52:55], v[104:107], v[156:159]
    v_mfma_f32_16x16x32_bf16 v[144:147], a[56:59], v[48:51], v[144:147]
    v_mfma_f32_16x16x32_bf16 v[148:151], a[56:59], v[68:71], v[148:151]
    v_mfma_f32_16x16x32_bf16 v[152:155], a[56:59], v[88:91], v[152:155]
    v_mfma_f32_16x16x32_bf16 v[156:159], a[56:59], v[108:111], v[156:159]
    s_waitcnt vmcnt(9)
    v_mfma_f32_16x16x32_bf16 v[160:163], a[60:63], v[32:35], 0
    v_mfma_f32_16x16x32_bf16 v[164:167], a[60:63], v[52:55], 0
    v_mfma_f32_16x16x32_bf16 v[168:171], a[60:63], v[72:75], 0
    v_mfma_f32_16x16x32_bf16 v[172:175], a[60:63], v[92:95], 0
    v_mfma_f32_16x16x32_bf16 v[160:163], a[64:67], v[36:39], v[160:163]
    v_mfma_f32_16x16x32_bf16 v[164:167], a[64:67], v[56:59], v[164:167]
    v_mfma_f32_16x16x32_bf16 v[168:171], a[64:67], v[76:79], v[168:171]
    v_mfma_f32_16x16x32_bf16 v[172:175], a[64:67], v[96:99], v[172:175]
    v_mfma_f32_16x16x32_bf16 v[160:163], a[68:71], v[40:43], v[160:163]
    v_mfma_f32_16x16x32_bf16 v[164:167], a[68:71], v[60:63], v[164:167]
    v_mfma_f32_16x16x32_bf16 v[168:171], a[68:71], v[80:83], v[168:171]
    v_mfma_f32_16x16x32_bf16 v[172:175], a[68:71], v[100:103], v[172:175]
    v_mfma_f32_16x16x32_bf16 v[160:163], a[72:75], v[44:47], v[160:163]
    v_mfma_f32_16x16x32_bf16 v[164:167], a[72:75], v[64:67], v[164:167]
    v_mfma_f32_16x16x32_bf16 v[168:171], a[72:75], v[84:87], v[168:171]
    v_mfma_f32_16x16x32_bf16 v[172:175], a[72:75], v[104:107], v[172:175]
    v_mfma_f32_16x16x32_bf16 v[160:163], a[76:79], v[48:51], v[160:163]
    v_mfma_f32_16x16x32_bf16 v[164:167], a[76:79], v[68:71], v[164:167]
    v_mfma_f32_16x16x32_bf16 v[168:171], a[76:79], v[88:91], v[168:171]
    v_mfma_f32_16x16x32_bf16 v[172:175], a[76:79], v[108:111], v[172:175]
    s_waitcnt vmcnt(5)
    v_mfma_f32_16x16x32_bf16 v[176:179], a[80:83], v[32:35], 0
    v_mfma_f32_16x16x32_bf16 v[180:183], a[80:83], v[52:55], 0
    v_mfma_f32_16x16x32_bf16 v[184:187], a[80:83], v[72:75], 0
    v_mfma_f32_16x16x32_bf16 v[188:191], a[80:83], v[92:95], 0
    v_mfma_f32_16x16x32_bf16 v[176:179], a[84:87], v[36:39], v[176:179]
    v_mfma_f32_16x16x32_bf16 v[180:183], a[84:87], v[56:59], v[180:183]
    v_mfma_f32_16x16x32_bf16 v[184:187], a[84:87], v[76:79], v[184:187]
    v_mfma_f32_16x16x32_bf16 v[188:191], a[84:87], v[96:99], v[188:191]
    v_mfma_f32_16x16x32_bf16 v[176:179], a[88:91], v[40:43], v[176:179]
    v_mfma_f32_16x16x32_bf16 v[180:183], a[88:91], v[60:63], v[180:183]
    v_mfma_f32_16x16x32_bf16 v[184:187], a[88:91], v[80:83], v[184:187]
    v_mfma_f32_16x16x32_bf16 v[188:191], a[88:91], v[100:103], v[188:191]
    v_mfma_f32_16x16x32_bf16 v[176:179], a[92:95], v[44:47], v[176:179]
    v_mfma_f32_16x16x32_bf16 v[180:183], a[92:95], v[64:67], v[180:183]
    v_mfma_f32_16x16x32_bf16 v[184:187], a[92:95], v[84:87], v[184:187]
    v_mfma_f32_16x16x32_bf16 v[188:191], a[92:95], v[104:107], v[188:191]
    v_mfma_f32_16x16x32_bf16 v[176:179], a[96:99], v[48:51], v[176:179]
    v_mfma_f32_16x16x32_bf16 v[180:183], a[96:99], v[68:71], v[180:183]
    v_mfma_f32_16x16x32_bf16 v[184:187], a[96:99], v[88:91], v[184:187]
    v_mfma_f32_16x16x32_bf16 v[188:191], a[96:99], v[108:111], v[188:191]
    s_barrier
    s_mov_b64 exec, s[4:5]
    s_nop 2
    ds_write_b128 v8, v[112:115] offset:0
    ds_write_b128 v9, v[116:119] offset:0
    ds_write_b128 v10, v[120:123] offset:0
    ds_write_b128 v11, v[124:127] offset:0
    ds_write_b128 v8, v[128:131] offset:8192
    ds_write_b128 v9, v[132:135] offset:8192
    ds_write_b128 v10, v[136:139] offset:8192
    ds_write_b128 v11, v[140:143] offset:8192
    ds_write_b128 v8, v[144:147] offset:16384
    ds_write_b128 v9, v[148:151] offset:16384
    ds_write_b128 v10, v[152:155] offset:16384
    ds_write_b128 v11, v[156:159] offset:16384
    ds_write_b128 v8, v[160:163] offset:24576
    ds_write_b128 v9, v[164:167] offset:24576
    ds_write_b128 v10, v[168:171] offset:24576
    ds_write_b128 v11, v[172:175] offset:24576
    ds_write_b128 v8, v[176:179] offset:32768
    ds_write_b128 v9, v[180:183] offset:32768
    ds_write_b128 v10, v[184:187] offset:32768
    ds_write_b128 v11, v[188:191] offset:32768
    s_mov_b64 exec, -1
    s_bitcmp1_b64 s[8:9], s87
    s_cbranch_scc0 L_pr_nosel_37
    s_lshl_b32 s80, s87, 2
    s_add_u32 s80, s80, s64
    s_lshl_b32 s80, s80, 3
    v_lshrrev_b32 v12, 3, v0
    v_add_u32 v12, s80, v12
    v_mov_b32 v13, -1
    v_cmp_eq_u32 vcc, s20, v12
    v_mov_b32 v14, 0
    s_nop 0
    v_cndmask_b32 v13, v13, v14, vcc
    v_cmp_eq_u32 vcc, s21, v12
    v_mov_b32 v14, 1280
    s_nop 0
    v_cndmask_b32 v13, v13, v14, vcc
    v_cmp_eq_u32 vcc, s22, v12
    v_mov_b32 v14, 2560
    s_nop 0
    v_cndmask_b32 v13, v13, v14, vcc
    v_cmp_eq_u32 vcc, s23, v12
    v_mov_b32 v14, 3840
    s_nop 0
    v_cndmask_b32 v13, v13, v14, vcc
    v_cmp_eq_u32 vcc, s24, v12
    v_mov_b32 v14, 5120
    s_nop 0
    v_cndmask_b32 v13, v13, v14, vcc
    v_cmp_eq_u32 vcc, s25, v12
    v_mov_b32 v14, 6400
    s_nop 0
    v_cndmask_b32 v13, v13, v14, vcc
    v_cmp_eq_u32 vcc, s26, v12
    v_mov_b32 v14, 7680
    s_nop 0
    v_cndmask_b32 v13, v13, v14, vcc
    v_cmp_eq_u32 vcc, s27, v12
    v_mov_b32 v14, 8960
    s_nop 0
    v_cndmask_b32 v13, v13, v14, vcc
    v_cmp_ne_u32 vcc, -1, v13
    v_bfe_u32 v14, v0, 2, 1
    v_lshl_add_u32 v13, v14, 3, v13
    s_lshl_b32 s80, s84, 4
    s_add_u32 s80, s80, 0x612000
    s_and_saveexec_b64 s[28:29], vcc
    s_cbranch_execz L_pr_sk_38
    buffer_load_dwordx2 v[192:193], v13, s[48:51], s80 offen offset:0 sc1
    buffer_load_dwordx2 v[194:195], v13, s[48:51], s80 offen offset:16 sc1
    buffer_load_dwordx2 v[196:197], v13, s[48:51], s80 offen offset:32 sc1
    buffer_load_dwordx2 v[198:199], v13, s[48:51], s80 offen offset:48 sc1
    buffer_load_dwordx2 v[200:201], v13, s[48:51], s80 offen offset:64 sc1
    s_waitcnt vmcnt(0)
L_pr_sk_38:
    s_mov_b64 exec, -1
L_pr_nosel_37:
    s_cmp_ge_u32 s82, s11
    s_cbranch_scc1 L_pr_nonext_39
    s_mul_i32 s73, s84, 0x101000
    s_lshl_b32 s80, s82, 2
    s_add_u32 s80, s80, s64
    s_lshl_b32 s81, s80, 12
    s_add_u32 s73, s73, s81
    s_add_u32 s73, s73, 0x8100000
    s_mul_i32 s74, s84, 0x41000
    s_lshl_b32 s81, s80, 10
    s_add_u32 s74, s74, s81
    s_add_u32 s74, s74, 0x3a00000
    s_mul_i32 s76, s80, 10240
    s_lshl_b32 s81, s84, 4
    s_add_u32 s76, s76, s81
    s_lshl_b32 s77, s80, 5
    s_add_u32 s77, s77, 0x60a000
    s_mul_i32 s75, s82, 81920
    s_mul_i32 s81, s64, 5120
    s_add_u32 s75, s75, s81
    s_add_u32 s75, s75, 0xa00000
    s_add_u32 s79, s82, 1
    s_min_u32 s79, s79, 63
    s_mov_b32 s30, 0
    v_mov_b32 v217, v216
    buffer_load_dwordx2 v[204:205], v6, s[52:55], s76 offen offset:0
    buffer_load_dwordx2 v[206:207], v6, s[52:55], s76 offen offset:16
    buffer_load_dwordx2 v[208:209], v6, s[52:55], s76 offen offset:32
    buffer_load_dwordx2 v[210:211], v6, s[52:55], s76 offen offset:48
    buffer_load_dwordx2 v[212:213], v6, s[52:55], s76 offen offset:64
    buffer_load_dword v214, v7, s[48:51], s77 offen sc1
    s_cmp_lg_u32 s64, 1
    s_cbranch_scc1 L_pr_ok_45
    s_cmp_ge_u32 s78, s79
    s_cbranch_scc1 L_pr_hit_47
L_pr_fp_44:
    buffer_load_dword v12, v217, s[48:51], 0 offen sc1
    s_waitcnt vmcnt(0)
    s_nop 1
    v_min_u32_dpp v12, v12, v12 quad_perm:[1,0,3,2] row_mask:0xf bank_mask:0xf
    s_nop 1
    v_min_u32_dpp v12, v12, v12 quad_perm:[2,3,0,1] row_mask:0xf bank_mask:0xf
    s_nop 1
    v_min_u32_dpp v12, v12, v12 row_half_mirror row_mask:0xf bank_mask:0xf
    s_nop 1
    v_min_u32_dpp v12, v12, v12 row_mirror row_mask:0xf bank_mask:0xf
    s_nop 0
    v_readlane_b32 s78, v12, 0
    v_readlane_b32 s80, v12, 16
    v_readlane_b32 s81, v12, 32
    v_readlane_b32 s31, v12, 48
    s_min_u32 s78, s78, s80
    s_min_u32 s81, s81, s31
    s_min_u32 s78, s78, s81
    s_cmp_ge_u32 s78, s79
    s_cbranch_scc1 L_pr_hit_47
    s_sleep 4
    s_add_u32 s80, s78, 1
    s_cmp_ge_u32 s80, s79
    s_cbranch_scc1 L_pr_far_46
    s_sleep 64
L_pr_far_46:
    s_sub_u32 s67, s67, 1
    s_cbranch_scc1 K2_DONE
    s_branch L_pr_fp_44
L_pr_hit_47:
    s_cmp_lt_u32 s82, 62
    s_cbranch_scc1 L_pr_ok_45
    s_cmp_lg_u32 s30, 0
    s_cbranch_scc1 L_pr_ok_45
    s_mov_b32 s30, 1
    s_add_u32 s79, s82, 1
    v_mov_b32 v217, v203
    s_branch L_pr_fp_44
L_pr_ok_45:
    s_barrier
    s_mul_i32 s81, s32, 10
    s_add_u32 s81, s81, s75
    buffer_load_dwordx4 v[32:35], v2, s[48:51], s81 offen offset:0 sc1
    buffer_load_dwordx4 v[36:39], v2, s[48:51], s81 offen offset:1280 sc1
    buffer_load_dwordx4 v[40:43], v2, s[48:51], s81 offen offset:2560 sc1
    buffer_load_dwordx4 v[44:47], v2, s[48:51], s81 offen offset:3840 sc1
    buffer_load_dwordx2 v[48:49], v3, s[48:51], s81 offen sc1
    buffer_load_dwordx2 v[50:51], v3, s[48:51], s81 offen offset:2560 sc1
    s_mul_i32 s81, s33, 10
    s_add_u32 s81, s81, s75
    buffer_load_dwordx4 v[52:55], v2, s[48:51], s81 offen offset:0 sc1
    buffer_load_dwordx4 v[56:59], v2, s[48:51], s81 offen offset:1280 sc1
    buffer_load_dwordx4 v[60:63], v2, s[48:51], s81 offen offset:2560 sc1
    buffer_load_dwordx4 v[64:67], v2, s[48:51], s81 offen offset:3840 sc1
    buffer_load_dwordx2 v[68:69], v3, s[48:51], s81 offen sc1
    buffer_load_dwordx2 v[70:71], v3, s[48:51], s81 offen offset:2560 sc1
    s_mul_i32 s81, s34, 10
    s_add_u32 s81, s81, s75
    buffer_load_dwordx4 v[72:75], v2, s[48:51], s81 offen offset:0 sc1
    buffer_load_dwordx4 v[76:79], v2, s[48:51], s81 offen offset:1280 sc1
    buffer_load_dwordx4 v[80:83], v2, s[48:51], s81 offen offset:2560 sc1
    buffer_load_dwordx4 v[84:87], v2, s[48:51], s81 offen offset:3840 sc1
    buffer_load_dwordx2 v[88:89], v3, s[48:51], s81 offen sc1
    buffer_load_dwordx2 v[90:91], v3, s[48:51], s81 offen offset:2560 sc1
    s_mul_i32 s81, s35, 10
    s_add_u32 s81, s81, s75
    buffer_load_dwordx4 v[92:95], v2, s[48:51], s81 offen offset:0 sc1
    buffer_load_dwordx4 v[96:99], v2, s[48:51], s81 offen offset:1280 sc1
    buffer_load_dwordx4 v[100:103], v2, s[48:51], s81 offen offset:2560 sc1
    buffer_load_dwordx4 v[104:107], v2, s[48:51], s81 offen offset:3840 sc1
    buffer_load_dwordx2 v[108:109], v3, s[48:51], s81 offen sc1
    buffer_load_dwordx2 v[110:111], v3, s[48:51], s81 offen offset:2560 sc1
    s_add_u32 s81, s74, 0x0
    buffer_load_dwordx4 a[16:19], v1, s[48:51], s81 offen sc1
    s_add_u32 s81, s74, 0x41000
    buffer_load_dwordx4 a[36:39], v1, s[48:51], s81 offen sc1
    s_add_u32 s81, s74, 0x82000
    buffer_load_dwordx4 a[56:59], v1, s[48:51], s81 offen sc1
    s_add_u32 s81, s74, 0xc3000
    buffer_load_dwordx4 a[76:79], v1, s[48:51], s81 offen sc1
    s_add_u32 s81, s74, 0x104000
    buffer_load_dwordx4 a[96:99], v1, s[48:51], s81 offen sc1
    s_add_u32 s81, s73, 0x0
    buffer_load_dwordx4 a[0:3], v1, s[48:51], s81 offen offset:0 sc1
    buffer_load_dwordx4 a[4:7], v1, s[48:51], s81 offen offset:1024 sc1
    buffer_load_dwordx4 a[8:11], v1, s[48:51], s81 offen offset:2048 sc1
    buffer_load_dwordx4 a[12:15], v1, s[48:51], s81 offen offset:3072 sc1
    s_add_u32 s81, s73, 0x101000
    buffer_load_dwordx4 a[20:23], v1, s[48:51], s81 offen offset:0 sc1
    buffer_load_dwordx4 a[24:27], v1, s[48:51], s81 offen offset:1024 sc1
    buffer_load_dwordx4 a[28:31], v1, s[48:51], s81 offen offset:2048 sc1
    buffer_load_dwordx4 a[32:35], v1, s[48:51], s81 offen offset:3072 sc1
    s_add_u32 s81, s73, 0x202000
    buffer_load_dwordx4 a[40:43], v1, s[48:51], s81 offen offset:0 sc1
    buffer_load_dwordx4 a[44:47], v1, s[48:51], s81 offen offset:1024 sc1
    buffer_load_dwordx4 a[48:51], v1, s[48:51], s81 offen offset:2048 sc1
    buffer_load_dwordx4 a[52:55], v1, s[48:51], s81 offen offset:3072 sc1
    s_add_u32 s81, s73, 0x303000
    buffer_load_dwordx4 a[60:63], v1, s[48:51], s81 offen offset:0 sc1
    buffer_load_dwordx4 a[64:67], v1, s[48:51], s81 offen offset:1024 sc1
    buffer_load_dwordx4 a[68:71], v1, s[48:51], s81 offen offset:2048 sc1
    buffer_load_dwordx4 a[72:75], v1, s[48:51], s81 offen offset:3072 sc1
    s_add_u32 s81, s73, 0x404000
    buffer_load_dwordx4 a[80:83], v1, s[48:51], s81 offen offset:0 sc1
    buffer_load_dwordx4 a[84:87], v1, s[48:51], s81 offen offset:1024 sc1
    buffer_load_dwordx4 a[88:91], v1, s[48:51], s81 offen offset:2048 sc1
    buffer_load_dwordx4 a[92:95], v1, s[48:51], s81 offen offset:3072 sc1
L_pr_nonext_39:
    v_sub_f32 v28, 1.0, v202
    v_cvt_pk_bf16_f32 v28, v28, v28
    v_and_b32 v28, 0xffff0000, v28
    s_waitcnt lgkmcnt(0)
    s_barrier
    ds_read_b128 v[8:11], v5 offset:0
    ds_read_b128 v[12:15], v5 offset:1024
    s_waitcnt lgkmcnt(0)
    v_pk_add_f32 v[8:9], v[8:9], v[12:13]
    v_pk_add_f32 v[10:11], v[10:11], v[14:15]
    s_nop 0
    v_add_f32_dpp v8, v8, v8 quad_perm:[1,0,3,2] row_mask:0xf bank_mask:0xf
    v_add_f32_dpp v9, v9, v9 quad_perm:[1,0,3,2] row_mask:0xf bank_mask:0xf
    v_add_f32_dpp v10, v10, v10 quad_perm:[1,0,3,2] row_mask:0xf bank_mask:0xf
    v_add_f32_dpp v11, v11, v11 quad_perm:[1,0,3,2] row_mask:0xf bank_mask:0xf
    v_add_f32_dpp v8, v8, v8 quad_perm:[2,3,0,1] row_mask:0xf bank_mask:0xf
    v_add_f32_dpp v9, v9, v9 quad_perm:[2,3,0,1] row_mask:0xf bank_mask:0xf
    v_add_f32_dpp v10, v10, v10 quad_perm:[2,3,0,1] row_mask:0xf bank_mask:0xf
    v_add_f32_dpp v11, v11, v11 quad_perm:[2,3,0,1] row_mask:0xf bank_mask:0xf
    v_cvt_pk_bf16_f32 v12, v8, v9
    v_cvt_pk_bf16_f32 v13, v10, v11
    v_lshlrev_b32 v16, 16, v12
    v_and_b32 v17, 0xffff0000, v12
    v_lshlrev_b32 v18, 16, v192
    v_and_b32 v19, 0xffff0000, v192
    v_mul_f32 v16, v16, v202
    v_mul_f32 v17, v17, v202
    v_mul_f32 v18, v18, v28
    v_mul_f32 v19, v19, v28
    v_cvt_pk_bf16_f32 v16, v16, v17
    v_cvt_pk_bf16_f32 v18, v18, v19
    v_lshlrev_b32 v20, 16, v16
    v_and_b32 v21, 0xffff0000, v16
    v_lshlrev_b32 v22, 16, v18
    v_and_b32 v23, 0xffff0000, v18
    v_add_f32 v20, v20, v22
    v_add_f32 v21, v21, v23
    v_cvt_pk_bf16_f32 v112, v20, v21
    v_lshlrev_b32 v16, 16, v13
    v_and_b32 v17, 0xffff0000, v13
    v_lshlrev_b32 v18, 16, v193
    v_and_b32 v19, 0xffff0000, v193
    v_mul_f32 v16, v16, v202
    v_mul_f32 v17, v17, v202
    v_mul_f32 v18, v18, v28
    v_mul_f32 v19, v19, v28
    v_cvt_pk_bf16_f32 v16, v16, v17
    v_cvt_pk_bf16_f32 v18, v18, v19
    v_lshlrev_b32 v20, 16, v16
    v_and_b32 v21, 0xffff0000, v16
    v_lshlrev_b32 v22, 16, v18
    v_and_b32 v23, 0xffff0000, v18
    v_add_f32 v20, v20, v22
    v_add_f32 v21, v21, v23
    v_cvt_pk_bf16_f32 v113, v20, v21
    s_nop 1
    v_mov_b32_dpp v114, v112 row_shl:4 row_mask:0xf bank_mask:0xf
    v_mov_b32_dpp v115, v113 row_shl:4 row_mask:0xf bank_mask:0xf
    s_mov_b64 exec, s[6:7]
    buffer_store_dwordx4 v[112:115], v6, s[56:59], s86 offen offset:0
    s_mov_b64 exec, -1
    ds_read_b128 v[8:11], v5 offset:8192
    ds_read_b128 v[12:15], v5 offset:9216
    s_waitcnt lgkmcnt(0)
    v_pk_add_f32 v[8:9], v[8:9], v[12:13]
    v_pk_add_f32 v[10:11], v[10:11], v[14:15]
    s_nop 0
    v_add_f32_dpp v8, v8, v8 quad_perm:[1,0,3,2] row_mask:0xf bank_mask:0xf
    v_add_f32_dpp v9, v9, v9 quad_perm:[1,0,3,2] row_mask:0xf bank_mask:0xf
    v_add_f32_dpp v10, v10, v10 quad_perm:[1,0,3,2] row_mask:0xf bank_mask:0xf
    v_add_f32_dpp v11, v11, v11 quad_perm:[1,0,3,2] row_mask:0xf bank_mask:0xf
    v_add_f32_dpp v8, v8, v8 quad_perm:[2,3,0,1] row_mask:0xf bank_mask:0xf
    v_add_f32_dpp v9, v9, v9 quad_perm:[2,3,0,1] row_mask:0xf bank_mask:0xf
    v_add_f32_dpp v10, v10, v10 quad_perm:[2,3,0,1] row_mask:0xf bank_mask:0xf
    v_add_f32_dpp v11, v11, v11 quad_perm:[2,3,0,1] row_mask:0xf bank_mask:0xf
    v_cvt_pk_bf16_f32 v12, v8, v9
    v_cvt_pk_bf16_f32 v13, v10, v11
    v_lshlrev_b32 v16, 16, v12
    v_and_b32 v17, 0xffff0000, v12
    v_lshlrev_b32 v18, 16, v194
    v_and_b32 v19, 0xffff0000, v194
    v_mul_f32 v16, v16, v202
    v_mul_f32 v17, v17, v202
    v_mul_f32 v18, v18, v28
    v_mul_f32 v19, v19, v28
    v_cvt_pk_bf16_f32 v16, v16, v17
    v_cvt_pk_bf16_f32 v18, v18, v19
    v_lshlrev_b32 v20, 16, v16
    v_and_b32 v21, 0xffff0000, v16
    v_lshlrev_b32 v22, 16, v18
    v_and_b32 v23, 0xffff0000, v18
    v_add_f32 v20, v20, v22
    v_add_f32 v21, v21, v23
    v_cvt_pk_bf16_f32 v116, v20, v21
    v_lshlrev_b32 v16, 16, v13
    v_and_b32 v17, 0xffff0000, v13
    v_lshlrev_b32 v18, 16, v195
    v_and_b32 v19, 0xffff0000, v195
    v_mul_f32 v16, v16, v202
    v_mul_f32 v17, v17, v202
    v_mul_f32 v18, v18, v28
    v_mul_f32 v19, v19, v28
    v_cvt_pk_bf16_f32 v16, v16, v17
    v_cvt_pk_bf16_f32 v18, v18, v19
    v_lshlrev_b32 v20, 16, v16
    v_and_b32 v21, 0xffff0000, v16
    v_lshlrev_b32 v22, 16, v18
    v_and_b32 v23, 0xffff0000, v18
    v_add_f32 v20, v20, v22
    v_add_f32 v21, v21, v23
    v_cvt_pk_bf16_f32 v117, v20, v21
    s_nop 1
    v_mov_b32_dpp v118, v116 row_shl:4 row_mask:0xf bank_mask:0xf
    v_mov_b32_dpp v119, v117 row_shl:4 row_mask:0xf bank_mask:0xf
    s_mov_b64 exec, s[6:7]
    buffer_store_dwordx4 v[116:119], v6, s[56:59], s86 offen offset:16
    s_mov_b64 exec, -1
    ds_read_b128 v[8:11], v5 offset:16384
    ds_read_b128 v[12:15], v5 offset:17408
    s_waitcnt lgkmcnt(0)
    v_pk_add_f32 v[8:9], v[8:9], v[12:13]
    v_pk_add_f32 v[10:11], v[10:11], v[14:15]
    s_nop 0
    v_add_f32_dpp v8, v8, v8 quad_perm:[1,0,3,2] row_mask:0xf bank_mask:0xf
    v_add_f32_dpp v9, v9, v9 quad_perm:[1,0,3,2] row_mask:0xf bank_mask:0xf
    v_add_f32_dpp v10, v10, v10 quad_perm:[1,0,3,2] row_mask:0xf bank_mask:0xf
    v_add_f32_dpp v11, v11, v11 quad_perm:[1,0,3,2] row_mask:0xf bank_mask:0xf
    v_add_f32_dpp v8, v8, v8 quad_perm:[2,3,0,1] row_mask:0xf bank_mask:0xf
    v_add_f32_dpp v9, v9, v9 quad_perm:[2,3,0,1] row_mask:0xf bank_mask:0xf
    v_add_f32_dpp v10, v10, v10 quad_perm:[2,3,0,1] row_mask:0xf bank_mask:0xf
    v_add_f32_dpp v11, v11, v11 quad_perm:[2,3,0,1] row_mask:0xf bank_mask:0xf
    v_cvt_pk_bf16_f32 v12, v8, v9
    v_cvt_pk_bf16_f32 v13, v10, v11
    v_lshlrev_b32 v16, 16, v12
    v_and_b32 v17, 0xffff0000, v12
    v_lshlrev_b32 v18, 16, v196
    v_and_b32 v19, 0xffff0000, v196
    v_mul_f32 v16, v16, v202
    v_mul_f32 v17, v17, v202
    v_mul_f32 v18, v18, v28
    v_mul_f32 v19, v19, v28
    v_cvt_pk_bf16_f32 v16, v16, v17
    v_cvt_pk_bf16_f32 v18, v18, v19
    v_lshlrev_b32 v20, 16, v16
    v_and_b32 v21, 0xffff0000, v16
    v_lshlrev_b32 v22, 16, v18
    v_and_b32 v23, 0xffff0000, v18
    v_add_f32 v20, v20, v22
    v_add_f32 v21, v21, v23
    v_cvt_pk_bf16_f32 v120, v20, v21
    v_lshlrev_b32 v16, 16, v13
    v_and_b32 v17, 0xffff0000, v13
    v_lshlrev_b32 v18, 16, v197
    v_and_b32 v19, 0xffff0000, v197
    v_mul_f32 v16, v16, v202
    v_mul_f32 v17, v17, v202
    v_mul_f32 v18, v18, v28
    v_mul_f32 v19, v19, v28
    v_cvt_pk_bf16_f32 v16, v16, v17
    v_cvt_pk_bf16_f32 v18, v18, v19
    v_lshlrev_b32 v20, 16, v16
    v_and_b32 v21, 0xffff0000, v16
    v_lshlrev_b32 v22, 16, v18
    v_and_b32 v23, 0xffff0000, v18
    v_add_f32 v20, v20, v22
    v_add_f32 v21, v21, v23
    v_cvt_pk_bf16_f32 v121, v20, v21
    s_nop 1
    v_mov_b32_dpp v122, v120 row_shl:4 row_mask:0xf bank_mask:0xf
    v_mov_b32_dpp v123, v121 row_shl:4 row_mask:0xf bank_mask:0xf
    s_mov_b64 exec, s[6:7]
    buffer_store_dwordx4 v[120:123], v6, s[56:59], s86 offen offset:32
    s_mov_b64 exec, -1
    ds_read_b128 v[8:11], v5 offset:24576
    ds_read_b128 v[12:15], v5 offset:25600
    s_waitcnt lgkmcnt(0)
    v_pk_add_f32 v[8:9], v[8:9], v[12:13]
    v_pk_add_f32 v[10:11], v[10:11], v[14:15]
    s_nop 0
    v_add_f32_dpp v8, v8, v8 quad_perm:[1,0,3,2] row_mask:0xf bank_mask:0xf
    v_add_f32_dpp v9, v9, v9 quad_perm:[1,0,3,2] row_mask:0xf bank_mask:0xf
    v_add_f32_dpp v10, v10, v10 quad_perm:[1,0,3,2] row_mask:0xf bank_mask:0xf
    v_add_f32_dpp v11, v11, v11 quad_perm:[1,0,3,2] row_mask:0xf bank_mask:0xf
    v_add_f32_dpp v8, v8, v8 quad_perm:[2,3,0,1] row_mask:0xf bank_mask:0xf
    v_add_f32_dpp v9, v9, v9 quad_perm:[2,3,0,1] row_mask:0xf bank_mask:0xf
    v_add_f32_dpp v10, v10, v10 quad_perm:[2,3,0,1] row_mask:0xf bank_mask:0xf
    v_add_f32_dpp v11, v11, v11 quad_perm:[2,3,0,1] row_mask:0xf bank_mask:0xf
    v_cvt_pk_bf16_f32 v12, v8, v9
    v_cvt_pk_bf16_f32 v13, v10, v11
    v_lshlrev_b32 v16, 16, v12
    v_and_b32 v17, 0xffff0000, v12
    v_lshlrev_b32 v18, 16, v198
    v_and_b32 v19, 0xffff0000, v198
    v_mul_f32 v16, v16, v202
    v_mul_f32 v17, v17, v202
    v_mul_f32 v18, v18, v28
    v_mul_f32 v19, v19, v28
    v_cvt_pk_bf16_f32 v16, v16, v17
    v_cvt_pk_bf16_f32 v18, v18, v19
    v_lshlrev_b32 v20, 16, v16
    v_and_b32 v21, 0xffff0000, v16
    v_lshlrev_b32 v22, 16, v18
    v_and_b32 v23, 0xffff0000, v18
    v_add_f32 v20, v20, v22
    v_add_f32 v21, v21, v23
    v_cvt_pk_bf16_f32 v124, v20, v21
    v_lshlrev_b32 v16, 16, v13
    v_and_b32 v17, 0xffff0000, v13
    v_lshlrev_b32 v18, 16, v199
    v_and_b32 v19, 0xffff0000, v199
    v_mul_f32 v16, v16, v202
    v_mul_f32 v17, v17, v202
    v_mul_f32 v18, v18, v28
    v_mul_f32 v19, v19, v28
    v_cvt_pk_bf16_f32 v16, v16, v17
    v_cvt_pk_bf16_f32 v18, v18, v19
    v_lshlrev_b32 v20, 16, v16
    v_and_b32 v21, 0xffff0000, v16
    v_lshlrev_b32 v22, 16, v18
    v_and_b32 v23, 0xffff0000, v18
    v_add_f32 v20, v20, v22
    v_add_f32 v21, v21, v23
    v_cvt_pk_bf16_f32 v125, v20, v21
    s_nop 1
    v_mov_b32_dpp v126, v124 row_shl:4 row_mask:0xf bank_mask:0xf
    v_mov_b32_dpp v127, v125 row_shl:4 row_mask:0xf bank_mask:0xf
    s_mov_b64 exec, s[6:7]
    buffer_store_dwordx4 v[124:127], v6, s[56:59], s86 offen offset:48
    s_mov_b64 exec, -1
    ds_read_b128 v[8:11], v5 offset:32768
    ds_read_b128 v[12:15], v5 offset:33792
    s_waitcnt lgkmcnt(0)
    v_pk_add_f32 v[8:9], v[8:9], v[12:13]
    v_pk_add_f32 v[10:11], v[10:11], v[14:15]
    s_nop 0
    v_add_f32_dpp v8, v8, v8 quad_perm:[1,0,3,2] row_mask:0xf bank_mask:0xf
    v_add_f32_dpp v9, v9, v9 quad_perm:[1,0,3,2] row_mask:0xf bank_mask:0xf
    v_add_f32_dpp v10, v10, v10 quad_perm:[1,0,3,2] row_mask:0xf bank_mask:0xf
    v_add_f32_dpp v11, v11, v11 quad_perm:[1,0,3,2] row_mask:0xf bank_mask:0xf
    v_add_f32_dpp v8, v8, v8 quad_perm:[2,3,0,1] row_mask:0xf bank_mask:0xf
    v_add_f32_dpp v9, v9, v9 quad_perm:[2,3,0,1] row_mask:0xf bank_mask:0xf
    v_add_f32_dpp v10, v10, v10 quad_perm:[2,3,0,1] row_mask:0xf bank_mask:0xf
    v_add_f32_dpp v11, v11, v11 quad_perm:[2,3,0,1] row_mask:0xf bank_mask:0xf
    v_cvt_pk_bf16_f32 v12, v8, v9
    v_cvt_pk_bf16_f32 v13, v10, v11
    v_lshlrev_b32 v16, 16, v12
    v_and_b32 v17, 0xffff0000, v12
    v_lshlrev_b32 v18, 16, v200
    v_and_b32 v19, 0xffff0000, v200
    v_mul_f32 v16, v16, v202
    v_mul_f32 v17, v17, v202
    v_mul_f32 v18, v18, v28
    v_mul_f32 v19, v19, v28
    v_cvt_pk_bf16_f32 v16, v16, v17
    v_cvt_pk_bf16_f32 v18, v18, v19
    v_lshlrev_b32 v20, 16, v16
    v_and_b32 v21, 0xffff0000, v16
    v_lshlrev_b32 v22, 16, v18
    v_and_b32 v23, 0xffff0000, v18
    v_add_f32 v20, v20, v22
    v_add_f32 v21, v21, v23
    v_cvt_pk_bf16_f32 v128, v20, v21
    v_lshlrev_b32 v16, 16, v13
    v_and_b32 v17, 0xffff0000, v13
    v_lshlrev_b32 v18, 16, v201
    v_and_b32 v19, 0xffff0000, v201
    v_mul_f32 v16, v16, v202
    v_mul_f32 v17, v17, v202
    v_mul_f32 v18, v18, v28
    v_mul_f32 v19, v19, v28
    v_cvt_pk_bf16_f32 v16, v16, v17
    v_cvt_pk_bf16_f32 v18, v18, v19
    v_lshlrev_b32 v20, 16, v16
    v_and_b32 v21, 0xffff0000, v16
    v_lshlrev_b32 v22, 16, v18
    v_and_b32 v23, 0xffff0000, v18
    v_add_f32 v20, v20, v22
    v_add_f32 v21, v21, v23
    v_cvt_pk_bf16_f32 v129, v20, v21
    s_nop 1
    v_mov_b32_dpp v130, v128 row_shl:4 row_mask:0xf bank_mask:0xf
    v_mov_b32_dpp v131, v129 row_shl:4 row_mask:0xf bank_mask:0xf
    s_mov_b64 exec, s[6:7]
    buffer_store_dwordx4 v[128:131], v6, s[56:59], s86 offen offset:64
    s_mov_b64 exec, -1
    s_cmp_ge_u32 s82, s11
    s_cbranch_scc1 K2_PR5E
    s_branch L_pr_top_36
K2_PR5E:
    s_cmp_lt_u32 s65, 192
    s_cbranch_scc1 K2_PR1
    s_branch K2_DONE
K2_A:
    s_mov_b32 s72, s65
    s_mov_b32 s3, -1
    s_cmp_eq_u32 s15, 2
    s_cselect_b32 s3, 0, s3
    s_cmp_eq_u32 s15, 126
    s_cselect_b32 s3, 4, s3
    v_lshrrev_b32 v1, 3, v0
    v_and_b32 v2, 7, v0
    s_and_b32 s92, s64, 1
    s_lshl_b32 s93, s92, 2
    v_xor_b32 v3, s93, v1
    s_lshr_b32 s94, s64, 1
    s_lshl_b32 s94, s94, 4
    s_add_u32 s94, s94, s93
    v_bfe_u32 v4, v3, 1, 1
    v_lshlrev_b32 v4, 3, v4
    v_lshrrev_b32 v5, 2, v3
    v_lshl_add_u32 v4, v5, 1, v4
    v_and_b32 v5, 1, v3
    v_add3_u32 v4, v4, v5, s94
    s_mov_b32 s94, 12288
    v_mul_lo_u32 v4, v4, s94
    v_lshrrev_b32 v5, 1, v2
    v_bfe_u32 v6, v1, 1, 2
    v_xor_b32 v5, v5, v6
    v_lshl_add_u32 v4, v5, 5, v4
    v_and_b32 v5, 1, v2
    v_lshl_add_u32 v136, v5, 4, v4
    v_lshrrev_b32 v1, 4, v0
    v_bfe_u32 v2, v0, 2, 2
    v_lshl_add_u32 v2, v1, 3, v2
    v_and_b32 v1, 1, v1
    v_lshlrev_b32 v1, 2, v1
    v_xor_b32 v2, v2, v1
    v_bfe_u32 v3, v2, 1, 2
    v_and_b32 v4, 3, v0
    v_lshlrev_b32 v4, 3, v4
    v_lshl_add_u32 v4, v2, 7, v4
    v_lshl_add_u32 v137, v3, 5, v4
    v_xor_b32 v138, 0x240, v137
    s_mul_i32 s95, s64, 3
    s_add_u32 s92, s95, 0
    s_and_b32 s93, s92, 3
    s_lshl_b32 s93, s93, 5
    s_lshr_b32 s92, s92, 2
    s_lshl_b32 s92, s92, 12
    v_xor_b32 v139, s93, v137
    v_xor_b32 v140, s93, v138
    v_add_u32 v139, s92, v139
    v_add_u32 v140, s92, v140
    v_add_u32 v145, 73728, v139
    v_add_u32 v146, 73728, v140
    s_add_u32 s92, s95, 1
    s_and_b32 s93, s92, 3
    s_lshl_b32 s93, s93, 5
    s_lshr_b32 s92, s92, 2
    s_lshl_b32 s92, s92, 12
    v_xor_b32 v141, s93, v137
    v_xor_b32 v142, s93, v138
    v_add_u32 v141, s92, v141
    v_add_u32 v142, s92, v142
    v_add_u32 v147, 73728, v141
    v_add_u32 v148, 73728, v142
    s_add_u32 s92, s95, 2
    s_and_b32 s93, s92, 3
    s_lshl_b32 s93, s93, 5
    s_lshr_b32 s92, s92, 2
    s_lshl_b32 s92, s92, 12
    v_xor_b32 v143, s93, v137
    v_xor_b32 v144, s93, v138
    v_add_u32 v143, s92, v143
    v_add_u32 v144, s92, v144
    v_add_u32 v149, 73728, v143
    v_add_u32 v150, 73728, v144
    s_mul_i32 s10, s65, 384
    s_lshl_b32 s11, s64, 10
    s_mov_b32 s52, s20
    s_mov_b32 s53, s21
    s_mov_b32 s54, 0x780000
    s_mov_b32 s55, 0x20000
    s_add_u32 s92, s10, 0
    s_add_u32 m0, s11, 0
    s_nop 0
    buffer_load_dwordx4 v136, s[52:55], s92 offen lds
    s_add_u32 s92, s10, 128
    s_add_u32 m0, s11, 4096
    s_nop 0
    buffer_load_dwordx4 v136, s[52:55], s92 offen lds
    s_add_u32 s92, s10, 256
    s_add_u32 m0, s11, 8192
    s_nop 0
    buffer_load_dwordx4 v136, s[52:55], s92 offen lds
    s_add_u32 s92, s10, 393216
    s_add_u32 m0, s11, 12288
    s_nop 0
    buffer_load_dwordx4 v136, s[52:55], s92 offen lds
    s_add_u32 s92, s10, 393344
    s_add_u32 m0, s11, 16384
    s_nop 0
    buffer_load_dwordx4 v136, s[52:55], s92 offen lds
    s_add_u32 s92, s10, 393472
    s_add_u32 m0, s11, 20480
    s_nop 0
    buffer_load_dwordx4 v136, s[52:55], s92 offen lds
    s_add_u32 s92, s10, 786432
    s_add_u32 m0, s11, 24576
    s_nop 0
    buffer_load_dwordx4 v136, s[52:55], s92 offen lds
    s_add_u32 s92, s10, 786560
    s_add_u32 m0, s11, 28672
    s_nop 0
    buffer_load_dwordx4 v136, s[52:55], s92 offen lds
    s_add_u32 s92, s10, 786688
    s_add_u32 m0, s11, 32768
    s_nop 0
    buffer_load_dwordx4 v136, s[52:55], s92 offen lds
    s_add_u32 s92, s10, 1179648
    s_add_u32 m0, s11, 36864
    s_nop 0
    buffer_load_dwordx4 v136, s[52:55], s92 offen lds
    s_add_u32 s92, s10, 1179776
    s_add_u32 m0, s11, 40960
    s_nop 0
    buffer_load_dwordx4 v136, s[52:55], s92 offen lds
    s_add_u32 s92, s10, 1179904
    s_add_u32 m0, s11, 45056
    s_nop 0
    buffer_load_dwordx4 v136, s[52:55], s92 offen lds
    s_add_u32 s92, s10, 1572864
    s_add_u32 m0, s11, 49152
    s_nop 0
    buffer_load_dwordx4 v136, s[52:55], s92 offen lds
    s_add_u32 s92, s10, 1572992
    s_add_u32 m0, s11, 53248
    s_nop 0
    buffer_load_dwordx4 v136, s[52:55], s92 offen lds
    s_add_u32 s92, s10, 1573120
    s_add_u32 m0, s11, 57344
    s_nop 0
    buffer_load_dwordx4 v136, s[52:55], s92 offen lds
    s_add_u32 s92, s10, 1966080
    s_add_u32 m0, s11, 61440
    s_nop 0
    buffer_load_dwordx4 v136, s[52:55], s92 offen lds
    s_add_u32 s92, s10, 1966208
    s_add_u32 m0, s11, 65536
    s_nop 0
    buffer_load_dwordx4 v136, s[52:55], s92 offen lds
    s_add_u32 s92, s10, 1966336
    s_add_u32 m0, s11, 69632
    s_nop 0
    buffer_load_dwordx4 v136, s[52:55], s92 offen lds
    s_cmp_eq_u32 s64, 3
    s_cbranch_scc1 L_A_i4_51
    s_lshl_b32 s80, s64, 21
    s_lshl_b32 s81, s65, 16
    s_add_u32 s81, s81, 7680
    s_lshl_b32 s82, s65, 15
    s_add_u32 s82, s82, 0x5800
    s_cmp_eq_u32 s64, 0
    s_cselect_b32 s81, s82, s81
    s_add_u32 s80, s80, s81
    s_add_u32 s81, s80, 8192
    s_mov_b32 s82, -1
    s_mov_b32 s83, -1
    s_memtime s[74:75]
    s_waitcnt lgkmcnt(0)
    s_buffer_load_dword s78, s[48:51], s80 glc
    s_waitcnt lgkmcnt(0)
    s_memtime s[76:77]
    s_waitcnt lgkmcnt(0)
    s_sub_u32 s76, s76, s74
    s_min_u32 s82, s82, s76
    s_memtime s[74:75]
    s_waitcnt lgkmcnt(0)
    s_buffer_load_dword s78, s[48:51], s81 glc
    s_waitcnt lgkmcnt(0)
    s_memtime s[76:77]
    s_waitcnt lgkmcnt(0)
    s_sub_u32 s76, s76, s74
    s_min_u32 s83, s83, s76
    s_memtime s[74:75]
    s_waitcnt lgkmcnt(0)
    s_buffer_load_dword s78, s[48:51], s80 glc
    s_waitcnt lgkmcnt(0)
    s_memtime s[76:77]
    s_waitcnt lgkmcnt(0)
    s_sub_u32 s76, s76, s74
    s_min_u32 s82, s82, s76
    s_memtime s[74:75]
    s_waitcnt lgkmcnt(0)
    s_buffer_load_dword s78, s[48:51], s81 glc
    s_waitcnt lgkmcnt(0)
    s_memtime s[76:77]
    s_waitcnt lgkmcnt(0)
    s_sub_u32 s76, s76, s74
    s_min_u32 s83, s83, s76
    s_memtime s[74:75]
    s_waitcnt lgkmcnt(0)
    s_buffer_load_dword s78, s[48:51], s80 glc
    s_waitcnt lgkmcnt(0)
    s_memtime s[76:77]
    s_waitcnt lgkmcnt(0)
    s_sub_u32 s76, s76, s74
    s_min_u32 s82, s82, s76
    s_memtime s[74:75]
    s_waitcnt lgkmcnt(0)
    s_buffer_load_dword s78, s[48:51], s81 glc
    s_waitcnt lgkmcnt(0)
    s_memtime s[76:77]
    s_waitcnt lgkmcnt(0)
    s_sub_u32 s76, s76, s74
    s_min_u32 s83, s83, s76
    s_memtime s[74:75]
    s_waitcnt lgkmcnt(0)
    s_buffer_load_dword s78, s[48:51], s80 glc
    s_waitcnt lgkmcnt(0)
    s_memtime s[76:77]
    s_waitcnt lgkmcnt(0)
    s_sub_u32 s76, s76, s74
    s_min_u32 s82, s82, s76
    s_memtime s[74:75]
    s_waitcnt lgkmcnt(0)
    s_buffer_load_dword s78, s[48:51], s81 glc
    s_waitcnt lgkmcnt(0)
    s_memtime s[76:77]
    s_waitcnt lgkmcnt(0)
    s_sub_u32 s76, s76, s74
    s_min_u32 s83, s83, s76
    s_memtime s[74:75]
    s_waitcnt lgkmcnt(0)
    s_buffer_load_dword s78, s[48:51], s80 glc
    s_waitcnt lgkmcnt(0)
    s_memtime s[76:77]
    s_waitcnt lgkmcnt(0)
    s_sub_u32 s76, s76, s74
    s_min_u32 s82, s82, s76
    s_memtime s[74:75]
    s_waitcnt lgkmcnt(0)
    s_buffer_load_dword s78, s[48:51], s81 glc
    s_waitcnt lgkmcnt(0)
    s_memtime s[76:77]
    s_waitcnt lgkmcnt(0)
    s_sub_u32 s76, s76, s74
    s_min_u32 s83, s83, s76
L_A_i4_51:
    s_cmp_lg_u32 s64, 1
    s_cbranch_scc1 L_waok_53
    v_min_u32 v3, 0, v0
    v_lshlrev_b32 v3, 2, v3
    v_add_u32 v3, 0xa0, v3
L_wa_52:
    buffer_load_dword v2, v3, s[60:63], 0 offen sc1
    s_waitcnt vmcnt(0)
    v_cmp_gt_u32 vcc, 1, v2
    s_cbranch_vccz L_waok_53
    s_sleep 12
    s_sub_u32 s67, s67, 1
    s_cbranch_scc1 K2_DONE
    s_branch L_wa_52
L_waok_53:
    s_barrier
    s_cmp_eq_u32 s64, 3
    s_cbranch_scc1 L_A_i1_48
    s_cmp_lt_u32 s83, s82
    s_cselect_b32 s75, 1, 0
    s_bfe_u32 s74, s14, 0x10002
    s_xor_b32 s75, s75, s74
    s_add_u32 s75, s75, 0x100
    v_mov_b32 v2, s75
    s_lshl_b32 s76, s64, 2
    s_add_u32 s76, s76, 192
    v_mov_b32 v3, s76
    s_mov_b64 exec, 1
    buffer_atomic_add v2, v3, s[60:63], 0 offen sc1
    s_mov_b64 exec, -1
L_A_i1_48:
    s_cmp_eq_u32 s65, 4
    s_cselect_b32 s70, 63, s65
    s_cmp_gt_u32 s65, 4
    s_cbranch_scc1 L_A_i3_50
    v_lshlrev_b32 v10, 4, v0
    s_cmp_eq_u32 s70, 63
    s_cbranch_scc1 L_fill_last_54
    v_mov_b32 v12, -1
    v_mov_b32 v13, -1
    v_mov_b32 v14, -1
    v_mov_b32 v15, -1
    s_lshl_b32 s71, s70, 16
    s_lshl_b32 s72, s64, 14
    s_add_u32 s71, s71, s72
    s_add_u32 s71, s71, 0x200000
    s_add_u32 s72, s71, 0
    buffer_store_dwordx4 v[12:15], v10, s[48:51], s72 offen sc1
    s_add_u32 s72, s71, 1024
    buffer_store_dwordx4 v[12:15], v10, s[48:51], s72 offen sc1
    s_add_u32 s72, s71, 2048
    buffer_store_dwordx4 v[12:15], v10, s[48:51], s72 offen sc1
    s_add_u32 s72, s71, 3072
    buffer_store_dwordx4 v[12:15], v10, s[48:51], s72 offen sc1
    s_add_u32 s72, s71, 4096
    buffer_store_dwordx4 v[12:15], v10, s[48:51], s72 offen sc1
    s_add_u32 s72, s71, 5120
    buffer_store_dwordx4 v[12:15], v10, s[48:51], s72 offen sc1
    s_add_u32 s72, s71, 6144
    buffer_store_dwordx4 v[12:15], v10, s[48:51], s72 offen sc1
    s_add_u32 s72, s71, 8192
    buffer_store_dwordx4 v[12:15], v10, s[48:51], s72 offen sc1
    s_add_u32 s72, s71, 9216
    buffer_store_dwordx4 v[12:15], v10, s[48:51], s72 offen sc1
    s_add_u32 s72, s71, 10240
    buffer_store_dwordx4 v[12:15], v10, s[48:51], s72 offen sc1
    s_add_u32 s72, s71, 11264
    buffer_store_dwordx4 v[12:15], v10, s[48:51], s72 offen sc1
    s_add_u32 s72, s71, 12288
    buffer_store_dwordx4 v[12:15], v10, s[48:51], s72 offen sc1
    s_add_u32 s72, s71, 13312
    buffer_store_dwordx4 v[12:15], v10, s[48:51], s72 offen sc1
    s_add_u32 s72, s71, 14336
    buffer_store_dwordx4 v[12:15], v10, s[48:51], s72 offen sc1
    s_mov_b32 exec_hi, 0
    s_add_u32 s72, s71, 7168
    buffer_store_dwordx4 v[12:15], v10, s[48:51], s72 offen sc1
    s_add_u32 s72, s71, 15360
    buffer_store_dwordx4 v[12:15], v10, s[48:51], s72 offen sc1
    s_mov_b64 exec, -1
    s_add_u32 s71, s70, 1
    s_lshl_b32 s71, s71, 15
    s_lshl_b32 s72, s64, 12
    s_add_u32 s72, s72, s71
    buffer_store_dwordx4 v[12:15], v10, s[48:51], s72 offen offset:0 sc1
    buffer_store_dwordx4 v[12:15], v10, s[48:51], s72 offen offset:1024 sc1
    buffer_store_dwordx4 v[12:15], v10, s[48:51], s72 offen offset:2048 sc1
    buffer_store_dwordx4 v[12:15], v10, s[48:51], s72 offen offset:3072 sc1
    s_and_b32 s72, s64, 1
    s_lshl_b32 s72, s72, 10
    s_lshr_b32 s73, s64, 1
    s_lshl_b32 s73, s73, 13
    s_add_u32 s72, s72, s73
    s_add_u32 s72, s72, s71
    s_add_u32 s72, s72, 16384
    buffer_store_dwordx4 v[12:15], v10, s[48:51], s72 offen sc1
    buffer_store_dwordx4 v[12:15], v10, s[48:51], s72 offen offset:2048 sc1
    s_add_u32 s72, s72, 4096
    buffer_store_dwordx4 v[12:15], v10, s[48:51], s72 offen sc1
    s_branch L_A_i3_50
L_fill_last_54:
    s_cmp_lg_u32 s64, 0
    s_cbranch_scc1 L_fill_w1_55
    s_mov_b32 s52, s18
    s_mov_b32 s53, s19
    s_mov_b32 s54, 0x2800
    s_mov_b32 s55, 0x20000
    v_and_b32 v1, 7, v0
    v_mul_u32_u24 v1, 1280, v1
    v_lshrrev_b32 v2, 3, v0
    v_lshl_add_u32 v11, v2, 4, v1
    buffer_load_dwordx4 v[32:35], v11, s[52:55], 0 offen offset:0
    buffer_load_dwordx4 v[36:39], v11, s[52:55], 0 offen offset:128
    buffer_load_dwordx4 v[40:43], v11, s[52:55], 0 offen offset:256
    buffer_load_dwordx4 v[44:47], v11, s[52:55], 0 offen offset:384
    buffer_load_dwordx4 v[48:51], v11, s[52:55], 0 offen offset:512
    buffer_load_dwordx4 v[52:55], v11, s[52:55], 0 offen offset:640
    buffer_load_dwordx4 v[56:59], v11, s[52:55], 0 offen offset:768
    buffer_load_dwordx4 v[60:63], v11, s[52:55], 0 offen offset:896
    buffer_load_dwordx4 v[64:67], v11, s[52:55], 0 offen offset:1024
    buffer_load_dwordx4 v[68:71], v11, s[52:55], 0 offen offset:1152
    s_waitcnt vmcnt(0)
    v_min_u32 v32, -2, v32
    v_min_u32 v33, -2, v33
    v_min_u32 v34, -2, v34
    v_min_u32 v35, -2, v35
    v_min_u32 v36, -2, v36
    v_min_u32 v37, -2, v37
    v_min_u32 v38, -2, v38
    v_min_u32 v39, -2, v39
    v_min_u32 v40, -2, v40
    v_min_u32 v41, -2, v41
    v_min_u32 v42, -2, v42
    v_min_u32 v43, -2, v43
    v_min_u32 v44, -2, v44
    v_min_u32 v45, -2, v45
    v_min_u32 v46, -2, v46
    v_min_u32 v47, -2, v47
    v_min_u32 v48, -2, v48
    v_min_u32 v49, -2, v49
    v_min_u32 v50, -2, v50
    v_min_u32 v51, -2, v51
    v_min_u32 v52, -2, v52
    v_min_u32 v53, -2, v53
    v_min_u32 v54, -2, v54
    v_min_u32 v55, -2, v55
    v_min_u32 v56, -2, v56
    v_min_u32 v57, -2, v57
    v_min_u32 v58, -2, v58
    v_min_u32 v59, -2, v59
    v_min_u32 v60, -2, v60
    v_min_u32 v61, -2, v61
    v_min_u32 v62, -2, v62
    v_min_u32 v63, -2, v63
    v_min_u32 v64, -2, v64
    v_min_u32 v65, -2, v65
    v_min_u32 v66, -2, v66
    v_min_u32 v67, -2, v67
    v_min_u32 v68, -2, v68
    v_min_u32 v69, -2, v69
    v_min_u32 v70, -2, v70
    v_min_u32 v71, -2, v71
    s_mov_b32 s72, 0
    buffer_store_dwordx4 v[32:35], v10, s[48:51], s72 offen sc1
    s_mov_b32 s72, 1024
    buffer_store_dwordx4 v[36:39], v10, s[48:51], s72 offen sc1
    s_mov_b32 s72, 2048
    buffer_store_dwordx4 v[40:43], v10, s[48:51], s72 offen sc1
    s_mov_b32 s72, 3072
    buffer_store_dwordx4 v[44:47], v10, s[48:51], s72 offen sc1
    s_mov_b32 s72, 4096
    buffer_store_dwordx4 v[48:51], v10, s[48:51], s72 offen sc1
    s_mov_b32 s72, 5120
    buffer_store_dwordx4 v[52:55], v10, s[48:51], s72 offen sc1
    s_mov_b32 s72, 6144
    buffer_store_dwordx4 v[56:59], v10, s[48:51], s72 offen sc1
    s_mov_b32 s72, 7168
    buffer_store_dwordx4 v[60:63], v10, s[48:51], s72 offen sc1
    s_mov_b32 s72, 16384
    buffer_store_dwordx4 v[64:67], v10, s[48:51], s72 offen sc1
    s_mov_b32 s72, 17408
    buffer_store_dwordx4 v[68:71], v10, s[48:51], s72 offen sc1
    s_mov_b32 s72, 8192
    buffer_store_dwordx4 v[32:35], v10, s[48:51], s72 offen sc1
    s_mov_b32 s72, 9216
    buffer_store_dwordx4 v[36:39], v10, s[48:51], s72 offen sc1
    s_mov_b32 s72, 10240
    buffer_store_dwordx4 v[40:43], v10, s[48:51], s72 offen sc1
    s_mov_b32 s72, 11264
    buffer_store_dwordx4 v[44:47], v10, s[48:51], s72 offen sc1
    s_mov_b32 s72, 12288
    buffer_store_dwordx4 v[48:51], v10, s[48:51], s72 offen sc1
    s_mov_b32 s72, 13312
    buffer_store_dwordx4 v[52:55], v10, s[48:51], s72 offen sc1
    s_mov_b32 s72, 14336
    buffer_store_dwordx4 v[56:59], v10, s[48:51], s72 offen sc1
    s_mov_b32 s72, 15360
    buffer_store_dwordx4 v[60:63], v10, s[48:51], s72 offen sc1
    s_mov_b32 s72, 24576
    buffer_store_dwordx4 v[64:67], v10, s[48:51], s72 offen sc1
    s_mov_b32 s72, 25600
    buffer_store_dwordx4 v[68:71], v10, s[48:51], s72 offen sc1
    s_branch L_A_i3_50
L_fill_w1_55:
    s_cmp_lg_u32 s64, 1
    s_cbranch_scc1 L_A_i3_50
    v_mov_b32 v12, 0
    v_mov_b32 v13, 0
    v_mov_b32 v14, 0
    v_mov_b32 v15, 0
    s_mov_b32 s72, 18432
    buffer_store_dwordx4 v[12:15], v10, s[48:51], s72 offen sc1
    s_mov_b32 s72, 19456
    buffer_store_dwordx4 v[12:15], v10, s[48:51], s72 offen sc1
    s_mov_b32 s72, 20480
    buffer_store_dwordx4 v[12:15], v10, s[48:51], s72 offen sc1
    s_mov_b32 s72, 21504
    buffer_store_dwordx4 v[12:15], v10, s[48:51], s72 offen sc1
    s_mov_b32 s72, 26624
    buffer_store_dwordx4 v[12:15], v10, s[48:51], s72 offen sc1
    s_mov_b32 s72, 27648
    buffer_store_dwordx4 v[12:15], v10, s[48:51], s72 offen sc1
    s_mov_b32 s72, 28672
    buffer_store_dwordx4 v[12:15], v10, s[48:51], s72 offen sc1
    s_mov_b32 s72, 29696
    buffer_store_dwordx4 v[12:15], v10, s[48:51], s72 offen sc1
L_A_i3_50:
    s_lshl_b32 s92, s65, 2
    s_add_u32 s92, s92, 0x603f00
    s_mov_b32 s93, 1
    s_waitcnt vmcnt(0)
    s_barrier
    s_cmp_lg_u32 s64, 1
    s_cbranch_scc1 L_fs_56
    v_mov_b32 v2, s93
    v_mov_b32 v3, 0
    s_mov_b64 exec, 1
    buffer_store_dword v2, v3, s[48:51], s92 offen sc1
    s_mov_b64 exec, -1
L_fs_56:
    s_mul_i32 s10, s65, 384
    s_lshl_b32 s11, s64, 10
    s_waitcnt vmcnt(12) lgkmcnt(0)
    s_barrier
    s_mov_b32 s52, s20
    s_mov_b32 s53, s21
    s_mov_b32 s54, 0x780000
    s_mov_b32 s55, 0x20000
    s_add_u32 s92, s10, 2359296
    s_add_u32 m0, s11, 73728
    s_nop 0
    buffer_load_dwordx4 v136, s[52:55], s92 offen lds
    s_add_u32 s92, s10, 2359424
    s_add_u32 m0, s11, 77824
    s_nop 0
    buffer_load_dwordx4 v136, s[52:55], s92 offen lds
    s_add_u32 s92, s10, 2359552
    s_add_u32 m0, s11, 81920
    s_nop 0
    buffer_load_dwordx4 v136, s[52:55], s92 offen lds
    s_add_u32 s92, s10, 2752512
    s_add_u32 m0, s11, 86016
    s_nop 0
    buffer_load_dwordx4 v136, s[52:55], s92 offen lds
    s_add_u32 s92, s10, 2752640
    s_add_u32 m0, s11, 90112
    s_nop 0
    buffer_load_dwordx4 v136, s[52:55], s92 offen lds
    s_add_u32 s92, s10, 2752768
    s_add_u32 m0, s11, 94208
    s_nop 0
    buffer_load_dwordx4 v136, s[52:55], s92 offen lds
    ds_read_b64_tr_b16 v[8:9], v139 offset:0
    ds_read_b64_tr_b16 v[10:11], v140 offset:0
    ds_read_b64_tr_b16 v[12:13], v139 offset:12288
    ds_read_b64_tr_b16 v[14:15], v140 offset:12288
    ds_read_b64_tr_b16 v[16:17], v141 offset:0
    ds_read_b64_tr_b16 v[18:19], v142 offset:0
    ds_read_b64_tr_b16 v[20:21], v141 offset:12288
    ds_read_b64_tr_b16 v[22:23], v142 offset:12288
    ds_read_b64_tr_b16 v[24:25], v143 offset:0
    ds_read_b64_tr_b16 v[26:27], v144 offset:0
    ds_read_b64_tr_b16 v[28:29], v143 offset:12288
    ds_read_b64_tr_b16 v[30:31], v144 offset:12288
    s_waitcnt vmcnt(12) lgkmcnt(0)
    s_barrier
    s_add_u32 s92, s10, 3145728
    s_add_u32 m0, s11, 0
    s_nop 0
    buffer_load_dwordx4 v136, s[52:55], s92 offen lds
    s_add_u32 s92, s10, 3145856
    s_add_u32 m0, s11, 4096
    s_nop 0
    buffer_load_dwordx4 v136, s[52:55], s92 offen lds
    s_add_u32 s92, s10, 3145984
    s_add_u32 m0, s11, 8192
    s_nop 0
    buffer_load_dwordx4 v136, s[52:55], s92 offen lds
    s_add_u32 s92, s10, 3538944
    s_add_u32 m0, s11, 12288
    s_nop 0
    buffer_load_dwordx4 v136, s[52:55], s92 offen lds
    s_add_u32 s92, s10, 3539072
    s_add_u32 m0, s11, 16384
    s_nop 0
    buffer_load_dwordx4 v136, s[52:55], s92 offen lds
    s_add_u32 s92, s10, 3539200
    s_add_u32 m0, s11, 20480
    s_nop 0
    buffer_load_dwordx4 v136, s[52:55], s92 offen lds
    ds_read_b64_tr_b16 a[16:17], v139 offset:24576
    ds_read_b64_tr_b16 a[18:19], v140 offset:24576
    ds_read_b64_tr_b16 a[20:21], v139 offset:36864
    ds_read_b64_tr_b16 a[22:23], v140 offset:36864
    ds_read_b64_tr_b16 a[24:25], v141 offset:24576
    ds_read_b64_tr_b16 a[26:27], v142 offset:24576
    ds_read_b64_tr_b16 a[28:29], v141 offset:36864
    ds_read_b64_tr_b16 a[30:31], v142 offset:36864
    ds_read_b64_tr_b16 a[32:33], v143 offset:24576
    ds_read_b64_tr_b16 a[34:35], v144 offset:24576
    ds_read_b64_tr_b16 a[36:37], v143 offset:36864
    ds_read_b64_tr_b16 a[38:39], v144 offset:36864
    s_waitcnt vmcnt(12) lgkmcnt(0)
    s_barrier
    s_add_u32 s92, s10, 3932160
    s_add_u32 m0, s11, 24576
    s_nop 0
    buffer_load_dwordx4 v136, s[52:55], s92 offen lds
    s_add_u32 s92, s10, 3932288
    s_add_u32 m0, s11, 28672
    s_nop 0
    buffer_load_dwordx4 v136, s[52:55], s92 offen lds
    s_add_u32 s92, s10, 3932416
    s_add_u32 m0, s11, 32768
    s_nop 0
    buffer_load_dwordx4 v136, s[52:55], s92 offen lds
    s_add_u32 s92, s10, 4325376
    s_add_u32 m0, s11, 36864
    s_nop 0
    buffer_load_dwordx4 v136, s[52:55], s92 offen lds
    s_add_u32 s92, s10, 4325504
    s_add_u32 m0, s11, 40960
    s_nop 0
    buffer_load_dwordx4 v136, s[52:55], s92 offen lds
    s_add_u32 s92, s10, 4325632
    s_add_u32 m0, s11, 45056
    s_nop 0
    buffer_load_dwordx4 v136, s[52:55], s92 offen lds
    ds_read_b64_tr_b16 v[48:49], v139 offset:49152
    ds_read_b64_tr_b16 v[50:51], v140 offset:49152
    ds_read_b64_tr_b16 v[52:53], v139 offset:61440
    ds_read_b64_tr_b16 v[54:55], v140 offset:61440
    ds_read_b64_tr_b16 v[56:57], v141 offset:49152
    ds_read_b64_tr_b16 v[58:59], v142 offset:49152
    ds_read_b64_tr_b16 v[60:61], v141 offset:61440
    ds_read_b64_tr_b16 v[62:63], v142 offset:61440
    ds_read_b64_tr_b16 v[64:65], v143 offset:49152
    ds_read_b64_tr_b16 v[66:67], v144 offset:49152
    ds_read_b64_tr_b16 v[68:69], v143 offset:61440
    ds_read_b64_tr_b16 v[70:71], v144 offset:61440
    s_waitcnt vmcnt(12) lgkmcnt(0)
    s_barrier
    s_add_u32 s92, s10, 4718592
    s_add_u32 m0, s11, 49152
    s_nop 0
    buffer_load_dwordx4 v136, s[52:55], s92 offen lds
    s_add_u32 s92, s10, 4718720
    s_add_u32 m0, s11, 53248
    s_nop 0
    buffer_load_dwordx4 v136, s[52:55], s92 offen lds
    s_add_u32 s92, s10, 4718848
    s_add_u32 m0, s11, 57344
    s_nop 0
    buffer_load_dwordx4 v136, s[52:55], s92 offen lds
    s_add_u32 s92, s10, 5111808
    s_add_u32 m0, s11, 61440
    s_nop 0
    buffer_load_dwordx4 v136, s[52:55], s92 offen lds
    s_add_u32 s92, s10, 5111936
    s_add_u32 m0, s11, 65536
    s_nop 0
    buffer_load_dwordx4 v136, s[52:55], s92 offen lds
    s_add_u32 s92, s10, 5112064
    s_add_u32 m0, s11, 69632
    s_nop 0
    buffer_load_dwordx4 v136, s[52:55], s92 offen lds
    ds_read_b64_tr_b16 a[56:57], v145 offset:0
    ds_read_b64_tr_b16 a[58:59], v146 offset:0
    ds_read_b64_tr_b16 a[60:61], v145 offset:12288
    ds_read_b64_tr_b16 a[62:63], v146 offset:12288
    ds_read_b64_tr_b16 a[64:65], v147 offset:0
    ds_read_b64_tr_b16 a[66:67], v148 offset:0
    ds_read_b64_tr_b16 a[68:69], v147 offset:12288
    ds_read_b64_tr_b16 a[70:71], v148 offset:12288
    ds_read_b64_tr_b16 a[72:73], v149 offset:0
    ds_read_b64_tr_b16 a[74:75], v150 offset:0
    ds_read_b64_tr_b16 a[76:77], v149 offset:12288
    ds_read_b64_tr_b16 a[78:79], v150 offset:12288
    s_waitcnt vmcnt(12) lgkmcnt(0)
    s_barrier
    s_add_u32 s92, s10, 5505024
    s_add_u32 m0, s11, 73728
    s_nop 0
    buffer_load_dwordx4 v136, s[52:55], s92 offen lds
    s_add_u32 s92, s10, 5505152
    s_add_u32 m0, s11, 77824
    s_nop 0
    buffer_load_dwordx4 v136, s[52:55], s92 offen lds
    s_add_u32 s92, s10, 5505280
    s_add_u32 m0, s11, 81920
    s_nop 0
    buffer_load_dwordx4 v136, s[52:55], s92 offen lds
    s_add_u32 s92, s10, 5898240
    s_add_u32 m0, s11, 86016
    s_nop 0
    buffer_load_dwordx4 v136, s[52:55], s92 offen lds
    s_add_u32 s92, s10, 5898368
    s_add_u32 m0, s11, 90112
    s_nop 0
    buffer_load_dwordx4 v136, s[52:55], s92 offen lds
    s_add_u32 s92, s10, 5898496
    s_add_u32 m0, s11, 94208
    s_nop 0
    buffer_load_dwordx4 v136, s[52:55], s92 offen lds
    ds_read_b64_tr_b16 a[80:81], v139 offset:0
    ds_read_b64_tr_b16 a[82:83], v140 offset:0
    ds_read_b64_tr_b16 a[84:85], v139 offset:12288
    ds_read_b64_tr_b16 a[86:87], v140 offset:12288
    ds_read_b64_tr_b16 a[96:97], v141 offset:0
    ds_read_b64_tr_b16 a[98:99], v142 offset:0
    ds_read_b64_tr_b16 a[100:101], v141 offset:12288
    ds_read_b64_tr_b16 a[102:103], v142 offset:12288
    ds_read_b64_tr_b16 a[184:185], v143 offset:0
    ds_read_b64_tr_b16 a[186:187], v144 offset:0
    ds_read_b64_tr_b16 a[188:189], v143 offset:12288
    ds_read_b64_tr_b16 a[190:191], v144 offset:12288
    s_waitcnt vmcnt(12) lgkmcnt(0)
    s_barrier
    s_add_u32 s92, s10, 6291456
    s_add_u32 m0, s11, 0
    s_nop 0
    buffer_load_dwordx4 v136, s[52:55], s92 offen lds
    s_add_u32 s92, s10, 6291584
    s_add_u32 m0, s11, 4096
    s_nop 0
    buffer_load_dwordx4 v136, s[52:55], s92 offen lds
    s_add_u32 s92, s10, 6291712
    s_add_u32 m0, s11, 8192
    s_nop 0
    buffer_load_dwordx4 v136, s[52:55], s92 offen lds
    s_add_u32 s92, s10, 6684672
    s_add_u32 m0, s11, 12288
    s_nop 0
    buffer_load_dwordx4 v136, s[52:55], s92 offen lds
    s_add_u32 s92, s10, 6684800
    s_add_u32 m0, s11, 16384
    s_nop 0
    buffer_load_dwordx4 v136, s[52:55], s92 offen lds
    s_add_u32 s92, s10, 6684928
    s_add_u32 m0, s11, 20480
    s_nop 0
    buffer_load_dwordx4 v136, s[52:55], s92 offen lds
    ds_read_b64_tr_b16 a[104:105], v139 offset:24576
    ds_read_b64_tr_b16 a[106:107], v140 offset:24576
    ds_read_b64_tr_b16 a[108:109], v139 offset:36864
    ds_read_b64_tr_b16 a[110:111], v140 offset:36864
    ds_read_b64_tr_b16 a[120:121], v141 offset:24576
    ds_read_b64_tr_b16 a[122:123], v142 offset:24576
    ds_read_b64_tr_b16 a[124:125], v141 offset:36864
    ds_read_b64_tr_b16 a[126:127], v142 offset:36864
    ds_read_b64_tr_b16 a[192:193], v143 offset:24576
    ds_read_b64_tr_b16 a[194:195], v144 offset:24576
    ds_read_b64_tr_b16 a[196:197], v143 offset:36864
    ds_read_b64_tr_b16 a[198:199], v144 offset:36864
    s_waitcnt vmcnt(12) lgkmcnt(0)
    s_barrier
    s_add_u32 s92, s10, 7077888
    s_add_u32 m0, s11, 24576
    s_nop 0
    buffer_load_dwordx4 v136, s[52:55], s92 offen lds
    s_add_u32 s92, s10, 7078016
    s_add_u32 m0, s11, 28672
    s_nop 0
    buffer_load_dwordx4 v136, s[52:55], s92 offen lds
    s_add_u32 s92, s10, 7078144
    s_add_u32 m0, s11, 32768
    s_nop 0
    buffer_load_dwordx4 v136, s[52:55], s92 offen lds
    s_add_u32 s92, s10, 7471104
    s_add_u32 m0, s11, 36864
    s_nop 0
    buffer_load_dwordx4 v136, s[52:55], s92 offen lds
    s_add_u32 s92, s10, 7471232
    s_add_u32 m0, s11, 40960
    s_nop 0
    buffer_load_dwordx4 v136, s[52:55], s92 offen lds
    s_add_u32 s92, s10, 7471360
    s_add_u32 m0, s11, 45056
    s_nop 0
    buffer_load_dwordx4 v136, s[52:55], s92 offen lds
    ds_read_b64_tr_b16 a[128:129], v139 offset:49152
    ds_read_b64_tr_b16 a[130:131], v140 offset:49152
    ds_read_b64_tr_b16 a[132:133], v139 offset:61440
    ds_read_b64_tr_b16 a[134:135], v140 offset:61440
    ds_read_b64_tr_b16 a[152:153], v141 offset:49152
    ds_read_b64_tr_b16 a[154:155], v142 offset:49152
    ds_read_b64_tr_b16 a[156:157], v141 offset:61440
    ds_read_b64_tr_b16 a[158:159], v142 offset:61440
    ds_read_b64_tr_b16 a[200:201], v143 offset:49152
    ds_read_b64_tr_b16 a[202:203], v144 offset:49152
    ds_read_b64_tr_b16 a[204:205], v143 offset:61440
    ds_read_b64_tr_b16 a[206:207], v144 offset:61440
    s_waitcnt vmcnt(12) lgkmcnt(0)
    s_barrier
    s_mov_b32 s52, s22
    s_mov_b32 s53, s23
    s_mov_b32 s54, 0x780000
    s_mov_b32 s55, 0x20000
    s_add_u32 s92, s10, 0
    s_add_u32 m0, s11, 49152
    s_nop 0
    buffer_load_dwordx4 v136, s[52:55], s92 offen lds
    s_add_u32 s92, s10, 128
    s_add_u32 m0, s11, 53248
    s_nop 0
    buffer_load_dwordx4 v136, s[52:55], s92 offen lds
    s_add_u32 s92, s10, 256
    s_add_u32 m0, s11, 57344
    s_nop 0
    buffer_load_dwordx4 v136, s[52:55], s92 offen lds
    s_add_u32 s92, s10, 393216
    s_add_u32 m0, s11, 61440
    s_nop 0
    buffer_load_dwordx4 v136, s[52:55], s92 offen lds
    s_add_u32 s92, s10, 393344
    s_add_u32 m0, s11, 65536
    s_nop 0
    buffer_load_dwordx4 v136, s[52:55], s92 offen lds
    s_add_u32 s92, s10, 393472
    s_add_u32 m0, s11, 69632
    s_nop 0
    buffer_load_dwordx4 v136, s[52:55], s92 offen lds
    ds_read_b64_tr_b16 v[104:105], v145 offset:0
    ds_read_b64_tr_b16 v[106:107], v146 offset:0
    ds_read_b64_tr_b16 v[108:109], v145 offset:12288
    ds_read_b64_tr_b16 v[110:111], v146 offset:12288
    ds_read_b64_tr_b16 a[160:161], v147 offset:0
    ds_read_b64_tr_b16 a[162:163], v148 offset:0
    ds_read_b64_tr_b16 a[164:165], v147 offset:12288
    ds_read_b64_tr_b16 a[166:167], v148 offset:12288
    ds_read_b64_tr_b16 a[208:209], v149 offset:0
    ds_read_b64_tr_b16 a[210:211], v150 offset:0
    ds_read_b64_tr_b16 a[212:213], v149 offset:12288
    ds_read_b64_tr_b16 a[214:215], v150 offset:12288
    s_waitcnt vmcnt(12) lgkmcnt(0)
    s_barrier
    s_add_u32 s92, s10, 786432
    s_add_u32 m0, s11, 73728
    s_nop 0
    buffer_load_dwordx4 v136, s[52:55], s92 offen lds
    s_add_u32 s92, s10, 786560
    s_add_u32 m0, s11, 77824
    s_nop 0
    buffer_load_dwordx4 v136, s[52:55], s92 offen lds
    s_add_u32 s92, s10, 786688
    s_add_u32 m0, s11, 81920
    s_nop 0
    buffer_load_dwordx4 v136, s[52:55], s92 offen lds
    s_add_u32 s92, s10, 1179648
    s_add_u32 m0, s11, 86016
    s_nop 0
    buffer_load_dwordx4 v136, s[52:55], s92 offen lds
    s_add_u32 s92, s10, 1179776
    s_add_u32 m0, s11, 90112
    s_nop 0
    buffer_load_dwordx4 v136, s[52:55], s92 offen lds
    s_add_u32 s92, s10, 1179904
    s_add_u32 m0, s11, 94208
    s_nop 0
    buffer_load_dwordx4 v136, s[52:55], s92 offen lds
    ds_read_b64_tr_b16 a[136:137], v139 offset:0
    ds_read_b64_tr_b16 a[138:139], v140 offset:0
    ds_read_b64_tr_b16 a[140:141], v139 offset:12288
    ds_read_b64_tr_b16 a[142:143], v140 offset:12288
    ds_read_b64_tr_b16 a[168:169], v141 offset:0
    ds_read_b64_tr_b16 a[170:171], v142 offset:0
    ds_read_b64_tr_b16 a[172:173], v141 offset:12288
    ds_read_b64_tr_b16 a[174:175], v142 offset:12288
    ds_read_b64_tr_b16 a[216:217], v143 offset:0
    ds_read_b64_tr_b16 a[218:219], v144 offset:0
    ds_read_b64_tr_b16 a[220:221], v143 offset:12288
    ds_read_b64_tr_b16 a[222:223], v144 offset:12288
    s_waitcnt vmcnt(12) lgkmcnt(0)
    s_barrier
    s_add_u32 s92, s10, 1572864
    s_add_u32 m0, s11, 0
    s_nop 0
    buffer_load_dwordx4 v136, s[52:55], s92 offen lds
    s_add_u32 s92, s10, 1572992
    s_add_u32 m0, s11, 4096
    s_nop 0
    buffer_load_dwordx4 v136, s[52:55], s92 offen lds
    s_add_u32 s92, s10, 1573120
    s_add_u32 m0, s11, 8192
    s_nop 0
    buffer_load_dwordx4 v136, s[52:55], s92 offen lds
    s_add_u32 s92, s10, 1966080
    s_add_u32 m0, s11, 12288
    s_nop 0
    buffer_load_dwordx4 v136, s[52:55], s92 offen lds
    s_add_u32 s92, s10, 1966208
    s_add_u32 m0, s11, 16384
    s_nop 0
    buffer_load_dwordx4 v136, s[52:55], s92 offen lds
    s_add_u32 s92, s10, 1966336
    s_add_u32 m0, s11, 20480
    s_nop 0
    buffer_load_dwordx4 v136, s[52:55], s92 offen lds
    ds_read_b64_tr_b16 a[144:145], v139 offset:24576
    ds_read_b64_tr_b16 a[146:147], v140 offset:24576
    ds_read_b64_tr_b16 a[148:149], v139 offset:36864
    ds_read_b64_tr_b16 a[150:151], v140 offset:36864
    ds_read_b64_tr_b16 a[176:177], v141 offset:24576
    ds_read_b64_tr_b16 a[178:179], v142 offset:24576
    ds_read_b64_tr_b16 a[180:181], v141 offset:36864
    ds_read_b64_tr_b16 a[182:183], v142 offset:36864
    ds_read_b64_tr_b16 a[224:225], v143 offset:24576
    ds_read_b64_tr_b16 a[226:227], v144 offset:24576
    ds_read_b64_tr_b16 a[228:229], v143 offset:36864
    ds_read_b64_tr_b16 a[230:231], v144 offset:36864
    s_waitcnt vmcnt(12) lgkmcnt(0)
    s_barrier
    s_add_u32 s92, s10, 2359296
    s_add_u32 m0, s11, 24576
    s_nop 0
    buffer_load_dwordx4 v136, s[52:55], s92 offen lds
    s_add_u32 s92, s10, 2359424
    s_add_u32 m0, s11, 28672
    s_nop 0
    buffer_load_dwordx4 v136, s[52:55], s92 offen lds
    s_add_u32 s92, s10, 2359552
    s_add_u32 m0, s11, 32768
    s_nop 0
    buffer_load_dwordx4 v136, s[52:55], s92 offen lds
    s_add_u32 s92, s10, 2752512
    s_add_u32 m0, s11, 36864
    s_nop 0
    buffer_load_dwordx4 v136, s[52:55], s92 offen lds
    s_add_u32 s92, s10, 2752640
    s_add_u32 m0, s11, 40960
    s_nop 0
    buffer_load_dwordx4 v136, s[52:55], s92 offen lds
    s_add_u32 s92, s10, 2752768
    s_add_u32 m0, s11, 45056
    s_nop 0
    buffer_load_dwordx4 v136, s[52:55], s92 offen lds
    ds_read_b64_tr_b16 a[0:1], v139 offset:49152
    ds_read_b64_tr_b16 a[2:3], v140 offset:49152
    ds_read_b64_tr_b16 a[4:5], v139 offset:61440
    ds_read_b64_tr_b16 a[6:7], v140 offset:61440
    ds_read_b64_tr_b16 a[8:9], v141 offset:49152
    ds_read_b64_tr_b16 a[10:11], v142 offset:49152
    ds_read_b64_tr_b16 a[12:13], v141 offset:61440
    ds_read_b64_tr_b16 a[14:15], v142 offset:61440
    ds_read_b64_tr_b16 v[184:185], v143 offset:49152
    ds_read_b64_tr_b16 v[186:187], v144 offset:49152
    ds_read_b64_tr_b16 v[188:189], v143 offset:61440
    ds_read_b64_tr_b16 v[190:191], v144 offset:61440
    s_waitcnt vmcnt(12) lgkmcnt(0)
    s_barrier
    s_add_u32 s92, s10, 3145728
    s_add_u32 m0, s11, 49152
    s_nop 0
    buffer_load_dwordx4 v136, s[52:55], s92 offen lds
    s_add_u32 s92, s10, 3145856
    s_add_u32 m0, s11, 53248
    s_nop 0
    buffer_load_dwordx4 v136, s[52:55], s92 offen lds
    s_add_u32 s92, s10, 3145984
    s_add_u32 m0, s11, 57344
    s_nop 0
    buffer_load_dwordx4 v136, s[52:55], s92 offen lds
    s_add_u32 s92, s10, 3538944
    s_add_u32 m0, s11, 61440
    s_nop 0
    buffer_load_dwordx4 v136, s[52:55], s92 offen lds
    s_add_u32 s92, s10, 3539072
    s_add_u32 m0, s11, 65536
    s_nop 0
    buffer_load_dwordx4 v136, s[52:55], s92 offen lds
    s_add_u32 s92, s10, 3539200
    s_add_u32 m0, s11, 69632
    s_nop 0
    buffer_load_dwordx4 v136, s[52:55], s92 offen lds
    ds_read_b64_tr_b16 v[32:33], v145 offset:0
    ds_read_b64_tr_b16 v[34:35], v146 offset:0
    ds_read_b64_tr_b16 v[36:37], v145 offset:12288
    ds_read_b64_tr_b16 v[38:39], v146 offset:12288
    ds_read_b64_tr_b16 v[40:41], v147 offset:0
    ds_read_b64_tr_b16 v[42:43], v148 offset:0
    ds_read_b64_tr_b16 v[44:45], v147 offset:12288
    ds_read_b64_tr_b16 v[46:47], v148 offset:12288
    ds_read_b64_tr_b16 v[192:193], v149 offset:0
    ds_read_b64_tr_b16 v[194:195], v150 offset:0
    ds_read_b64_tr_b16 v[196:197], v149 offset:12288
    ds_read_b64_tr_b16 v[198:199], v150 offset:12288
    s_waitcnt vmcnt(12) lgkmcnt(0)
    s_barrier
    s_add_u32 s92, s10, 3932160
    s_add_u32 m0, s11, 73728
    s_nop 0
    buffer_load_dwordx4 v136, s[52:55], s92 offen lds
    s_add_u32 s92, s10, 3932288
    s_add_u32 m0, s11, 77824
    s_nop 0
    buffer_load_dwordx4 v136, s[52:55], s92 offen lds
    s_add_u32 s92, s10, 3932416
    s_add_u32 m0, s11, 81920
    s_nop 0
    buffer_load_dwordx4 v136, s[52:55], s92 offen lds
    s_add_u32 s92, s10, 4325376
    s_add_u32 m0, s11, 86016
    s_nop 0
    buffer_load_dwordx4 v136, s[52:55], s92 offen lds
    s_add_u32 s92, s10, 4325504
    s_add_u32 m0, s11, 90112
    s_nop 0
    buffer_load_dwordx4 v136, s[52:55], s92 offen lds
    s_add_u32 s92, s10, 4325632
    s_add_u32 m0, s11, 94208
    s_nop 0
    buffer_load_dwordx4 v136, s[52:55], s92 offen lds
    ds_read_b64_tr_b16 a[40:41], v139 offset:0
    ds_read_b64_tr_b16 a[42:43], v140 offset:0
    ds_read_b64_tr_b16 a[44:45], v139 offset:12288
    ds_read_b64_tr_b16 a[46:47], v140 offset:12288
    ds_read_b64_tr_b16 a[48:49], v141 offset:0
    ds_read_b64_tr_b16 a[50:51], v142 offset:0
    ds_read_b64_tr_b16 a[52:53], v141 offset:12288
    ds_read_b64_tr_b16 a[54:55], v142 offset:12288
    ds_read_b64_tr_b16 v[200:201], v143 offset:0
    ds_read_b64_tr_b16 v[202:203], v144 offset:0
    ds_read_b64_tr_b16 v[204:205], v143 offset:12288
    ds_read_b64_tr_b16 v[206:207], v144 offset:12288
    s_waitcnt vmcnt(12) lgkmcnt(0)
    s_barrier
    s_add_u32 s92, s10, 4718592
    s_add_u32 m0, s11, 0
    s_nop 0
    buffer_load_dwordx4 v136, s[52:55], s92 offen lds
    s_add_u32 s92, s10, 4718720
    s_add_u32 m0, s11, 4096
    s_nop 0
    buffer_load_dwordx4 v136, s[52:55], s92 offen lds
    s_add_u32 s92, s10, 4718848
    s_add_u32 m0, s11, 8192
    s_nop 0
    buffer_load_dwordx4 v136, s[52:55], s92 offen lds
    s_add_u32 s92, s10, 5111808
    s_add_u32 m0, s11, 12288
    s_nop 0
    buffer_load_dwordx4 v136, s[52:55], s92 offen lds
    s_add_u32 s92, s10, 5111936
    s_add_u32 m0, s11, 16384
    s_nop 0
    buffer_load_dwordx4 v136, s[52:55], s92 offen lds
    s_add_u32 s92, s10, 5112064
    s_add_u32 m0, s11, 20480
    s_nop 0
    buffer_load_dwordx4 v136, s[52:55], s92 offen lds
    ds_read_b64_tr_b16 v[72:73], v139 offset:24576
    ds_read_b64_tr_b16 v[74:75], v140 offset:24576
    ds_read_b64_tr_b16 v[76:77], v139 offset:36864
    ds_read_b64_tr_b16 v[78:79], v140 offset:36864
    ds_read_b64_tr_b16 v[80:81], v141 offset:24576
    ds_read_b64_tr_b16 v[82:83], v142 offset:24576
    ds_read_b64_tr_b16 v[84:85], v141 offset:36864
    ds_read_b64_tr_b16 v[86:87], v142 offset:36864
    ds_read_b64_tr_b16 v[208:209], v143 offset:24576
    ds_read_b64_tr_b16 v[210:211], v144 offset:24576
    ds_read_b64_tr_b16 v[212:213], v143 offset:36864
    ds_read_b64_tr_b16 v[214:215], v144 offset:36864
    s_waitcnt vmcnt(12) lgkmcnt(0)
    s_barrier
    s_add_u32 s92, s10, 5505024
    s_add_u32 m0, s11, 24576
    s_nop 0
    buffer_load_dwordx4 v136, s[52:55], s92 offen lds
    s_add_u32 s92, s10, 5505152
    s_add_u32 m0, s11, 28672
    s_nop 0
    buffer_load_dwordx4 v136, s[52:55], s92 offen lds
    s_add_u32 s92, s10, 5505280
    s_add_u32 m0, s11, 32768
    s_nop 0
    buffer_load_dwordx4 v136, s[52:55], s92 offen lds
    s_add_u32 s92, s10, 5898240
    s_add_u32 m0, s11, 36864
    s_nop 0
    buffer_load_dwordx4 v136, s[52:55], s92 offen lds
    s_add_u32 s92, s10, 5898368
    s_add_u32 m0, s11, 40960
    s_nop 0
    buffer_load_dwordx4 v136, s[52:55], s92 offen lds
    s_add_u32 s92, s10, 5898496
    s_add_u32 m0, s11, 45056
    s_nop 0
    buffer_load_dwordx4 v136, s[52:55], s92 offen lds
    ds_read_b64_tr_b16 a[88:89], v139 offset:49152
    ds_read_b64_tr_b16 a[90:91], v140 offset:49152
    ds_read_b64_tr_b16 a[92:93], v139 offset:61440
    ds_read_b64_tr_b16 a[94:95], v140 offset:61440
    ds_read_b64_tr_b16 v[88:89], v141 offset:49152
    ds_read_b64_tr_b16 v[90:91], v142 offset:49152
    ds_read_b64_tr_b16 v[92:93], v141 offset:61440
    ds_read_b64_tr_b16 v[94:95], v142 offset:61440
    ds_read_b64_tr_b16 v[216:217], v143 offset:49152
    ds_read_b64_tr_b16 v[218:219], v144 offset:49152
    ds_read_b64_tr_b16 v[220:221], v143 offset:61440
    ds_read_b64_tr_b16 v[222:223], v144 offset:61440
    s_waitcnt vmcnt(12) lgkmcnt(0)
    s_barrier
    s_add_u32 s92, s10, 6291456
    s_add_u32 m0, s11, 49152
    s_nop 0
    buffer_load_dwordx4 v136, s[52:55], s92 offen lds
    s_add_u32 s92, s10, 6291584
    s_add_u32 m0, s11, 53248
    s_nop 0
    buffer_load_dwordx4 v136, s[52:55], s92 offen lds
    s_add_u32 s92, s10, 6291712
    s_add_u32 m0, s11, 57344
    s_nop 0
    buffer_load_dwordx4 v136, s[52:55], s92 offen lds
    s_add_u32 s92, s10, 6684672
    s_add_u32 m0, s11, 61440
    s_nop 0
    buffer_load_dwordx4 v136, s[52:55], s92 offen lds
    s_add_u32 s92, s10, 6684800
    s_add_u32 m0, s11, 65536
    s_nop 0
    buffer_load_dwordx4 v136, s[52:55], s92 offen lds
    s_add_u32 s92, s10, 6684928
    s_add_u32 m0, s11, 69632
    s_nop 0
    buffer_load_dwordx4 v136, s[52:55], s92 offen lds
    ds_read_b64_tr_b16 a[112:113], v145 offset:0
    ds_read_b64_tr_b16 a[114:115], v146 offset:0
    ds_read_b64_tr_b16 a[116:117], v145 offset:12288
    ds_read_b64_tr_b16 a[118:119], v146 offset:12288
    ds_read_b64_tr_b16 v[96:97], v147 offset:0
    ds_read_b64_tr_b16 v[98:99], v148 offset:0
    ds_read_b64_tr_b16 v[100:101], v147 offset:12288
    ds_read_b64_tr_b16 v[102:103], v148 offset:12288
    ds_read_b64_tr_b16 v[224:225], v149 offset:0
    ds_read_b64_tr_b16 v[226:227], v150 offset:0
    ds_read_b64_tr_b16 v[228:229], v149 offset:12288
    ds_read_b64_tr_b16 v[230:231], v150 offset:12288
    s_waitcnt vmcnt(12) lgkmcnt(0)
    s_barrier
    s_add_u32 s92, s10, 7077888
    s_add_u32 m0, s11, 73728
    s_nop 0
    buffer_load_dwordx4 v136, s[52:55], s92 offen lds
    s_add_u32 s92, s10, 7078016
    s_add_u32 m0, s11, 77824
    s_nop 0
    buffer_load_dwordx4 v136, s[52:55], s92 offen lds
    s_add_u32 s92, s10, 7078144
    s_add_u32 m0, s11, 81920
    s_nop 0
    buffer_load_dwordx4 v136, s[52:55], s92 offen lds
    s_add_u32 s92, s10, 7471104
    s_add_u32 m0, s11, 86016
    s_nop 0
    buffer_load_dwordx4 v136, s[52:55], s92 offen lds
    s_add_u32 s92, s10, 7471232
    s_add_u32 m0, s11, 90112
    s_nop 0
    buffer_load_dwordx4 v136, s[52:55], s92 offen lds
    s_add_u32 s92, s10, 7471360
    s_add_u32 m0, s11, 94208
    s_nop 0
    buffer_load_dwordx4 v136, s[52:55], s92 offen lds
    ds_read_b64_tr_b16 v[112:113], v139 offset:0
    ds_read_b64_tr_b16 v[114:115], v140 offset:0
    ds_read_b64_tr_b16 v[116:117], v139 offset:12288
    ds_read_b64_tr_b16 v[118:119], v140 offset:12288
    ds_read_b64_tr_b16 v[160:161], v141 offset:0
    ds_read_b64_tr_b16 v[162:163], v142 offset:0
    ds_read_b64_tr_b16 v[164:165], v141 offset:12288
    ds_read_b64_tr_b16 v[166:167], v142 offset:12288
    ds_read_b64_tr_b16 v[128:129], v143 offset:0
    ds_read_b64_tr_b16 v[130:131], v144 offset:0
    ds_read_b64_tr_b16 v[132:133], v143 offset:12288
    ds_read_b64_tr_b16 v[134:135], v144 offset:12288
    s_waitcnt vmcnt(12) lgkmcnt(0)
    s_barrier
    ds_read_b64_tr_b16 a[232:233], v139 offset:24576
    ds_read_b64_tr_b16 a[234:235], v140 offset:24576
    ds_read_b64_tr_b16 a[236:237], v139 offset:36864
    ds_read_b64_tr_b16 a[238:239], v140 offset:36864
    ds_read_b64_tr_b16 v[168:169], v141 offset:24576
    ds_read_b64_tr_b16 v[170:171], v142 offset:24576
    ds_read_b64_tr_b16 v[172:173], v141 offset:36864
    ds_read_b64_tr_b16 v[174:175], v142 offset:36864
    ds_read_b64_tr_b16 v[232:233], v143 offset:24576
    ds_read_b64_tr_b16 v[234:235], v144 offset:24576
    ds_read_b64_tr_b16 v[236:237], v143 offset:36864
    ds_read_b64_tr_b16 v[238:239], v144 offset:36864
    s_waitcnt vmcnt(6) lgkmcnt(0)
    s_barrier
    ds_read_b64_tr_b16 a[240:241], v139 offset:49152
    ds_read_b64_tr_b16 a[242:243], v140 offset:49152
    ds_read_b64_tr_b16 a[244:245], v139 offset:61440
    ds_read_b64_tr_b16 a[246:247], v140 offset:61440
    ds_read_b64_tr_b16 v[176:177], v141 offset:49152
    ds_read_b64_tr_b16 v[178:179], v142 offset:49152
    ds_read_b64_tr_b16 v[180:181], v141 offset:61440
    ds_read_b64_tr_b16 v[182:183], v142 offset:61440
    ds_read_b64_tr_b16 v[240:241], v143 offset:49152
    ds_read_b64_tr_b16 v[242:243], v144 offset:49152
    ds_read_b64_tr_b16 v[244:245], v143 offset:61440
    ds_read_b64_tr_b16 v[246:247], v144 offset:61440
    s_waitcnt vmcnt(0) lgkmcnt(0)
    s_barrier
    ds_read_b64_tr_b16 a[248:249], v145 offset:0
    ds_read_b64_tr_b16 a[250:251], v146 offset:0
    ds_read_b64_tr_b16 a[252:253], v145 offset:12288
    ds_read_b64_tr_b16 a[254:255], v146 offset:12288
    ds_read_b64_tr_b16 v[120:121], v147 offset:0
    ds_read_b64_tr_b16 v[122:123], v148 offset:0
    ds_read_b64_tr_b16 v[124:125], v147 offset:12288
    ds_read_b64_tr_b16 v[126:127], v148 offset:12288
    ds_read_b64_tr_b16 v[248:249], v149 offset:0
    ds_read_b64_tr_b16 v[250:251], v150 offset:0
    ds_read_b64_tr_b16 v[252:253], v149 offset:12288
    ds_read_b64_tr_b16 v[254:255], v150 offset:12288
    s_waitcnt lgkmcnt(0)
    s_barrier
    s_mov_b32 s72, s65
    v_lshlrev_b32 v1, 4, v0
    s_lshl_b32 s86, s64, 15
    v_add_u32 v2, s86, v1
    ds_write_b128 v2, v[8:11] offset:0
    ds_write_b128 v2, v[12:15] offset:1024
    ds_write_b128 v2, v[16:19] offset:2048
    ds_write_b128 v2, v[20:23] offset:3072
    ds_write_b128 v2, v[24:27] offset:4096
    ds_write_b128 v2, v[28:31] offset:5120
    ds_write_b128 v2, v[32:35] offset:6144
    ds_write_b128 v2, v[36:39] offset:7168
    ds_write_b128 v2, v[40:43] offset:8192
    ds_write_b128 v2, v[44:47] offset:9216
    ds_write_b128 v2, v[48:51] offset:10240
    ds_write_b128 v2, v[52:55] offset:11264
    ds_write_b128 v2, v[56:59] offset:12288
    ds_write_b128 v2, v[60:63] offset:13312
    ds_write_b128 v2, v[64:67] offset:14336
    ds_write_b128 v2, v[68:71] offset:15360
    ds_write_b128 v2, v[72:75] offset:16384
    ds_write_b128 v2, v[76:79] offset:17408
    ds_write_b128 v2, v[80:83] offset:18432
    ds_write_b128 v2, v[84:87] offset:19456
    ds_write_b128 v2, v[88:91] offset:20480
    ds_write_b128 v2, v[92:95] offset:21504
    ds_write_b128 v2, v[96:99] offset:22528
    ds_write_b128 v2, v[100:103] offset:23552
    ds_write_b128 v2, v[104:107] offset:24576
    ds_write_b128 v2, v[108:111] offset:25600
    ds_write_b128 v2, v[112:115] offset:26624
    ds_write_b128 v2, v[116:119] offset:27648
    ds_write_b128 v2, v[120:123] offset:28672
    ds_write_b128 v2, v[124:127] offset:29696
    ds_write_b128 v2, v[128:131] offset:30720
    ds_write_b128 v2, v[132:135] offset:31744
    s_cmp_lg_u32 s64, 1
    s_cbranch_scc1 L_waok_58
    v_min_u32 v137, 31, v0
    v_lshlrev_b32 v137, 2, v137
    v_add_u32 v137, 0x603f00, v137
L_wa_57:
    buffer_load_dword v136, v137, s[48:51], 0 offen sc1
    s_waitcnt vmcnt(0)
    v_cmp_gt_u32 vcc, 1, v136
    s_cbranch_vccz L_waok_58
    s_sleep 12
    s_sub_u32 s67, s67, 1
    s_cbranch_scc1 K2_DONE
    s_branch L_wa_57
L_waok_58:
    s_barrier
    v_min_u32 v137, 2, v0
    v_lshlrev_b32 v137, 2, v137
    v_add_u32 v137, 0xc0, v137
L_wa_59:
    buffer_load_dword v136, v137, s[60:63], 0 offen sc1
    s_waitcnt vmcnt(0)
    v_cmp_gt_u32 vcc, 8192, v136
    s_cbranch_vccz L_waok_60
    s_sleep 12
    s_sub_u32 s67, s67, 1
    s_cbranch_scc1 K2_DONE
    s_branch L_wa_59
L_waok_60:
    v_readlane_b32 s68, v136, 0
    v_readlane_b32 s69, v136, 1
    v_readlane_b32 s70, v136, 2
    s_waitcnt lgkmcnt(0)
    s_and_b32 s68, s68, 0xff
    s_cmp_gt_u32 s68, 16
    s_cselect_b32 s68, 0x2000, 0
    s_and_b32 s69, s69, 0xff
    s_cmp_gt_u32 s69, 16
    s_cselect_b32 s69, 0x2000, 0
    s_and_b32 s70, s70, 0xff
    s_cmp_gt_u32 s70, 16
    s_cselect_b32 s70, 0x2000, 0
    v_and_b32 v130, 8, v0
    v_cmp_eq_u32 vcc, 0, v130
    v_mov_b32 v130, 0xeeee
    v_mov_b32 v8, 0x4444
    v_cndmask_b32 v130, v130, v8, vcc
    v_and_b32 v8, 15, v0
    v_lshrrev_b32 v9, 4, v0
    v_lshlrev_b32 v10, 2, v9
    v_and_b32 v10, 7, v10
    v_sub_u32 v10, v8, v10
    v_mov_b32 v11, 0x3f80
    v_mov_b32 v12, 0x3f800000
    v_mov_b32 v132, 0
    v_mov_b32 v133, 0
    v_cmp_eq_u32 vcc, 0, v10
    s_nop 1
    v_cndmask_b32 v132, v132, v11, vcc
    v_cmp_eq_u32 vcc, 1, v10
    s_nop 1
    v_cndmask_b32 v132, v132, v12, vcc
    v_cmp_eq_u32 vcc, 2, v10
    s_nop 1
    v_cndmask_b32 v133, v133, v11, vcc
    v_cmp_eq_u32 vcc, 3, v10
    s_nop 1
    v_cndmask_b32 v133, v133, v12, vcc
    v_mov_b32 v134, 0
    v_mov_b32 v135, 0
    v_cmp_eq_u32 vcc, 8, v10
    s_nop 1
    v_cndmask_b32 v134, v134, v11, vcc
    v_cmp_eq_u32 vcc, 9, v10
    s_nop 1
    v_cndmask_b32 v134, v134, v12, vcc
    v_cmp_eq_u32 vcc, 10, v10
    s_nop 1
    v_cndmask_b32 v135, v135, v11, vcc
    v_cmp_eq_u32 vcc, 11, v10
    s_nop 1
    v_cndmask_b32 v135, v135, v12, vcc
    v_mov_b32 v126, 0
    v_mov_b32 v127, 0
    v_and_b32 v10, 7, v8
    v_lshrrev_b32 v11, 3, v8
    v_lshlrev_b32 v12, 1, v9
    v_xor_b32 v12, v12, v10
    v_lshl_add_u32 v12, v10, 3, v12
    v_lshlrev_b32 v12, 4, v12
    v_lshl_add_u32 v12, v11, 12, v12
    s_lshl_b32 s86, s64, 10
    s_add_u32 s86, s86, 131072
    v_add_u32 v3, s86, v12
    v_xor_b32 v4, 16, v3
    v_and_b32 v12, 1, v9
    v_lshlrev_b32 v12, 7, v12
    v_lshl_add_u32 v12, v10, 4, v12
    v_lshl_add_u32 v12, v11, 10, v12
    s_lshl_b32 s86, s64, 8
    s_add_u32 s86, s86, 139264
    v_add_u32 v5, s86, v12
    v_lshrrev_b32 v10, 3, v0
    v_xor_b32 v6, v10, v0
    v_lshlrev_b32 v6, 4, v6
    s_lshl_b32 s86, s64, 12
    s_add_u32 s86, s86, 131072
    v_add_u32 v6, s86, v6
    v_bfe_u32 v11, v0, 2, 1
    v_lshlrev_b32 v11, 7, v11
    v_lshl_add_u32 v11, v10, 4, v11
    v_and_b32 v12, 3, v0
    v_lshl_add_u32 v11, v12, 2, v11
    s_lshl_b32 s86, s64, 10
    s_add_u32 s86, s86, 139264
    v_add_u32 v7, s86, v11
    v_bfe_u32 v11, v0, 1, 2
    v_lshlrev_b32 v12, 7, v11
    v_lshl_add_u32 v131, v10, 4, v12
    v_lshlrev_b32 v11, 2, v11
    v_and_b32 v12, 1, v0
    v_lshl_add_u32 v11, v12, 4, v11
    s_lshl_b32 s86, s64, 3
    v_add_u32 v10, s86, v10
    v_add_u32 v12, 0, v11
    v_cmp_le_u32 s[20:21], v12, v10
    v_add_u32 v12, 1, v11
    v_cmp_le_u32 s[22:23], v12, v10
    v_add_u32 v12, 2, v11
    v_cmp_le_u32 s[24:25], v12, v10
    v_add_u32 v12, 3, v11
    v_cmp_le_u32 s[26:27], v12, v10
    s_lshl_b32 s10, s64, 8
    s_add_u32 s10, s10, 161792
    s_lshl_b32 s11, s64, 10
    s_add_u32 s11, s11, 141312
    s_lshl_b32 s12, s64, 10
    s_cmp_ge_u32 s64, 2
    s_cselect_b32 s86, 8192, 0
    s_add_u32 s12, s12, s86
    s_add_u32 s12, s12, 6144
    s_mov_b32 s4, 0x55555555
    s_mov_b32 s5, 0x55555555
    s_mov_b32 s6, 0x1010101
    s_mov_b32 s7, 0x1010101
    s_mov_b32 s8, 0x0
    s_mov_b32 s9, 0xffffffff
    s_mov_b32 s84, 0x3dd53b95
    s_mov_b32 s85, 0
    s_mov_b32 s80, 0
    s_lshl_b32 s82, s72, 7
    s_add_u32 s82, s82, 0x600000
    s_lshl_b32 s83, s72, 2
    s_add_u32 s83, s83, 0x607000
    s_lshr_b32 s77, s72, 3
    s_lshl_b32 s77, s77, 14
    s_and_b32 s86, s72, 7
    s_mul_i32 s86, s86, 640
    s_add_u32 s77, s77, s86
    s_add_u32 s77, s77, 0x200000
    s_mul_i32 s78, s64, 20480
    s_mul_i32 s86, s72, 640
    s_add_u32 s78, s78, s86
    s_add_u32 s78, s78, 0xa00000
    s_mul_i32 s79, s72, 0x181000
    s_mul_i32 s86, s64, 6144
    s_add_u32 s79, s79, s86
    s_add_u32 s79, s79, 0x5000000
    s_mov_b32 s81, 1
    s_cmp_ge_u32 s80, s81
    s_cbranch_scc1 L_fwok_62
    v_mov_b32 v138, 0
L_fw_61:
    buffer_load_dwordx2 v[136:137], v138, s[48:51], s82 offen sc1
    s_waitcnt vmcnt(0)
    v_min_u32 v136, v136, v137
    s_nop 0
    v_readfirstlane_b32 s80, v136
    s_cmp_ge_u32 s80, s81
    s_cbranch_scc1 L_fwok_62
    s_sleep 2
    s_sub_u32 s67, s67, 1
    s_cbranch_scc1 K2_DONE
    s_branch L_fw_61
L_fwok_62:
    s_add_u32 s86, s79, 3072
    buffer_load_dwordx4 v[96:99], v1, s[48:51], s86 offen offset:0 sc1
    buffer_load_dwordx4 v[100:103], v1, s[48:51], s86 offen offset:1024 sc1
    buffer_load_dwordx4 v[104:107], v1, s[48:51], s86 offen offset:2048 sc1
    buffer_load_dwordx4 v[108:111], v1, s[48:51], s79 offen offset:0 sc1
    buffer_load_dwordx4 v[112:115], v1, s[48:51], s79 offen offset:1024 sc1
    buffer_load_dwordx4 v[116:119], v1, s[48:51], s79 offen offset:2048 sc1
    s_waitcnt vmcnt(0)
L_A_step_63:
    s_lshl_b32 s73, s66, 15
    s_add_u32 s73, s73, s68
    s_add_u32 s74, s73, 4096
    s_add_u32 s75, s73, 16384
    s_cmp_ge_u32 s66, 32
    s_cselect_b32 s86, s70, s69
    s_lshl_b32 s76, s66, 16
    s_add_u32 s76, s76, s86
    s_add_u32 s76, s76, s77
    ds_read_b128 v[72:75], v2 offset:0
    ds_read_b128 v[76:79], v2 offset:1024
    ds_read_b128 v[80:83], v2 offset:2048
    ds_read_b128 v[84:87], v2 offset:3072
    ds_read_b128 v[88:91], v2 offset:4096
    ds_read_b128 v[92:95], v2 offset:5120
    v_mov_b32 v48, 0
    v_mov_b32 v49, 0
    v_mov_b32 v50, 0
    v_mov_b32 v51, 0
    v_mov_b32 v52, 0
    v_mov_b32 v53, 0
    v_mov_b32 v54, 0
    v_mov_b32 v55, 0
    v_mov_b32 v56, 0
    v_mov_b32 v57, 0
    v_mov_b32 v58, 0
    v_mov_b32 v59, 0
    v_mov_b32 v60, 0
    v_mov_b32 v61, 0
    v_mov_b32 v62, 0
    v_mov_b32 v63, 0
    v_mov_b32 v64, 0
    v_mov_b32 v65, 0
    v_mov_b32 v66, 0
    v_mov_b32 v67, 0
    v_mov_b32 v68, 0
    v_mov_b32 v69, 0
    v_mov_b32 v70, 0
    v_mov_b32 v71, 0
    v_mov_b32 v148, 0
    s_cmp_lg_u32 s66, 63
    s_cselect_b32 s13, 1, 0
    s_cmp_eq_u32 s64, 0
    s_cselect_b32 s13, s13, 0
    v_add_u32 v159, 141312, v1
    v_lshlrev_b32 v158, 3, v1
    s_mov_b32 m0, s11
    s_add_u32 s30, s73, s12
    s_lshl_b32 s86, s72, 7
    s_add_u32 s86, s86, s75
    s_add_u32 s86, s86, 2048
    s_cmp_lg_u32 s64, 3
    s_cbranch_scc1 L_hwok_71
    s_mov_b64 s[32:33], -1
    s_mov_b64 s[34:35], -1
    s_mov_b64 s[36:37], -1
    s_mov_b64 s[38:39], -1
    s_waitcnt lgkmcnt(0)
    s_buffer_load_dwordx2 s[32:33], s[48:51], s86 glc
    s_nop 14
    s_buffer_load_dwordx2 s[34:35], s[48:51], s86 glc
    s_nop 14
    s_buffer_load_dwordx2 s[36:37], s[48:51], s86 glc
    s_nop 14
L_hw_70:
    s_buffer_load_dwordx2 s[38:39], s[48:51], s86 glc
    s_waitcnt lgkmcnt(6)
    s_max_u32 s31, s32, s33
    s_cmp_lg_u32 s31, -1
    s_cbranch_scc1 L_hwok_71
    s_buffer_load_dwordx2 s[32:33], s[48:51], s86 glc
    s_waitcnt lgkmcnt(6)
    s_max_u32 s31, s34, s35
    s_cmp_lg_u32 s31, -1
    s_cbranch_scc1 L_hwok_71
    s_buffer_load_dwordx2 s[34:35], s[48:51], s86 glc
    s_waitcnt lgkmcnt(6)
    s_max_u32 s31, s36, s37
    s_cmp_lg_u32 s31, -1
    s_cbranch_scc1 L_hwok_71
    s_buffer_load_dwordx2 s[36:37], s[48:51], s86 glc
    s_waitcnt lgkmcnt(6)
    s_max_u32 s31, s38, s39
    s_cmp_lg_u32 s31, -1
    s_cbranch_scc1 L_hwok_71
    s_sub_u32 s67, s67, 1
    s_cbranch_scc1 K2_DONE
    s_branch L_hw_70
L_hwok_71:
    s_barrier
    buffer_load_dwordx4 v[8:11], v1, s[48:51], s73 offen offset:0
    s_nop 11
    buffer_load_dwordx4 v[12:15], v1, s[48:51], s73 offen offset:1024
    s_nop 11
    buffer_load_dwordx4 v[16:19], v1, s[48:51], s73 offen offset:2048
    s_nop 11
    buffer_load_dwordx4 v1, s[48:51], s30 offen lds
    s_mov_b32 m0, s10
    s_add_u32 s30, s79, 24576
    s_nop 9
    buffer_load_dwordx4 v[20:23], v1, s[48:51], s73 offen offset:3072
    s_nop 11
    buffer_load_dwordx4 v[24:27], v1, s[48:51], s74 offen offset:0
    s_nop 11
    buffer_load_dwordx4 v[28:31], v1, s[48:51], s74 offen offset:1024
    s_waitcnt vmcnt(6)
    s_waitcnt lgkmcnt(4)
    v_smfmac_f32_16x16x64_bf16 v[48:51], v[8:11], v[72:79], v130
    ds_read_b128 v[72:75], v2 offset:6144
    v_smfmac_f32_16x16x64_bf16 v[52:55], v[8:11], a[0:7], v130
    ds_read_b128 v[76:79], v2 offset:7168
    s_waitcnt lgkmcnt(4)
    v_smfmac_f32_16x16x64_bf16 v[56:59], v[8:11], v[80:87], v130
    ds_read_b128 v[80:83], v2 offset:8192
    v_smfmac_f32_16x16x64_bf16 v[60:63], v[8:11], a[8:15], v130
    ds_read_b128 v[84:87], v2 offset:9216
    s_waitcnt lgkmcnt(4)
    v_smfmac_f32_16x16x64_bf16 v[64:67], v[8:11], v[88:95], v130
    ds_read_b128 v[88:91], v2 offset:10240
    buffer_load_dword v158, s[48:51], s30 offen sc1 lds
    s_waitcnt vmcnt(6)
    v_smfmac_f32_16x16x64_bf16 v[48:51], v[12:15], a[16:23], v130
    ds_read_b128 v[92:95], v2 offset:11264
    s_waitcnt lgkmcnt(4)
    v_smfmac_f32_16x16x64_bf16 v[52:55], v[12:15], v[72:79], v130
    ds_read_b128 v[72:75], v2 offset:12288
    v_smfmac_f32_16x16x64_bf16 v[56:59], v[12:15], a[24:31], v130
    ds_read_b128 v[76:79], v2 offset:13312
    s_waitcnt lgkmcnt(4)
    v_smfmac_f32_16x16x64_bf16 v[60:63], v[12:15], v[80:87], v130
    ds_read_b128 v[80:83], v2 offset:14336
    v_smfmac_f32_16x16x64_bf16 v[64:67], v[12:15], a[32:39], v130
    ds_read_b128 v[84:87], v2 offset:15360
    s_waitcnt vmcnt(5)
    s_waitcnt lgkmcnt(4)
    v_smfmac_f32_16x16x64_bf16 v[48:51], v[16:19], v[88:95], v130
    ds_read_b128 v[88:91], v2 offset:16384
    v_smfmac_f32_16x16x64_bf16 v[52:55], v[16:19], a[40:47], v130
    ds_read_b128 v[92:95], v2 offset:17408
    s_waitcnt lgkmcnt(4)
    v_smfmac_f32_16x16x64_bf16 v[56:59], v[16:19], v[72:79], v130
    ds_read_b128 v[72:75], v2 offset:18432
    v_smfmac_f32_16x16x64_bf16 v[60:63], v[16:19], a[48:55], v130
    ds_read_b128 v[76:79], v2 offset:19456
    s_waitcnt lgkmcnt(4)
    v_smfmac_f32_16x16x64_bf16 v[64:67], v[16:19], v[80:87], v130
    ds_read_b128 v[80:83], v2 offset:20480
    s_waitcnt vmcnt(3)
    v_smfmac_f32_16x16x64_bf16 v[48:51], v[20:23], a[56:63], v130
    ds_read_b128 v[84:87], v2 offset:21504
    s_waitcnt lgkmcnt(4)
    v_smfmac_f32_16x16x64_bf16 v[52:55], v[20:23], v[88:95], v130
    ds_read_b128 v[88:91], v2 offset:22528
    v_smfmac_f32_16x16x64_bf16 v[56:59], v[20:23], a[64:71], v130
    ds_read_b128 v[92:95], v2 offset:23552
    s_waitcnt lgkmcnt(4)
    v_smfmac_f32_16x16x64_bf16 v[60:63], v[20:23], v[72:79], v130
    ds_read_b128 v[72:75], v2 offset:24576
    v_smfmac_f32_16x16x64_bf16 v[64:67], v[20:23], a[72:79], v130
    ds_read_b128 v[76:79], v2 offset:25600
    s_barrier
    s_waitcnt vmcnt(2)
    v_smfmac_f32_16x16x64_bf16 v[48:51], v[24:27], a[80:87], v130
    ds_read_b128 v[32:35], v159 offset:0
    v_smfmac_f32_16x16x64_bf16 v[52:55], v[24:27], a[88:95], v130
    ds_read_b128 v[36:39], v159 offset:1024
    v_smfmac_f32_16x16x64_bf16 v[56:59], v[24:27], a[96:103], v130
    ds_read_b128 v[40:43], v159 offset:2048
    s_waitcnt lgkmcnt(7)
    v_smfmac_f32_16x16x64_bf16 v[60:63], v[24:27], v[80:87], v130
    ds_read_b128 v[80:83], v2 offset:26624
    s_waitcnt vmcnt(1)
    v_smfmac_f32_16x16x64_bf16 v[48:51], v[28:31], a[104:111], v130
    ds_read_b128 v[84:87], v2 offset:27648
    v_smfmac_f32_16x16x64_bf16 v[52:55], v[28:31], a[112:119], v130
    ds_read_b128 v[44:47], v159 offset:3072
    v_smfmac_f32_16x16x64_bf16 v[56:59], v[28:31], a[120:127], v130
    s_waitcnt lgkmcnt(8)
    v_smfmac_f32_16x16x64_bf16 v[60:63], v[28:31], v[88:95], v130
    ds_read_b128 v[88:91], v2 offset:28672
    s_waitcnt lgkmcnt(1)
    s_mov_b64 s[28:29], -1
    s_mov_b32 s30, s3
L_A_g2_67:
    v_smfmac_f32_16x16x64_bf16 v[48:51], v[32:35], a[128:135], v130
    ds_read_b128 v[92:95], v2 offset:29696
    v_smfmac_f32_16x16x64_bf16 v[48:51], v[36:39], v[72:79], v130
    ds_read_b128 v[72:75], v2 offset:30720
    v_smfmac_f32_16x16x64_bf16 v[48:51], v[40:43], a[136:143], v130
    ds_read_b128 v[76:79], v2 offset:31744
    v_smfmac_f32_16x16x64_bf16 v[48:51], v[44:47], a[144:151], v130
    s_nop 2
    v_smfmac_f32_16x16x64_bf16 v[56:59], v[32:35], a[152:159], v130
    s_nop 2
    v_smfmac_f32_16x16x64_bf16 v[56:59], v[36:39], a[160:167], v130
    v_cvt_pk_bf16_f32 v128, v48, v49
    v_smfmac_f32_16x16x64_bf16 v[56:59], v[40:43], a[168:175], v130
    v_cvt_pk_bf16_f32 v129, v50, v51
    v_smfmac_f32_16x16x64_bf16 v[56:59], v[44:47], a[176:183], v130
    s_nop 0
    v_mfma_f32_16x16x32_bf16 v[136:139], v[126:129], v[130:133], 0
    s_nop 2
    v_smfmac_f32_16x16x64_bf16 v[64:67], v[24:27], a[184:191], v130
    s_nop 1
    v_cvt_pk_bf16_f32 v128, v56, v57
    v_smfmac_f32_16x16x64_bf16 v[64:67], v[28:31], a[192:199], v130
    v_cvt_pk_bf16_f32 v120, v136, v137
    v_smfmac_f32_16x16x64_bf16 v[64:67], v[32:35], a[200:207], v130
    v_cvt_pk_bf16_f32 v121, v138, v139
    v_smfmac_f32_16x16x64_bf16 v[64:67], v[36:39], a[208:215], v130
    v_cmp_u_f32 vcc, v136, v136
    v_smfmac_f32_16x16x64_bf16 v[64:67], v[40:43], a[216:223], v130
    s_and_b64 vcc, vcc, s[28:29]
    s_cbranch_scc1 L_A_ret1_66
    v_cvt_pk_bf16_f32 v129, v58, v59
    v_smfmac_f32_16x16x64_bf16 v[64:67], v[44:47], a[224:231], v130
    s_nop 0
    v_mfma_f32_16x16x32_bf16 v[140:143], v[126:129], v[130:133], 0
    s_nop 2
    v_smfmac_f32_16x16x64_bf16 v[52:55], v[32:35], v[80:87], v130
    s_nop 1
    v_cvt_pk_bf16_f32 v128, v64, v65
    v_smfmac_f32_16x16x64_bf16 v[52:55], v[36:39], a[232:239], v130
    v_cvt_pk_bf16_f32 v122, v140, v141
    v_smfmac_f32_16x16x64_bf16 v[52:55], v[40:43], a[240:247], v130
    v_cvt_pk_bf16_f32 v123, v142, v143
    v_smfmac_f32_16x16x64_bf16 v[52:55], v[44:47], a[248:255], v130
    v_cvt_pk_bf16_f32 v129, v66, v67
    v_mfma_f32_16x16x32_bf16 v[148:151], v[96:99], v[120:123], 0
    s_nop 0
    v_mfma_f32_16x16x32_bf16 v[152:155], v[100:103], v[120:123], 0
    v_mfma_f32_16x16x32_bf16 v[144:147], v[126:129], v[130:133], 0
    s_nop 2
    v_smfmac_f32_16x16x64_bf16 v[60:63], v[32:35], v[160:167], v130
    v_cvt_pk_bf16_f32 v128, v52, v53
    v_smfmac_f32_16x16x64_bf16 v[60:63], v[36:39], v[168:175], v130
    v_cvt_pk_bf16_f32 v129, v54, v55
    v_smfmac_f32_16x16x64_bf16 v[60:63], v[40:43], v[176:183], v130
    v_cvt_pk_bf16_f32 v124, v144, v145
    v_mfma_f32_16x16x32_bf16 v[136:139], v[126:129], v[132:135], v[136:139]
    v_cvt_pk_bf16_f32 v125, v146, v147
    s_waitcnt lgkmcnt(2)
    v_smfmac_f32_16x16x64_bf16 v[60:63], v[44:47], v[88:95], v130
    s_nop 2
    v_mfma_f32_16x16x32_bf16 v[148:151], v[104:107], v[124:127], v[148:151]
    s_nop 0
    v_cvt_pk_bf16_f32 v120, v136, v137
    v_cvt_pk_bf16_f32 v121, v138, v139
    v_mfma_f32_16x16x32_bf16 v[152:155], v[106:109], v[124:127], v[152:155]
    v_cvt_pk_bf16_f32 v128, v60, v61
    v_cvt_pk_bf16_f32 v129, v62, v63
    v_smfmac_f32_16x16x64_bf16 v[68:71], v[8:11], v[184:191], v130
    s_nop 0
    ds_write_b128 v3, v[148:151]
    v_mfma_f32_16x16x32_bf16 v[140:143], v[126:129], v[132:135], v[140:143]
    s_nop 1
    ds_write_b128 v4, v[152:155]
    v_smfmac_f32_16x16x64_bf16 v[68:71], v[12:15], v[192:199], v130
    s_nop 2
    v_smfmac_f32_16x16x64_bf16 v[68:71], v[16:19], v[200:207], v130
    v_cvt_pk_bf16_f32 v122, v140, v141
    v_smfmac_f32_16x16x64_bf16 v[68:71], v[20:23], v[208:215], v130
    v_cvt_pk_bf16_f32 v123, v142, v143
    v_smfmac_f32_16x16x64_bf16 v[68:71], v[24:27], v[216:223], v130
    s_nop 0
    v_mfma_f32_16x16x32_bf16 v[156:159], v[120:123], v[120:123], 0
    s_nop 2
    v_smfmac_f32_16x16x64_bf16 v[68:71], v[28:31], v[224:231], v130
    s_waitcnt lgkmcnt(0)
    s_cmp_eq_u32 s13, 0
    s_barrier
    s_cbranch_scc1 L_A_oth_72
    ds_read_b128 v[48:51], v6 offset:0
    v_smfmac_f32_16x16x64_bf16 v[68:71], v[32:35], v[72:79], v130
    ds_read_b128 v[56:59], v6 offset:1024
    v_smfmac_f32_16x16x64_bf16 v[68:71], v[36:39], v[232:239], v130
    ds_read_b128 v[64:67], v6 offset:2048
    v_smfmac_f32_16x16x64_bf16 v[68:71], v[40:43], v[240:247], v130
    ds_read_b128 v[148:151], v6 offset:3072
    v_smfmac_f32_16x16x64_bf16 v[68:71], v[44:47], v[248:255], v130
    s_waitcnt lgkmcnt(0)
    v_add_f32 v48, v48, v56
    v_add_f32 v49, v49, v57
    v_add_f32 v50, v50, v58
    v_add_f32 v51, v51, v59
    v_add_f32 v64, v64, v148
    v_add_f32 v65, v65, v149
    v_add_f32 v66, v66, v150
    v_cvt_pk_bf16_f32 v128, v68, v69
    v_cvt_pk_bf16_f32 v129, v70, v71
    v_add_f32 v67, v67, v151
    v_add_f32 v32, v48, v64
    v_mfma_f32_16x16x32_bf16 v[144:147], v[126:129], v[132:135], v[144:147]
    v_add_f32 v33, v49, v65
    v_add_f32 v34, v50, v66
    v_add_f32 v35, v51, v67
    v_max3_f32 v36, v32, v33, v34
    v_max_f32 v36, v36, v35
    s_nop 1
    v_max_f32_dpp v36, v36, v36 quad_perm:[1,0,3,2] row_mask:0xf bank_mask:0xf
    v_cvt_pk_bf16_f32 v124, v144, v145
    v_cvt_pk_bf16_f32 v125, v146, v147
    v_max_f32_dpp v36, v36, v36 quad_perm:[2,3,0,1] row_mask:0xf bank_mask:0xf
    s_nop 0
    v_mfma_f32_16x16x32_bf16 v[156:159], v[124:127], v[124:127], v[156:159]
    v_max_f32_dpp v36, v36, v36 row_half_mirror row_mask:0xf bank_mask:0xf
    v_mul_f32 v36, s84, v36
    v_fma_f32 v32, v32, s84, -v36
    v_fma_f32 v33, v33, s84, -v36
    v_fma_f32 v34, v34, s84, -v36
    v_fma_f32 v35, v35, s84, -v36
    v_exp_f32 v32, v32
    s_mov_b64 exec, s[8:9]
    ds_write_b128 v5, v[156:159]
    s_mov_b64 exec, -1
    v_exp_f32 v33, v33
    v_exp_f32 v34, v34
    v_exp_f32 v35, v35
    s_nop 0
    v_pk_add_f32 v[38:39], v[32:33], v[34:35]
    v_add_f32 v38, v38, v39
    s_nop 1
    v_add_f32_dpp v38, v38, v38 quad_perm:[1,0,3,2] row_mask:0xf bank_mask:0xf
    s_waitcnt lgkmcnt(0)
    s_barrier
    ds_read_b32 v136, v7 offset:0
    ds_read_b32 v137, v7 offset:256
    ds_read_b32 v138, v7 offset:512
    ds_read_b32 v139, v7 offset:768
    v_add_f32_dpp v38, v38, v38 quad_perm:[2,3,0,1] row_mask:0xf bank_mask:0xf
    s_nop 1
    v_add_f32_dpp v38, v38, v38 row_half_mirror row_mask:0xf bank_mask:0xf
    s_nop 1
    s_waitcnt lgkmcnt(0)
    v_pk_add_f32 v[136:137], v[136:137], v[138:139]
    v_add_f32 v136, v136, v137
    v_mul_f32 v136, s84, v136
    v_max_f32 v138, v36, v136
    s_nop 1
    v_max_f32_dpp v138, v138, v138 quad_perm:[1,0,3,2] row_mask:0xf bank_mask:0xf
    s_nop 1
    v_max_f32_dpp v138, v138, v138 quad_perm:[2,3,0,1] row_mask:0xf bank_mask:0xf
    s_nop 1
    v_max_f32_dpp v138, v138, v138 row_half_mirror row_mask:0xf bank_mask:0xf
    v_sub_f32 v136, v136, v138
    v_sub_f32 v36, v36, v138
    v_exp_f32 v136, v136
    v_exp_f32 v36, v36
    s_nop 0
    v_add_f32_dpp v138, v136, v136 quad_perm:[1,0,3,2] row_mask:0xf bank_mask:0xf
    s_nop 1
    v_add_f32_dpp v138, v138, v138 quad_perm:[2,3,0,1] row_mask:0xf bank_mask:0xf
    s_nop 1
    v_add_f32_dpp v138, v138, v138 row_half_mirror row_mask:0xf bank_mask:0xf
    v_fma_f32 v138, v38, v36, v138
    v_rcp_f32 v138, v138
    s_nop 0
    v_mul_f32 v136, v136, v138
    v_mul_f32 v138, v36, v138
    v_pk_mul_f32 v[32:33], v[32:33], v[138:139] op_sel_hi:[1,0]
    v_mov_b32_dpp v137, v136 quad_perm:[1,1,3,3] row_mask:0xf bank_mask:0xf
    v_pk_mul_f32 v[34:35], v[34:35], v[138:139] op_sel_hi:[1,0]
    v_cvt_pk_bf16_f32 v140, v32, v33
    v_cvt_pk_bf16_f32 v144, v136, v137
    v_cvt_pk_bf16_f32 v141, v34, v35
    v_mov_b32_dpp v142, v140 quad_perm:[1,1,3,3] row_mask:0xf bank_mask:0xf
    v_mov_b32_dpp v145, v144 row_shl:2 row_mask:0xf bank_mask:0xf
    v_mov_b32_dpp v143, v141 quad_perm:[1,1,3,3] row_mask:0xf bank_mask:0xf
    v_mov_b32_dpp v146, v144 row_shl:4 row_mask:0xf bank_mask:0xf
    v_mov_b32_dpp v147, v144 row_shl:6 row_mask:0xf bank_mask:0xf
    s_mov_b64 exec, s[4:5]
    buffer_store_dwordx4 v[140:143], v131, s[48:51], s76 offen sc1
    s_mov_b64 exec, s[6:7]
    buffer_store_dwordx4 v[144:147], v131, s[48:51], s76 offen offset:512 sc1
    s_mov_b64 exec, -1
L_A_notw0_68:
    v_mfma_f32_16x16x32_bf16 v[8:11], v[96:99], v[108:111], 0
    v_mfma_f32_16x16x32_bf16 v[12:15], v[100:103], v[108:111], 0
    v_mfma_f32_16x16x32_bf16 v[16:19], v[120:123], v[108:111], 0
    v_mfma_f32_16x16x32_bf16 v[20:23], v[96:99], v[112:115], 0
    v_mfma_f32_16x16x32_bf16 v[24:27], v[100:103], v[112:115], 0
    v_mfma_f32_16x16x32_bf16 v[28:31], v[120:123], v[112:115], 0
    v_mfma_f32_16x16x16_bf16 v[8:11], v[104:105], v[116:117], v[8:11]
    v_mfma_f32_16x16x16_bf16 v[12:15], v[106:107], v[116:117], v[12:15]
    v_mfma_f32_16x16x16_bf16 v[16:19], v[124:125], v[116:117], v[16:19]
    v_mfma_f32_16x16x16_bf16 v[20:23], v[104:105], v[118:119], v[20:23]
    v_mfma_f32_16x16x16_bf16 v[24:27], v[106:107], v[118:119], v[24:27]
    v_mfma_f32_16x16x16_bf16 v[28:31], v[124:125], v[118:119], v[28:31]
    s_nop 4
    ds_write_b128 v3, v[8:11] offset:10240
    ds_write_b128 v4, v[12:15] offset:10240
    ds_write_b128 v3, v[20:23] offset:18432
    ds_write_b128 v4, v[24:27] offset:18432
    s_mov_b64 exec, s[8:9]
    ds_write_b128 v5, v[16:19] offset:18432
    ds_write_b128 v5, v[28:31] offset:20480
    s_mov_b64 exec, -1
    s_waitcnt vmcnt(0)
    s_cmp_eq_u32 s66, 63
    s_cbranch_scc1 L_A_noqk_73
    s_add_u32 s79, s79, 24576
    s_add_u32 s81, s66, 2
    s_cmp_ge_u32 s80, s81
    s_cbranch_scc1 L_fwok_75
    v_mov_b32 v138, 0
L_fw_74:
    buffer_load_dwordx2 v[136:137], v138, s[48:51], s82 offen sc1
    s_waitcnt vmcnt(0)
    v_min_u32 v136, v136, v137
    s_nop 0
    v_readfirstlane_b32 s80, v136
    s_cmp_ge_u32 s80, s81
    s_cbranch_scc1 L_fwok_75
    s_sleep 2
    s_sub_u32 s67, s67, 1
    s_cbranch_scc1 K2_DONE
    s_branch L_fw_74
L_fwok_75:
    s_add_u32 s86, s79, 3072
    buffer_load_dwordx4 v[96:99], v1, s[48:51], s86 offen offset:0 sc1
    buffer_load_dwordx4 v[100:103], v1, s[48:51], s86 offen offset:1024 sc1
    buffer_load_dwordx4 v[104:107], v1, s[48:51], s86 offen offset:2048 sc1
    buffer_load_dwordx4 v[108:111], v1, s[48:51], s79 offen offset:0 sc1
    buffer_load_dwordx4 v[112:115], v1, s[48:51], s79 offen offset:1024 sc1
    buffer_load_dwordx4 v[116:119], v1, s[48:51], s79 offen offset:2048 sc1
L_A_noqk_73:
    s_waitcnt lgkmcnt(0)
    s_barrier
    s_cmp_lg_u32 s64, 1
    s_cbranch_scc1 L_fs_76
    v_mov_b32 v136, s66
    v_mov_b32 v137, 0
    s_mov_b64 exec, 1
    buffer_store_dword v136, v137, s[48:51], s83 offen sc1
    s_mov_b64 exec, -1
L_fs_76:
    ds_read_b128 v[32:35], v6 offset:10240
    ds_read_b128 v[36:39], v6 offset:11264
    ds_read_b128 v[40:43], v6 offset:12288
    ds_read_b128 v[44:47], v6 offset:13312
    ds_read_b32 v136, v7 offset:18432
    ds_read_b32 v137, v7 offset:18688
    ds_read_b32 v138, v7 offset:18944
    ds_read_b32 v139, v7 offset:19200
    v_mov_b32 v140, 0xd04e79ff
    s_waitcnt lgkmcnt(4)
    v_pk_add_f32 v[32:33], v[32:33], v[36:37]
    v_pk_add_f32 v[34:35], v[34:35], v[38:39]
    v_pk_add_f32 v[40:41], v[40:41], v[44:45]
    v_pk_add_f32 v[42:43], v[42:43], v[46:47]
    v_pk_add_f32 v[32:33], v[32:33], v[40:41]
    v_pk_add_f32 v[34:35], v[34:35], v[42:43]
    v_cndmask_b32 v32, v140, v32, s[20:21]
    v_cndmask_b32 v33, v140, v33, s[22:23]
    v_cndmask_b32 v34, v140, v34, s[24:25]
    v_cndmask_b32 v35, v140, v35, s[26:27]
    v_max3_f32 v36, v32, v33, v34
    v_max_f32 v36, v36, v35
    s_waitcnt lgkmcnt(0)
    v_pk_add_f32 v[136:137], v[136:137], v[138:139]
    v_add_f32 v136, v136, v137
    v_max_f32 v138, v36, v136
    s_nop 1
    v_max_f32_dpp v138, v138, v138 quad_perm:[1,0,3,2] row_mask:0xf bank_mask:0xf
    s_nop 1
    v_max_f32_dpp v138, v138, v138 quad_perm:[2,3,0,1] row_mask:0xf bank_mask:0xf
    s_nop 1
    v_max_f32_dpp v138, v138, v138 row_half_mirror row_mask:0xf bank_mask:0xf
    v_mul_f32 v138, s84, v138
    v_fma_f32 v32, v32, s84, -v138
    v_fma_f32 v33, v33, s84, -v138
    v_fma_f32 v34, v34, s84, -v138
    v_fma_f32 v35, v35, s84, -v138
    v_fma_f32 v136, v136, s84, -v138
    v_exp_f32 v32, v32
    v_exp_f32 v33, v33
    v_exp_f32 v34, v34
    v_exp_f32 v35, v35
    v_exp_f32 v136, v136
    v_pk_add_f32 v[138:139], v[32:33], v[34:35]
    v_add_f32 v138, v138, v136
    v_add_f32 v138, v138, v139
    s_nop 1
    v_add_f32_dpp v138, v138, v138 quad_perm:[1,0,3,2] row_mask:0xf bank_mask:0xf
    s_nop 1
    v_add_f32_dpp v138, v138, v138 quad_perm:[2,3,0,1] row_mask:0xf bank_mask:0xf
    s_nop 1
    v_add_f32_dpp v138, v138, v138 row_half_mirror row_mask:0xf bank_mask:0xf
    v_rcp_f32 v138, v138
    s_nop 0
    v_mul_f32 v136, v136, v138
    v_pk_mul_f32 v[32:33], v[32:33], v[138:139] op_sel_hi:[1,0]
    v_pk_mul_f32 v[34:35], v[34:35], v[138:139] op_sel_hi:[1,0]
    v_mov_b32_dpp v137, v136 quad_perm:[1,1,3,3] row_mask:0xf bank_mask:0xf
    v_cvt_pk_bf16_f32 v140, v32, v33
    v_cvt_pk_bf16_f32 v141, v34, v35
    v_cvt_pk_bf16_f32 v144, v136, v137
    v_mov_b32_dpp v142, v140 quad_perm:[1,1,3,3] row_mask:0xf bank_mask:0xf
    v_mov_b32_dpp v143, v141 quad_perm:[1,1,3,3] row_mask:0xf bank_mask:0xf
    v_mov_b32_dpp v145, v144 row_shl:2 row_mask:0xf bank_mask:0xf
    v_mov_b32_dpp v146, v144 row_shl:4 row_mask:0xf bank_mask:0xf
    v_mov_b32_dpp v147, v144 row_shl:6 row_mask:0xf bank_mask:0xf
    s_mov_b64 exec, s[4:5]
    buffer_store_dwordx4 v[140:143], v131, s[48:51], s78 offen sc1
    s_mov_b64 exec, s[6:7]
    buffer_store_dwordx4 v[144:147], v131, s[48:51], s78 offen offset:512 sc1
    s_mov_b64 exec, -1
    s_cmp_eq_u32 s66, 63
    s_cbranch_scc1 L_A_last_69
    s_add_u32 s66, s66, 1
    s_add_u32 s78, s78, 81920
    s_branch L_A_step_63
L_A_oth_72:
    s_nop 0
    v_smfmac_f32_16x16x64_bf16 v[68:71], v[32:35], v[72:79], v130
    s_nop 0
    v_smfmac_f32_16x16x64_bf16 v[68:71], v[36:39], v[232:239], v130
    s_nop 0
    v_smfmac_f32_16x16x64_bf16 v[68:71], v[40:43], v[240:247], v130
    s_nop 0
    v_smfmac_f32_16x16x64_bf16 v[68:71], v[44:47], v[248:255], v130
    s_waitcnt lgkmcnt(0)
    s_nop 6
    v_cvt_pk_bf16_f32 v128, v68, v69
    v_cvt_pk_bf16_f32 v129, v70, v71
    s_nop 1
    v_mfma_f32_16x16x32_bf16 v[144:147], v[126:129], v[132:135], v[144:147]
    s_nop 7
    v_cvt_pk_bf16_f32 v124, v144, v145
    v_cvt_pk_bf16_f32 v125, v146, v147
    s_nop 1
    v_mfma_f32_16x16x32_bf16 v[156:159], v[124:127], v[124:127], v[156:159]
    s_nop 6
    s_mov_b64 exec, s[8:9]
    ds_write_b128 v5, v[156:159]
    s_mov_b64 exec, -1
    s_cmp_lt_i32 s30, 0
    s_cbranch_scc1 L_hs_77
L_hsgo_78:
    v_cmp_le_u32 vcc, 20, v0
    v_lshlrev_b32 v136, 7, v0
    v_add_u32 v137, 13824, v136
    v_cndmask_b32 v136, v136, v137, vcc
    s_add_u32 s31, s3, 0x201400
    s_sub_u32 s29, s76, s77
    v_add_u32 v136, s31, v136
    v_add_u32 v137, 32768, v136
    s_mov_b32 exec_hi, 0xff
    buffer_store_dword v136, v136, s[48:51], s29 offen sc1
    buffer_store_dword v136, v137, s[48:51], s29 offen sc1
    s_mov_b64 exec, -1
    s_branch L_hsen_79
L_hs_77:
    s_cmp_lt_i32 s3, 0
    s_cbranch_scc1 L_hsen_79
    s_sleep 8
    s_branch L_hsgo_78
L_hsen_79:
    s_cmp_lg_u32 s66, 63
    s_cbranch_scc1 L_A_near_80
    s_waitcnt vmcnt(0) lgkmcnt(0)
    s_barrier
    s_cmp_lg_u32 s64, 1
    s_cbranch_scc1 L_fs_81
    v_mov_b32 v136, s66
    v_mov_b32 v137, 0
    s_mov_b64 exec, 1
    buffer_store_dword v136, v137, s[48:51], s83 offen sc1
    s_mov_b64 exec, -1
L_fs_81:
    s_branch L_A_notw0_68
L_A_near_80:
    s_waitcnt lgkmcnt(0)
    s_barrier
    s_branch L_A_notw0_68
L_A_ret1_66:
    s_add_u32 s85, s85, 0
    s_min_u32 s85, s85, 0
    s_sub_u32 s67, s67, 1
    s_cbranch_scc1 K2_DONE
    s_waitcnt vmcnt(0) lgkmcnt(0)
    s_nop 7
    buffer_load_dwordx4 v[8:11], v1, s[48:51], s73 offen offset:0 sc1
    s_nop 11
    buffer_load_dwordx4 v[12:15], v1, s[48:51], s73 offen offset:1024 sc1
    s_nop 11
    buffer_load_dwordx4 v[16:19], v1, s[48:51], s73 offen offset:2048 sc1
    s_nop 11
    buffer_load_dwordx4 v[20:23], v1, s[48:51], s73 offen offset:3072 sc1
    s_nop 11
    buffer_load_dwordx4 v[24:27], v1, s[48:51], s74 offen offset:0 sc1
    s_nop 11
    buffer_load_dwordx4 v[28:31], v1, s[48:51], s74 offen offset:1024 sc1
    s_nop 11
    buffer_load_dwordx4 v[32:35], v1, s[48:51], s74 offen offset:2048 sc1
    s_nop 11
    buffer_load_dwordx4 v[36:39], v1, s[48:51], s74 offen offset:3072 sc1
    s_nop 11
    buffer_load_dwordx4 v[40:43], v1, s[48:51], s75 offen offset:0 sc1
    s_nop 11
    buffer_load_dwordx4 v[44:47], v1, s[48:51], s75 offen offset:1024 sc1
    ds_read_b128 v[72:75], v2 offset:0
    ds_read_b128 v[76:79], v2 offset:1024
    ds_read_b128 v[80:83], v2 offset:2048
    ds_read_b128 v[84:87], v2 offset:3072
    ds_read_b128 v[88:91], v2 offset:4096
    ds_read_b128 v[92:95], v2 offset:5120
    v_mov_b32 v48, 0
    v_mov_b32 v49, 0
    v_mov_b32 v50, 0
    v_mov_b32 v51, 0
    v_mov_b32 v52, 0
    v_mov_b32 v53, 0
    v_mov_b32 v54, 0
    v_mov_b32 v55, 0
    v_mov_b32 v56, 0
    v_mov_b32 v57, 0
    v_mov_b32 v58, 0
    v_mov_b32 v59, 0
    v_mov_b32 v60, 0
    v_mov_b32 v61, 0
    v_mov_b32 v62, 0
    v_mov_b32 v63, 0
    v_mov_b32 v64, 0
    v_mov_b32 v65, 0
    v_mov_b32 v66, 0
    v_mov_b32 v67, 0
    v_mov_b32 v68, 0
    v_mov_b32 v69, 0
    v_mov_b32 v70, 0
    v_mov_b32 v71, 0
    v_mov_b32 v148, 0
    s_waitcnt vmcnt(9)
    s_waitcnt lgkmcnt(4)
    v_smfmac_f32_16x16x64_bf16 v[48:51], v[8:11], v[72:79], v130
    ds_read_b128 v[72:75], v2 offset:6144
    v_smfmac_f32_16x16x64_bf16 v[52:55], v[8:11], a[0:7], v130
    ds_read_b128 v[76:79], v2 offset:7168
    s_waitcnt lgkmcnt(4)
    v_smfmac_f32_16x16x64_bf16 v[56:59], v[8:11], v[80:87], v130
    ds_read_b128 v[80:83], v2 offset:8192
    v_smfmac_f32_16x16x64_bf16 v[60:63], v[8:11], a[8:15], v130
    ds_read_b128 v[84:87], v2 offset:9216
    s_waitcnt lgkmcnt(4)
    v_smfmac_f32_16x16x64_bf16 v[64:67], v[8:11], v[88:95], v130
    ds_read_b128 v[88:91], v2 offset:10240
    s_waitcnt vmcnt(8)
    v_smfmac_f32_16x16x64_bf16 v[48:51], v[12:15], a[16:23], v130
    ds_read_b128 v[92:95], v2 offset:11264
    s_waitcnt lgkmcnt(4)
    v_smfmac_f32_16x16x64_bf16 v[52:55], v[12:15], v[72:79], v130
    ds_read_b128 v[72:75], v2 offset:12288
    v_smfmac_f32_16x16x64_bf16 v[56:59], v[12:15], a[24:31], v130
    ds_read_b128 v[76:79], v2 offset:13312
    s_waitcnt lgkmcnt(4)
    v_smfmac_f32_16x16x64_bf16 v[60:63], v[12:15], v[80:87], v130
    ds_read_b128 v[80:83], v2 offset:14336
    v_smfmac_f32_16x16x64_bf16 v[64:67], v[12:15], a[32:39], v130
    ds_read_b128 v[84:87], v2 offset:15360
    s_waitcnt vmcnt(7)
    s_waitcnt lgkmcnt(4)
    v_smfmac_f32_16x16x64_bf16 v[48:51], v[16:19], v[88:95], v130
    ds_read_b128 v[88:91], v2 offset:16384
    v_smfmac_f32_16x16x64_bf16 v[52:55], v[16:19], a[40:47], v130
    ds_read_b128 v[92:95], v2 offset:17408
    s_waitcnt lgkmcnt(4)
    v_smfmac_f32_16x16x64_bf16 v[56:59], v[16:19], v[72:79], v130
    ds_read_b128 v[72:75], v2 offset:18432
    v_smfmac_f32_16x16x64_bf16 v[60:63], v[16:19], a[48:55], v130
    ds_read_b128 v[76:79], v2 offset:19456
    s_waitcnt lgkmcnt(4)
    v_smfmac_f32_16x16x64_bf16 v[64:67], v[16:19], v[80:87], v130
    ds_read_b128 v[80:83], v2 offset:20480
    s_waitcnt vmcnt(6)
    v_smfmac_f32_16x16x64_bf16 v[48:51], v[20:23], a[56:63], v130
    ds_read_b128 v[84:87], v2 offset:21504
    s_waitcnt lgkmcnt(4)
    v_smfmac_f32_16x16x64_bf16 v[52:55], v[20:23], v[88:95], v130
    ds_read_b128 v[88:91], v2 offset:22528
    v_smfmac_f32_16x16x64_bf16 v[56:59], v[20:23], a[64:71], v130
    ds_read_b128 v[92:95], v2 offset:23552
    s_waitcnt lgkmcnt(4)
    v_smfmac_f32_16x16x64_bf16 v[60:63], v[20:23], v[72:79], v130
    ds_read_b128 v[72:75], v2 offset:24576
    v_smfmac_f32_16x16x64_bf16 v[64:67], v[20:23], a[72:79], v130
    ds_read_b128 v[76:79], v2 offset:25600
    s_waitcnt vmcnt(5)
    v_smfmac_f32_16x16x64_bf16 v[48:51], v[24:27], a[80:87], v130
    v_smfmac_f32_16x16x64_bf16 v[52:55], v[24:27], a[88:95], v130
    v_smfmac_f32_16x16x64_bf16 v[56:59], v[24:27], a[96:103], v130
    s_waitcnt lgkmcnt(4)
    v_smfmac_f32_16x16x64_bf16 v[60:63], v[24:27], v[80:87], v130
    ds_read_b128 v[80:83], v2 offset:26624
    s_waitcnt vmcnt(4)
    v_smfmac_f32_16x16x64_bf16 v[48:51], v[28:31], a[104:111], v130
    ds_read_b128 v[84:87], v2 offset:27648
    v_smfmac_f32_16x16x64_bf16 v[52:55], v[28:31], a[112:119], v130
    v_smfmac_f32_16x16x64_bf16 v[56:59], v[28:31], a[120:127], v130
    s_waitcnt lgkmcnt(4)
    v_smfmac_f32_16x16x64_bf16 v[60:63], v[28:31], v[88:95], v130
    ds_read_b128 v[88:91], v2 offset:28672
    s_waitcnt vmcnt(0) lgkmcnt(0)
    v_max3_u32 v148, v148, v8, v9
    v_max3_u32 v148, v148, v10, v11
    v_max3_u32 v148, v148, v12, v13
    v_max3_u32 v148, v148, v14, v15
    v_max3_u32 v148, v148, v16, v17
    v_max3_u32 v148, v148, v18, v19
    v_max3_u32 v148, v148, v20, v21
    v_max3_u32 v148, v148, v22, v23
    v_max3_u32 v148, v148, v24, v25
    v_max3_u32 v148, v148, v26, v27
    v_max3_u32 v148, v148, v28, v29
    v_max3_u32 v148, v148, v30, v31
    v_max3_u32 v148, v148, v32, v33
    v_max3_u32 v148, v148, v34, v35
    v_max3_u32 v148, v148, v36, v37
    v_max3_u32 v148, v148, v38, v39
    v_max3_u32 v148, v148, v40, v41
    v_max3_u32 v148, v148, v42, v43
    v_max3_u32 v148, v148, v44, v45
    v_max3_u32 v148, v148, v46, v47
    v_cmp_eq_u32 vcc, -1, v148
    s_cbranch_vccnz L_A_ret1_66
    s_mov_b64 s[28:29], 0
    s_mov_b32 s30, -1
    s_branch L_A_g2_67
L_A_last_69:
    s_waitcnt vmcnt(0)
    s_barrier
    s_mov_b32 s66, 64
    s_cmp_lg_u32 s64, 1
    s_cbranch_scc1 L_fs_82
    v_mov_b32 v136, s66
    v_mov_b32 v137, 0
    s_mov_b64 exec, 1
    buffer_store_dword v136, v137, s[48:51], s83 offen sc1
    s_mov_b64 exec, -1
L_fs_82:
    s_branch K2_DONE
K2_B:
    s_mov_b32 s75, 0x33333334
    s_mul_hi_u32 s70, s13, s75
    s_mul_i32 s75, s70, 5
    s_sub_u32 s71, s13, s75
    s_mov_b32 s52, s24
    s_mov_b32 s53, s25
    s_mov_b32 s54, 0x780000
    s_mov_b32 s55, 0x20000
    s_mov_b32 s56, s26
    s_mov_b32 s57, s27
    s_mov_b32 s58, 0x780000
    s_mov_b32 s59, 0x20000
    s_mov_b32 s4, s16
    s_mov_b32 s5, s17
    s_mov_b32 s6, 0x280000
    s_mov_b32 s7, 0x20000
    s_mov_b32 s8, s18
    s_mov_b32 s9, s19
    s_mov_b32 s10, 0x2800
    s_mov_b32 s11, 0x20000
    v_lshrrev_b32 v1, 3, v0
    v_and_b32 v2, 7, v0
    s_and_b32 s92, s64, 1
    s_lshl_b32 s93, s92, 2
    v_xor_b32 v3, s93, v1
    s_lshl_b32 s94, s64, 3
    v_add_u32 v4, s94, v3
    s_mov_b32 s94, 1280
    v_mul_lo_u32 v4, v4, s94
    v_lshrrev_b32 v5, 1, v2
    v_bfe_u32 v6, v1, 1, 2
    v_xor_b32 v5, v5, v6
    v_lshl_add_u32 v4, v5, 5, v4
    v_and_b32 v5, 1, v2
    v_lshl_add_u32 v11, v5, 4, v4
    v_lshrrev_b32 v1, 3, v0
    v_and_b32 v2, 7, v0
    v_xor_b32 v2, v2, v1
    v_mul_u32_u24 v1, 12288, v1
    v_lshl_add_u32 v10, v2, 4, v1
    v_lshrrev_b32 v1, 2, v0
    v_lshrrev_b32 v2, 4, v0
    v_xor_b32 v2, v2, v0
    v_and_b32 v2, 3, v2
    v_mul_u32_u24 v1, 1280, v1
    v_lshl_add_u32 v23, v2, 4, v1
    s_mul_i32 s79, s64, 98304
    s_mul_i32 s75, s70, 384
    s_add_u32 s79, s79, s75
    s_mul_i32 s80, s64, 20480
    s_lshl_b32 s76, s64, 10
    s_lshl_b32 s81, s71, 8
    s_mov_b32 s87, s79
    s_mul_i32 s75, s71, 1572864
    s_add_u32 s79, s79, s75
    s_mov_b32 s88, 0
    v_add_u32 v26, s80, v23
    s_add_u32 s80, s80, 81920
    s_add_u32 m0, s76, 0
    s_nop 0
    buffer_load_dwordx4 v10, s[52:55], s79 offen offset:0 lds
    s_add_u32 m0, s76, 3968
    s_nop 0
    buffer_load_dwordx4 v10, s[52:55], s79 offen offset:128 lds
    s_add_u32 m0, s76, 7936
    s_nop 0
    buffer_load_dwordx4 v10, s[52:55], s79 offen offset:256 lds
    s_add_u32 m0, s76, 12288
    s_nop 0
    buffer_load_dwordx4 v26, s[4:7], s81 offen lds
    s_mov_b32 m0, 16384
    s_nop 0
    buffer_load_dwordx4 v23, s[8:11], s81 offen lds
    s_add_u32 s79, s79, 393216
    s_add_u32 s81, s81, 64
    s_mul_i32 s74, s70, 245760
    s_lshl_b32 s75, s71, 8
    s_add_u32 s74, s74, s75
    s_add_u32 m0, s76, 110592
    s_nop 0
    buffer_load_dwordx4 v11, s[56:59], s74 offen offset:0 lds
    s_add_u32 m0, s76, 114560
    s_nop 0
    buffer_load_dwordx4 v11, s[56:59], s74 offen offset:128 lds
    s_add_u32 m0, s76, 118784
    s_add_u32 s74, s74, 40960
    buffer_load_dwordx4 v11, s[56:59], s74 offen offset:0 lds
    s_add_u32 m0, s76, 122752
    s_nop 0
    buffer_load_dwordx4 v11, s[56:59], s74 offen offset:128 lds
    s_add_u32 m0, s76, 126976
    s_add_u32 s74, s74, 40960
    buffer_load_dwordx4 v11, s[56:59], s74 offen offset:0 lds
    s_add_u32 m0, s76, 130944
    s_nop 0
    buffer_load_dwordx4 v11, s[56:59], s74 offen offset:128 lds
    s_add_u32 m0, s76, 135168
    s_add_u32 s74, s74, 40960
    buffer_load_dwordx4 v11, s[56:59], s74 offen offset:0 lds
    s_add_u32 m0, s76, 139136
    s_nop 0
    buffer_load_dwordx4 v11, s[56:59], s74 offen offset:128 lds
    s_add_u32 m0, s76, 143360
    s_add_u32 s74, s74, 40960
    buffer_load_dwordx4 v11, s[56:59], s74 offen offset:0 lds
    s_add_u32 m0, s76, 147328
    s_nop 0
    buffer_load_dwordx4 v11, s[56:59], s74 offen offset:128 lds
    s_add_u32 m0, s76, 151552
    s_add_u32 s74, s74, 40960
    buffer_load_dwordx4 v11, s[56:59], s74 offen offset:0 lds
    s_add_u32 m0, s76, 155520
    s_nop 0
    buffer_load_dwordx4 v11, s[56:59], s74 offen offset:128 lds
    s_add_u32 m0, s76, 17408
    s_nop 0
    buffer_load_dwordx4 v10, s[52:55], s79 offen offset:0 lds
    s_add_u32 m0, s76, 21376
    s_nop 0
    buffer_load_dwordx4 v10, s[52:55], s79 offen offset:128 lds
    s_add_u32 m0, s76, 25344
    s_nop 0
    buffer_load_dwordx4 v10, s[52:55], s79 offen offset:256 lds
    s_add_u32 m0, s76, 29696
    s_nop 0
    buffer_load_dwordx4 v26, s[4:7], s81 offen lds
    s_mov_b32 m0, 33792
    s_nop 0
    buffer_load_dwordx4 v23, s[8:11], s81 offen lds
    s_add_u32 s79, s79, 393216
    s_add_u32 s81, s81, 64
    s_add_u32 m0, s76, 34816
    s_nop 0
    buffer_load_dwordx4 v10, s[52:55], s79 offen offset:0 lds
    s_add_u32 m0, s76, 38784
    s_nop 0
    buffer_load_dwordx4 v10, s[52:55], s79 offen offset:128 lds
    s_add_u32 m0, s76, 42752
    s_nop 0
    buffer_load_dwordx4 v10, s[52:55], s79 offen offset:256 lds
    s_add_u32 m0, s76, 47104
    s_nop 0
    buffer_load_dwordx4 v26, s[4:7], s81 offen lds
    s_mov_b32 m0, 51200
    s_nop 0
    buffer_load_dwordx4 v23, s[8:11], s81 offen lds
    s_add_u32 s79, s79, 393216
    s_add_u32 s81, s81, 64
    s_mov_b32 s90, 0x10000
    buffer_load_dword v30, v23, s[8:11], s90 offen
    buffer_load_dword v30, v23, s[8:11], s90 offen
    v_and_b32 v1, 15, v0
    v_lshrrev_b32 v2, 4, v0
    v_and_b32 v3, 7, v0
    v_xor_b32 v3, v2, v3
    v_lshlrev_b32 v3, 4, v3
    v_lshl_add_u32 v12, v1, 7, v3
    v_xor_b32 v13, 64, v12
    v_lshrrev_b32 v3, 1, v2
    v_lshrrev_b32 v4, 2, v1
    v_xor_b32 v3, v3, v4
    v_lshlrev_b32 v3, 4, v3
    v_lshl_add_u32 v3, v1, 6, v3
    v_and_b32 v2, 1, v2
    v_lshl_add_u32 v3, v2, 3, v3
    v_add_u32 v24, 12288, v3
    v_xor_b32 v25, 32, v24
    v_lshrrev_b32 v1, 4, v0
    v_bfe_u32 v2, v0, 2, 2
    v_lshl_add_u32 v2, v1, 3, v2
    v_and_b32 v1, 1, v1
    v_lshlrev_b32 v1, 2, v1
    v_xor_b32 v2, v2, v1
    v_bfe_u32 v3, v2, 1, 2
    v_and_b32 v4, 3, v0
    v_lshlrev_b32 v4, 3, v4
    v_lshl_add_u32 v4, v2, 7, v4
    v_lshl_add_u32 v21, v3, 5, v4
    v_xor_b32 v22, 0x240, v21
    s_lshr_b32 s74, s64, 1
    s_lshl_b32 s74, s74, 12
    s_add_u32 s74, s74, 110592
    s_and_b32 s75, s64, 1
    s_lshl_b32 s75, s75, 6
    v_xor_b32 v21, s75, v21
    v_xor_b32 v22, s75, v22
    v_add_u32 v16, s74, v21
    v_add_u32 v17, s74, v22
    v_xor_b32 v18, 32, v16
    v_xor_b32 v19, 32, v17
    v_and_b32 v1, 7, v0
    v_lshlrev_b32 v1, 4, v1
    v_lshrrev_b32 v2, 4, v0
    v_lshl_add_u32 v21, v2, 8, v1
    v_bfe_u32 v22, v0, 3, 1
    s_mov_b32 s74, 331776
    v_mul_lo_u32 v2, v22, s74
    v_add_u32 v20, v21, v2
    s_lshl_b32 s82, s71, 3
    s_lshl_b32 s75, s64, 1
    s_add_u32 s82, s82, s75
    s_mul_i32 s74, s82, 663552
    s_lshr_b32 s75, s70, 1
    s_mul_i32 s75, s75, 20480
    s_add_u32 s74, s74, s75
    s_and_b32 s83, s70, 1
    s_lshl_b32 s83, s83, 7
    s_add_u32 s74, s74, s83
    s_add_u32 s89, s74, 0x2000000
    s_add_u32 s91, s89, 20480
    s_lshl_b32 s75, s71, 12
    s_add_u32 s72, s89, s75
    s_add_u32 s73, s72, 663552
    v_accvgpr_write_b32 a48, 0
    v_accvgpr_write_b32 a49, 0
    v_accvgpr_write_b32 a50, 0
    v_accvgpr_write_b32 a51, 0
    v_accvgpr_write_b32 a52, 0
    v_accvgpr_write_b32 a53, 0
    v_accvgpr_write_b32 a54, 0
    v_accvgpr_write_b32 a55, 0
    v_accvgpr_write_b32 a56, 0
    v_accvgpr_write_b32 a57, 0
    v_accvgpr_write_b32 a58, 0
    v_accvgpr_write_b32 a59, 0
    v_accvgpr_write_b32 a60, 0
    v_accvgpr_write_b32 a61, 0
    v_accvgpr_write_b32 a62, 0
    v_accvgpr_write_b32 a63, 0
    v_accvgpr_write_b32 a64, 0
    v_accvgpr_write_b32 a65, 0
    v_accvgpr_write_b32 a66, 0
    v_accvgpr_write_b32 a67, 0
    v_accvgpr_write_b32 a68, 0
    v_accvgpr_write_b32 a69, 0
    v_accvgpr_write_b32 a70, 0
    v_accvgpr_write_b32 a71, 0
    v_accvgpr_write_b32 a72, 0
    v_accvgpr_write_b32 a73, 0
    v_accvgpr_write_b32 a74, 0
    v_accvgpr_write_b32 a75, 0
    v_accvgpr_write_b32 a76, 0
    v_accvgpr_write_b32 a77, 0
    v_accvgpr_write_b32 a78, 0
    v_accvgpr_write_b32 a79, 0
    v_accvgpr_write_b32 a80, 0
    v_accvgpr_write_b32 a81, 0
    v_accvgpr_write_b32 a82, 0
    v_accvgpr_write_b32 a83, 0
    v_accvgpr_write_b32 a84, 0
    v_accvgpr_write_b32 a85, 0
    v_accvgpr_write_b32 a86, 0
    v_accvgpr_write_b32 a87, 0
    s_waitcnt vmcnt(12)
    s_barrier
    ds_read_b64_tr_b16 a[0:1], v16 offset:0
    ds_read_b64_tr_b16 a[2:3], v17 offset:0
    ds_read_b64_tr_b16 a[4:5], v18 offset:0
    ds_read_b64_tr_b16 a[6:7], v19 offset:0
    ds_read_b64_tr_b16 a[8:9], v16 offset:8192
    ds_read_b64_tr_b16 a[10:11], v17 offset:8192
    ds_read_b64_tr_b16 a[12:13], v18 offset:8192
    ds_read_b64_tr_b16 a[14:15], v19 offset:8192
    ds_read_b64_tr_b16 a[16:17], v16 offset:16384
    ds_read_b64_tr_b16 a[18:19], v17 offset:16384
    ds_read_b64_tr_b16 a[20:21], v18 offset:16384
    ds_read_b64_tr_b16 a[22:23], v19 offset:16384
    s_waitcnt lgkmcnt(0)
    ds_read_b64_tr_b16 a[24:25], v16 offset:24576
    ds_read_b64_tr_b16 a[26:27], v17 offset:24576
    ds_read_b64_tr_b16 a[28:29], v18 offset:24576
    ds_read_b64_tr_b16 a[30:31], v19 offset:24576
    ds_read_b64_tr_b16 a[32:33], v16 offset:32768
    ds_read_b64_tr_b16 a[34:35], v17 offset:32768
    ds_read_b64_tr_b16 a[36:37], v18 offset:32768
    ds_read_b64_tr_b16 a[38:39], v19 offset:32768
    ds_read_b64_tr_b16 a[40:41], v16 offset:40960
    ds_read_b64_tr_b16 a[42:43], v17 offset:40960
    ds_read_b64_tr_b16 a[44:45], v18 offset:40960
    ds_read_b64_tr_b16 a[46:47], v19 offset:40960
    s_waitcnt lgkmcnt(0)
    ds_read_b128 v[32:35], v12 offset:0
    ds_read_b128 v[36:39], v12 offset:2048
    ds_read_b128 v[40:43], v13 offset:0
    ds_read_b128 v[44:47], v13 offset:2048
    ds_read_b128 v[48:51], v12 offset:4096
    ds_read_b128 v[52:55], v12 offset:6144
    ds_read_b128 v[56:59], v13 offset:4096
    ds_read_b128 v[60:63], v13 offset:6144
    ds_read_b128 v[64:67], v12 offset:8192
    ds_read_b128 v[68:71], v12 offset:10240
    ds_read_b128 v[72:75], v13 offset:8192
    ds_read_b128 v[76:79], v13 offset:10240
    s_waitcnt vmcnt(7) lgkmcnt(0)
    s_barrier
    v_mfma_f32_16x16x32_bf16 v[168:171], v[32:35], a[0:3], 0
    ds_read_b128 v[80:83], v12 offset:17408
    v_mfma_f32_16x16x32_bf16 v[172:175], v[32:35], a[4:7], 0
    ds_read_b128 v[84:87], v12 offset:19456
    s_add_u32 m0, s76, 52224
    v_mfma_f32_16x16x32_bf16 v[176:179], v[36:39], a[0:3], 0
    buffer_load_dwordx4 v10, s[52:55], s79 offen offset:0 lds
    v_mfma_f32_16x16x32_bf16 v[180:183], v[36:39], a[4:7], 0
    ds_read_b128 v[88:91], v13 offset:17408
    v_mfma_f32_16x16x32_bf16 v[168:171], v[40:43], a[8:11], v[168:171]
    ds_read_b128 v[92:95], v13 offset:19456
    v_mfma_f32_16x16x32_bf16 v[172:175], v[40:43], a[12:15], v[172:175]
    ds_read_b128 v[96:99], v12 offset:21504
    v_mfma_f32_16x16x32_bf16 v[176:179], v[44:47], a[8:11], v[176:179]
    ds_read_b128 v[100:103], v12 offset:23552
    s_add_u32 m0, s76, 56192
    v_mfma_f32_16x16x32_bf16 v[180:183], v[44:47], a[12:15], v[180:183]
    buffer_load_dwordx4 v10, s[52:55], s79 offen offset:128 lds
    v_mfma_f32_16x16x32_bf16 v[168:171], v[48:51], a[16:19], v[168:171]
    ds_read_b128 v[104:107], v13 offset:21504
    v_mfma_f32_16x16x32_bf16 v[172:175], v[48:51], a[20:23], v[172:175]
    ds_read_b128 v[108:111], v13 offset:23552
    v_mfma_f32_16x16x32_bf16 v[176:179], v[52:55], a[16:19], v[176:179]
    ds_read_b128 v[112:115], v12 offset:25600
    v_mfma_f32_16x16x32_bf16 v[180:183], v[52:55], a[20:23], v[180:183]
    ds_read_b128 v[116:119], v12 offset:27648
    s_add_u32 m0, s76, 60160
    v_mfma_f32_16x16x32_bf16 v[168:171], v[56:59], a[24:27], v[168:171]
    buffer_load_dwordx4 v10, s[52:55], s79 offen offset:256 lds
    v_mfma_f32_16x16x32_bf16 v[172:175], v[56:59], a[28:31], v[172:175]
    ds_read_b64 v[128:129], v24 offset:0
    ds_read_b64 v[130:131], v25 offset:0
    v_mfma_f32_16x16x32_bf16 v[176:179], v[60:63], a[24:27], v[176:179]
    ds_read_b64 v[132:133], v24 offset:1024
    ds_read_b64 v[134:135], v25 offset:1024
    v_mfma_f32_16x16x32_bf16 v[180:183], v[60:63], a[28:31], v[180:183]
    ds_read_b64 v[136:137], v24 offset:2048
    ds_read_b64 v[138:139], v25 offset:2048
    v_mfma_f32_16x16x32_bf16 v[168:171], v[64:67], a[32:35], v[168:171]
    ds_read_b64 v[140:141], v24 offset:3072
    ds_read_b64 v[142:143], v25 offset:3072
    s_add_u32 m0, s76, 64512
    v_mfma_f32_16x16x32_bf16 v[172:175], v[64:67], a[36:39], v[172:175]
    buffer_load_dwordx4 v26, s[4:7], s81 offen lds
    ds_read_b64 v[144:145], v24 offset:4096
    ds_read_b64 v[146:147], v25 offset:4096
    v_mfma_f32_16x16x32_bf16 v[176:179], v[68:71], a[32:35], v[176:179]
    v_mfma_f32_16x16x32_bf16 v[180:183], v[68:71], a[36:39], v[180:183]
    v_mfma_f32_16x16x32_bf16 v[168:171], v[72:75], a[40:43], v[168:171]
    v_mfma_f32_16x16x32_bf16 v[172:175], v[72:75], a[44:47], v[172:175]
    s_mov_b32 m0, 68608
    v_mfma_f32_16x16x32_bf16 v[176:179], v[76:79], a[40:43], v[176:179]
    buffer_load_dwordx4 v23, s[8:11], s81 offen lds
    s_add_u32 s79, s79, 393216
    s_add_u32 s81, s81, 64
    v_mfma_f32_16x16x32_bf16 v[180:183], v[76:79], a[44:47], v[180:183]
    ds_read_b128 v[120:123], v13 offset:25600
    ds_read_b128 v[124:127], v13 offset:27648
    buffer_load_dword v30, v23, s[8:11], s90 offen
    buffer_load_dword v30, v23, s[8:11], s90 offen
L_bm_loop_83:
    s_waitcnt vmcnt(9) lgkmcnt(0)
    s_barrier
    s_cmp_eq_u32 s81, 1280
    s_cselect_b32 s81, 0, s81
    s_cselect_b32 s79, s87, s79
    s_add_u32 s88, s88, 1
    s_cmp_eq_u32 s88, 5
    s_cselect_b32 s79, 0x40000000, s79
    s_cmp_eq_u32 s72, s91
    s_cselect_b32 s72, s89, s72
    s_add_u32 s73, s72, 663552
    v_mfma_f32_16x16x32_bf16 v[184:187], v[80:83], a[0:3], 0
    ds_read_b128 v[32:35], v12 offset:34816
    v_mfma_f32_16x16x32_bf16 v[188:191], v[80:83], a[4:7], 0
    ds_read_b128 v[36:39], v12 offset:36864
    s_add_u32 m0, s76, 0
    v_mfma_f32_16x16x32_bf16 v[192:195], v[84:87], a[0:3], 0
    buffer_load_dwordx4 v10, s[52:55], s79 offen offset:0 lds
    v_mfma_f32_16x16x32_bf16 v[196:199], v[84:87], a[4:7], 0
    ds_read_b128 v[40:43], v13 offset:34816
    v_cvt_pk_bf16_f32 v200, v168, v169
    v_mfma_f32_16x16x32_bf16 v[184:187], v[88:91], a[8:11], v[184:187]
    ds_read_b128 v[44:47], v13 offset:36864
    v_cvt_pk_bf16_f32 v201, v170, v171
    v_mfma_f32_16x16x32_bf16 v[188:191], v[88:91], a[12:15], v[188:191]
    ds_read_b128 v[48:51], v12 offset:38912
    v_cvt_pk_bf16_f32 v202, v176, v177
    v_mfma_f32_16x16x32_bf16 v[192:195], v[92:95], a[8:11], v[192:195]
    ds_read_b128 v[52:55], v12 offset:40960
    v_cvt_pk_bf16_f32 v203, v178, v179
    s_add_u32 m0, s76, 3968
    v_mfma_f32_16x16x32_bf16 v[196:199], v[92:95], a[12:15], v[196:199]
    buffer_load_dwordx4 v10, s[52:55], s79 offen offset:128 lds
    v_cvt_pk_bf16_f32 v204, v172, v173
    v_mfma_f32_16x16x32_bf16 v[184:187], v[96:99], a[16:19], v[184:187]
    ds_read_b128 v[56:59], v13 offset:38912
    v_cvt_pk_bf16_f32 v205, v174, v175
    v_mfma_f32_16x16x32_bf16 v[188:191], v[96:99], a[20:23], v[188:191]
    ds_read_b128 v[60:63], v13 offset:40960
    v_cvt_pk_bf16_f32 v206, v180, v181
    v_mfma_f32_16x16x32_bf16 v[192:195], v[100:103], a[16:19], v[192:195]
    ds_read_b128 v[64:67], v12 offset:43008
    v_cvt_pk_bf16_f32 v207, v182, v183
    v_mfma_f32_16x16x32_bf16 v[196:199], v[100:103], a[20:23], v[196:199]
    ds_read_b128 v[68:71], v12 offset:45056
    s_add_u32 m0, s76, 7936
    v_mfma_f32_16x16x32_bf16 v[184:187], v[104:107], a[24:27], v[184:187]
    buffer_load_dwordx4 v10, s[52:55], s79 offen offset:256 lds
    v_mfma_f32_16x16x32_bf16 a[48:51], v[128:131], v[200:203], a[48:51]
    ds_read_b128 v[72:75], v13 offset:43008
    v_mfma_f32_16x16x32_bf16 a[52:55], v[128:131], v[204:207], a[52:55]
    ds_read_b128 v[76:79], v13 offset:45056
    v_mfma_f32_16x16x32_bf16 a[56:59], v[132:135], v[200:203], a[56:59]
    v_mfma_f32_16x16x32_bf16 a[60:63], v[132:135], v[204:207], a[60:63]
    s_add_u32 m0, s76, 12288
    v_mfma_f32_16x16x32_bf16 a[64:67], v[136:139], v[200:203], a[64:67]
    buffer_load_dwordx4 v26, s[4:7], s81 offen lds
    v_mfma_f32_16x16x32_bf16 a[68:71], v[136:139], v[204:207], a[68:71]
    v_mfma_f32_16x16x32_bf16 a[72:75], v[140:143], v[200:203], a[72:75]
    v_mfma_f32_16x16x32_bf16 a[76:79], v[140:143], v[204:207], a[76:79]
    v_mfma_f32_16x16x32_bf16 a[80:83], v[144:147], v[200:203], a[80:83]
    s_mov_b32 m0, 16384
    v_mfma_f32_16x16x32_bf16 a[84:87], v[144:147], v[204:207], a[84:87]
    buffer_load_dwordx4 v23, s[8:11], s81 offen lds
    s_add_u32 s79, s79, 393216
    s_add_u32 s81, s81, 64
    v_mfma_f32_16x16x32_bf16 v[188:191], v[104:107], a[28:31], v[188:191]
    v_swap_b32 v201, v202
    v_swap_b32 v205, v206
    v_mfma_f32_16x16x32_bf16 v[192:195], v[108:111], a[24:27], v[192:195]
    v_permlane32_swap_b32 v200, v201
    v_mfma_f32_16x16x32_bf16 v[196:199], v[108:111], a[28:31], v[196:199]
    v_permlane32_swap_b32 v202, v203
    buffer_store_dwordx4 v[200:203], v20, s[48:51], s72 offen sc1
    s_add_u32 s72, s72, 1024
    v_mfma_f32_16x16x32_bf16 v[184:187], v[112:115], a[32:35], v[184:187]
    v_permlane32_swap_b32 v204, v205
    v_permlane32_swap_b32 v206, v207
    v_mfma_f32_16x16x32_bf16 v[188:191], v[112:115], a[36:39], v[188:191]
    buffer_store_dwordx4 v[204:207], v20, s[48:51], s73 offen sc1
    s_add_u32 s73, s73, 1024
    ds_read_b64 v[128:129], v24 offset:17408
    v_mfma_f32_16x16x32_bf16 v[192:195], v[116:119], a[32:35], v[192:195]
    ds_read_b64 v[130:131], v25 offset:17408
    ds_read_b64 v[132:133], v24 offset:18432
    v_mfma_f32_16x16x32_bf16 v[196:199], v[116:119], a[36:39], v[196:199]
    ds_read_b64 v[134:135], v25 offset:18432
    ds_read_b64 v[136:137], v24 offset:19456
    v_mfma_f32_16x16x32_bf16 v[184:187], v[120:123], a[40:43], v[184:187]
    ds_read_b64 v[138:139], v25 offset:19456
    ds_read_b64 v[140:141], v24 offset:20480
    v_mfma_f32_16x16x32_bf16 v[188:191], v[120:123], a[44:47], v[188:191]
    ds_read_b64 v[142:143], v25 offset:20480
    ds_read_b64 v[144:145], v24 offset:21504
    v_mfma_f32_16x16x32_bf16 v[192:195], v[124:127], a[40:43], v[192:195]
    ds_read_b64 v[146:147], v25 offset:21504
    v_mfma_f32_16x16x32_bf16 v[196:199], v[124:127], a[44:47], v[196:199]
    s_waitcnt vmcnt(9) lgkmcnt(0)
    s_barrier
    v_mfma_f32_16x16x32_bf16 v[168:171], v[32:35], a[0:3], 0
    ds_read_b128 v[80:83], v12 offset:52224
    v_mfma_f32_16x16x32_bf16 v[172:175], v[32:35], a[4:7], 0
    ds_read_b128 v[84:87], v12 offset:54272
    s_add_u32 m0, s76, 17408
    v_mfma_f32_16x16x32_bf16 v[176:179], v[36:39], a[0:3], 0
    buffer_load_dwordx4 v10, s[52:55], s79 offen offset:0 lds
    v_mfma_f32_16x16x32_bf16 v[180:183], v[36:39], a[4:7], 0
    ds_read_b128 v[88:91], v13 offset:52224
    v_cvt_pk_bf16_f32 v200, v184, v185
    v_mfma_f32_16x16x32_bf16 v[168:171], v[40:43], a[8:11], v[168:171]
    ds_read_b128 v[92:95], v13 offset:54272
    v_cvt_pk_bf16_f32 v201, v186, v187
    v_mfma_f32_16x16x32_bf16 v[172:175], v[40:43], a[12:15], v[172:175]
    ds_read_b128 v[96:99], v12 offset:56320
    v_cvt_pk_bf16_f32 v202, v192, v193
    v_mfma_f32_16x16x32_bf16 v[176:179], v[44:47], a[8:11], v[176:179]
    ds_read_b128 v[100:103], v12 offset:58368
    v_cvt_pk_bf16_f32 v203, v194, v195
    s_add_u32 m0, s76, 21376
    v_mfma_f32_16x16x32_bf16 v[180:183], v[44:47], a[12:15], v[180:183]
    buffer_load_dwordx4 v10, s[52:55], s79 offen offset:128 lds
    v_cvt_pk_bf16_f32 v204, v188, v189
    v_mfma_f32_16x16x32_bf16 v[168:171], v[48:51], a[16:19], v[168:171]
    ds_read_b128 v[104:107], v13 offset:56320
    v_cvt_pk_bf16_f32 v205, v190, v191
    v_mfma_f32_16x16x32_bf16 v[172:175], v[48:51], a[20:23], v[172:175]
    ds_read_b128 v[108:111], v13 offset:58368
    v_cvt_pk_bf16_f32 v206, v196, v197
    v_mfma_f32_16x16x32_bf16 v[176:179], v[52:55], a[16:19], v[176:179]
    ds_read_b128 v[112:115], v12 offset:60416
    v_cvt_pk_bf16_f32 v207, v198, v199
    v_mfma_f32_16x16x32_bf16 v[180:183], v[52:55], a[20:23], v[180:183]
    ds_read_b128 v[116:119], v12 offset:62464
    s_add_u32 m0, s76, 25344
    v_mfma_f32_16x16x32_bf16 v[168:171], v[56:59], a[24:27], v[168:171]
    buffer_load_dwordx4 v10, s[52:55], s79 offen offset:256 lds
    v_mfma_f32_16x16x32_bf16 a[48:51], v[128:131], v[200:203], a[48:51]
    ds_read_b128 v[120:123], v13 offset:60416
    v_mfma_f32_16x16x32_bf16 a[52:55], v[128:131], v[204:207], a[52:55]
    ds_read_b128 v[124:127], v13 offset:62464
    v_mfma_f32_16x16x32_bf16 a[56:59], v[132:135], v[200:203], a[56:59]
    v_mfma_f32_16x16x32_bf16 a[60:63], v[132:135], v[204:207], a[60:63]
    s_add_u32 m0, s76, 29696
    v_mfma_f32_16x16x32_bf16 a[64:67], v[136:139], v[200:203], a[64:67]
    buffer_load_dwordx4 v26, s[4:7], s81 offen lds
    v_mfma_f32_16x16x32_bf16 a[68:71], v[136:139], v[204:207], a[68:71]
    v_mfma_f32_16x16x32_bf16 a[72:75], v[140:143], v[200:203], a[72:75]
    v_mfma_f32_16x16x32_bf16 a[76:79], v[140:143], v[204:207], a[76:79]
    v_mfma_f32_16x16x32_bf16 a[80:83], v[144:147], v[200:203], a[80:83]
    s_mov_b32 m0, 33792
    v_mfma_f32_16x16x32_bf16 a[84:87], v[144:147], v[204:207], a[84:87]
    buffer_load_dwordx4 v23, s[8:11], s81 offen lds
    s_add_u32 s79, s79, 393216
    s_add_u32 s81, s81, 64
    v_mfma_f32_16x16x32_bf16 v[172:175], v[56:59], a[28:31], v[172:175]
    v_swap_b32 v201, v202
    v_swap_b32 v205, v206
    v_mfma_f32_16x16x32_bf16 v[176:179], v[60:63], a[24:27], v[176:179]
    v_permlane32_swap_b32 v200, v201
    v_mfma_f32_16x16x32_bf16 v[180:183], v[60:63], a[28:31], v[180:183]
    v_permlane32_swap_b32 v202, v203
    buffer_store_dwordx4 v[200:203], v20, s[48:51], s72 offen sc1
    s_add_u32 s72, s72, 1024
    v_mfma_f32_16x16x32_bf16 v[168:171], v[64:67], a[32:35], v[168:171]
    v_permlane32_swap_b32 v204, v205
    v_permlane32_swap_b32 v206, v207
    v_mfma_f32_16x16x32_bf16 v[172:175], v[64:67], a[36:39], v[172:175]
    buffer_store_dwordx4 v[204:207], v20, s[48:51], s73 offen sc1
    s_add_u32 s73, s73, 1024
    ds_read_b64 v[128:129], v24 offset:34816
    v_mfma_f32_16x16x32_bf16 v[176:179], v[68:71], a[32:35], v[176:179]
    ds_read_b64 v[130:131], v25 offset:34816
    ds_read_b64 v[132:133], v24 offset:35840
    v_mfma_f32_16x16x32_bf16 v[180:183], v[68:71], a[36:39], v[180:183]
    ds_read_b64 v[134:135], v25 offset:35840
    ds_read_b64 v[136:137], v24 offset:36864
    v_mfma_f32_16x16x32_bf16 v[168:171], v[72:75], a[40:43], v[168:171]
    ds_read_b64 v[138:139], v25 offset:36864
    ds_read_b64 v[140:141], v24 offset:37888
    v_mfma_f32_16x16x32_bf16 v[172:175], v[72:75], a[44:47], v[172:175]
    ds_read_b64 v[142:143], v25 offset:37888
    ds_read_b64 v[144:145], v24 offset:38912
    v_mfma_f32_16x16x32_bf16 v[176:179], v[76:79], a[40:43], v[176:179]
    ds_read_b64 v[146:147], v25 offset:38912
    v_mfma_f32_16x16x32_bf16 v[180:183], v[76:79], a[44:47], v[180:183]
    s_waitcnt vmcnt(9) lgkmcnt(0)
    s_barrier
    v_mfma_f32_16x16x32_bf16 v[184:187], v[80:83], a[0:3], 0
    ds_read_b128 v[32:35], v12 offset:0
    v_mfma_f32_16x16x32_bf16 v[188:191], v[80:83], a[4:7], 0
    ds_read_b128 v[36:39], v12 offset:2048
    s_add_u32 m0, s76, 34816
    v_mfma_f32_16x16x32_bf16 v[192:195], v[84:87], a[0:3], 0
    buffer_load_dwordx4 v10, s[52:55], s79 offen offset:0 lds
    v_mfma_f32_16x16x32_bf16 v[196:199], v[84:87], a[4:7], 0
    ds_read_b128 v[40:43], v13 offset:0
    v_cvt_pk_bf16_f32 v200, v168, v169
    v_mfma_f32_16x16x32_bf16 v[184:187], v[88:91], a[8:11], v[184:187]
    ds_read_b128 v[44:47], v13 offset:2048
    v_cvt_pk_bf16_f32 v201, v170, v171
    v_mfma_f32_16x16x32_bf16 v[188:191], v[88:91], a[12:15], v[188:191]
    ds_read_b128 v[48:51], v12 offset:4096
    v_cvt_pk_bf16_f32 v202, v176, v177
    v_mfma_f32_16x16x32_bf16 v[192:195], v[92:95], a[8:11], v[192:195]
    ds_read_b128 v[52:55], v12 offset:6144
    v_cvt_pk_bf16_f32 v203, v178, v179
    s_add_u32 m0, s76, 38784
    v_mfma_f32_16x16x32_bf16 v[196:199], v[92:95], a[12:15], v[196:199]
    buffer_load_dwordx4 v10, s[52:55], s79 offen offset:128 lds
    v_cvt_pk_bf16_f32 v204, v172, v173
    v_mfma_f32_16x16x32_bf16 v[184:187], v[96:99], a[16:19], v[184:187]
    ds_read_b128 v[56:59], v13 offset:4096
    v_cvt_pk_bf16_f32 v205, v174, v175
    v_mfma_f32_16x16x32_bf16 v[188:191], v[96:99], a[20:23], v[188:191]
    ds_read_b128 v[60:63], v13 offset:6144
    v_cvt_pk_bf16_f32 v206, v180, v181
    v_mfma_f32_16x16x32_bf16 v[192:195], v[100:103], a[16:19], v[192:195]
    ds_read_b128 v[64:67], v12 offset:8192
    v_cvt_pk_bf16_f32 v207, v182, v183
    v_mfma_f32_16x16x32_bf16 v[196:199], v[100:103], a[20:23], v[196:199]
    ds_read_b128 v[68:71], v12 offset:10240
    s_add_u32 m0, s76, 42752
    v_mfma_f32_16x16x32_bf16 v[184:187], v[104:107], a[24:27], v[184:187]
    buffer_load_dwordx4 v10, s[52:55], s79 offen offset:256 lds
    v_mfma_f32_16x16x32_bf16 a[48:51], v[128:131], v[200:203], a[48:51]
    ds_read_b128 v[72:75], v13 offset:8192
    v_mfma_f32_16x16x32_bf16 a[52:55], v[128:131], v[204:207], a[52:55]
    ds_read_b128 v[76:79], v13 offset:10240
    v_mfma_f32_16x16x32_bf16 a[56:59], v[132:135], v[200:203], a[56:59]
    v_mfma_f32_16x16x32_bf16 a[60:63], v[132:135], v[204:207], a[60:63]
    s_add_u32 m0, s76, 47104
    v_mfma_f32_16x16x32_bf16 a[64:67], v[136:139], v[200:203], a[64:67]
    buffer_load_dwordx4 v26, s[4:7], s81 offen lds
    v_mfma_f32_16x16x32_bf16 a[68:71], v[136:139], v[204:207], a[68:71]
    v_mfma_f32_16x16x32_bf16 a[72:75], v[140:143], v[200:203], a[72:75]
    v_mfma_f32_16x16x32_bf16 a[76:79], v[140:143], v[204:207], a[76:79]
    v_mfma_f32_16x16x32_bf16 a[80:83], v[144:147], v[200:203], a[80:83]
    s_mov_b32 m0, 51200
    v_mfma_f32_16x16x32_bf16 a[84:87], v[144:147], v[204:207], a[84:87]
    buffer_load_dwordx4 v23, s[8:11], s81 offen lds
    s_add_u32 s79, s79, 393216
    s_add_u32 s81, s81, 64
    v_mfma_f32_16x16x32_bf16 v[188:191], v[104:107], a[28:31], v[188:191]
    v_swap_b32 v201, v202
    v_swap_b32 v205, v206
    v_mfma_f32_16x16x32_bf16 v[192:195], v[108:111], a[24:27], v[192:195]
    v_permlane32_swap_b32 v200, v201
    v_mfma_f32_16x16x32_bf16 v[196:199], v[108:111], a[28:31], v[196:199]
    v_permlane32_swap_b32 v202, v203
    buffer_store_dwordx4 v[200:203], v20, s[48:51], s72 offen sc1
    s_add_u32 s72, s72, 1024
    v_mfma_f32_16x16x32_bf16 v[184:187], v[112:115], a[32:35], v[184:187]
    v_permlane32_swap_b32 v204, v205
    v_permlane32_swap_b32 v206, v207
    v_mfma_f32_16x16x32_bf16 v[188:191], v[112:115], a[36:39], v[188:191]
    buffer_store_dwordx4 v[204:207], v20, s[48:51], s73 offen sc1
    s_add_u32 s73, s73, 1024
    ds_read_b64 v[128:129], v24 offset:52224
    v_mfma_f32_16x16x32_bf16 v[192:195], v[116:119], a[32:35], v[192:195]
    ds_read_b64 v[130:131], v25 offset:52224
    ds_read_b64 v[132:133], v24 offset:53248
    v_mfma_f32_16x16x32_bf16 v[196:199], v[116:119], a[36:39], v[196:199]
    ds_read_b64 v[134:135], v25 offset:53248
    ds_read_b64 v[136:137], v24 offset:54272
    v_mfma_f32_16x16x32_bf16 v[184:187], v[120:123], a[40:43], v[184:187]
    ds_read_b64 v[138:139], v25 offset:54272
    ds_read_b64 v[140:141], v24 offset:55296
    v_mfma_f32_16x16x32_bf16 v[188:191], v[120:123], a[44:47], v[188:191]
    ds_read_b64 v[142:143], v25 offset:55296
    ds_read_b64 v[144:145], v24 offset:56320
    v_mfma_f32_16x16x32_bf16 v[192:195], v[124:127], a[40:43], v[192:195]
    ds_read_b64 v[146:147], v25 offset:56320
    v_mfma_f32_16x16x32_bf16 v[196:199], v[124:127], a[44:47], v[196:199]
    s_waitcnt vmcnt(9) lgkmcnt(0)
    s_barrier
    v_mfma_f32_16x16x32_bf16 v[168:171], v[32:35], a[0:3], 0
    ds_read_b128 v[80:83], v12 offset:17408
    v_mfma_f32_16x16x32_bf16 v[172:175], v[32:35], a[4:7], 0
    ds_read_b128 v[84:87], v12 offset:19456
    s_add_u32 m0, s76, 52224
    v_mfma_f32_16x16x32_bf16 v[176:179], v[36:39], a[0:3], 0
    buffer_load_dwordx4 v10, s[52:55], s79 offen offset:0 lds
    v_mfma_f32_16x16x32_bf16 v[180:183], v[36:39], a[4:7], 0
    ds_read_b128 v[88:91], v13 offset:17408
    v_cvt_pk_bf16_f32 v200, v184, v185
    v_mfma_f32_16x16x32_bf16 v[168:171], v[40:43], a[8:11], v[168:171]
    ds_read_b128 v[92:95], v13 offset:19456
    v_cvt_pk_bf16_f32 v201, v186, v187
    v_mfma_f32_16x16x32_bf16 v[172:175], v[40:43], a[12:15], v[172:175]
    ds_read_b128 v[96:99], v12 offset:21504
    v_cvt_pk_bf16_f32 v202, v192, v193
    v_mfma_f32_16x16x32_bf16 v[176:179], v[44:47], a[8:11], v[176:179]
    ds_read_b128 v[100:103], v12 offset:23552
    v_cvt_pk_bf16_f32 v203, v194, v195
    s_add_u32 m0, s76, 56192
    v_mfma_f32_16x16x32_bf16 v[180:183], v[44:47], a[12:15], v[180:183]
    buffer_load_dwordx4 v10, s[52:55], s79 offen offset:128 lds
    v_cvt_pk_bf16_f32 v204, v188, v189
    v_mfma_f32_16x16x32_bf16 v[168:171], v[48:51], a[16:19], v[168:171]
    ds_read_b128 v[104:107], v13 offset:21504
    v_cvt_pk_bf16_f32 v205, v190, v191
    v_mfma_f32_16x16x32_bf16 v[172:175], v[48:51], a[20:23], v[172:175]
    ds_read_b128 v[108:111], v13 offset:23552
    v_cvt_pk_bf16_f32 v206, v196, v197
    v_mfma_f32_16x16x32_bf16 v[176:179], v[52:55], a[16:19], v[176:179]
    ds_read_b128 v[112:115], v12 offset:25600
    v_cvt_pk_bf16_f32 v207, v198, v199
    v_mfma_f32_16x16x32_bf16 v[180:183], v[52:55], a[20:23], v[180:183]
    ds_read_b128 v[116:119], v12 offset:27648
    s_add_u32 m0, s76, 60160
    v_mfma_f32_16x16x32_bf16 v[168:171], v[56:59], a[24:27], v[168:171]
    buffer_load_dwordx4 v10, s[52:55], s79 offen offset:256 lds
    v_mfma_f32_16x16x32_bf16 a[48:51], v[128:131], v[200:203], a[48:51]
    ds_read_b128 v[120:123], v13 offset:25600
    v_mfma_f32_16x16x32_bf16 a[52:55], v[128:131], v[204:207], a[52:55]
    ds_read_b128 v[124:127], v13 offset:27648
    v_mfma_f32_16x16x32_bf16 a[56:59], v[132:135], v[200:203], a[56:59]
    v_mfma_f32_16x16x32_bf16 a[60:63], v[132:135], v[204:207], a[60:63]
    s_add_u32 m0, s76, 64512
    v_mfma_f32_16x16x32_bf16 a[64:67], v[136:139], v[200:203], a[64:67]
    buffer_load_dwordx4 v26, s[4:7], s81 offen lds
    v_mfma_f32_16x16x32_bf16 a[68:71], v[136:139], v[204:207], a[68:71]
    v_mfma_f32_16x16x32_bf16 a[72:75], v[140:143], v[200:203], a[72:75]
    v_mfma_f32_16x16x32_bf16 a[76:79], v[140:143], v[204:207], a[76:79]
    v_mfma_f32_16x16x32_bf16 a[80:83], v[144:147], v[200:203], a[80:83]
    s_mov_b32 m0, 68608
    v_mfma_f32_16x16x32_bf16 a[84:87], v[144:147], v[204:207], a[84:87]
    buffer_load_dwordx4 v23, s[8:11], s81 offen lds
    s_add_u32 s79, s79, 393216
    s_add_u32 s81, s81, 64
    v_mfma_f32_16x16x32_bf16 v[172:175], v[56:59], a[28:31], v[172:175]
    v_swap_b32 v201, v202
    v_swap_b32 v205, v206
    v_mfma_f32_16x16x32_bf16 v[176:179], v[60:63], a[24:27], v[176:179]
    v_permlane32_swap_b32 v200, v201
    v_mfma_f32_16x16x32_bf16 v[180:183], v[60:63], a[28:31], v[180:183]
    v_permlane32_swap_b32 v202, v203
    buffer_store_dwordx4 v[200:203], v20, s[48:51], s72 offen sc1
    s_add_u32 s72, s72, 1024
    v_mfma_f32_16x16x32_bf16 v[168:171], v[64:67], a[32:35], v[168:171]
    v_permlane32_swap_b32 v204, v205
    v_permlane32_swap_b32 v206, v207
    v_mfma_f32_16x16x32_bf16 v[172:175], v[64:67], a[36:39], v[172:175]
    buffer_store_dwordx4 v[204:207], v20, s[48:51], s73 offen sc1
    s_add_u32 s73, s73, 1024
    ds_read_b64 v[128:129], v24 offset:0
    v_mfma_f32_16x16x32_bf16 v[176:179], v[68:71], a[32:35], v[176:179]
    ds_read_b64 v[130:131], v25 offset:0
    ds_read_b64 v[132:133], v24 offset:1024
    v_mfma_f32_16x16x32_bf16 v[180:183], v[68:71], a[36:39], v[180:183]
    ds_read_b64 v[134:135], v25 offset:1024
    ds_read_b64 v[136:137], v24 offset:2048
    v_mfma_f32_16x16x32_bf16 v[168:171], v[72:75], a[40:43], v[168:171]
    ds_read_b64 v[138:139], v25 offset:2048
    ds_read_b64 v[140:141], v24 offset:3072
    v_mfma_f32_16x16x32_bf16 v[172:175], v[72:75], a[44:47], v[172:175]
    ds_read_b64 v[142:143], v25 offset:3072
    ds_read_b64 v[144:145], v24 offset:4096
    v_mfma_f32_16x16x32_bf16 v[176:179], v[76:79], a[40:43], v[176:179]
    ds_read_b64 v[146:147], v25 offset:4096
    v_mfma_f32_16x16x32_bf16 v[180:183], v[76:79], a[44:47], v[180:183]
    s_cmp_lt_u32 s88, 5
    s_cbranch_scc1 L_bm_loop_83
    s_waitcnt lgkmcnt(0)
    s_mov_b32 s74, 0x101000
    v_mul_lo_u32 v2, v22, s74
    v_add_u32 v2, v21, v2
    s_mul_i32 s74, s82, 0x202000
    s_lshr_b32 s75, s70, 1
    s_lshl_b32 s75, s75, 10
    s_add_u32 s74, s74, s75
    s_add_u32 s74, s74, s83
    s_add_u32 s74, s74, 0x8100000
    s_nop 2
    v_accvgpr_read_b32 v36, a48
    v_accvgpr_read_b32 v37, a49
    v_accvgpr_read_b32 v38, a50
    v_accvgpr_read_b32 v39, a51
    v_accvgpr_read_b32 v40, a56
    v_accvgpr_read_b32 v41, a57
    v_accvgpr_read_b32 v42, a58
    v_accvgpr_read_b32 v43, a59
    v_cvt_pk_bf16_f32 v32, v36, v37
    v_cvt_pk_bf16_f32 v33, v38, v39
    v_cvt_pk_bf16_f32 v34, v40, v41
    v_cvt_pk_bf16_f32 v35, v42, v43
    s_add_u32 s75, s74, 0x0
    buffer_store_dwordx4 v[32:35], v2, s[48:51], s75 offen sc1
    v_accvgpr_read_b32 v48, a52
    v_accvgpr_read_b32 v49, a53
    v_accvgpr_read_b32 v50, a54
    v_accvgpr_read_b32 v51, a55
    v_accvgpr_read_b32 v52, a60
    v_accvgpr_read_b32 v53, a61
    v_accvgpr_read_b32 v54, a62
    v_accvgpr_read_b32 v55, a63
    v_cvt_pk_bf16_f32 v44, v48, v49
    v_cvt_pk_bf16_f32 v45, v50, v51
    v_cvt_pk_bf16_f32 v46, v52, v53
    v_cvt_pk_bf16_f32 v47, v54, v55
    s_add_u32 s75, s74, 0x202000
    buffer_store_dwordx4 v[44:47], v2, s[48:51], s75 offen sc1
    v_accvgpr_read_b32 v60, a64
    v_accvgpr_read_b32 v61, a65
    v_accvgpr_read_b32 v62, a66
    v_accvgpr_read_b32 v63, a67
    v_accvgpr_read_b32 v64, a72
    v_accvgpr_read_b32 v65, a73
    v_accvgpr_read_b32 v66, a74
    v_accvgpr_read_b32 v67, a75
    v_cvt_pk_bf16_f32 v56, v60, v61
    v_cvt_pk_bf16_f32 v57, v62, v63
    v_cvt_pk_bf16_f32 v58, v64, v65
    v_cvt_pk_bf16_f32 v59, v66, v67
    s_add_u32 s75, s74, 0x4000
    buffer_store_dwordx4 v[56:59], v2, s[48:51], s75 offen sc1
    v_accvgpr_read_b32 v72, a68
    v_accvgpr_read_b32 v73, a69
    v_accvgpr_read_b32 v74, a70
    v_accvgpr_read_b32 v75, a71
    v_accvgpr_read_b32 v76, a76
    v_accvgpr_read_b32 v77, a77
    v_accvgpr_read_b32 v78, a78
    v_accvgpr_read_b32 v79, a79
    v_cvt_pk_bf16_f32 v68, v72, v73
    v_cvt_pk_bf16_f32 v69, v74, v75
    v_cvt_pk_bf16_f32 v70, v76, v77
    v_cvt_pk_bf16_f32 v71, v78, v79
    s_add_u32 s75, s74, 0x206000
    buffer_store_dwordx4 v[68:71], v2, s[48:51], s75 offen sc1
    s_mov_b32 s74, 0x41000
    v_mul_lo_u32 v2, v22, s74
    v_add_u32 v2, v21, v2
    s_mul_i32 s74, s82, 0x82000
    s_lshr_b32 s75, s70, 3
    s_lshl_b32 s75, s75, 10
    s_add_u32 s74, s74, s75
    s_add_u32 s74, s74, s83
    s_bfe_u32 s75, s70, 0x10001
    s_lshl_b32 s75, s75, 9
    s_add_u32 s74, s74, s75
    s_bfe_u32 s75, s70, 0x10002
    s_lshl_b32 s75, s75, 3
    s_add_u32 s74, s74, s75
    s_add_u32 s74, s74, 0x3a00000
    v_accvgpr_read_b32 v130, a80
    v_accvgpr_read_b32 v131, a81
    v_accvgpr_read_b32 v132, a82
    v_accvgpr_read_b32 v133, a83
    v_cvt_pk_bf16_f32 v128, v130, v131
    v_cvt_pk_bf16_f32 v129, v132, v133
    s_add_u32 s75, s74, 0x0
    s_mov_b32 exec_hi, 0
    buffer_store_dwordx2 v[128:129], v2, s[48:51], s75 offen sc1
    s_mov_b64 exec, -1
    v_accvgpr_read_b32 v138, a84
    v_accvgpr_read_b32 v139, a85
    v_accvgpr_read_b32 v140, a86
    v_accvgpr_read_b32 v141, a87
    v_cvt_pk_bf16_f32 v136, v138, v139
    v_cvt_pk_bf16_f32 v137, v140, v141
    s_add_u32 s75, s74, 0x82000
    s_mov_b32 exec_hi, 0
    buffer_store_dwordx2 v[136:137], v2, s[48:51], s75 offen sc1
    s_mov_b64 exec, -1
    s_cmp_lg_u32 s64, 1
    s_cbranch_scc1 L_waok_85
    v_min_u32 v3, 0, v0
    v_lshlrev_b32 v3, 2, v3
    v_add_u32 v3, 0xa0, v3
L_wa_84:
    buffer_load_dword v2, v3, s[60:63], 0 offen sc1
    s_waitcnt vmcnt(0)
    v_cmp_gt_u32 vcc, 1, v2
    s_cbranch_vccz L_waok_85
    s_sleep 12
    s_sub_u32 s67, s67, 1
    s_cbranch_scc1 K2_DONE
    s_branch L_wa_84
L_waok_85:
    s_barrier
    s_lshl_b32 s74, s71, 5
    s_add_u32 s74, s74, s70
    s_lshl_b32 s92, s74, 2
    s_add_u32 s92, s92, 0x603a00
    s_mov_b32 s93, 1
    s_waitcnt vmcnt(0)
    s_barrier
    s_cmp_lg_u32 s64, 1
    s_cbranch_scc1 L_fs_86
    v_mov_b32 v2, s93
    v_mov_b32 v3, 0
    s_mov_b64 exec, 1
    buffer_store_dword v2, v3, s[48:51], s92 offen sc1
    s_mov_b64 exec, -1
L_fs_86:
    s_sub_u32 s72, s65, 32
    v_lshlrev_b32 v1, 4, v0
    s_lshr_b32 s92, s72, 4
    s_lshl_b32 s92, s92, 7
    s_cmp_lg_u32 s64, 1
    s_cbranch_scc1 L_waok_88
    v_min_u32 v3, 31, v0
    v_lshlrev_b32 v3, 2, v3
    v_add_u32 v3, 0x603a00, v3
L_wa_87:
    buffer_load_dword v2, v3, s[48:51], s92 offen sc1
    s_waitcnt vmcnt(0)
    v_cmp_gt_u32 vcc, 1, v2
    s_cbranch_vccz L_waok_88
    s_sleep 12
    s_sub_u32 s67, s67, 1
    s_cbranch_scc1 K2_DONE
    s_branch L_wa_87
L_waok_88:
    s_barrier
    s_cmp_lg_u32 s64, 1
    s_cbranch_scc1 L_waok_90
    v_min_u32 v3, 31, v0
    v_lshlrev_b32 v3, 2, v3
    v_add_u32 v3, 0x603f00, v3
L_wa_89:
    buffer_load_dword v2, v3, s[48:51], 0 offen sc1
    s_waitcnt vmcnt(0)
    v_cmp_gt_u32 vcc, 1, v2
    s_cbranch_vccz L_waok_90
    s_sleep 12
    s_sub_u32 s67, s67, 1
    s_cbranch_scc1 K2_DONE
    s_branch L_wa_89
L_waok_90:
    s_barrier
    v_min_u32 v3, 2, v0
    v_lshlrev_b32 v3, 2, v3
    v_add_u32 v3, 0xc0, v3
L_wa_91:
    buffer_load_dword v2, v3, s[60:63], 0 offen sc1
    s_waitcnt vmcnt(0)
    v_cmp_gt_u32 vcc, 8192, v2
    s_cbranch_vccz L_waok_92
    s_sleep 12
    s_sub_u32 s67, s67, 1
    s_cbranch_scc1 K2_DONE
    s_branch L_wa_91
L_waok_92:
    v_readlane_b32 s68, v2, 0
    v_readlane_b32 s69, v2, 1
    v_readlane_b32 s70, v2, 2
    s_waitcnt lgkmcnt(0)
    s_and_b32 s68, s68, 0xff
    s_cmp_gt_u32 s68, 16
    s_cselect_b32 s68, 0x2000, 0
    s_and_b32 s69, s69, 0xff
    s_cmp_gt_u32 s69, 16
    s_cselect_b32 s69, 0x2000, 0
    s_and_b32 s70, s70, 0xff
    s_cmp_gt_u32 s70, 16
    s_cselect_b32 s70, 0x2000, 0
    v_and_b32 v7, 8, v0
    v_cmp_eq_u32 vcc, 0, v7
    v_mov_b32 v7, 0xeeee
    v_mov_b32 v8, 0x4444
    v_cndmask_b32 v7, v7, v8, vcc
    v_and_b32 v8, 7, v0
    v_bfe_u32 v9, v0, 3, 1
    v_lshrrev_b32 v10, 4, v0
    v_mul_u32_u24 v11, 640, v9
    v_lshl_add_u32 v12, v8, 4, v11
    v_lshl_add_u32 v2, v10, 7, v12
    v_lshrrev_b32 v12, 1, v10
    v_mul_u32_u24 v12, 1280, v12
    v_add3_u32 v12, v12, v11, 0
    v_lshl_add_u32 v12, v8, 4, v12
    v_and_b32 v13, 1, v10
    v_lshl_add_u32 v12, v13, 3, v12
    v_add_u32 v3, 512, v12
    v_lshlrev_b32 v13, 2, v13
    v_add_u32 v13, s64, v13
    v_xor_b32 v13, v13, v8
    v_lshl_add_u32 v13, v8, 3, v13
    v_lshlrev_b32 v13, 4, v13
    v_lshl_add_u32 v13, v9, 10, v13
    v_add_u32 v4, 0, v13
    v_lshrrev_b32 v8, 3, v0
    v_xor_b32 v5, v8, v0
    v_lshlrev_b32 v5, 4, v5
    v_add_u32 v5, 0, v5
    v_lshrrev_b32 v6, 3, v0
    v_lshlrev_b32 v6, 4, v6
    s_mov_b32 s4, 0xff00ff
    s_mov_b32 s5, 0xff00ff00
    s_mov_b32 s6, 0x1010101
    s_mov_b32 s7, 0x1010101
    s_mov_b32 s84, 8
    s_mov_b32 s85, 0
    s_mov_b32 s80, 2
    s_lshl_b32 s86, s72, 7
    s_add_u32 s82, s86, 0x601000
    s_add_u32 s83, s86, 0x604000
    s_lshl_b32 s77, s64, 14
    s_add_u32 s77, s77, 0x200000
    s_mul_i32 s79, s72, 0x41000
    s_lshl_b32 s86, s64, 10
    s_add_u32 s79, s79, s86
    s_add_u32 s79, s79, 0x3a00000
    s_mul_i32 s78, s72, 0x101000
    s_lshl_b32 s86, s64, 12
    s_add_u32 s78, s78, s86
    s_add_u32 s78, s78, 0x8100000
    s_lshl_b32 s87, s72, 7
    s_cmp_ge_u32 s72, 64
    s_cselect_b32 s86, 8192, 0
    s_add_u32 s87, s87, s86
    s_add_u32 s87, s87, 32768
    s_mov_b32 s81, 1
    s_mov_b32 s3, -1
    s_cmp_eq_u32 s15, 130
    s_cselect_b32 s3, 0, s3
    s_cmp_eq_u32 s15, 446
    s_cselect_b32 s3, 4, s3
    v_lshlrev_b32 v132, 7, v0
    s_add_u32 s31, s3, 34816
    v_add_u32 v132, s31, v132
    s_mov_b32 s86, 0xccccccd
    s_mul_hi_u32 s8, s72, s86
    s_mul_i32 s86, s8, 20
    s_sub_u32 s9, s72, s86
    s_lshl_b32 s8, s8, 14
    s_lshl_b32 s9, s9, 7
    s_add_u32 s8, s8, s9
    s_add_u32 s9, s8, s9
    s_add_u32 s9, s9, 0x200000
    s_add_u32 s8, s8, 0x201400
    v_add_u32 v126, s9, v1
    s_sub_u32 s31, s8, 256
    v_add_u32 v127, s31, v1
    v_cmp_gt_u32 vcc, 16, v0
    s_sub_u32 s31, s87, 32768
    s_lshl_b32 s11, s72, 7
    v_cndmask_b32 v126, v127, v126, vcc
    v_add_u32 v127, s31, v1
    s_add_u32 s11, s11, 18304
    v_add_u32 v128, s11, v1
    v_cmp_gt_u32 vcc, 8, v0
    s_cmp_lt_u32 s72, 32
    s_movk_i32 s20, 0xff
    s_cselect_b32 s20, 0xffff, s20
    v_cndmask_b32 v127, v128, v127, vcc
    s_mov_b32 s21, 0
    v_mov_b32 v128, -1
    v_mov_b32 v129, -1
    v_mov_b32 v130, -1
    v_mov_b32 v131, -1
    v_mov_b32 v122, 0
    s_lshl_b32 s73, s66, 15
    s_add_u32 s73, s73, s68
    s_add_u32 s74, s73, 4096
    s_add_u32 s75, s73, 16384
    s_cmp_ge_u32 s66, 32
    s_cselect_b32 s86, s70, s69
    s_lshl_b32 s76, s66, 16
    s_add_u32 s76, s76, s86
    s_add_u32 s76, s76, s77
    s_sub_u32 s12, s76, s77
    s_add_u32 s12, s12, s8
    buffer_load_dwordx4 v[80:83], v1, s[48:51], s79 offen sc1
    buffer_load_dwordx4 v[64:67], v1, s[48:51], s78 offen offset:0 sc1
    buffer_load_dwordx4 v[68:71], v1, s[48:51], s78 offen offset:1024 sc1
    buffer_load_dwordx4 v[72:75], v1, s[48:51], s78 offen offset:2048 sc1
    buffer_load_dwordx4 v[76:79], v1, s[48:51], s78 offen offset:3072 sc1
    buffer_load_dword v121, v122, s[48:51], s82 offen sc1
    s_buffer_load_dwordx2 s[22:23], s[48:51], s12 glc
    s_waitcnt lgkmcnt(0)
    s_max_u32 s22, s22, s23
    s_cmp_lg_u32 s22, -1
    s_cbranch_scc1 L_B_yok_101
L_B_ldw_102:
    s_mul_i32 s10, s72, 331776
    s_mul_i32 s11, s64, 81920
    s_add_u32 s10, s10, s11
    s_add_u32 s10, s10, 0x2000000
    s_add_u32 s11, s10, 0
    buffer_load_dwordx4 a[0:3], v1, s[48:51], s11 offen offset:0 sc1
    buffer_load_dwordx4 a[4:7], v1, s[48:51], s11 offen offset:1024 sc1
    buffer_load_dwordx4 a[8:11], v1, s[48:51], s11 offen offset:2048 sc1
    buffer_load_dwordx4 a[12:15], v1, s[48:51], s11 offen offset:3072 sc1
    s_add_u32 s11, s10, 4096
    buffer_load_dwordx4 a[16:19], v1, s[48:51], s11 offen offset:0 sc1
    buffer_load_dwordx4 a[20:23], v1, s[48:51], s11 offen offset:1024 sc1
    buffer_load_dwordx4 a[24:27], v1, s[48:51], s11 offen offset:2048 sc1
    buffer_load_dwordx4 a[28:31], v1, s[48:51], s11 offen offset:3072 sc1
    s_add_u32 s11, s10, 8192
    buffer_load_dwordx4 a[32:35], v1, s[48:51], s11 offen offset:0 sc1
    buffer_load_dwordx4 a[36:39], v1, s[48:51], s11 offen offset:1024 sc1
    buffer_load_dwordx4 a[40:43], v1, s[48:51], s11 offen offset:2048 sc1
    buffer_load_dwordx4 a[44:47], v1, s[48:51], s11 offen offset:3072 sc1
    s_add_u32 s11, s10, 12288
    buffer_load_dwordx4 a[48:51], v1, s[48:51], s11 offen offset:0 sc1
    buffer_load_dwordx4 a[52:55], v1, s[48:51], s11 offen offset:1024 sc1
    buffer_load_dwordx4 a[56:59], v1, s[48:51], s11 offen offset:2048 sc1
    buffer_load_dwordx4 a[60:63], v1, s[48:51], s11 offen offset:3072 sc1
    s_add_u32 s11, s10, 16384
    buffer_load_dwordx4 a[64:67], v1, s[48:51], s11 offen offset:0 sc1
    buffer_load_dwordx4 a[68:71], v1, s[48:51], s11 offen offset:1024 sc1
    buffer_load_dwordx4 a[72:75], v1, s[48:51], s11 offen offset:2048 sc1
    buffer_load_dwordx4 a[76:79], v1, s[48:51], s11 offen offset:3072 sc1
    s_add_u32 s11, s10, 20480
    buffer_load_dwordx4 a[80:83], v1, s[48:51], s11 offen offset:0 sc1
    buffer_load_dwordx4 a[84:87], v1, s[48:51], s11 offen offset:1024 sc1
    buffer_load_dwordx4 a[88:91], v1, s[48:51], s11 offen offset:2048 sc1
    buffer_load_dwordx4 a[92:95], v1, s[48:51], s11 offen offset:3072 sc1
    s_add_u32 s11, s10, 24576
    buffer_load_dwordx4 a[96:99], v1, s[48:51], s11 offen offset:0 sc1
    buffer_load_dwordx4 a[100:103], v1, s[48:51], s11 offen offset:1024 sc1
    buffer_load_dwordx4 a[104:107], v1, s[48:51], s11 offen offset:2048 sc1
    buffer_load_dwordx4 a[108:111], v1, s[48:51], s11 offen offset:3072 sc1
    s_add_u32 s11, s10, 28672
    buffer_load_dwordx4 a[112:115], v1, s[48:51], s11 offen offset:0 sc1
    buffer_load_dwordx4 a[116:119], v1, s[48:51], s11 offen offset:1024 sc1
    buffer_load_dwordx4 a[120:123], v1, s[48:51], s11 offen offset:2048 sc1
    buffer_load_dwordx4 a[124:127], v1, s[48:51], s11 offen offset:3072 sc1
    s_add_u32 s11, s10, 32768
    buffer_load_dwordx4 a[128:131], v1, s[48:51], s11 offen offset:0 sc1
    buffer_load_dwordx4 a[132:135], v1, s[48:51], s11 offen offset:1024 sc1
    buffer_load_dwordx4 a[136:139], v1, s[48:51], s11 offen offset:2048 sc1
    buffer_load_dwordx4 a[140:143], v1, s[48:51], s11 offen offset:3072 sc1
    s_add_u32 s11, s10, 36864
    buffer_load_dwordx4 a[144:147], v1, s[48:51], s11 offen offset:0 sc1
    buffer_load_dwordx4 a[148:151], v1, s[48:51], s11 offen offset:1024 sc1
    buffer_load_dwordx4 a[152:155], v1, s[48:51], s11 offen offset:2048 sc1
    buffer_load_dwordx4 a[156:159], v1, s[48:51], s11 offen offset:3072 sc1
    s_add_u32 s11, s10, 40960
    buffer_load_dwordx4 a[160:163], v1, s[48:51], s11 offen offset:0 sc1
    buffer_load_dwordx4 a[164:167], v1, s[48:51], s11 offen offset:1024 sc1
    buffer_load_dwordx4 a[168:171], v1, s[48:51], s11 offen offset:2048 sc1
    buffer_load_dwordx4 a[172:175], v1, s[48:51], s11 offen offset:3072 sc1
    s_add_u32 s11, s10, 45056
    buffer_load_dwordx4 a[176:179], v1, s[48:51], s11 offen offset:0 sc1
    buffer_load_dwordx4 a[180:183], v1, s[48:51], s11 offen offset:1024 sc1
    buffer_load_dwordx4 a[184:187], v1, s[48:51], s11 offen offset:2048 sc1
    buffer_load_dwordx4 a[188:191], v1, s[48:51], s11 offen offset:3072 sc1
    s_waitcnt vmcnt(24)
    s_add_u32 s11, s10, 49152
    buffer_load_dwordx4 a[192:195], v1, s[48:51], s11 offen offset:0 sc1
    buffer_load_dwordx4 a[196:199], v1, s[48:51], s11 offen offset:1024 sc1
    buffer_load_dwordx4 a[200:203], v1, s[48:51], s11 offen offset:2048 sc1
    buffer_load_dwordx4 a[204:207], v1, s[48:51], s11 offen offset:3072 sc1
    s_add_u32 s11, s10, 53248
    buffer_load_dwordx4 a[208:211], v1, s[48:51], s11 offen offset:0 sc1
    buffer_load_dwordx4 a[212:215], v1, s[48:51], s11 offen offset:1024 sc1
    buffer_load_dwordx4 a[216:219], v1, s[48:51], s11 offen offset:2048 sc1
    buffer_load_dwordx4 a[220:223], v1, s[48:51], s11 offen offset:3072 sc1
    s_add_u32 s11, s10, 57344
    buffer_load_dwordx4 a[224:227], v1, s[48:51], s11 offen offset:0 sc1
    buffer_load_dwordx4 a[228:231], v1, s[48:51], s11 offen offset:1024 sc1
    buffer_load_dwordx4 a[232:235], v1, s[48:51], s11 offen offset:2048 sc1
    buffer_load_dwordx4 a[236:239], v1, s[48:51], s11 offen offset:3072 sc1
    s_add_u32 s11, s10, 61440
    buffer_load_dwordx4 a[240:243], v1, s[48:51], s11 offen offset:0 sc1
    buffer_load_dwordx4 a[244:247], v1, s[48:51], s11 offen offset:1024 sc1
    buffer_load_dwordx4 a[248:251], v1, s[48:51], s11 offen offset:2048 sc1
    buffer_load_dwordx4 a[252:255], v1, s[48:51], s11 offen offset:3072 sc1
    s_add_u32 s11, s10, 65536
    buffer_load_dwordx4 v[192:195], v1, s[48:51], s11 offen offset:0 sc1
    buffer_load_dwordx4 v[196:199], v1, s[48:51], s11 offen offset:1024 sc1
    buffer_load_dwordx4 v[200:203], v1, s[48:51], s11 offen offset:2048 sc1
    buffer_load_dwordx4 v[204:207], v1, s[48:51], s11 offen offset:3072 sc1
    s_add_u32 s11, s10, 69632
    buffer_load_dwordx4 v[208:211], v1, s[48:51], s11 offen offset:0 sc1
    buffer_load_dwordx4 v[212:215], v1, s[48:51], s11 offen offset:1024 sc1
    buffer_load_dwordx4 v[216:219], v1, s[48:51], s11 offen offset:2048 sc1
    buffer_load_dwordx4 v[220:223], v1, s[48:51], s11 offen offset:3072 sc1
    s_add_u32 s11, s10, 73728
    buffer_load_dwordx4 v[224:227], v1, s[48:51], s11 offen offset:0 sc1
    buffer_load_dwordx4 v[228:231], v1, s[48:51], s11 offen offset:1024 sc1
    buffer_load_dwordx4 v[232:235], v1, s[48:51], s11 offen offset:2048 sc1
    buffer_load_dwordx4 v[236:239], v1, s[48:51], s11 offen offset:3072 sc1
    s_add_u32 s11, s10, 77824
    buffer_load_dwordx4 v[240:243], v1, s[48:51], s11 offen offset:0 sc1
    buffer_load_dwordx4 v[244:247], v1, s[48:51], s11 offen offset:1024 sc1
    buffer_load_dwordx4 v[248:251], v1, s[48:51], s11 offen offset:2048 sc1
    buffer_load_dwordx4 v[252:255], v1, s[48:51], s11 offen offset:3072 sc1
    s_waitcnt vmcnt(40)
    s_mov_b32 s22, -1
    s_cmp_eq_u32 s66, 0
    s_cbranch_scc1 L_B_yok_101
L_B_step_93:
    s_cmp_ge_u32 s80, s81
    s_cbranch_scc1 L_fwok_104
    v_mov_b32 v110, 0
L_fw_103:
    buffer_load_dword v108, v110, s[48:51], s82 offen sc1
    s_waitcnt vmcnt(0)
    v_readfirstlane_b32 s80, v108
    s_cmp_ge_u32 s80, s81
    s_cbranch_scc1 L_fwok_104
    s_sleep 2
    s_sub_u32 s67, s67, 1
    s_cbranch_scc1 K2_DONE
    s_branch L_fw_103
L_fwok_104:
    s_lshl_b32 s73, s66, 15
    s_add_u32 s73, s73, s68
    s_add_u32 s74, s73, 4096
    s_add_u32 s75, s73, 16384
    s_cmp_ge_u32 s66, 32
    s_cselect_b32 s86, s70, s69
    s_lshl_b32 s76, s66, 16
    s_add_u32 s76, s76, s86
    s_add_u32 s76, s76, s77
    s_sub_u32 s12, s76, s77
    s_add_u32 s12, s12, s8
    v_mov_b32 v48, 0
    v_mov_b32 v49, 0
    v_mov_b32 v50, 0
    v_mov_b32 v51, 0
    v_mov_b32 v52, 0
    v_mov_b32 v53, 0
    v_mov_b32 v54, 0
    v_mov_b32 v55, 0
    v_mov_b32 v56, 0
    v_mov_b32 v57, 0
    v_mov_b32 v58, 0
    v_mov_b32 v59, 0
    v_mov_b32 v60, 0
    v_mov_b32 v61, 0
    v_mov_b32 v62, 0
    v_mov_b32 v63, 0
    v_mov_b32 v120, 0
    s_mov_b32 s86, s84
L_bo_105:
    s_sub_u32 s86, s86, 1
    s_cbranch_scc1 L_boe_106
    s_sleep 1
    s_branch L_bo_105
L_boe_106:
    s_cmp_lg_u32 s66, 63
    s_cbranch_scc1 L_B_ne_107
    s_waitcnt vmcnt(0)
    s_barrier
    s_cmp_lg_u32 s64, 1
    s_cbranch_scc1 L_fs_108
    v_mov_b32 v116, s66
    v_mov_b32 v117, 0
    s_mov_b64 exec, 1
    buffer_store_dword v116, v117, s[48:51], s83 offen sc1
    s_mov_b64 exec, -1
L_fs_108:
L_B_ne_107:
    buffer_load_dwordx4 v[8:11], v1, s[48:51], s73 offen offset:0
    s_nop 9
    buffer_load_dwordx4 v[12:15], v1, s[48:51], s73 offen offset:1024
    s_nop 9
    buffer_load_dwordx4 v[16:19], v1, s[48:51], s73 offen offset:2048
    s_nop 9
    buffer_load_dwordx4 v[20:23], v1, s[48:51], s73 offen offset:3072
    s_nop 9
    buffer_load_dwordx4 v[24:27], v1, s[48:51], s74 offen offset:0
    s_nop 9
    buffer_load_dwordx4 v[28:31], v1, s[48:51], s74 offen offset:1024
    s_nop 9
    buffer_load_dwordx4 v[32:35], v1, s[48:51], s74 offen offset:2048
    s_nop 9
    buffer_load_dwordx4 v[36:39], v1, s[48:51], s74 offen offset:3072
    s_nop 9
    buffer_load_dwordx4 v[40:43], v1, s[48:51], s75 offen offset:0
    s_nop 9
    buffer_load_dwordx4 v[44:47], v1, s[48:51], s75 offen offset:1024
L_B_prepm_94:
    s_waitcnt vmcnt(9)
    v_smfmac_f32_16x16x64_bf16 v[48:51], v[8:11], a[0:7], v7
    v_max3_u32 v120, v120, v8, v9
    v_smfmac_f32_16x16x64_bf16 v[52:55], v[8:11], a[80:87], v7
    v_max3_u32 v120, v120, v10, v11
    v_smfmac_f32_16x16x64_bf16 v[56:59], v[8:11], a[160:167], v7
    v_cmp_eq_u32 vcc, -1, v120
    v_smfmac_f32_16x16x64_bf16 v[60:63], v[8:11], a[240:247], v7
    s_cbranch_vccnz L_B_retm_95
    buffer_load_dwordx4 v[64:67], v1, s[48:51], s78 offen offset:0 sc1
    buffer_load_dwordx4 v[68:71], v1, s[48:51], s78 offen offset:1024 sc1
    buffer_load_dwordx4 v[72:75], v1, s[48:51], s78 offen offset:2048 sc1
    buffer_load_dwordx4 v[76:79], v1, s[48:51], s78 offen offset:3072 sc1
    buffer_load_dword v121, v122, s[48:51], s82 offen sc1
    s_waitcnt vmcnt(13)
    v_smfmac_f32_16x16x64_bf16 v[48:51], v[12:15], a[8:15], v7
    v_max3_u32 v120, v120, v12, v13
    v_smfmac_f32_16x16x64_bf16 v[52:55], v[12:15], a[88:95], v7
    v_max3_u32 v120, v120, v14, v15
    v_smfmac_f32_16x16x64_bf16 v[56:59], v[12:15], a[168:175], v7
    v_smfmac_f32_16x16x64_bf16 v[60:63], v[12:15], a[248:255], v7
    s_waitcnt vmcnt(12)
    v_smfmac_f32_16x16x64_bf16 v[48:51], v[16:19], a[16:23], v7
    v_max3_u32 v120, v120, v16, v17
    v_smfmac_f32_16x16x64_bf16 v[52:55], v[16:19], a[96:103], v7
    v_max3_u32 v120, v120, v18, v19
    v_smfmac_f32_16x16x64_bf16 v[56:59], v[16:19], a[176:183], v7
    v_smfmac_f32_16x16x64_bf16 v[60:63], v[16:19], v[192:199], v7
    s_waitcnt vmcnt(11)
    v_smfmac_f32_16x16x64_bf16 v[48:51], v[20:23], a[24:31], v7
    v_max3_u32 v120, v120, v20, v21
    v_smfmac_f32_16x16x64_bf16 v[52:55], v[20:23], a[104:111], v7
    v_max3_u32 v120, v120, v22, v23
    v_smfmac_f32_16x16x64_bf16 v[56:59], v[20:23], a[184:191], v7
    v_smfmac_f32_16x16x64_bf16 v[60:63], v[20:23], v[200:207], v7
    s_waitcnt vmcnt(10)
    v_smfmac_f32_16x16x64_bf16 v[48:51], v[24:27], a[32:39], v7
    v_max3_u32 v120, v120, v24, v25
    v_smfmac_f32_16x16x64_bf16 v[52:55], v[24:27], a[112:119], v7
    v_max3_u32 v120, v120, v26, v27
    v_smfmac_f32_16x16x64_bf16 v[56:59], v[24:27], a[192:199], v7
    v_smfmac_f32_16x16x64_bf16 v[60:63], v[24:27], v[208:215], v7
    s_waitcnt vmcnt(9)
    v_smfmac_f32_16x16x64_bf16 v[48:51], v[28:31], a[40:47], v7
    v_max3_u32 v120, v120, v28, v29
    v_smfmac_f32_16x16x64_bf16 v[52:55], v[28:31], a[120:127], v7
    v_max3_u32 v120, v120, v30, v31
    v_smfmac_f32_16x16x64_bf16 v[56:59], v[28:31], a[200:207], v7
    v_smfmac_f32_16x16x64_bf16 v[60:63], v[28:31], v[216:223], v7
    s_waitcnt vmcnt(8)
    v_smfmac_f32_16x16x64_bf16 v[48:51], v[32:35], a[48:55], v7
    v_max3_u32 v120, v120, v32, v33
    v_smfmac_f32_16x16x64_bf16 v[52:55], v[32:35], a[128:135], v7
    v_max3_u32 v120, v120, v34, v35
    v_smfmac_f32_16x16x64_bf16 v[56:59], v[32:35], a[208:215], v7
    v_smfmac_f32_16x16x64_bf16 v[60:63], v[32:35], v[224:231], v7
    s_waitcnt vmcnt(7)
    v_smfmac_f32_16x16x64_bf16 v[48:51], v[36:39], a[56:63], v7
    v_max3_u32 v120, v120, v36, v37
    v_smfmac_f32_16x16x64_bf16 v[52:55], v[36:39], a[136:143], v7
    v_max3_u32 v120, v120, v38, v39
    v_smfmac_f32_16x16x64_bf16 v[56:59], v[36:39], a[216:223], v7
    v_smfmac_f32_16x16x64_bf16 v[60:63], v[36:39], v[232:239], v7
    s_waitcnt vmcnt(6)
    v_smfmac_f32_16x16x64_bf16 v[48:51], v[40:43], a[64:71], v7
    v_max3_u32 v120, v120, v40, v41
    v_smfmac_f32_16x16x64_bf16 v[52:55], v[40:43], a[144:151], v7
    v_max3_u32 v120, v120, v42, v43
    v_smfmac_f32_16x16x64_bf16 v[56:59], v[40:43], a[224:231], v7
    v_smfmac_f32_16x16x64_bf16 v[60:63], v[40:43], v[240:247], v7
    s_waitcnt vmcnt(5)
    v_smfmac_f32_16x16x64_bf16 v[48:51], v[44:47], a[72:79], v7
    v_max3_u32 v120, v120, v44, v45
    v_smfmac_f32_16x16x64_bf16 v[52:55], v[44:47], a[152:159], v7
    v_max3_u32 v120, v120, v46, v47
    v_smfmac_f32_16x16x64_bf16 v[56:59], v[44:47], a[232:239], v7
    v_cmp_eq_u32 vcc, -1, v120
    v_smfmac_f32_16x16x64_bf16 v[60:63], v[44:47], v[248:255], v7
    s_cbranch_vccnz L_B_retm_95
    s_nop 7
    v_permlane32_swap_b32 v48, v52
    v_permlane32_swap_b32 v49, v53
    v_permlane32_swap_b32 v50, v54
    v_permlane32_swap_b32 v51, v55
    v_pk_add_f32 v[48:49], v[48:49], v[52:53]
    v_pk_add_f32 v[50:51], v[50:51], v[54:55]
    v_permlane32_swap_b32 v56, v60
    v_permlane32_swap_b32 v57, v61
    v_permlane32_swap_b32 v58, v62
    v_permlane32_swap_b32 v59, v63
    v_pk_add_f32 v[56:57], v[56:57], v[60:61]
    v_pk_add_f32 v[58:59], v[58:59], v[62:63]
    v_cvt_pk_bf16_f32 v80, v48, v49
    v_cvt_pk_bf16_f32 v81, v50, v51
    v_cvt_pk_bf16_f32 v82, v56, v57
    v_cvt_pk_bf16_f32 v83, v58, v59
    s_cmp_eq_u32 s66, 63
    s_cbranch_scc1 L_B_last_98
L_B_yok_101:
    s_mov_b32 s24, s3
    s_add_u32 s30, s73, s87
    s_add_u32 s66, s66, 1
    s_cmp_lg_u32 s64, 3
    s_cbranch_scc1 L_hwok_110
    s_mov_b64 s[32:33], -1
    s_mov_b64 s[34:35], -1
    s_mov_b64 s[36:37], -1
    s_mov_b64 s[38:39], -1
    s_waitcnt lgkmcnt(0)
    s_buffer_load_dwordx2 s[32:33], s[48:51], s12 glc
    s_nop 14
    s_buffer_load_dwordx2 s[34:35], s[48:51], s12 glc
    s_nop 14
    s_buffer_load_dwordx2 s[36:37], s[48:51], s12 glc
    s_nop 14
L_hw_109:
    s_buffer_load_dwordx2 s[38:39], s[48:51], s12 glc
    s_waitcnt lgkmcnt(6)
    s_max_u32 s31, s32, s33
    s_cmp_lg_u32 s31, -1
    s_cbranch_scc1 L_hwok_110
    s_buffer_load_dwordx2 s[32:33], s[48:51], s12 glc
    s_waitcnt lgkmcnt(6)
    s_max_u32 s31, s34, s35
    s_cmp_lg_u32 s31, -1
    s_cbranch_scc1 L_hwok_110
    s_buffer_load_dwordx2 s[34:35], s[48:51], s12 glc
    s_waitcnt lgkmcnt(6)
    s_max_u32 s31, s36, s37
    s_cmp_lg_u32 s31, -1
    s_cbranch_scc1 L_hwok_110
    s_buffer_load_dwordx2 s[36:37], s[48:51], s12 glc
    s_waitcnt lgkmcnt(6)
    s_max_u32 s31, s38, s39
    s_cmp_lg_u32 s31, -1
    s_cbranch_scc1 L_hwok_110
    s_sub_u32 s67, s67, 1
    s_cbranch_scc1 K2_DONE
    s_branch L_hw_109
L_hwok_110:
    s_barrier
L_B_prepp_96:
    buffer_load_dwordx4 v[84:87], v2, s[48:51], s76 offen offset:0 sc1
    buffer_load_dwordx4 v[88:91], v2, s[48:51], s76 offen offset:1280 sc1
    buffer_load_dwordx4 v[92:95], v2, s[48:51], s76 offen offset:2560 sc1
    buffer_load_dwordx4 v[96:99], v2, s[48:51], s76 offen offset:3840 sc1
    buffer_load_dwordx2 v[100:101], v3, s[48:51], s76 offen sc1
    buffer_load_dwordx2 v[102:103], v3, s[48:51], s76 offen offset:2560 sc1
    s_waitcnt vmcnt(5)
    v_mfma_f32_16x16x32_bf16 v[104:107], v[64:67], v[84:87], 0
    v_max3_u32 v120, v84, v85, v86
    v_max_u32 v120, v120, v87
    s_waitcnt vmcnt(4)
    v_mfma_f32_16x16x32_bf16 v[104:107], v[68:71], v[88:91], v[104:107]
    v_max3_u32 v120, v120, v88, v89
    v_max3_u32 v120, v120, v90, v91
    s_waitcnt vmcnt(3)
    v_mfma_f32_16x16x32_bf16 v[104:107], v[72:75], v[92:95], v[104:107]
    v_max3_u32 v120, v120, v92, v93
    v_max3_u32 v120, v120, v94, v95
    s_waitcnt vmcnt(2)
    v_mfma_f32_16x16x32_bf16 v[104:107], v[76:79], v[96:99], v[104:107]
    v_max3_u32 v120, v120, v96, v97
    v_max3_u32 v120, v120, v98, v99
    s_waitcnt vmcnt(0)
    v_mfma_f32_16x16x32_bf16 v[104:107], v[80:83], v[100:103], v[104:107]
    v_max3_u32 v120, v120, v100, v101
    v_max3_u32 v120, v120, v102, v103
    v_cmp_eq_u32 vcc, -1, v120
    s_mov_b64 exec, s[4:5]
    s_cmp_lg_u32 s64, 0
    s_nop 2
    ds_write_b128 v4, v[104:107]
    s_mov_b64 exec, -1
    s_cbranch_vccnz L_B_retp_97
    s_cbranch_scc1 L_B_notw0_99
    s_waitcnt lgkmcnt(0)
    s_barrier
    ds_read_b128 v[108:111], v5 offset:0
    ds_read_b128 v[112:115], v5 offset:1024
    s_waitcnt lgkmcnt(0)
    v_pk_add_f32 v[108:109], v[108:109], v[112:113]
    v_pk_add_f32 v[110:111], v[110:111], v[114:115]
    s_nop 0
    v_add_f32_dpp v108, v108, v108 quad_perm:[1,0,3,2] row_mask:0xf bank_mask:0xf
    v_add_f32_dpp v109, v109, v109 quad_perm:[1,0,3,2] row_mask:0xf bank_mask:0xf
    v_add_f32_dpp v110, v110, v110 quad_perm:[1,0,3,2] row_mask:0xf bank_mask:0xf
    v_add_f32_dpp v111, v111, v111 quad_perm:[1,0,3,2] row_mask:0xf bank_mask:0xf
    v_add_f32_dpp v108, v108, v108 quad_perm:[2,3,0,1] row_mask:0xf bank_mask:0xf
    v_add_f32_dpp v109, v109, v109 quad_perm:[2,3,0,1] row_mask:0xf bank_mask:0xf
    v_add_f32_dpp v110, v110, v110 quad_perm:[2,3,0,1] row_mask:0xf bank_mask:0xf
    v_add_f32_dpp v111, v111, v111 quad_perm:[2,3,0,1] row_mask:0xf bank_mask:0xf
    v_cvt_pk_bf16_f32 v112, v108, v109
    v_cvt_pk_bf16_f32 v113, v110, v111
    s_nop 0
    v_mov_b32_dpp v114, v112 row_shl:4 row_mask:0xf bank_mask:0xf
    v_mov_b32_dpp v115, v113 row_shl:4 row_mask:0xf bank_mask:0xf
    s_mov_b64 exec, s[6:7]
    buffer_store_dwordx4 v[112:115], v6, s[48:51], s30 offen sc1
    s_mov_b64 exec, -1
    s_branch L_B_jn_100
L_B_notw0_99:
    s_waitcnt lgkmcnt(0)
    s_barrier
    s_cmp_lt_i32 s24, 0
    s_cbranch_scc1 L_hs_111
L_hsgo_112:
    s_mov_b32 exec_hi, 0
    buffer_store_dword v132, v132, s[48:51], s75 offen sc1
    s_mov_b64 exec, -1
    s_branch L_hsen_113
L_hs_111:
    s_cmp_lt_i32 s3, 0
    s_cbranch_scc1 L_hsen_113
    s_sleep 8
    s_branch L_hsgo_112
L_hsen_113:
    s_sleep 3
L_B_jn_100:
    v_readfirstlane_b32 s86, v121
    s_max_u32 s80, s80, s86
    buffer_store_dwordx4 v[80:83], v1, s[48:51], s79 offen sc1
    s_add_u32 s78, s78, 16384
    s_add_u32 s79, s79, 4096
    s_add_u32 s81, s66, 1
    s_min_u32 s81, s81, 63
    s_sub_u32 s13, s66, 1
    s_cmp_lg_u32 s64, 1
    s_cbranch_scc1 L_fs_114
    v_mov_b32 v116, s13
    v_mov_b32 v117, 0
    s_mov_b64 exec, 1
    buffer_store_dword v116, v117, s[48:51], s83 offen sc1
    s_mov_b64 exec, -1
L_fs_114:
    s_add_u32 s31, s66, 3
    s_cmp_gt_u32 s31, 62
    s_cselect_b32 s11, 0, s64
    s_cmp_lg_u32 s11, 2
    s_cbranch_scc1 L_B_arm_115
    s_cmp_ge_u32 s31, 32
    s_cselect_b32 s11, s70, s69
    s_lshl_b32 s31, s31, 16
    s_add_u32 s31, s31, s11
    s_add_u32 s11, s73, 163840
    s_mov_b64 exec, 0xffffff
    buffer_store_dwordx4 v[128:131], v126, s[48:51], s31 offen sc1
    s_mov_b64 exec, s[20:21]
    buffer_store_dwordx4 v[128:131], v127, s[48:51], s11 offen sc1
    s_mov_b64 exec, -1
L_B_arm_115:
    s_cmp_lg_u32 s22, -1
    s_cbranch_scc1 L_B_ldw_102
    s_branch L_B_step_93
L_B_retm_95:
    s_add_u32 s84, s84, 0
    s_sub_u32 s67, s67, 1
    s_cbranch_scc1 K2_DONE
    s_waitcnt vmcnt(0)
    s_nop 7
    buffer_load_dwordx4 v[8:11], v1, s[48:51], s73 offen offset:0 sc1
    s_nop 9
    buffer_load_dwordx4 v[12:15], v1, s[48:51], s73 offen offset:1024 sc1
    s_nop 9
    buffer_load_dwordx4 v[16:19], v1, s[48:51], s73 offen offset:2048 sc1
    s_nop 9
    buffer_load_dwordx4 v[20:23], v1, s[48:51], s73 offen offset:3072 sc1
    s_nop 9
    buffer_load_dwordx4 v[24:27], v1, s[48:51], s74 offen offset:0 sc1
    s_nop 9
    buffer_load_dwordx4 v[28:31], v1, s[48:51], s74 offen offset:1024 sc1
    s_nop 9
    buffer_load_dwordx4 v[32:35], v1, s[48:51], s74 offen offset:2048 sc1
    s_nop 9
    buffer_load_dwordx4 v[36:39], v1, s[48:51], s74 offen offset:3072 sc1
    s_nop 9
    buffer_load_dwordx4 v[40:43], v1, s[48:51], s75 offen offset:0 sc1
    s_nop 9
    buffer_load_dwordx4 v[44:47], v1, s[48:51], s75 offen offset:1024 sc1
    v_mov_b32 v48, 0
    v_mov_b32 v49, 0
    v_mov_b32 v50, 0
    v_mov_b32 v51, 0
    v_mov_b32 v52, 0
    v_mov_b32 v53, 0
    v_mov_b32 v54, 0
    v_mov_b32 v55, 0
    v_mov_b32 v56, 0
    v_mov_b32 v57, 0
    v_mov_b32 v58, 0
    v_mov_b32 v59, 0
    v_mov_b32 v60, 0
    v_mov_b32 v61, 0
    v_mov_b32 v62, 0
    v_mov_b32 v63, 0
    v_mov_b32 v120, 0
    s_branch L_B_prepm_94
L_B_retp_97:
    s_mov_b32 s24, -1
    s_add_u32 s85, s85, 0
    s_min_u32 s85, s85, 0
    s_sub_u32 s67, s67, 1
    s_cbranch_scc1 K2_DONE
    s_waitcnt lgkmcnt(0)
    s_branch L_B_prepp_96
L_B_last_98:
    buffer_store_dwordx4 v[80:83], v1, s[48:51], s79 offen sc1
    s_waitcnt vmcnt(0)
    s_barrier
    s_mov_b32 s66, 64
    s_cmp_lg_u32 s64, 1
    s_cbranch_scc1 L_fs_116
    v_mov_b32 v116, s66
    v_mov_b32 v117, 0
    s_mov_b64 exec, 1
    buffer_store_dword v116, v117, s[48:51], s83 offen sc1
    s_mov_b64 exec, -1
L_fs_116:
    s_branch K2_DONE
K2_G2:
    s_mov_b32 s75, 0x33333334
    s_mul_hi_u32 s70, s13, s75
    s_mul_i32 s75, s70, 5
    s_sub_u32 s71, s13, s75
    s_mov_b32 s52, s24
    s_mov_b32 s53, s25
    s_mov_b32 s54, 0x780000
    s_mov_b32 s55, 0x20000
    s_mov_b32 s56, s26
    s_mov_b32 s57, s27
    s_mov_b32 s58, 0x780000
    s_mov_b32 s59, 0x20000
    s_mov_b32 s4, s16
    s_mov_b32 s5, s17
    s_mov_b32 s6, 0x280000
    s_mov_b32 s7, 0x20000
    s_mov_b32 s8, s18
    s_mov_b32 s9, s19
    s_mov_b32 s10, 0x2800
    s_mov_b32 s11, 0x20000
    v_lshrrev_b32 v1, 3, v0
    v_and_b32 v2, 7, v0
    s_and_b32 s92, s64, 1
    s_lshl_b32 s93, s92, 2
    v_xor_b32 v3, s93, v1
    s_lshl_b32 s94, s64, 3
    v_add_u32 v4, s94, v3
    s_mov_b32 s94, 1280
    v_mul_lo_u32 v4, v4, s94
    v_lshrrev_b32 v5, 1, v2
    v_bfe_u32 v6, v1, 1, 2
    v_xor_b32 v5, v5, v6
    v_lshl_add_u32 v4, v5, 5, v4
    v_and_b32 v5, 1, v2
    v_lshl_add_u32 v11, v5, 4, v4
    v_lshrrev_b32 v1, 3, v0
    v_and_b32 v2, 7, v0
    v_xor_b32 v2, v2, v1
    v_mul_u32_u24 v1, 12288, v1
    v_lshl_add_u32 v10, v2, 4, v1
    v_lshrrev_b32 v1, 2, v0
    v_lshrrev_b32 v2, 4, v0
    v_xor_b32 v2, v2, v0
    v_and_b32 v2, 3, v2
    v_mul_u32_u24 v1, 1280, v1
    v_lshl_add_u32 v23, v2, 4, v1
    s_mul_i32 s79, s64, 98304
    s_mul_i32 s75, s70, 384
    s_add_u32 s79, s79, s75
    s_mul_i32 s80, s64, 20480
    s_lshl_b32 s76, s64, 10
    s_lshl_b32 s81, s71, 8
    s_mov_b32 s87, s79
    s_mul_i32 s75, s71, 1572864
    s_add_u32 s79, s79, s75
    s_mov_b32 s88, 0
    v_add_u32 v26, s80, v23
    s_add_u32 s80, s80, 81920
    s_add_u32 m0, s76, 0
    s_nop 0
    buffer_load_dwordx4 v10, s[52:55], s79 offen offset:0 lds
    s_add_u32 m0, s76, 3968
    s_nop 0
    buffer_load_dwordx4 v10, s[52:55], s79 offen offset:128 lds
    s_add_u32 m0, s76, 7936
    s_nop 0
    buffer_load_dwordx4 v10, s[52:55], s79 offen offset:256 lds
    s_add_u32 m0, s76, 12288
    s_nop 0
    buffer_load_dwordx4 v26, s[4:7], s81 offen lds
    s_mov_b32 m0, 16384
    s_nop 0
    buffer_load_dwordx4 v23, s[8:11], s81 offen lds
    s_add_u32 s79, s79, 393216
    s_add_u32 s81, s81, 64
    s_mul_i32 s74, s70, 245760
    s_lshl_b32 s75, s71, 8
    s_add_u32 s74, s74, s75
    s_add_u32 m0, s76, 110592
    s_nop 0
    buffer_load_dwordx4 v11, s[56:59], s74 offen offset:0 lds
    s_add_u32 m0, s76, 114560
    s_nop 0
    buffer_load_dwordx4 v11, s[56:59], s74 offen offset:128 lds
    s_add_u32 m0, s76, 118784
    s_add_u32 s74, s74, 40960
    buffer_load_dwordx4 v11, s[56:59], s74 offen offset:0 lds
    s_add_u32 m0, s76, 122752
    s_nop 0
    buffer_load_dwordx4 v11, s[56:59], s74 offen offset:128 lds
    s_add_u32 m0, s76, 126976
    s_add_u32 s74, s74, 40960
    buffer_load_dwordx4 v11, s[56:59], s74 offen offset:0 lds
    s_add_u32 m0, s76, 130944
    s_nop 0
    buffer_load_dwordx4 v11, s[56:59], s74 offen offset:128 lds
    s_add_u32 m0, s76, 135168
    s_add_u32 s74, s74, 40960
    buffer_load_dwordx4 v11, s[56:59], s74 offen offset:0 lds
    s_add_u32 m0, s76, 139136
    s_nop 0
    buffer_load_dwordx4 v11, s[56:59], s74 offen offset:128 lds
    s_add_u32 m0, s76, 143360
    s_add_u32 s74, s74, 40960
    buffer_load_dwordx4 v11, s[56:59], s74 offen offset:0 lds
    s_add_u32 m0, s76, 147328
    s_nop 0
    buffer_load_dwordx4 v11, s[56:59], s74 offen offset:128 lds
    s_add_u32 m0, s76, 151552
    s_add_u32 s74, s74, 40960
    buffer_load_dwordx4 v11, s[56:59], s74 offen offset:0 lds
    s_add_u32 m0, s76, 155520
    s_nop 0
    buffer_load_dwordx4 v11, s[56:59], s74 offen offset:128 lds
    s_add_u32 m0, s76, 17408
    s_nop 0
    buffer_load_dwordx4 v10, s[52:55], s79 offen offset:0 lds
    s_add_u32 m0, s76, 21376
    s_nop 0
    buffer_load_dwordx4 v10, s[52:55], s79 offen offset:128 lds
    s_add_u32 m0, s76, 25344
    s_nop 0
    buffer_load_dwordx4 v10, s[52:55], s79 offen offset:256 lds
    s_add_u32 m0, s76, 29696
    s_nop 0
    buffer_load_dwordx4 v26, s[4:7], s81 offen lds
    s_mov_b32 m0, 33792
    s_nop 0
    buffer_load_dwordx4 v23, s[8:11], s81 offen lds
    s_add_u32 s79, s79, 393216
    s_add_u32 s81, s81, 64
    s_add_u32 m0, s76, 34816
    s_nop 0
    buffer_load_dwordx4 v10, s[52:55], s79 offen offset:0 lds
    s_add_u32 m0, s76, 38784
    s_nop 0
    buffer_load_dwordx4 v10, s[52:55], s79 offen offset:128 lds
    s_add_u32 m0, s76, 42752
    s_nop 0
    buffer_load_dwordx4 v10, s[52:55], s79 offen offset:256 lds
    s_add_u32 m0, s76, 47104
    s_nop 0
    buffer_load_dwordx4 v26, s[4:7], s81 offen lds
    s_mov_b32 m0, 51200
    s_nop 0
    buffer_load_dwordx4 v23, s[8:11], s81 offen lds
    s_add_u32 s79, s79, 393216
    s_add_u32 s81, s81, 64
    s_mov_b32 s90, 0x10000
    buffer_load_dword v30, v23, s[8:11], s90 offen
    buffer_load_dword v30, v23, s[8:11], s90 offen
    v_and_b32 v1, 15, v0
    v_lshrrev_b32 v2, 4, v0
    v_and_b32 v3, 7, v0
    v_xor_b32 v3, v2, v3
    v_lshlrev_b32 v3, 4, v3
    v_lshl_add_u32 v12, v1, 7, v3
    v_xor_b32 v13, 64, v12
    v_lshrrev_b32 v3, 1, v2
    v_lshrrev_b32 v4, 2, v1
    v_xor_b32 v3, v3, v4
    v_lshlrev_b32 v3, 4, v3
    v_lshl_add_u32 v3, v1, 6, v3
    v_and_b32 v2, 1, v2
    v_lshl_add_u32 v3, v2, 3, v3
    v_add_u32 v24, 12288, v3
    v_xor_b32 v25, 32, v24
    v_lshrrev_b32 v1, 4, v0
    v_bfe_u32 v2, v0, 2, 2
    v_lshl_add_u32 v2, v1, 3, v2
    v_and_b32 v1, 1, v1
    v_lshlrev_b32 v1, 2, v1
    v_xor_b32 v2, v2, v1
    v_bfe_u32 v3, v2, 1, 2
    v_and_b32 v4, 3, v0
    v_lshlrev_b32 v4, 3, v4
    v_lshl_add_u32 v4, v2, 7, v4
    v_lshl_add_u32 v21, v3, 5, v4
    v_xor_b32 v22, 0x240, v21
    s_lshr_b32 s74, s64, 1
    s_lshl_b32 s74, s74, 12
    s_add_u32 s74, s74, 110592
    s_and_b32 s75, s64, 1
    s_lshl_b32 s75, s75, 6
    v_xor_b32 v21, s75, v21
    v_xor_b32 v22, s75, v22
    v_add_u32 v16, s74, v21
    v_add_u32 v17, s74, v22
    v_xor_b32 v18, 32, v16
    v_xor_b32 v19, 32, v17
    v_and_b32 v1, 7, v0
    v_lshlrev_b32 v1, 4, v1
    v_lshrrev_b32 v2, 4, v0
    v_lshl_add_u32 v21, v2, 8, v1
    v_bfe_u32 v22, v0, 3, 1
    s_mov_b32 s74, 331776
    v_mul_lo_u32 v2, v22, s74
    v_add_u32 v20, v21, v2
    s_lshl_b32 s82, s71, 3
    s_lshl_b32 s75, s64, 1
    s_add_u32 s82, s82, s75
    s_mul_i32 s74, s82, 663552
    s_lshr_b32 s75, s70, 1
    s_mul_i32 s75, s75, 20480
    s_add_u32 s74, s74, s75
    s_and_b32 s83, s70, 1
    s_lshl_b32 s83, s83, 7
    s_add_u32 s74, s74, s83
    s_add_u32 s89, s74, 0x2000000
    s_add_u32 s91, s89, 20480
    s_lshl_b32 s75, s71, 12
    s_add_u32 s72, s89, s75
    s_add_u32 s73, s72, 663552
    v_accvgpr_write_b32 a48, 0
    v_accvgpr_write_b32 a49, 0
    v_accvgpr_write_b32 a50, 0
    v_accvgpr_write_b32 a51, 0
    v_accvgpr_write_b32 a52, 0
    v_accvgpr_write_b32 a53, 0
    v_accvgpr_write_b32 a54, 0
    v_accvgpr_write_b32 a55, 0
    v_accvgpr_write_b32 a56, 0
    v_accvgpr_write_b32 a57, 0
    v_accvgpr_write_b32 a58, 0
    v_accvgpr_write_b32 a59, 0
    v_accvgpr_write_b32 a60, 0
    v_accvgpr_write_b32 a61, 0
    v_accvgpr_write_b32 a62, 0
    v_accvgpr_write_b32 a63, 0
    v_accvgpr_write_b32 a64, 0
    v_accvgpr_write_b32 a65, 0
    v_accvgpr_write_b32 a66, 0
    v_accvgpr_write_b32 a67, 0
    v_accvgpr_write_b32 a68, 0
    v_accvgpr_write_b32 a69, 0
    v_accvgpr_write_b32 a70, 0
    v_accvgpr_write_b32 a71, 0
    v_accvgpr_write_b32 a72, 0
    v_accvgpr_write_b32 a73, 0
    v_accvgpr_write_b32 a74, 0
    v_accvgpr_write_b32 a75, 0
    v_accvgpr_write_b32 a76, 0
    v_accvgpr_write_b32 a77, 0
    v_accvgpr_write_b32 a78, 0
    v_accvgpr_write_b32 a79, 0
    v_accvgpr_write_b32 a80, 0
    v_accvgpr_write_b32 a81, 0
    v_accvgpr_write_b32 a82, 0
    v_accvgpr_write_b32 a83, 0
    v_accvgpr_write_b32 a84, 0
    v_accvgpr_write_b32 a85, 0
    v_accvgpr_write_b32 a86, 0
    v_accvgpr_write_b32 a87, 0
    s_waitcnt vmcnt(12)
    s_barrier
    ds_read_b64_tr_b16 a[0:1], v16 offset:0
    ds_read_b64_tr_b16 a[2:3], v17 offset:0
    ds_read_b64_tr_b16 a[4:5], v18 offset:0
    ds_read_b64_tr_b16 a[6:7], v19 offset:0
    ds_read_b64_tr_b16 a[8:9], v16 offset:8192
    ds_read_b64_tr_b16 a[10:11], v17 offset:8192
    ds_read_b64_tr_b16 a[12:13], v18 offset:8192
    ds_read_b64_tr_b16 a[14:15], v19 offset:8192
    ds_read_b64_tr_b16 a[16:17], v16 offset:16384
    ds_read_b64_tr_b16 a[18:19], v17 offset:16384
    ds_read_b64_tr_b16 a[20:21], v18 offset:16384
    ds_read_b64_tr_b16 a[22:23], v19 offset:16384
    s_waitcnt lgkmcnt(0)
    ds_read_b64_tr_b16 a[24:25], v16 offset:24576
    ds_read_b64_tr_b16 a[26:27], v17 offset:24576
    ds_read_b64_tr_b16 a[28:29], v18 offset:24576
    ds_read_b64_tr_b16 a[30:31], v19 offset:24576
    ds_read_b64_tr_b16 a[32:33], v16 offset:32768
    ds_read_b64_tr_b16 a[34:35], v17 offset:32768
    ds_read_b64_tr_b16 a[36:37], v18 offset:32768
    ds_read_b64_tr_b16 a[38:39], v19 offset:32768
    ds_read_b64_tr_b16 a[40:41], v16 offset:40960
    ds_read_b64_tr_b16 a[42:43], v17 offset:40960
    ds_read_b64_tr_b16 a[44:45], v18 offset:40960
    ds_read_b64_tr_b16 a[46:47], v19 offset:40960
    s_waitcnt lgkmcnt(0)
    ds_read_b128 v[32:35], v12 offset:0
    ds_read_b128 v[36:39], v12 offset:2048
    ds_read_b128 v[40:43], v13 offset:0
    ds_read_b128 v[44:47], v13 offset:2048
    ds_read_b128 v[48:51], v12 offset:4096
    ds_read_b128 v[52:55], v12 offset:6144
    ds_read_b128 v[56:59], v13 offset:4096
    ds_read_b128 v[60:63], v13 offset:6144
    ds_read_b128 v[64:67], v12 offset:8192
    ds_read_b128 v[68:71], v12 offset:10240
    ds_read_b128 v[72:75], v13 offset:8192
    ds_read_b128 v[76:79], v13 offset:10240
    s_waitcnt vmcnt(7) lgkmcnt(0)
    s_barrier
    v_mfma_f32_16x16x32_bf16 v[168:171], v[32:35], a[0:3], 0
    ds_read_b128 v[80:83], v12 offset:17408
    v_mfma_f32_16x16x32_bf16 v[172:175], v[32:35], a[4:7], 0
    ds_read_b128 v[84:87], v12 offset:19456
    s_add_u32 m0, s76, 52224
    v_mfma_f32_16x16x32_bf16 v[176:179], v[36:39], a[0:3], 0
    buffer_load_dwordx4 v10, s[52:55], s79 offen offset:0 lds
    v_mfma_f32_16x16x32_bf16 v[180:183], v[36:39], a[4:7], 0
    ds_read_b128 v[88:91], v13 offset:17408
    v_mfma_f32_16x16x32_bf16 v[168:171], v[40:43], a[8:11], v[168:171]
    ds_read_b128 v[92:95], v13 offset:19456
    v_mfma_f32_16x16x32_bf16 v[172:175], v[40:43], a[12:15], v[172:175]
    ds_read_b128 v[96:99], v12 offset:21504
    v_mfma_f32_16x16x32_bf16 v[176:179], v[44:47], a[8:11], v[176:179]
    ds_read_b128 v[100:103], v12 offset:23552
    s_add_u32 m0, s76, 56192
    v_mfma_f32_16x16x32_bf16 v[180:183], v[44:47], a[12:15], v[180:183]
    buffer_load_dwordx4 v10, s[52:55], s79 offen offset:128 lds
    v_mfma_f32_16x16x32_bf16 v[168:171], v[48:51], a[16:19], v[168:171]
    ds_read_b128 v[104:107], v13 offset:21504
    v_mfma_f32_16x16x32_bf16 v[172:175], v[48:51], a[20:23], v[172:175]
    ds_read_b128 v[108:111], v13 offset:23552
    v_mfma_f32_16x16x32_bf16 v[176:179], v[52:55], a[16:19], v[176:179]
    ds_read_b128 v[112:115], v12 offset:25600
    v_mfma_f32_16x16x32_bf16 v[180:183], v[52:55], a[20:23], v[180:183]
    ds_read_b128 v[116:119], v12 offset:27648
    s_add_u32 m0, s76, 60160
    v_mfma_f32_16x16x32_bf16 v[168:171], v[56:59], a[24:27], v[168:171]
    buffer_load_dwordx4 v10, s[52:55], s79 offen offset:256 lds
    v_mfma_f32_16x16x32_bf16 v[172:175], v[56:59], a[28:31], v[172:175]
    ds_read_b64 v[128:129], v24 offset:0
    ds_read_b64 v[130:131], v25 offset:0
    v_mfma_f32_16x16x32_bf16 v[176:179], v[60:63], a[24:27], v[176:179]
    ds_read_b64 v[132:133], v24 offset:1024
    ds_read_b64 v[134:135], v25 offset:1024
    v_mfma_f32_16x16x32_bf16 v[180:183], v[60:63], a[28:31], v[180:183]
    ds_read_b64 v[136:137], v24 offset:2048
    ds_read_b64 v[138:139], v25 offset:2048
    v_mfma_f32_16x16x32_bf16 v[168:171], v[64:67], a[32:35], v[168:171]
    ds_read_b64 v[140:141], v24 offset:3072
    ds_read_b64 v[142:143], v25 offset:3072
    s_add_u32 m0, s76, 64512
    v_mfma_f32_16x16x32_bf16 v[172:175], v[64:67], a[36:39], v[172:175]
    buffer_load_dwordx4 v26, s[4:7], s81 offen lds
    ds_read_b64 v[144:145], v24 offset:4096
    ds_read_b64 v[146:147], v25 offset:4096
    v_mfma_f32_16x16x32_bf16 v[176:179], v[68:71], a[32:35], v[176:179]
    v_mfma_f32_16x16x32_bf16 v[180:183], v[68:71], a[36:39], v[180:183]
    v_mfma_f32_16x16x32_bf16 v[168:171], v[72:75], a[40:43], v[168:171]
    v_mfma_f32_16x16x32_bf16 v[172:175], v[72:75], a[44:47], v[172:175]
    s_mov_b32 m0, 68608
    v_mfma_f32_16x16x32_bf16 v[176:179], v[76:79], a[40:43], v[176:179]
    buffer_load_dwordx4 v23, s[8:11], s81 offen lds
    s_add_u32 s79, s79, 393216
    s_add_u32 s81, s81, 64
    v_mfma_f32_16x16x32_bf16 v[180:183], v[76:79], a[44:47], v[180:183]
    ds_read_b128 v[120:123], v13 offset:25600
    ds_read_b128 v[124:127], v13 offset:27648
    buffer_load_dword v30, v23, s[8:11], s90 offen
    buffer_load_dword v30, v23, s[8:11], s90 offen
L_bm_loop_117:
    s_waitcnt vmcnt(9) lgkmcnt(0)
    s_barrier
    s_cmp_eq_u32 s81, 1280
    s_cselect_b32 s81, 0, s81
    s_cselect_b32 s79, s87, s79
    s_add_u32 s88, s88, 1
    s_cmp_eq_u32 s88, 5
    s_cselect_b32 s79, 0x40000000, s79
    s_cmp_eq_u32 s72, s91
    s_cselect_b32 s72, s89, s72
    s_add_u32 s73, s72, 663552
    v_mfma_f32_16x16x32_bf16 v[184:187], v[80:83], a[0:3], 0
    ds_read_b128 v[32:35], v12 offset:34816
    v_mfma_f32_16x16x32_bf16 v[188:191], v[80:83], a[4:7], 0
    ds_read_b128 v[36:39], v12 offset:36864
    s_add_u32 m0, s76, 0
    v_mfma_f32_16x16x32_bf16 v[192:195], v[84:87], a[0:3], 0
    buffer_load_dwordx4 v10, s[52:55], s79 offen offset:0 lds
    v_mfma_f32_16x16x32_bf16 v[196:199], v[84:87], a[4:7], 0
    ds_read_b128 v[40:43], v13 offset:34816
    v_cvt_pk_bf16_f32 v200, v168, v169
    v_mfma_f32_16x16x32_bf16 v[184:187], v[88:91], a[8:11], v[184:187]
    ds_read_b128 v[44:47], v13 offset:36864
    v_cvt_pk_bf16_f32 v201, v170, v171
    v_mfma_f32_16x16x32_bf16 v[188:191], v[88:91], a[12:15], v[188:191]
    ds_read_b128 v[48:51], v12 offset:38912
    v_cvt_pk_bf16_f32 v202, v176, v177
    v_mfma_f32_16x16x32_bf16 v[192:195], v[92:95], a[8:11], v[192:195]
    ds_read_b128 v[52:55], v12 offset:40960
    v_cvt_pk_bf16_f32 v203, v178, v179
    s_add_u32 m0, s76, 3968
    v_mfma_f32_16x16x32_bf16 v[196:199], v[92:95], a[12:15], v[196:199]
    buffer_load_dwordx4 v10, s[52:55], s79 offen offset:128 lds
    v_cvt_pk_bf16_f32 v204, v172, v173
    v_mfma_f32_16x16x32_bf16 v[184:187], v[96:99], a[16:19], v[184:187]
    ds_read_b128 v[56:59], v13 offset:38912
    v_cvt_pk_bf16_f32 v205, v174, v175
    v_mfma_f32_16x16x32_bf16 v[188:191], v[96:99], a[20:23], v[188:191]
    ds_read_b128 v[60:63], v13 offset:40960
    v_cvt_pk_bf16_f32 v206, v180, v181
    v_mfma_f32_16x16x32_bf16 v[192:195], v[100:103], a[16:19], v[192:195]
    ds_read_b128 v[64:67], v12 offset:43008
    v_cvt_pk_bf16_f32 v207, v182, v183
    v_mfma_f32_16x16x32_bf16 v[196:199], v[100:103], a[20:23], v[196:199]
    ds_read_b128 v[68:71], v12 offset:45056
    s_add_u32 m0, s76, 7936
    v_mfma_f32_16x16x32_bf16 v[184:187], v[104:107], a[24:27], v[184:187]
    buffer_load_dwordx4 v10, s[52:55], s79 offen offset:256 lds
    v_mfma_f32_16x16x32_bf16 a[48:51], v[128:131], v[200:203], a[48:51]
    ds_read_b128 v[72:75], v13 offset:43008
    v_mfma_f32_16x16x32_bf16 a[52:55], v[128:131], v[204:207], a[52:55]
    ds_read_b128 v[76:79], v13 offset:45056
    v_mfma_f32_16x16x32_bf16 a[56:59], v[132:135], v[200:203], a[56:59]
    v_mfma_f32_16x16x32_bf16 a[60:63], v[132:135], v[204:207], a[60:63]
    s_add_u32 m0, s76, 12288
    v_mfma_f32_16x16x32_bf16 a[64:67], v[136:139], v[200:203], a[64:67]
    buffer_load_dwordx4 v26, s[4:7], s81 offen lds
    v_mfma_f32_16x16x32_bf16 a[68:71], v[136:139], v[204:207], a[68:71]
    v_mfma_f32_16x16x32_bf16 a[72:75], v[140:143], v[200:203], a[72:75]
    v_mfma_f32_16x16x32_bf16 a[76:79], v[140:143], v[204:207], a[76:79]
    v_mfma_f32_16x16x32_bf16 a[80:83], v[144:147], v[200:203], a[80:83]
    s_mov_b32 m0, 16384
    v_mfma_f32_16x16x32_bf16 a[84:87], v[144:147], v[204:207], a[84:87]
    buffer_load_dwordx4 v23, s[8:11], s81 offen lds
    s_add_u32 s79, s79, 393216
    s_add_u32 s81, s81, 64
    v_mfma_f32_16x16x32_bf16 v[188:191], v[104:107], a[28:31], v[188:191]
    v_swap_b32 v201, v202
    v_swap_b32 v205, v206
    v_mfma_f32_16x16x32_bf16 v[192:195], v[108:111], a[24:27], v[192:195]
    v_permlane32_swap_b32 v200, v201
    v_mfma_f32_16x16x32_bf16 v[196:199], v[108:111], a[28:31], v[196:199]
    v_permlane32_swap_b32 v202, v203
    buffer_store_dwordx4 v[200:203], v20, s[48:51], s72 offen sc1
    s_add_u32 s72, s72, 1024
    v_mfma_f32_16x16x32_bf16 v[184:187], v[112:115], a[32:35], v[184:187]
    v_permlane32_swap_b32 v204, v205
    v_permlane32_swap_b32 v206, v207
    v_mfma_f32_16x16x32_bf16 v[188:191], v[112:115], a[36:39], v[188:191]
    buffer_store_dwordx4 v[204:207], v20, s[48:51], s73 offen sc1
    s_add_u32 s73, s73, 1024
    ds_read_b64 v[128:129], v24 offset:17408
    v_mfma_f32_16x16x32_bf16 v[192:195], v[116:119], a[32:35], v[192:195]
    ds_read_b64 v[130:131], v25 offset:17408
    ds_read_b64 v[132:133], v24 offset:18432
    v_mfma_f32_16x16x32_bf16 v[196:199], v[116:119], a[36:39], v[196:199]
    ds_read_b64 v[134:135], v25 offset:18432
    ds_read_b64 v[136:137], v24 offset:19456
    v_mfma_f32_16x16x32_bf16 v[184:187], v[120:123], a[40:43], v[184:187]
    ds_read_b64 v[138:139], v25 offset:19456
    ds_read_b64 v[140:141], v24 offset:20480
    v_mfma_f32_16x16x32_bf16 v[188:191], v[120:123], a[44:47], v[188:191]
    ds_read_b64 v[142:143], v25 offset:20480
    ds_read_b64 v[144:145], v24 offset:21504
    v_mfma_f32_16x16x32_bf16 v[192:195], v[124:127], a[40:43], v[192:195]
    ds_read_b64 v[146:147], v25 offset:21504
    v_mfma_f32_16x16x32_bf16 v[196:199], v[124:127], a[44:47], v[196:199]
    s_waitcnt vmcnt(9) lgkmcnt(0)
    s_barrier
    v_mfma_f32_16x16x32_bf16 v[168:171], v[32:35], a[0:3], 0
    ds_read_b128 v[80:83], v12 offset:52224
    v_mfma_f32_16x16x32_bf16 v[172:175], v[32:35], a[4:7], 0
    ds_read_b128 v[84:87], v12 offset:54272
    s_add_u32 m0, s76, 17408
    v_mfma_f32_16x16x32_bf16 v[176:179], v[36:39], a[0:3], 0
    buffer_load_dwordx4 v10, s[52:55], s79 offen offset:0 lds
    v_mfma_f32_16x16x32_bf16 v[180:183], v[36:39], a[4:7], 0
    ds_read_b128 v[88:91], v13 offset:52224
    v_cvt_pk_bf16_f32 v200, v184, v185
    v_mfma_f32_16x16x32_bf16 v[168:171], v[40:43], a[8:11], v[168:171]
    ds_read_b128 v[92:95], v13 offset:54272
    v_cvt_pk_bf16_f32 v201, v186, v187
    v_mfma_f32_16x16x32_bf16 v[172:175], v[40:43], a[12:15], v[172:175]
    ds_read_b128 v[96:99], v12 offset:56320
    v_cvt_pk_bf16_f32 v202, v192, v193
    v_mfma_f32_16x16x32_bf16 v[176:179], v[44:47], a[8:11], v[176:179]
    ds_read_b128 v[100:103], v12 offset:58368
    v_cvt_pk_bf16_f32 v203, v194, v195
    s_add_u32 m0, s76, 21376
    v_mfma_f32_16x16x32_bf16 v[180:183], v[44:47], a[12:15], v[180:183]
    buffer_load_dwordx4 v10, s[52:55], s79 offen offset:128 lds
    v_cvt_pk_bf16_f32 v204, v188, v189
    v_mfma_f32_16x16x32_bf16 v[168:171], v[48:51], a[16:19], v[168:171]
    ds_read_b128 v[104:107], v13 offset:56320
    v_cvt_pk_bf16_f32 v205, v190, v191
    v_mfma_f32_16x16x32_bf16 v[172:175], v[48:51], a[20:23], v[172:175]
    ds_read_b128 v[108:111], v13 offset:58368
    v_cvt_pk_bf16_f32 v206, v196, v197
    v_mfma_f32_16x16x32_bf16 v[176:179], v[52:55], a[16:19], v[176:179]
    ds_read_b128 v[112:115], v12 offset:60416
    v_cvt_pk_bf16_f32 v207, v198, v199
    v_mfma_f32_16x16x32_bf16 v[180:183], v[52:55], a[20:23], v[180:183]
    ds_read_b128 v[116:119], v12 offset:62464
    s_add_u32 m0, s76, 25344
    v_mfma_f32_16x16x32_bf16 v[168:171], v[56:59], a[24:27], v[168:171]
    buffer_load_dwordx4 v10, s[52:55], s79 offen offset:256 lds
    v_mfma_f32_16x16x32_bf16 a[48:51], v[128:131], v[200:203], a[48:51]
    ds_read_b128 v[120:123], v13 offset:60416
    v_mfma_f32_16x16x32_bf16 a[52:55], v[128:131], v[204:207], a[52:55]
    ds_read_b128 v[124:127], v13 offset:62464
    v_mfma_f32_16x16x32_bf16 a[56:59], v[132:135], v[200:203], a[56:59]
    v_mfma_f32_16x16x32_bf16 a[60:63], v[132:135], v[204:207], a[60:63]
    s_add_u32 m0, s76, 29696
    v_mfma_f32_16x16x32_bf16 a[64:67], v[136:139], v[200:203], a[64:67]
    buffer_load_dwordx4 v26, s[4:7], s81 offen lds
    v_mfma_f32_16x16x32_bf16 a[68:71], v[136:139], v[204:207], a[68:71]
    v_mfma_f32_16x16x32_bf16 a[72:75], v[140:143], v[200:203], a[72:75]
    v_mfma_f32_16x16x32_bf16 a[76:79], v[140:143], v[204:207], a[76:79]
    v_mfma_f32_16x16x32_bf16 a[80:83], v[144:147], v[200:203], a[80:83]
    s_mov_b32 m0, 33792
    v_mfma_f32_16x16x32_bf16 a[84:87], v[144:147], v[204:207], a[84:87]
    buffer_load_dwordx4 v23, s[8:11], s81 offen lds
    s_add_u32 s79, s79, 393216
    s_add_u32 s81, s81, 64
    v_mfma_f32_16x16x32_bf16 v[172:175], v[56:59], a[28:31], v[172:175]
    v_swap_b32 v201, v202
    v_swap_b32 v205, v206
    v_mfma_f32_16x16x32_bf16 v[176:179], v[60:63], a[24:27], v[176:179]
    v_permlane32_swap_b32 v200, v201
    v_mfma_f32_16x16x32_bf16 v[180:183], v[60:63], a[28:31], v[180:183]
    v_permlane32_swap_b32 v202, v203
    buffer_store_dwordx4 v[200:203], v20, s[48:51], s72 offen sc1
    s_add_u32 s72, s72, 1024
    v_mfma_f32_16x16x32_bf16 v[168:171], v[64:67], a[32:35], v[168:171]
    v_permlane32_swap_b32 v204, v205
    v_permlane32_swap_b32 v206, v207
    v_mfma_f32_16x16x32_bf16 v[172:175], v[64:67], a[36:39], v[172:175]
    buffer_store_dwordx4 v[204:207], v20, s[48:51], s73 offen sc1
    s_add_u32 s73, s73, 1024
    ds_read_b64 v[128:129], v24 offset:34816
    v_mfma_f32_16x16x32_bf16 v[176:179], v[68:71], a[32:35], v[176:179]
    ds_read_b64 v[130:131], v25 offset:34816
    ds_read_b64 v[132:133], v24 offset:35840
    v_mfma_f32_16x16x32_bf16 v[180:183], v[68:71], a[36:39], v[180:183]
    ds_read_b64 v[134:135], v25 offset:35840
    ds_read_b64 v[136:137], v24 offset:36864
    v_mfma_f32_16x16x32_bf16 v[168:171], v[72:75], a[40:43], v[168:171]
    ds_read_b64 v[138:139], v25 offset:36864
    ds_read_b64 v[140:141], v24 offset:37888
    v_mfma_f32_16x16x32_bf16 v[172:175], v[72:75], a[44:47], v[172:175]
    ds_read_b64 v[142:143], v25 offset:37888
    ds_read_b64 v[144:145], v24 offset:38912
    v_mfma_f32_16x16x32_bf16 v[176:179], v[76:79], a[40:43], v[176:179]
    ds_read_b64 v[146:147], v25 offset:38912
    v_mfma_f32_16x16x32_bf16 v[180:183], v[76:79], a[44:47], v[180:183]
    s_waitcnt vmcnt(9) lgkmcnt(0)
    s_barrier
    v_mfma_f32_16x16x32_bf16 v[184:187], v[80:83], a[0:3], 0
    ds_read_b128 v[32:35], v12 offset:0
    v_mfma_f32_16x16x32_bf16 v[188:191], v[80:83], a[4:7], 0
    ds_read_b128 v[36:39], v12 offset:2048
    s_add_u32 m0, s76, 34816
    v_mfma_f32_16x16x32_bf16 v[192:195], v[84:87], a[0:3], 0
    buffer_load_dwordx4 v10, s[52:55], s79 offen offset:0 lds
    v_mfma_f32_16x16x32_bf16 v[196:199], v[84:87], a[4:7], 0
    ds_read_b128 v[40:43], v13 offset:0
    v_cvt_pk_bf16_f32 v200, v168, v169
    v_mfma_f32_16x16x32_bf16 v[184:187], v[88:91], a[8:11], v[184:187]
    ds_read_b128 v[44:47], v13 offset:2048
    v_cvt_pk_bf16_f32 v201, v170, v171
    v_mfma_f32_16x16x32_bf16 v[188:191], v[88:91], a[12:15], v[188:191]
    ds_read_b128 v[48:51], v12 offset:4096
    v_cvt_pk_bf16_f32 v202, v176, v177
    v_mfma_f32_16x16x32_bf16 v[192:195], v[92:95], a[8:11], v[192:195]
    ds_read_b128 v[52:55], v12 offset:6144
    v_cvt_pk_bf16_f32 v203, v178, v179
    s_add_u32 m0, s76, 38784
    v_mfma_f32_16x16x32_bf16 v[196:199], v[92:95], a[12:15], v[196:199]
    buffer_load_dwordx4 v10, s[52:55], s79 offen offset:128 lds
    v_cvt_pk_bf16_f32 v204, v172, v173
    v_mfma_f32_16x16x32_bf16 v[184:187], v[96:99], a[16:19], v[184:187]
    ds_read_b128 v[56:59], v13 offset:4096
    v_cvt_pk_bf16_f32 v205, v174, v175
    v_mfma_f32_16x16x32_bf16 v[188:191], v[96:99], a[20:23], v[188:191]
    ds_read_b128 v[60:63], v13 offset:6144
    v_cvt_pk_bf16_f32 v206, v180, v181
    v_mfma_f32_16x16x32_bf16 v[192:195], v[100:103], a[16:19], v[192:195]
    ds_read_b128 v[64:67], v12 offset:8192
    v_cvt_pk_bf16_f32 v207, v182, v183
    v_mfma_f32_16x16x32_bf16 v[196:199], v[100:103], a[20:23], v[196:199]
    ds_read_b128 v[68:71], v12 offset:10240
    s_add_u32 m0, s76, 42752
    v_mfma_f32_16x16x32_bf16 v[184:187], v[104:107], a[24:27], v[184:187]
    buffer_load_dwordx4 v10, s[52:55], s79 offen offset:256 lds
    v_mfma_f32_16x16x32_bf16 a[48:51], v[128:131], v[200:203], a[48:51]
    ds_read_b128 v[72:75], v13 offset:8192
    v_mfma_f32_16x16x32_bf16 a[52:55], v[128:131], v[204:207], a[52:55]
    ds_read_b128 v[76:79], v13 offset:10240
    v_mfma_f32_16x16x32_bf16 a[56:59], v[132:135], v[200:203], a[56:59]
    v_mfma_f32_16x16x32_bf16 a[60:63], v[132:135], v[204:207], a[60:63]
    s_add_u32 m0, s76, 47104
    v_mfma_f32_16x16x32_bf16 a[64:67], v[136:139], v[200:203], a[64:67]
    buffer_load_dwordx4 v26, s[4:7], s81 offen lds
    v_mfma_f32_16x16x32_bf16 a[68:71], v[136:139], v[204:207], a[68:71]
    v_mfma_f32_16x16x32_bf16 a[72:75], v[140:143], v[200:203], a[72:75]
    v_mfma_f32_16x16x32_bf16 a[76:79], v[140:143], v[204:207], a[76:79]
    v_mfma_f32_16x16x32_bf16 a[80:83], v[144:147], v[200:203], a[80:83]
    s_mov_b32 m0, 51200
    v_mfma_f32_16x16x32_bf16 a[84:87], v[144:147], v[204:207], a[84:87]
    buffer_load_dwordx4 v23, s[8:11], s81 offen lds
    s_add_u32 s79, s79, 393216
    s_add_u32 s81, s81, 64
    v_mfma_f32_16x16x32_bf16 v[188:191], v[104:107], a[28:31], v[188:191]
    v_swap_b32 v201, v202
    v_swap_b32 v205, v206
    v_mfma_f32_16x16x32_bf16 v[192:195], v[108:111], a[24:27], v[192:195]
    v_permlane32_swap_b32 v200, v201
    v_mfma_f32_16x16x32_bf16 v[196:199], v[108:111], a[28:31], v[196:199]
    v_permlane32_swap_b32 v202, v203
    buffer_store_dwordx4 v[200:203], v20, s[48:51], s72 offen sc1
    s_add_u32 s72, s72, 1024
    v_mfma_f32_16x16x32_bf16 v[184:187], v[112:115], a[32:35], v[184:187]
    v_permlane32_swap_b32 v204, v205
    v_permlane32_swap_b32 v206, v207
    v_mfma_f32_16x16x32_bf16 v[188:191], v[112:115], a[36:39], v[188:191]
    buffer_store_dwordx4 v[204:207], v20, s[48:51], s73 offen sc1
    s_add_u32 s73, s73, 1024
    ds_read_b64 v[128:129], v24 offset:52224
    v_mfma_f32_16x16x32_bf16 v[192:195], v[116:119], a[32:35], v[192:195]
    ds_read_b64 v[130:131], v25 offset:52224
    ds_read_b64 v[132:133], v24 offset:53248
    v_mfma_f32_16x16x32_bf16 v[196:199], v[116:119], a[36:39], v[196:199]
    ds_read_b64 v[134:135], v25 offset:53248
    ds_read_b64 v[136:137], v24 offset:54272
    v_mfma_f32_16x16x32_bf16 v[184:187], v[120:123], a[40:43], v[184:187]
    ds_read_b64 v[138:139], v25 offset:54272
    ds_read_b64 v[140:141], v24 offset:55296
    v_mfma_f32_16x16x32_bf16 v[188:191], v[120:123], a[44:47], v[188:191]
    ds_read_b64 v[142:143], v25 offset:55296
    ds_read_b64 v[144:145], v24 offset:56320
    v_mfma_f32_16x16x32_bf16 v[192:195], v[124:127], a[40:43], v[192:195]
    ds_read_b64 v[146:147], v25 offset:56320
    v_mfma_f32_16x16x32_bf16 v[196:199], v[124:127], a[44:47], v[196:199]
    s_waitcnt vmcnt(9) lgkmcnt(0)
    s_barrier
    v_mfma_f32_16x16x32_bf16 v[168:171], v[32:35], a[0:3], 0
    ds_read_b128 v[80:83], v12 offset:17408
    v_mfma_f32_16x16x32_bf16 v[172:175], v[32:35], a[4:7], 0
    ds_read_b128 v[84:87], v12 offset:19456
    s_add_u32 m0, s76, 52224
    v_mfma_f32_16x16x32_bf16 v[176:179], v[36:39], a[0:3], 0
    buffer_load_dwordx4 v10, s[52:55], s79 offen offset:0 lds
    v_mfma_f32_16x16x32_bf16 v[180:183], v[36:39], a[4:7], 0
    ds_read_b128 v[88:91], v13 offset:17408
    v_cvt_pk_bf16_f32 v200, v184, v185
    v_mfma_f32_16x16x32_bf16 v[168:171], v[40:43], a[8:11], v[168:171]
    ds_read_b128 v[92:95], v13 offset:19456
    v_cvt_pk_bf16_f32 v201, v186, v187
    v_mfma_f32_16x16x32_bf16 v[172:175], v[40:43], a[12:15], v[172:175]
    ds_read_b128 v[96:99], v12 offset:21504
    v_cvt_pk_bf16_f32 v202, v192, v193
    v_mfma_f32_16x16x32_bf16 v[176:179], v[44:47], a[8:11], v[176:179]
    ds_read_b128 v[100:103], v12 offset:23552
    v_cvt_pk_bf16_f32 v203, v194, v195
    s_add_u32 m0, s76, 56192
    v_mfma_f32_16x16x32_bf16 v[180:183], v[44:47], a[12:15], v[180:183]
    buffer_load_dwordx4 v10, s[52:55], s79 offen offset:128 lds
    v_cvt_pk_bf16_f32 v204, v188, v189
    v_mfma_f32_16x16x32_bf16 v[168:171], v[48:51], a[16:19], v[168:171]
    ds_read_b128 v[104:107], v13 offset:21504
    v_cvt_pk_bf16_f32 v205, v190, v191
    v_mfma_f32_16x16x32_bf16 v[172:175], v[48:51], a[20:23], v[172:175]
    ds_read_b128 v[108:111], v13 offset:23552
    v_cvt_pk_bf16_f32 v206, v196, v197
    v_mfma_f32_16x16x32_bf16 v[176:179], v[52:55], a[16:19], v[176:179]
    ds_read_b128 v[112:115], v12 offset:25600
    v_cvt_pk_bf16_f32 v207, v198, v199
    v_mfma_f32_16x16x32_bf16 v[180:183], v[52:55], a[20:23], v[180:183]
    ds_read_b128 v[116:119], v12 offset:27648
    s_add_u32 m0, s76, 60160
    v_mfma_f32_16x16x32_bf16 v[168:171], v[56:59], a[24:27], v[168:171]
    buffer_load_dwordx4 v10, s[52:55], s79 offen offset:256 lds
    v_mfma_f32_16x16x32_bf16 a[48:51], v[128:131], v[200:203], a[48:51]
    ds_read_b128 v[120:123], v13 offset:25600
    v_mfma_f32_16x16x32_bf16 a[52:55], v[128:131], v[204:207], a[52:55]
    ds_read_b128 v[124:127], v13 offset:27648
    v_mfma_f32_16x16x32_bf16 a[56:59], v[132:135], v[200:203], a[56:59]
    v_mfma_f32_16x16x32_bf16 a[60:63], v[132:135], v[204:207], a[60:63]
    s_add_u32 m0, s76, 64512
    v_mfma_f32_16x16x32_bf16 a[64:67], v[136:139], v[200:203], a[64:67]
    buffer_load_dwordx4 v26, s[4:7], s81 offen lds
    v_mfma_f32_16x16x32_bf16 a[68:71], v[136:139], v[204:207], a[68:71]
    v_mfma_f32_16x16x32_bf16 a[72:75], v[140:143], v[200:203], a[72:75]
    v_mfma_f32_16x16x32_bf16 a[76:79], v[140:143], v[204:207], a[76:79]
    v_mfma_f32_16x16x32_bf16 a[80:83], v[144:147], v[200:203], a[80:83]
    s_mov_b32 m0, 68608
    v_mfma_f32_16x16x32_bf16 a[84:87], v[144:147], v[204:207], a[84:87]
    buffer_load_dwordx4 v23, s[8:11], s81 offen lds
    s_add_u32 s79, s79, 393216
    s_add_u32 s81, s81, 64
    v_mfma_f32_16x16x32_bf16 v[172:175], v[56:59], a[28:31], v[172:175]
    v_swap_b32 v201, v202
    v_swap_b32 v205, v206
    v_mfma_f32_16x16x32_bf16 v[176:179], v[60:63], a[24:27], v[176:179]
    v_permlane32_swap_b32 v200, v201
    v_mfma_f32_16x16x32_bf16 v[180:183], v[60:63], a[28:31], v[180:183]
    v_permlane32_swap_b32 v202, v203
    buffer_store_dwordx4 v[200:203], v20, s[48:51], s72 offen sc1
    s_add_u32 s72, s72, 1024
    v_mfma_f32_16x16x32_bf16 v[168:171], v[64:67], a[32:35], v[168:171]
    v_permlane32_swap_b32 v204, v205
    v_permlane32_swap_b32 v206, v207
    v_mfma_f32_16x16x32_bf16 v[172:175], v[64:67], a[36:39], v[172:175]
    buffer_store_dwordx4 v[204:207], v20, s[48:51], s73 offen sc1
    s_add_u32 s73, s73, 1024
    ds_read_b64 v[128:129], v24 offset:0
    v_mfma_f32_16x16x32_bf16 v[176:179], v[68:71], a[32:35], v[176:179]
    ds_read_b64 v[130:131], v25 offset:0
    ds_read_b64 v[132:133], v24 offset:1024
    v_mfma_f32_16x16x32_bf16 v[180:183], v[68:71], a[36:39], v[180:183]
    ds_read_b64 v[134:135], v25 offset:1024
    ds_read_b64 v[136:137], v24 offset:2048
    v_mfma_f32_16x16x32_bf16 v[168:171], v[72:75], a[40:43], v[168:171]
    ds_read_b64 v[138:139], v25 offset:2048
    ds_read_b64 v[140:141], v24 offset:3072
    v_mfma_f32_16x16x32_bf16 v[172:175], v[72:75], a[44:47], v[172:175]
    ds_read_b64 v[142:143], v25 offset:3072
    ds_read_b64 v[144:145], v24 offset:4096
    v_mfma_f32_16x16x32_bf16 v[176:179], v[76:79], a[40:43], v[176:179]
    ds_read_b64 v[146:147], v25 offset:4096
    v_mfma_f32_16x16x32_bf16 v[180:183], v[76:79], a[44:47], v[180:183]
    s_cmp_lt_u32 s88, 5
    s_cbranch_scc1 L_bm_loop_117
    s_waitcnt lgkmcnt(0)
    s_mov_b32 s74, 0x101000
    v_mul_lo_u32 v2, v22, s74
    v_add_u32 v2, v21, v2
    s_mul_i32 s74, s82, 0x202000
    s_lshr_b32 s75, s70, 1
    s_lshl_b32 s75, s75, 10
    s_add_u32 s74, s74, s75
    s_add_u32 s74, s74, s83
    s_add_u32 s74, s74, 0x8100000
    s_nop 2
    v_accvgpr_read_b32 v36, a48
    v_accvgpr_read_b32 v37, a49
    v_accvgpr_read_b32 v38, a50
    v_accvgpr_read_b32 v39, a51
    v_accvgpr_read_b32 v40, a56
    v_accvgpr_read_b32 v41, a57
    v_accvgpr_read_b32 v42, a58
    v_accvgpr_read_b32 v43, a59
    v_cvt_pk_bf16_f32 v32, v36, v37
    v_cvt_pk_bf16_f32 v33, v38, v39
    v_cvt_pk_bf16_f32 v34, v40, v41
    v_cvt_pk_bf16_f32 v35, v42, v43
    s_add_u32 s75, s74, 0x0
    buffer_store_dwordx4 v[32:35], v2, s[48:51], s75 offen sc1
    v_accvgpr_read_b32 v48, a52
    v_accvgpr_read_b32 v49, a53
    v_accvgpr_read_b32 v50, a54
    v_accvgpr_read_b32 v51, a55
    v_accvgpr_read_b32 v52, a60
    v_accvgpr_read_b32 v53, a61
    v_accvgpr_read_b32 v54, a62
    v_accvgpr_read_b32 v55, a63
    v_cvt_pk_bf16_f32 v44, v48, v49
    v_cvt_pk_bf16_f32 v45, v50, v51
    v_cvt_pk_bf16_f32 v46, v52, v53
    v_cvt_pk_bf16_f32 v47, v54, v55
    s_add_u32 s75, s74, 0x202000
    buffer_store_dwordx4 v[44:47], v2, s[48:51], s75 offen sc1
    v_accvgpr_read_b32 v60, a64
    v_accvgpr_read_b32 v61, a65
    v_accvgpr_read_b32 v62, a66
    v_accvgpr_read_b32 v63, a67
    v_accvgpr_read_b32 v64, a72
    v_accvgpr_read_b32 v65, a73
    v_accvgpr_read_b32 v66, a74
    v_accvgpr_read_b32 v67, a75
    v_cvt_pk_bf16_f32 v56, v60, v61
    v_cvt_pk_bf16_f32 v57, v62, v63
    v_cvt_pk_bf16_f32 v58, v64, v65
    v_cvt_pk_bf16_f32 v59, v66, v67
    s_add_u32 s75, s74, 0x4000
    buffer_store_dwordx4 v[56:59], v2, s[48:51], s75 offen sc1
    v_accvgpr_read_b32 v72, a68
    v_accvgpr_read_b32 v73, a69
    v_accvgpr_read_b32 v74, a70
    v_accvgpr_read_b32 v75, a71
    v_accvgpr_read_b32 v76, a76
    v_accvgpr_read_b32 v77, a77
    v_accvgpr_read_b32 v78, a78
    v_accvgpr_read_b32 v79, a79
    v_cvt_pk_bf16_f32 v68, v72, v73
    v_cvt_pk_bf16_f32 v69, v74, v75
    v_cvt_pk_bf16_f32 v70, v76, v77
    v_cvt_pk_bf16_f32 v71, v78, v79
    s_add_u32 s75, s74, 0x206000
    buffer_store_dwordx4 v[68:71], v2, s[48:51], s75 offen sc1
    s_mov_b32 s74, 0x41000
    v_mul_lo_u32 v2, v22, s74
    v_add_u32 v2, v21, v2
    s_mul_i32 s74, s82, 0x82000
    s_lshr_b32 s75, s70, 3
    s_lshl_b32 s75, s75, 10
    s_add_u32 s74, s74, s75
    s_add_u32 s74, s74, s83
    s_bfe_u32 s75, s70, 0x10001
    s_lshl_b32 s75, s75, 9
    s_add_u32 s74, s74, s75
    s_bfe_u32 s75, s70, 0x10002
    s_lshl_b32 s75, s75, 3
    s_add_u32 s74, s74, s75
    s_add_u32 s74, s74, 0x3a00000
    v_accvgpr_read_b32 v130, a80
    v_accvgpr_read_b32 v131, a81
    v_accvgpr_read_b32 v132, a82
    v_accvgpr_read_b32 v133, a83
    v_cvt_pk_bf16_f32 v128, v130, v131
    v_cvt_pk_bf16_f32 v129, v132, v133
    s_add_u32 s75, s74, 0x0
    s_mov_b32 exec_hi, 0
    buffer_store_dwordx2 v[128:129], v2, s[48:51], s75 offen sc1
    s_mov_b64 exec, -1
    v_accvgpr_read_b32 v138, a84
    v_accvgpr_read_b32 v139, a85
    v_accvgpr_read_b32 v140, a86
    v_accvgpr_read_b32 v141, a87
    v_cvt_pk_bf16_f32 v136, v138, v139
    v_cvt_pk_bf16_f32 v137, v140, v141
    s_add_u32 s75, s74, 0x82000
    s_mov_b32 exec_hi, 0
    buffer_store_dwordx2 v[136:137], v2, s[48:51], s75 offen sc1
    s_mov_b64 exec, -1
    s_cmp_lg_u32 s64, 1
    s_cbranch_scc1 L_waok_119
    v_min_u32 v3, 0, v0
    v_lshlrev_b32 v3, 2, v3
    v_add_u32 v3, 0xa0, v3
L_wa_118:
    buffer_load_dword v2, v3, s[60:63], 0 offen sc1
    s_waitcnt vmcnt(0)
    v_cmp_gt_u32 vcc, 1, v2
    s_cbranch_vccz L_waok_119
    s_sleep 12
    s_sub_u32 s67, s67, 1
    s_cbranch_scc1 K2_DONE
    s_branch L_wa_118
L_waok_119:
    s_barrier
    s_lshl_b32 s74, s71, 5
    s_add_u32 s74, s74, s70
    s_lshl_b32 s92, s74, 2
    s_add_u32 s92, s92, 0x603a00
    s_mov_b32 s93, 1
    s_waitcnt vmcnt(0)
    s_barrier
    s_cmp_lg_u32 s64, 1
    s_cbranch_scc1 L_fs_120
    v_mov_b32 v2, s93
    v_mov_b32 v3, 0
    s_mov_b64 exec, 1
    buffer_store_dword v2, v3, s[48:51], s92 offen sc1
    s_mov_b64 exec, -1
L_fs_120:
    s_cmp_lg_u32 s64, 1
    s_cbranch_scc1 L_waok_122
    v_min_u32 v3, 63, v0
    v_lshlrev_b32 v3, 2, v3
    v_add_u32 v3, 0x603800, v3
L_wa_121:
    buffer_load_dword v2, v3, s[48:51], 0 offen sc1
    s_waitcnt vmcnt(0)
    v_cmp_gt_u32 vcc, 1, v2
    s_cbranch_vccz L_waok_122
    s_sleep 12
    s_sub_u32 s67, s67, 1
    s_cbranch_scc1 K2_DONE
    s_branch L_wa_121
L_waok_122:
    s_barrier
    s_sub_u32 s72, s65, 112
    v_lshlrev_b32 v1, 4, v0
    v_mov_b32 v2, v1
    s_mul_i32 s79, s64, 10240
    s_add_u32 s78, s79, 0x714000
    s_mov_b32 s66, 2
    s_add_u32 m0, s79, 0
    s_add_u32 s85, s78, 0
    buffer_load_dwordx4 v1, s[48:51], s85 offen offset:0 sc1 lds
    buffer_load_dwordx4 v1, s[48:51], s85 offen offset:1024 sc1 lds
    buffer_load_dwordx4 v1, s[48:51], s85 offen offset:2048 sc1 lds
    buffer_load_dwordx4 v1, s[48:51], s85 offen offset:3072 sc1 lds
    s_add_u32 m0, s79, 4096
    s_add_u32 s85, s78, 4096
    buffer_load_dwordx4 v1, s[48:51], s85 offen offset:0 sc1 lds
    buffer_load_dwordx4 v1, s[48:51], s85 offen offset:1024 sc1 lds
    buffer_load_dwordx4 v1, s[48:51], s85 offen offset:2048 sc1 lds
    buffer_load_dwordx4 v1, s[48:51], s85 offen offset:3072 sc1 lds
    s_add_u32 m0, s79, 8192
    s_add_u32 s85, s78, 8192
    buffer_load_dwordx4 v1, s[48:51], s85 offen offset:0 sc1 lds
    buffer_load_dwordx4 v1, s[48:51], s85 offen offset:1024 sc1 lds
    s_lshr_b32 s92, s72, 4
    s_lshl_b32 s92, s92, 7
    s_cmp_lg_u32 s64, 1
    s_cbranch_scc1 L_waok_124
    v_min_u32 v3, 31, v0
    v_lshlrev_b32 v3, 2, v3
    v_add_u32 v3, 0x603a00, v3
L_wa_123:
    buffer_load_dword v2, v3, s[48:51], s92 offen sc1
    s_waitcnt vmcnt(0)
    v_cmp_gt_u32 vcc, 1, v2
    s_cbranch_vccz L_waok_124
    s_sleep 12
    s_sub_u32 s67, s67, 1
    s_cbranch_scc1 K2_DONE
    s_branch L_wa_123
L_waok_124:
    s_barrier
    v_mov_b32 v2, v1
    s_mul_i32 s74, s72, 331776
    s_mul_i32 s85, s64, 81920
    s_add_u32 s74, s74, s85
    s_add_u32 s74, s74, 0x2000000
    s_add_u32 s85, s74, 0
    buffer_load_dwordx4 a[0:3], v1, s[48:51], s85 offen offset:0 sc1
    buffer_load_dwordx4 a[4:7], v1, s[48:51], s85 offen offset:1024 sc1
    buffer_load_dwordx4 a[8:11], v1, s[48:51], s85 offen offset:2048 sc1
    buffer_load_dwordx4 a[12:15], v1, s[48:51], s85 offen offset:3072 sc1
    s_add_u32 s85, s74, 4096
    buffer_load_dwordx4 a[16:19], v1, s[48:51], s85 offen offset:0 sc1
    buffer_load_dwordx4 a[20:23], v1, s[48:51], s85 offen offset:1024 sc1
    buffer_load_dwordx4 a[24:27], v1, s[48:51], s85 offen offset:2048 sc1
    buffer_load_dwordx4 a[28:31], v1, s[48:51], s85 offen offset:3072 sc1
    s_add_u32 s85, s74, 8192
    buffer_load_dwordx4 a[32:35], v1, s[48:51], s85 offen offset:0 sc1
    buffer_load_dwordx4 a[36:39], v1, s[48:51], s85 offen offset:1024 sc1
    buffer_load_dwordx4 a[40:43], v1, s[48:51], s85 offen offset:2048 sc1
    buffer_load_dwordx4 a[44:47], v1, s[48:51], s85 offen offset:3072 sc1
    s_add_u32 s85, s74, 12288
    buffer_load_dwordx4 a[48:51], v1, s[48:51], s85 offen offset:0 sc1
    buffer_load_dwordx4 a[52:55], v1, s[48:51], s85 offen offset:1024 sc1
    buffer_load_dwordx4 a[56:59], v1, s[48:51], s85 offen offset:2048 sc1
    buffer_load_dwordx4 a[60:63], v1, s[48:51], s85 offen offset:3072 sc1
    s_add_u32 s85, s74, 16384
    buffer_load_dwordx4 a[64:67], v1, s[48:51], s85 offen offset:0 sc1
    buffer_load_dwordx4 a[68:71], v1, s[48:51], s85 offen offset:1024 sc1
    buffer_load_dwordx4 a[72:75], v1, s[48:51], s85 offen offset:2048 sc1
    buffer_load_dwordx4 a[76:79], v1, s[48:51], s85 offen offset:3072 sc1
    s_add_u32 s85, s74, 20480
    buffer_load_dwordx4 a[80:83], v1, s[48:51], s85 offen offset:0 sc1
    buffer_load_dwordx4 a[84:87], v1, s[48:51], s85 offen offset:1024 sc1
    buffer_load_dwordx4 a[88:91], v1, s[48:51], s85 offen offset:2048 sc1
    buffer_load_dwordx4 a[92:95], v1, s[48:51], s85 offen offset:3072 sc1
    s_add_u32 s85, s74, 24576
    buffer_load_dwordx4 a[96:99], v1, s[48:51], s85 offen offset:0 sc1
    buffer_load_dwordx4 a[100:103], v1, s[48:51], s85 offen offset:1024 sc1
    buffer_load_dwordx4 a[104:107], v1, s[48:51], s85 offen offset:2048 sc1
    buffer_load_dwordx4 a[108:111], v1, s[48:51], s85 offen offset:3072 sc1
    s_add_u32 s85, s74, 28672
    buffer_load_dwordx4 a[112:115], v1, s[48:51], s85 offen offset:0 sc1
    buffer_load_dwordx4 a[116:119], v1, s[48:51], s85 offen offset:1024 sc1
    buffer_load_dwordx4 a[120:123], v1, s[48:51], s85 offen offset:2048 sc1
    buffer_load_dwordx4 a[124:127], v1, s[48:51], s85 offen offset:3072 sc1
    s_add_u32 s85, s74, 32768
    buffer_load_dwordx4 a[128:131], v1, s[48:51], s85 offen offset:0 sc1
    buffer_load_dwordx4 a[132:135], v1, s[48:51], s85 offen offset:1024 sc1
    buffer_load_dwordx4 a[136:139], v1, s[48:51], s85 offen offset:2048 sc1
    buffer_load_dwordx4 a[140:143], v1, s[48:51], s85 offen offset:3072 sc1
    s_add_u32 s85, s74, 36864
    buffer_load_dwordx4 a[144:147], v1, s[48:51], s85 offen offset:0 sc1
    buffer_load_dwordx4 a[148:151], v1, s[48:51], s85 offen offset:1024 sc1
    buffer_load_dwordx4 a[152:155], v1, s[48:51], s85 offen offset:2048 sc1
    buffer_load_dwordx4 a[156:159], v1, s[48:51], s85 offen offset:3072 sc1
    s_add_u32 s85, s74, 40960
    buffer_load_dwordx4 a[160:163], v1, s[48:51], s85 offen offset:0 sc1
    buffer_load_dwordx4 a[164:167], v1, s[48:51], s85 offen offset:1024 sc1
    buffer_load_dwordx4 a[168:171], v1, s[48:51], s85 offen offset:2048 sc1
    buffer_load_dwordx4 a[172:175], v1, s[48:51], s85 offen offset:3072 sc1
    s_add_u32 s85, s74, 45056
    buffer_load_dwordx4 a[176:179], v1, s[48:51], s85 offen offset:0 sc1
    buffer_load_dwordx4 a[180:183], v1, s[48:51], s85 offen offset:1024 sc1
    buffer_load_dwordx4 a[184:187], v1, s[48:51], s85 offen offset:2048 sc1
    buffer_load_dwordx4 a[188:191], v1, s[48:51], s85 offen offset:3072 sc1
    s_waitcnt vmcnt(24)
    s_add_u32 s85, s74, 49152
    buffer_load_dwordx4 a[192:195], v1, s[48:51], s85 offen offset:0 sc1
    buffer_load_dwordx4 a[196:199], v1, s[48:51], s85 offen offset:1024 sc1
    buffer_load_dwordx4 a[200:203], v1, s[48:51], s85 offen offset:2048 sc1
    buffer_load_dwordx4 a[204:207], v1, s[48:51], s85 offen offset:3072 sc1
    s_add_u32 s85, s74, 53248
    buffer_load_dwordx4 a[208:211], v1, s[48:51], s85 offen offset:0 sc1
    buffer_load_dwordx4 a[212:215], v1, s[48:51], s85 offen offset:1024 sc1
    buffer_load_dwordx4 a[216:219], v1, s[48:51], s85 offen offset:2048 sc1
    buffer_load_dwordx4 a[220:223], v1, s[48:51], s85 offen offset:3072 sc1
    s_add_u32 s85, s74, 57344
    buffer_load_dwordx4 a[224:227], v1, s[48:51], s85 offen offset:0 sc1
    buffer_load_dwordx4 a[228:231], v1, s[48:51], s85 offen offset:1024 sc1
    buffer_load_dwordx4 a[232:235], v1, s[48:51], s85 offen offset:2048 sc1
    buffer_load_dwordx4 a[236:239], v1, s[48:51], s85 offen offset:3072 sc1
    s_add_u32 s85, s74, 61440
    buffer_load_dwordx4 a[240:243], v1, s[48:51], s85 offen offset:0 sc1
    buffer_load_dwordx4 a[244:247], v1, s[48:51], s85 offen offset:1024 sc1
    buffer_load_dwordx4 a[248:251], v1, s[48:51], s85 offen offset:2048 sc1
    buffer_load_dwordx4 a[252:255], v1, s[48:51], s85 offen offset:3072 sc1
    s_add_u32 s85, s74, 65536
    buffer_load_dwordx4 v[192:195], v1, s[48:51], s85 offen offset:0 sc1
    buffer_load_dwordx4 v[196:199], v1, s[48:51], s85 offen offset:1024 sc1
    buffer_load_dwordx4 v[200:203], v1, s[48:51], s85 offen offset:2048 sc1
    buffer_load_dwordx4 v[204:207], v1, s[48:51], s85 offen offset:3072 sc1
    s_add_u32 s85, s74, 69632
    buffer_load_dwordx4 v[208:211], v1, s[48:51], s85 offen offset:0 sc1
    buffer_load_dwordx4 v[212:215], v1, s[48:51], s85 offen offset:1024 sc1
    buffer_load_dwordx4 v[216:219], v1, s[48:51], s85 offen offset:2048 sc1
    buffer_load_dwordx4 v[220:223], v1, s[48:51], s85 offen offset:3072 sc1
    s_add_u32 s85, s74, 73728
    buffer_load_dwordx4 v[224:227], v1, s[48:51], s85 offen offset:0 sc1
    buffer_load_dwordx4 v[228:231], v1, s[48:51], s85 offen offset:1024 sc1
    buffer_load_dwordx4 v[232:235], v1, s[48:51], s85 offen offset:2048 sc1
    buffer_load_dwordx4 v[236:239], v1, s[48:51], s85 offen offset:3072 sc1
    s_add_u32 s85, s74, 77824
    buffer_load_dwordx4 v[240:243], v1, s[48:51], s85 offen offset:0 sc1
    buffer_load_dwordx4 v[244:247], v1, s[48:51], s85 offen offset:1024 sc1
    buffer_load_dwordx4 v[248:251], v1, s[48:51], s85 offen offset:2048 sc1
    buffer_load_dwordx4 v[252:255], v1, s[48:51], s85 offen offset:3072 sc1
    s_lshl_b32 s80, s72, 7
    s_add_u32 s80, s80, 0x601000
    s_mul_i32 s74, s72, 0x101000
    s_lshl_b32 s85, s64, 12
    s_add_u32 s74, s74, s85
    s_add_u32 s74, s74, 0x8108000
    s_waitcnt vmcnt(0)
    s_barrier
    s_add_u32 s78, s78, 40960
    s_mul_i32 s79, s64, 10240
    s_add_u32 s79, s79, 40960
    ds_read_b128 v[40:43], v2 offset:0
    ds_read_b128 v[44:47], v2 offset:20480
    ds_read_b128 v[48:51], v2 offset:1024
    ds_read_b128 v[52:55], v2 offset:21504
    ds_read_b128 v[56:59], v2 offset:2048
    ds_read_b128 v[60:63], v2 offset:22528
    s_waitcnt lgkmcnt(4)
    v_mfma_f32_16x16x32_bf16 v[8:11], v[40:43], a[0:3], 0
    v_mfma_f32_16x16x32_bf16 v[12:15], v[40:43], a[80:83], 0
    v_mfma_f32_16x16x32_bf16 v[16:19], v[40:43], a[160:163], 0
    v_mfma_f32_16x16x32_bf16 v[20:23], v[40:43], a[240:243], 0
    v_mfma_f32_16x16x32_bf16 v[24:27], v[44:47], a[0:3], 0
    v_mfma_f32_16x16x32_bf16 v[28:31], v[44:47], a[80:83], 0
    v_mfma_f32_16x16x32_bf16 v[32:35], v[44:47], a[160:163], 0
    v_mfma_f32_16x16x32_bf16 v[36:39], v[44:47], a[240:243], 0
    ds_read_b128 v[40:43], v2 offset:3072
    ds_read_b128 v[44:47], v2 offset:23552
    s_waitcnt lgkmcnt(4)
    v_mfma_f32_16x16x32_bf16 v[8:11], v[48:51], a[4:7], v[8:11]
    v_mfma_f32_16x16x32_bf16 v[12:15], v[48:51], a[84:87], v[12:15]
    v_mfma_f32_16x16x32_bf16 v[16:19], v[48:51], a[164:167], v[16:19]
    v_mfma_f32_16x16x32_bf16 v[20:23], v[48:51], a[244:247], v[20:23]
    v_mfma_f32_16x16x32_bf16 v[24:27], v[52:55], a[4:7], v[24:27]
    v_mfma_f32_16x16x32_bf16 v[28:31], v[52:55], a[84:87], v[28:31]
    v_mfma_f32_16x16x32_bf16 v[32:35], v[52:55], a[164:167], v[32:35]
    v_mfma_f32_16x16x32_bf16 v[36:39], v[52:55], a[244:247], v[36:39]
    ds_read_b128 v[48:51], v2 offset:4096
    ds_read_b128 v[52:55], v2 offset:24576
    s_waitcnt lgkmcnt(4)
    v_mfma_f32_16x16x32_bf16 v[8:11], v[56:59], a[8:11], v[8:11]
    v_mfma_f32_16x16x32_bf16 v[12:15], v[56:59], a[88:91], v[12:15]
    v_mfma_f32_16x16x32_bf16 v[16:19], v[56:59], a[168:171], v[16:19]
    v_mfma_f32_16x16x32_bf16 v[20:23], v[56:59], a[248:251], v[20:23]
    v_mfma_f32_16x16x32_bf16 v[24:27], v[60:63], a[8:11], v[24:27]
    v_mfma_f32_16x16x32_bf16 v[28:31], v[60:63], a[88:91], v[28:31]
    v_mfma_f32_16x16x32_bf16 v[32:35], v[60:63], a[168:171], v[32:35]
    v_mfma_f32_16x16x32_bf16 v[36:39], v[60:63], a[248:251], v[36:39]
    ds_read_b128 v[56:59], v2 offset:5120
    ds_read_b128 v[60:63], v2 offset:25600
    s_waitcnt lgkmcnt(4)
    v_mfma_f32_16x16x32_bf16 v[8:11], v[40:43], a[12:15], v[8:11]
    v_mfma_f32_16x16x32_bf16 v[12:15], v[40:43], a[92:95], v[12:15]
    v_mfma_f32_16x16x32_bf16 v[16:19], v[40:43], a[172:175], v[16:19]
    v_mfma_f32_16x16x32_bf16 v[20:23], v[40:43], a[252:255], v[20:23]
    v_mfma_f32_16x16x32_bf16 v[24:27], v[44:47], a[12:15], v[24:27]
    v_mfma_f32_16x16x32_bf16 v[28:31], v[44:47], a[92:95], v[28:31]
    v_mfma_f32_16x16x32_bf16 v[32:35], v[44:47], a[172:175], v[32:35]
    v_mfma_f32_16x16x32_bf16 v[36:39], v[44:47], a[252:255], v[36:39]
    ds_read_b128 v[40:43], v2 offset:6144
    ds_read_b128 v[44:47], v2 offset:26624
    s_waitcnt lgkmcnt(4)
    v_mfma_f32_16x16x32_bf16 v[8:11], v[48:51], a[16:19], v[8:11]
    v_mfma_f32_16x16x32_bf16 v[12:15], v[48:51], a[96:99], v[12:15]
    v_mfma_f32_16x16x32_bf16 v[16:19], v[48:51], a[176:179], v[16:19]
    v_mfma_f32_16x16x32_bf16 v[20:23], v[48:51], v[192:195], v[20:23]
    v_mfma_f32_16x16x32_bf16 v[24:27], v[52:55], a[16:19], v[24:27]
    v_mfma_f32_16x16x32_bf16 v[28:31], v[52:55], a[96:99], v[28:31]
    v_mfma_f32_16x16x32_bf16 v[32:35], v[52:55], a[176:179], v[32:35]
    v_mfma_f32_16x16x32_bf16 v[36:39], v[52:55], v[192:195], v[36:39]
    ds_read_b128 v[48:51], v2 offset:7168
    ds_read_b128 v[52:55], v2 offset:27648
    s_waitcnt lgkmcnt(4)
    v_mfma_f32_16x16x32_bf16 v[8:11], v[56:59], a[20:23], v[8:11]
    v_mfma_f32_16x16x32_bf16 v[12:15], v[56:59], a[100:103], v[12:15]
    v_mfma_f32_16x16x32_bf16 v[16:19], v[56:59], a[180:183], v[16:19]
    v_mfma_f32_16x16x32_bf16 v[20:23], v[56:59], v[196:199], v[20:23]
    v_mfma_f32_16x16x32_bf16 v[24:27], v[60:63], a[20:23], v[24:27]
    v_mfma_f32_16x16x32_bf16 v[28:31], v[60:63], a[100:103], v[28:31]
    v_mfma_f32_16x16x32_bf16 v[32:35], v[60:63], a[180:183], v[32:35]
    v_mfma_f32_16x16x32_bf16 v[36:39], v[60:63], v[196:199], v[36:39]
    ds_read_b128 v[56:59], v2 offset:8192
    ds_read_b128 v[60:63], v2 offset:28672
    s_waitcnt lgkmcnt(4)
    v_mfma_f32_16x16x32_bf16 v[8:11], v[40:43], a[24:27], v[8:11]
    v_mfma_f32_16x16x32_bf16 v[12:15], v[40:43], a[104:107], v[12:15]
    s_add_u32 m0, s79, 0
    s_add_u32 s85, s78, 0
    buffer_load_dwordx4 v1, s[48:51], s85 offen offset:0 sc1 lds
    v_mfma_f32_16x16x32_bf16 v[16:19], v[40:43], a[184:187], v[16:19]
    v_mfma_f32_16x16x32_bf16 v[20:23], v[40:43], v[200:203], v[20:23]
    v_mfma_f32_16x16x32_bf16 v[24:27], v[44:47], a[24:27], v[24:27]
    v_mfma_f32_16x16x32_bf16 v[28:31], v[44:47], a[104:107], v[28:31]
    v_mfma_f32_16x16x32_bf16 v[32:35], v[44:47], a[184:187], v[32:35]
    v_mfma_f32_16x16x32_bf16 v[36:39], v[44:47], v[200:203], v[36:39]
    ds_read_b128 v[40:43], v2 offset:9216
    ds_read_b128 v[44:47], v2 offset:29696
    s_waitcnt lgkmcnt(4)
    v_mfma_f32_16x16x32_bf16 v[8:11], v[48:51], a[28:31], v[8:11]
    v_mfma_f32_16x16x32_bf16 v[12:15], v[48:51], a[108:111], v[12:15]
    buffer_load_dwordx4 v1, s[48:51], s85 offen offset:1024 sc1 lds
    v_mfma_f32_16x16x32_bf16 v[16:19], v[48:51], a[188:191], v[16:19]
    v_mfma_f32_16x16x32_bf16 v[20:23], v[48:51], v[204:207], v[20:23]
    v_mfma_f32_16x16x32_bf16 v[24:27], v[52:55], a[28:31], v[24:27]
    v_mfma_f32_16x16x32_bf16 v[28:31], v[52:55], a[108:111], v[28:31]
    v_mfma_f32_16x16x32_bf16 v[32:35], v[52:55], a[188:191], v[32:35]
    v_mfma_f32_16x16x32_bf16 v[36:39], v[52:55], v[204:207], v[36:39]
    ds_read_b128 v[48:51], v2 offset:10240
    ds_read_b128 v[52:55], v2 offset:30720
    s_waitcnt lgkmcnt(4)
    v_mfma_f32_16x16x32_bf16 v[8:11], v[56:59], a[32:35], v[8:11]
    v_mfma_f32_16x16x32_bf16 v[12:15], v[56:59], a[112:115], v[12:15]
    buffer_load_dwordx4 v1, s[48:51], s85 offen offset:2048 sc1 lds
    v_mfma_f32_16x16x32_bf16 v[16:19], v[56:59], a[192:195], v[16:19]
    v_mfma_f32_16x16x32_bf16 v[20:23], v[56:59], v[208:211], v[20:23]
    v_mfma_f32_16x16x32_bf16 v[24:27], v[60:63], a[32:35], v[24:27]
    v_mfma_f32_16x16x32_bf16 v[28:31], v[60:63], a[112:115], v[28:31]
    v_mfma_f32_16x16x32_bf16 v[32:35], v[60:63], a[192:195], v[32:35]
    v_mfma_f32_16x16x32_bf16 v[36:39], v[60:63], v[208:211], v[36:39]
    ds_read_b128 v[56:59], v2 offset:11264
    ds_read_b128 v[60:63], v2 offset:31744
    s_waitcnt lgkmcnt(4)
    v_mfma_f32_16x16x32_bf16 v[8:11], v[40:43], a[36:39], v[8:11]
    v_mfma_f32_16x16x32_bf16 v[12:15], v[40:43], a[116:119], v[12:15]
    buffer_load_dwordx4 v1, s[48:51], s85 offen offset:3072 sc1 lds
    v_mfma_f32_16x16x32_bf16 v[16:19], v[40:43], a[196:199], v[16:19]
    v_mfma_f32_16x16x32_bf16 v[20:23], v[40:43], v[212:215], v[20:23]
    v_mfma_f32_16x16x32_bf16 v[24:27], v[44:47], a[36:39], v[24:27]
    v_mfma_f32_16x16x32_bf16 v[28:31], v[44:47], a[116:119], v[28:31]
    v_mfma_f32_16x16x32_bf16 v[32:35], v[44:47], a[196:199], v[32:35]
    v_mfma_f32_16x16x32_bf16 v[36:39], v[44:47], v[212:215], v[36:39]
    ds_read_b128 v[40:43], v2 offset:12288
    ds_read_b128 v[44:47], v2 offset:32768
    s_waitcnt lgkmcnt(4)
    v_mfma_f32_16x16x32_bf16 v[8:11], v[48:51], a[40:43], v[8:11]
    v_mfma_f32_16x16x32_bf16 v[12:15], v[48:51], a[120:123], v[12:15]
    s_add_u32 m0, s79, 4096
    s_add_u32 s85, s78, 4096
    buffer_load_dwordx4 v1, s[48:51], s85 offen offset:0 sc1 lds
    v_mfma_f32_16x16x32_bf16 v[16:19], v[48:51], a[200:203], v[16:19]
    v_mfma_f32_16x16x32_bf16 v[20:23], v[48:51], v[216:219], v[20:23]
    v_mfma_f32_16x16x32_bf16 v[24:27], v[52:55], a[40:43], v[24:27]
    v_mfma_f32_16x16x32_bf16 v[28:31], v[52:55], a[120:123], v[28:31]
    v_mfma_f32_16x16x32_bf16 v[32:35], v[52:55], a[200:203], v[32:35]
    v_mfma_f32_16x16x32_bf16 v[36:39], v[52:55], v[216:219], v[36:39]
    ds_read_b128 v[48:51], v2 offset:13312
    ds_read_b128 v[52:55], v2 offset:33792
    s_waitcnt lgkmcnt(4)
    v_mfma_f32_16x16x32_bf16 v[8:11], v[56:59], a[44:47], v[8:11]
    v_mfma_f32_16x16x32_bf16 v[12:15], v[56:59], a[124:127], v[12:15]
    buffer_load_dwordx4 v1, s[48:51], s85 offen offset:1024 sc1 lds
    v_mfma_f32_16x16x32_bf16 v[16:19], v[56:59], a[204:207], v[16:19]
    v_mfma_f32_16x16x32_bf16 v[20:23], v[56:59], v[220:223], v[20:23]
    v_mfma_f32_16x16x32_bf16 v[24:27], v[60:63], a[44:47], v[24:27]
    v_mfma_f32_16x16x32_bf16 v[28:31], v[60:63], a[124:127], v[28:31]
    v_mfma_f32_16x16x32_bf16 v[32:35], v[60:63], a[204:207], v[32:35]
    v_mfma_f32_16x16x32_bf16 v[36:39], v[60:63], v[220:223], v[36:39]
    ds_read_b128 v[56:59], v2 offset:14336
    ds_read_b128 v[60:63], v2 offset:34816
    s_waitcnt lgkmcnt(4)
    v_mfma_f32_16x16x32_bf16 v[8:11], v[40:43], a[48:51], v[8:11]
    v_mfma_f32_16x16x32_bf16 v[12:15], v[40:43], a[128:131], v[12:15]
    buffer_load_dwordx4 v1, s[48:51], s85 offen offset:2048 sc1 lds
    v_mfma_f32_16x16x32_bf16 v[16:19], v[40:43], a[208:211], v[16:19]
    v_mfma_f32_16x16x32_bf16 v[20:23], v[40:43], v[224:227], v[20:23]
    v_mfma_f32_16x16x32_bf16 v[24:27], v[44:47], a[48:51], v[24:27]
    v_mfma_f32_16x16x32_bf16 v[28:31], v[44:47], a[128:131], v[28:31]
    v_mfma_f32_16x16x32_bf16 v[32:35], v[44:47], a[208:211], v[32:35]
    v_mfma_f32_16x16x32_bf16 v[36:39], v[44:47], v[224:227], v[36:39]
    ds_read_b128 v[40:43], v2 offset:15360
    ds_read_b128 v[44:47], v2 offset:35840
    s_waitcnt lgkmcnt(4)
    v_mfma_f32_16x16x32_bf16 v[8:11], v[48:51], a[52:55], v[8:11]
    v_mfma_f32_16x16x32_bf16 v[12:15], v[48:51], a[132:135], v[12:15]
    buffer_load_dwordx4 v1, s[48:51], s85 offen offset:3072 sc1 lds
    v_mfma_f32_16x16x32_bf16 v[16:19], v[48:51], a[212:215], v[16:19]
    v_mfma_f32_16x16x32_bf16 v[20:23], v[48:51], v[228:231], v[20:23]
    v_mfma_f32_16x16x32_bf16 v[24:27], v[52:55], a[52:55], v[24:27]
    v_mfma_f32_16x16x32_bf16 v[28:31], v[52:55], a[132:135], v[28:31]
    v_mfma_f32_16x16x32_bf16 v[32:35], v[52:55], a[212:215], v[32:35]
    v_mfma_f32_16x16x32_bf16 v[36:39], v[52:55], v[228:231], v[36:39]
    ds_read_b128 v[48:51], v2 offset:16384
    ds_read_b128 v[52:55], v2 offset:36864
    s_waitcnt lgkmcnt(4)
    v_mfma_f32_16x16x32_bf16 v[8:11], v[56:59], a[56:59], v[8:11]
    v_mfma_f32_16x16x32_bf16 v[12:15], v[56:59], a[136:139], v[12:15]
    s_add_u32 m0, s79, 8192
    s_add_u32 s85, s78, 8192
    buffer_load_dwordx4 v1, s[48:51], s85 offen offset:0 sc1 lds
    v_mfma_f32_16x16x32_bf16 v[16:19], v[56:59], a[216:219], v[16:19]
    v_mfma_f32_16x16x32_bf16 v[20:23], v[56:59], v[232:235], v[20:23]
    v_mfma_f32_16x16x32_bf16 v[24:27], v[60:63], a[56:59], v[24:27]
    v_mfma_f32_16x16x32_bf16 v[28:31], v[60:63], a[136:139], v[28:31]
    v_mfma_f32_16x16x32_bf16 v[32:35], v[60:63], a[216:219], v[32:35]
    v_mfma_f32_16x16x32_bf16 v[36:39], v[60:63], v[232:235], v[36:39]
    ds_read_b128 v[56:59], v2 offset:17408
    ds_read_b128 v[60:63], v2 offset:37888
    s_waitcnt lgkmcnt(4)
    v_mfma_f32_16x16x32_bf16 v[8:11], v[40:43], a[60:63], v[8:11]
    v_mfma_f32_16x16x32_bf16 v[12:15], v[40:43], a[140:143], v[12:15]
    buffer_load_dwordx4 v1, s[48:51], s85 offen offset:1024 sc1 lds
    v_mfma_f32_16x16x32_bf16 v[16:19], v[40:43], a[220:223], v[16:19]
    v_mfma_f32_16x16x32_bf16 v[20:23], v[40:43], v[236:239], v[20:23]
    v_mfma_f32_16x16x32_bf16 v[24:27], v[44:47], a[60:63], v[24:27]
    v_mfma_f32_16x16x32_bf16 v[28:31], v[44:47], a[140:143], v[28:31]
    v_mfma_f32_16x16x32_bf16 v[32:35], v[44:47], a[220:223], v[32:35]
    v_mfma_f32_16x16x32_bf16 v[36:39], v[44:47], v[236:239], v[36:39]
    ds_read_b128 v[40:43], v2 offset:18432
    ds_read_b128 v[44:47], v2 offset:38912
    s_waitcnt lgkmcnt(4)
    v_mfma_f32_16x16x32_bf16 v[8:11], v[48:51], a[64:67], v[8:11]
    v_mfma_f32_16x16x32_bf16 v[12:15], v[48:51], a[144:147], v[12:15]
    v_mfma_f32_16x16x32_bf16 v[16:19], v[48:51], a[224:227], v[16:19]
    v_mfma_f32_16x16x32_bf16 v[20:23], v[48:51], v[240:243], v[20:23]
    v_mfma_f32_16x16x32_bf16 v[24:27], v[52:55], a[64:67], v[24:27]
    v_mfma_f32_16x16x32_bf16 v[28:31], v[52:55], a[144:147], v[28:31]
    v_mfma_f32_16x16x32_bf16 v[32:35], v[52:55], a[224:227], v[32:35]
    v_mfma_f32_16x16x32_bf16 v[36:39], v[52:55], v[240:243], v[36:39]
    ds_read_b128 v[48:51], v2 offset:19456
    ds_read_b128 v[52:55], v2 offset:39936
    s_waitcnt lgkmcnt(4)
    v_mfma_f32_16x16x32_bf16 v[8:11], v[56:59], a[68:71], v[8:11]
    v_mfma_f32_16x16x32_bf16 v[12:15], v[56:59], a[148:151], v[12:15]
    v_mfma_f32_16x16x32_bf16 v[16:19], v[56:59], a[228:231], v[16:19]
    v_mfma_f32_16x16x32_bf16 v[20:23], v[56:59], v[244:247], v[20:23]
    v_mfma_f32_16x16x32_bf16 v[24:27], v[60:63], a[68:71], v[24:27]
    v_mfma_f32_16x16x32_bf16 v[28:31], v[60:63], a[148:151], v[28:31]
    v_mfma_f32_16x16x32_bf16 v[32:35], v[60:63], a[228:231], v[32:35]
    v_mfma_f32_16x16x32_bf16 v[36:39], v[60:63], v[244:247], v[36:39]
    s_waitcnt lgkmcnt(2)
    v_mfma_f32_16x16x32_bf16 v[8:11], v[40:43], a[72:75], v[8:11]
    v_mfma_f32_16x16x32_bf16 v[12:15], v[40:43], a[152:155], v[12:15]
    v_mfma_f32_16x16x32_bf16 v[16:19], v[40:43], a[232:235], v[16:19]
    v_mfma_f32_16x16x32_bf16 v[20:23], v[40:43], v[248:251], v[20:23]
    v_mfma_f32_16x16x32_bf16 v[24:27], v[44:47], a[72:75], v[24:27]
    v_mfma_f32_16x16x32_bf16 v[28:31], v[44:47], a[152:155], v[28:31]
    v_mfma_f32_16x16x32_bf16 v[32:35], v[44:47], a[232:235], v[32:35]
    v_mfma_f32_16x16x32_bf16 v[36:39], v[44:47], v[248:251], v[36:39]
    s_waitcnt lgkmcnt(0)
    v_mfma_f32_16x16x32_bf16 v[8:11], v[48:51], a[76:79], v[8:11]
    v_mfma_f32_16x16x32_bf16 v[12:15], v[48:51], a[156:159], v[12:15]
    v_mfma_f32_16x16x32_bf16 v[16:19], v[48:51], a[236:239], v[16:19]
    v_mfma_f32_16x16x32_bf16 v[20:23], v[48:51], v[252:255], v[20:23]
    v_mfma_f32_16x16x32_bf16 v[24:27], v[52:55], a[76:79], v[24:27]
    v_mfma_f32_16x16x32_bf16 v[28:31], v[52:55], a[156:159], v[28:31]
    v_mfma_f32_16x16x32_bf16 v[32:35], v[52:55], a[236:239], v[32:35]
    v_mfma_f32_16x16x32_bf16 v[36:39], v[52:55], v[252:255], v[36:39]
    v_xor_b32 v2, 0xa000, v2
    s_nop 7
    v_cvt_pk_bf16_f32 v64, v8, v9
    v_cvt_pk_bf16_f32 v65, v10, v11
    v_cvt_pk_bf16_f32 v66, v24, v25
    v_cvt_pk_bf16_f32 v67, v26, v27
    buffer_store_dwordx4 v[64:67], v1, s[48:51], s74 offen offset:0 sc1
    v_cvt_pk_bf16_f32 v68, v12, v13
    v_cvt_pk_bf16_f32 v69, v14, v15
    v_cvt_pk_bf16_f32 v70, v28, v29
    v_cvt_pk_bf16_f32 v71, v30, v31
    buffer_store_dwordx4 v[68:71], v1, s[48:51], s74 offen offset:1024 sc1
    v_cvt_pk_bf16_f32 v72, v16, v17
    v_cvt_pk_bf16_f32 v73, v18, v19
    v_cvt_pk_bf16_f32 v74, v32, v33
    v_cvt_pk_bf16_f32 v75, v34, v35
    buffer_store_dwordx4 v[72:75], v1, s[48:51], s74 offen offset:2048 sc1
    v_cvt_pk_bf16_f32 v76, v20, v21
    v_cvt_pk_bf16_f32 v77, v22, v23
    v_cvt_pk_bf16_f32 v78, v36, v37
    v_cvt_pk_bf16_f32 v79, v38, v39
    buffer_store_dwordx4 v[76:79], v1, s[48:51], s74 offen offset:3072 sc1
    s_add_u32 s74, s74, 16384
    s_add_u32 s66, s66, 1
    s_waitcnt vmcnt(0)
    s_barrier
    s_cmp_lg_u32 s64, 1
    s_cbranch_scc1 L_fs_127
    v_mov_b32 v84, s66
    v_mov_b32 v85, 0
    s_mov_b64 exec, 1
    buffer_store_dword v84, v85, s[48:51], s80 offen sc1
    s_mov_b64 exec, -1
L_fs_127:
    s_add_u32 s78, s78, 40960
    s_mul_i32 s79, s64, 10240
    s_add_u32 s79, s79, 0
    ds_read_b128 v[40:43], v2 offset:0
    ds_read_b128 v[44:47], v2 offset:20480
    ds_read_b128 v[48:51], v2 offset:1024
    ds_read_b128 v[52:55], v2 offset:21504
    ds_read_b128 v[56:59], v2 offset:2048
    ds_read_b128 v[60:63], v2 offset:22528
    s_waitcnt lgkmcnt(4)
    v_mfma_f32_16x16x32_bf16 v[96:99], v[40:43], a[0:3], 0
    v_mfma_f32_16x16x32_bf16 v[100:103], v[40:43], a[80:83], 0
    v_mfma_f32_16x16x32_bf16 v[104:107], v[40:43], a[160:163], 0
    v_mfma_f32_16x16x32_bf16 v[108:111], v[40:43], a[240:243], 0
    v_mfma_f32_16x16x32_bf16 v[112:115], v[44:47], a[0:3], 0
    v_mfma_f32_16x16x32_bf16 v[116:119], v[44:47], a[80:83], 0
    v_mfma_f32_16x16x32_bf16 v[120:123], v[44:47], a[160:163], 0
    v_mfma_f32_16x16x32_bf16 v[124:127], v[44:47], a[240:243], 0
    ds_read_b128 v[40:43], v2 offset:3072
    ds_read_b128 v[44:47], v2 offset:23552
    s_waitcnt lgkmcnt(4)
    v_mfma_f32_16x16x32_bf16 v[96:99], v[48:51], a[4:7], v[96:99]
    v_mfma_f32_16x16x32_bf16 v[100:103], v[48:51], a[84:87], v[100:103]
    v_mfma_f32_16x16x32_bf16 v[104:107], v[48:51], a[164:167], v[104:107]
    v_mfma_f32_16x16x32_bf16 v[108:111], v[48:51], a[244:247], v[108:111]
    v_mfma_f32_16x16x32_bf16 v[112:115], v[52:55], a[4:7], v[112:115]
    v_mfma_f32_16x16x32_bf16 v[116:119], v[52:55], a[84:87], v[116:119]
    v_mfma_f32_16x16x32_bf16 v[120:123], v[52:55], a[164:167], v[120:123]
    v_mfma_f32_16x16x32_bf16 v[124:127], v[52:55], a[244:247], v[124:127]
    ds_read_b128 v[48:51], v2 offset:4096
    ds_read_b128 v[52:55], v2 offset:24576
    s_waitcnt lgkmcnt(4)
    v_mfma_f32_16x16x32_bf16 v[96:99], v[56:59], a[8:11], v[96:99]
    v_mfma_f32_16x16x32_bf16 v[100:103], v[56:59], a[88:91], v[100:103]
    v_mfma_f32_16x16x32_bf16 v[104:107], v[56:59], a[168:171], v[104:107]
    v_mfma_f32_16x16x32_bf16 v[108:111], v[56:59], a[248:251], v[108:111]
    v_mfma_f32_16x16x32_bf16 v[112:115], v[60:63], a[8:11], v[112:115]
    v_mfma_f32_16x16x32_bf16 v[116:119], v[60:63], a[88:91], v[116:119]
    v_mfma_f32_16x16x32_bf16 v[120:123], v[60:63], a[168:171], v[120:123]
    v_mfma_f32_16x16x32_bf16 v[124:127], v[60:63], a[248:251], v[124:127]
    ds_read_b128 v[56:59], v2 offset:5120
    ds_read_b128 v[60:63], v2 offset:25600
    s_waitcnt lgkmcnt(4)
    v_mfma_f32_16x16x32_bf16 v[96:99], v[40:43], a[12:15], v[96:99]
    v_mfma_f32_16x16x32_bf16 v[100:103], v[40:43], a[92:95], v[100:103]
    v_mfma_f32_16x16x32_bf16 v[104:107], v[40:43], a[172:175], v[104:107]
    v_mfma_f32_16x16x32_bf16 v[108:111], v[40:43], a[252:255], v[108:111]
    v_mfma_f32_16x16x32_bf16 v[112:115], v[44:47], a[12:15], v[112:115]
    v_mfma_f32_16x16x32_bf16 v[116:119], v[44:47], a[92:95], v[116:119]
    v_mfma_f32_16x16x32_bf16 v[120:123], v[44:47], a[172:175], v[120:123]
    v_mfma_f32_16x16x32_bf16 v[124:127], v[44:47], a[252:255], v[124:127]
    ds_read_b128 v[40:43], v2 offset:6144
    ds_read_b128 v[44:47], v2 offset:26624
    s_waitcnt lgkmcnt(4)
    v_mfma_f32_16x16x32_bf16 v[96:99], v[48:51], a[16:19], v[96:99]
    v_mfma_f32_16x16x32_bf16 v[100:103], v[48:51], a[96:99], v[100:103]
    v_mfma_f32_16x16x32_bf16 v[104:107], v[48:51], a[176:179], v[104:107]
    v_mfma_f32_16x16x32_bf16 v[108:111], v[48:51], v[192:195], v[108:111]
    v_mfma_f32_16x16x32_bf16 v[112:115], v[52:55], a[16:19], v[112:115]
    v_mfma_f32_16x16x32_bf16 v[116:119], v[52:55], a[96:99], v[116:119]
    v_mfma_f32_16x16x32_bf16 v[120:123], v[52:55], a[176:179], v[120:123]
    v_mfma_f32_16x16x32_bf16 v[124:127], v[52:55], v[192:195], v[124:127]
    ds_read_b128 v[48:51], v2 offset:7168
    ds_read_b128 v[52:55], v2 offset:27648
    s_waitcnt lgkmcnt(4)
    v_mfma_f32_16x16x32_bf16 v[96:99], v[56:59], a[20:23], v[96:99]
    v_mfma_f32_16x16x32_bf16 v[100:103], v[56:59], a[100:103], v[100:103]
    v_mfma_f32_16x16x32_bf16 v[104:107], v[56:59], a[180:183], v[104:107]
    v_mfma_f32_16x16x32_bf16 v[108:111], v[56:59], v[196:199], v[108:111]
    v_mfma_f32_16x16x32_bf16 v[112:115], v[60:63], a[20:23], v[112:115]
    v_mfma_f32_16x16x32_bf16 v[116:119], v[60:63], a[100:103], v[116:119]
    v_mfma_f32_16x16x32_bf16 v[120:123], v[60:63], a[180:183], v[120:123]
    v_mfma_f32_16x16x32_bf16 v[124:127], v[60:63], v[196:199], v[124:127]
    ds_read_b128 v[56:59], v2 offset:8192
    ds_read_b128 v[60:63], v2 offset:28672
    s_waitcnt lgkmcnt(4)
    v_mfma_f32_16x16x32_bf16 v[96:99], v[40:43], a[24:27], v[96:99]
    v_mfma_f32_16x16x32_bf16 v[100:103], v[40:43], a[104:107], v[100:103]
    s_add_u32 m0, s79, 0
    s_add_u32 s85, s78, 0
    buffer_load_dwordx4 v1, s[48:51], s85 offen offset:0 sc1 lds
    v_mfma_f32_16x16x32_bf16 v[104:107], v[40:43], a[184:187], v[104:107]
    v_mfma_f32_16x16x32_bf16 v[108:111], v[40:43], v[200:203], v[108:111]
    v_mfma_f32_16x16x32_bf16 v[112:115], v[44:47], a[24:27], v[112:115]
    v_mfma_f32_16x16x32_bf16 v[116:119], v[44:47], a[104:107], v[116:119]
    v_mfma_f32_16x16x32_bf16 v[120:123], v[44:47], a[184:187], v[120:123]
    v_mfma_f32_16x16x32_bf16 v[124:127], v[44:47], v[200:203], v[124:127]
    ds_read_b128 v[40:43], v2 offset:9216
    ds_read_b128 v[44:47], v2 offset:29696
    s_waitcnt lgkmcnt(4)
    v_mfma_f32_16x16x32_bf16 v[96:99], v[48:51], a[28:31], v[96:99]
    v_mfma_f32_16x16x32_bf16 v[100:103], v[48:51], a[108:111], v[100:103]
    buffer_load_dwordx4 v1, s[48:51], s85 offen offset:1024 sc1 lds
    v_mfma_f32_16x16x32_bf16 v[104:107], v[48:51], a[188:191], v[104:107]
    v_mfma_f32_16x16x32_bf16 v[108:111], v[48:51], v[204:207], v[108:111]
    v_mfma_f32_16x16x32_bf16 v[112:115], v[52:55], a[28:31], v[112:115]
    v_mfma_f32_16x16x32_bf16 v[116:119], v[52:55], a[108:111], v[116:119]
    v_mfma_f32_16x16x32_bf16 v[120:123], v[52:55], a[188:191], v[120:123]
    v_mfma_f32_16x16x32_bf16 v[124:127], v[52:55], v[204:207], v[124:127]
    ds_read_b128 v[48:51], v2 offset:10240
    ds_read_b128 v[52:55], v2 offset:30720
    s_waitcnt lgkmcnt(4)
    v_mfma_f32_16x16x32_bf16 v[96:99], v[56:59], a[32:35], v[96:99]
    v_mfma_f32_16x16x32_bf16 v[100:103], v[56:59], a[112:115], v[100:103]
    buffer_load_dwordx4 v1, s[48:51], s85 offen offset:2048 sc1 lds
    v_mfma_f32_16x16x32_bf16 v[104:107], v[56:59], a[192:195], v[104:107]
    v_mfma_f32_16x16x32_bf16 v[108:111], v[56:59], v[208:211], v[108:111]
    v_mfma_f32_16x16x32_bf16 v[112:115], v[60:63], a[32:35], v[112:115]
    v_mfma_f32_16x16x32_bf16 v[116:119], v[60:63], a[112:115], v[116:119]
    v_mfma_f32_16x16x32_bf16 v[120:123], v[60:63], a[192:195], v[120:123]
    v_mfma_f32_16x16x32_bf16 v[124:127], v[60:63], v[208:211], v[124:127]
    ds_read_b128 v[56:59], v2 offset:11264
    ds_read_b128 v[60:63], v2 offset:31744
    s_waitcnt lgkmcnt(4)
    v_mfma_f32_16x16x32_bf16 v[96:99], v[40:43], a[36:39], v[96:99]
    v_mfma_f32_16x16x32_bf16 v[100:103], v[40:43], a[116:119], v[100:103]
    buffer_load_dwordx4 v1, s[48:51], s85 offen offset:3072 sc1 lds
    v_mfma_f32_16x16x32_bf16 v[104:107], v[40:43], a[196:199], v[104:107]
    v_mfma_f32_16x16x32_bf16 v[108:111], v[40:43], v[212:215], v[108:111]
    v_mfma_f32_16x16x32_bf16 v[112:115], v[44:47], a[36:39], v[112:115]
    v_mfma_f32_16x16x32_bf16 v[116:119], v[44:47], a[116:119], v[116:119]
    v_mfma_f32_16x16x32_bf16 v[120:123], v[44:47], a[196:199], v[120:123]
    v_mfma_f32_16x16x32_bf16 v[124:127], v[44:47], v[212:215], v[124:127]
    ds_read_b128 v[40:43], v2 offset:12288
    ds_read_b128 v[44:47], v2 offset:32768
    s_waitcnt lgkmcnt(4)
    v_mfma_f32_16x16x32_bf16 v[96:99], v[48:51], a[40:43], v[96:99]
    v_mfma_f32_16x16x32_bf16 v[100:103], v[48:51], a[120:123], v[100:103]
    s_add_u32 m0, s79, 4096
    s_add_u32 s85, s78, 4096
    buffer_load_dwordx4 v1, s[48:51], s85 offen offset:0 sc1 lds
    v_mfma_f32_16x16x32_bf16 v[104:107], v[48:51], a[200:203], v[104:107]
    v_mfma_f32_16x16x32_bf16 v[108:111], v[48:51], v[216:219], v[108:111]
    v_mfma_f32_16x16x32_bf16 v[112:115], v[52:55], a[40:43], v[112:115]
    v_mfma_f32_16x16x32_bf16 v[116:119], v[52:55], a[120:123], v[116:119]
    v_mfma_f32_16x16x32_bf16 v[120:123], v[52:55], a[200:203], v[120:123]
    v_mfma_f32_16x16x32_bf16 v[124:127], v[52:55], v[216:219], v[124:127]
    ds_read_b128 v[48:51], v2 offset:13312
    ds_read_b128 v[52:55], v2 offset:33792
    s_waitcnt lgkmcnt(4)
    v_mfma_f32_16x16x32_bf16 v[96:99], v[56:59], a[44:47], v[96:99]
    v_mfma_f32_16x16x32_bf16 v[100:103], v[56:59], a[124:127], v[100:103]
    buffer_load_dwordx4 v1, s[48:51], s85 offen offset:1024 sc1 lds
    v_mfma_f32_16x16x32_bf16 v[104:107], v[56:59], a[204:207], v[104:107]
    v_mfma_f32_16x16x32_bf16 v[108:111], v[56:59], v[220:223], v[108:111]
    v_mfma_f32_16x16x32_bf16 v[112:115], v[60:63], a[44:47], v[112:115]
    v_mfma_f32_16x16x32_bf16 v[116:119], v[60:63], a[124:127], v[116:119]
    v_mfma_f32_16x16x32_bf16 v[120:123], v[60:63], a[204:207], v[120:123]
    v_mfma_f32_16x16x32_bf16 v[124:127], v[60:63], v[220:223], v[124:127]
    ds_read_b128 v[56:59], v2 offset:14336
    ds_read_b128 v[60:63], v2 offset:34816
    s_waitcnt lgkmcnt(4)
    v_mfma_f32_16x16x32_bf16 v[96:99], v[40:43], a[48:51], v[96:99]
    v_mfma_f32_16x16x32_bf16 v[100:103], v[40:43], a[128:131], v[100:103]
    buffer_load_dwordx4 v1, s[48:51], s85 offen offset:2048 sc1 lds
    v_mfma_f32_16x16x32_bf16 v[104:107], v[40:43], a[208:211], v[104:107]
    v_mfma_f32_16x16x32_bf16 v[108:111], v[40:43], v[224:227], v[108:111]
    v_mfma_f32_16x16x32_bf16 v[112:115], v[44:47], a[48:51], v[112:115]
    v_mfma_f32_16x16x32_bf16 v[116:119], v[44:47], a[128:131], v[116:119]
    v_mfma_f32_16x16x32_bf16 v[120:123], v[44:47], a[208:211], v[120:123]
    v_mfma_f32_16x16x32_bf16 v[124:127], v[44:47], v[224:227], v[124:127]
    ds_read_b128 v[40:43], v2 offset:15360
    ds_read_b128 v[44:47], v2 offset:35840
    s_waitcnt lgkmcnt(4)
    v_mfma_f32_16x16x32_bf16 v[96:99], v[48:51], a[52:55], v[96:99]
    v_mfma_f32_16x16x32_bf16 v[100:103], v[48:51], a[132:135], v[100:103]
    buffer_load_dwordx4 v1, s[48:51], s85 offen offset:3072 sc1 lds
    v_mfma_f32_16x16x32_bf16 v[104:107], v[48:51], a[212:215], v[104:107]
    v_mfma_f32_16x16x32_bf16 v[108:111], v[48:51], v[228:231], v[108:111]
    v_mfma_f32_16x16x32_bf16 v[112:115], v[52:55], a[52:55], v[112:115]
    v_mfma_f32_16x16x32_bf16 v[116:119], v[52:55], a[132:135], v[116:119]
    v_mfma_f32_16x16x32_bf16 v[120:123], v[52:55], a[212:215], v[120:123]
    v_mfma_f32_16x16x32_bf16 v[124:127], v[52:55], v[228:231], v[124:127]
    ds_read_b128 v[48:51], v2 offset:16384
    ds_read_b128 v[52:55], v2 offset:36864
    s_waitcnt lgkmcnt(4)
    v_mfma_f32_16x16x32_bf16 v[96:99], v[56:59], a[56:59], v[96:99]
    v_mfma_f32_16x16x32_bf16 v[100:103], v[56:59], a[136:139], v[100:103]
    s_add_u32 m0, s79, 8192
    s_add_u32 s85, s78, 8192
    buffer_load_dwordx4 v1, s[48:51], s85 offen offset:0 sc1 lds
    v_mfma_f32_16x16x32_bf16 v[104:107], v[56:59], a[216:219], v[104:107]
    v_mfma_f32_16x16x32_bf16 v[108:111], v[56:59], v[232:235], v[108:111]
    v_mfma_f32_16x16x32_bf16 v[112:115], v[60:63], a[56:59], v[112:115]
    v_mfma_f32_16x16x32_bf16 v[116:119], v[60:63], a[136:139], v[116:119]
    v_mfma_f32_16x16x32_bf16 v[120:123], v[60:63], a[216:219], v[120:123]
    v_mfma_f32_16x16x32_bf16 v[124:127], v[60:63], v[232:235], v[124:127]
    ds_read_b128 v[56:59], v2 offset:17408
    ds_read_b128 v[60:63], v2 offset:37888
    s_waitcnt lgkmcnt(4)
    v_mfma_f32_16x16x32_bf16 v[96:99], v[40:43], a[60:63], v[96:99]
    v_mfma_f32_16x16x32_bf16 v[100:103], v[40:43], a[140:143], v[100:103]
    buffer_load_dwordx4 v1, s[48:51], s85 offen offset:1024 sc1 lds
    v_mfma_f32_16x16x32_bf16 v[104:107], v[40:43], a[220:223], v[104:107]
    v_mfma_f32_16x16x32_bf16 v[108:111], v[40:43], v[236:239], v[108:111]
    v_mfma_f32_16x16x32_bf16 v[112:115], v[44:47], a[60:63], v[112:115]
    v_mfma_f32_16x16x32_bf16 v[116:119], v[44:47], a[140:143], v[116:119]
    v_mfma_f32_16x16x32_bf16 v[120:123], v[44:47], a[220:223], v[120:123]
    v_mfma_f32_16x16x32_bf16 v[124:127], v[44:47], v[236:239], v[124:127]
    ds_read_b128 v[40:43], v2 offset:18432
    ds_read_b128 v[44:47], v2 offset:38912
    s_waitcnt lgkmcnt(4)
    v_mfma_f32_16x16x32_bf16 v[96:99], v[48:51], a[64:67], v[96:99]
    v_mfma_f32_16x16x32_bf16 v[100:103], v[48:51], a[144:147], v[100:103]
    v_mfma_f32_16x16x32_bf16 v[104:107], v[48:51], a[224:227], v[104:107]
    v_mfma_f32_16x16x32_bf16 v[108:111], v[48:51], v[240:243], v[108:111]
    v_mfma_f32_16x16x32_bf16 v[112:115], v[52:55], a[64:67], v[112:115]
    v_mfma_f32_16x16x32_bf16 v[116:119], v[52:55], a[144:147], v[116:119]
    v_mfma_f32_16x16x32_bf16 v[120:123], v[52:55], a[224:227], v[120:123]
    v_mfma_f32_16x16x32_bf16 v[124:127], v[52:55], v[240:243], v[124:127]
    ds_read_b128 v[48:51], v2 offset:19456
    ds_read_b128 v[52:55], v2 offset:39936
    s_waitcnt lgkmcnt(4)
    v_mfma_f32_16x16x32_bf16 v[96:99], v[56:59], a[68:71], v[96:99]
    v_mfma_f32_16x16x32_bf16 v[100:103], v[56:59], a[148:151], v[100:103]
    v_mfma_f32_16x16x32_bf16 v[104:107], v[56:59], a[228:231], v[104:107]
    v_mfma_f32_16x16x32_bf16 v[108:111], v[56:59], v[244:247], v[108:111]
    v_mfma_f32_16x16x32_bf16 v[112:115], v[60:63], a[68:71], v[112:115]
    v_mfma_f32_16x16x32_bf16 v[116:119], v[60:63], a[148:151], v[116:119]
    v_mfma_f32_16x16x32_bf16 v[120:123], v[60:63], a[228:231], v[120:123]
    v_mfma_f32_16x16x32_bf16 v[124:127], v[60:63], v[244:247], v[124:127]
    s_waitcnt lgkmcnt(2)
    v_mfma_f32_16x16x32_bf16 v[96:99], v[40:43], a[72:75], v[96:99]
    v_mfma_f32_16x16x32_bf16 v[100:103], v[40:43], a[152:155], v[100:103]
    v_mfma_f32_16x16x32_bf16 v[104:107], v[40:43], a[232:235], v[104:107]
    v_mfma_f32_16x16x32_bf16 v[108:111], v[40:43], v[248:251], v[108:111]
    v_mfma_f32_16x16x32_bf16 v[112:115], v[44:47], a[72:75], v[112:115]
    v_mfma_f32_16x16x32_bf16 v[116:119], v[44:47], a[152:155], v[116:119]
    v_mfma_f32_16x16x32_bf16 v[120:123], v[44:47], a[232:235], v[120:123]
    v_mfma_f32_16x16x32_bf16 v[124:127], v[44:47], v[248:251], v[124:127]
    s_waitcnt lgkmcnt(0)
    v_mfma_f32_16x16x32_bf16 v[96:99], v[48:51], a[76:79], v[96:99]
    v_mfma_f32_16x16x32_bf16 v[100:103], v[48:51], a[156:159], v[100:103]
    v_mfma_f32_16x16x32_bf16 v[104:107], v[48:51], a[236:239], v[104:107]
    v_mfma_f32_16x16x32_bf16 v[108:111], v[48:51], v[252:255], v[108:111]
    v_mfma_f32_16x16x32_bf16 v[112:115], v[52:55], a[76:79], v[112:115]
    v_mfma_f32_16x16x32_bf16 v[116:119], v[52:55], a[156:159], v[116:119]
    v_mfma_f32_16x16x32_bf16 v[120:123], v[52:55], a[236:239], v[120:123]
    v_mfma_f32_16x16x32_bf16 v[124:127], v[52:55], v[252:255], v[124:127]
    v_xor_b32 v2, 0xa000, v2
    s_nop 7
    v_cvt_pk_bf16_f32 v64, v96, v97
    v_cvt_pk_bf16_f32 v65, v98, v99
    v_cvt_pk_bf16_f32 v66, v112, v113
    v_cvt_pk_bf16_f32 v67, v114, v115
    buffer_store_dwordx4 v[64:67], v1, s[48:51], s74 offen offset:0 sc1
    v_cvt_pk_bf16_f32 v68, v100, v101
    v_cvt_pk_bf16_f32 v69, v102, v103
    v_cvt_pk_bf16_f32 v70, v116, v117
    v_cvt_pk_bf16_f32 v71, v118, v119
    buffer_store_dwordx4 v[68:71], v1, s[48:51], s74 offen offset:1024 sc1
    v_cvt_pk_bf16_f32 v72, v104, v105
    v_cvt_pk_bf16_f32 v73, v106, v107
    v_cvt_pk_bf16_f32 v74, v120, v121
    v_cvt_pk_bf16_f32 v75, v122, v123
    buffer_store_dwordx4 v[72:75], v1, s[48:51], s74 offen offset:2048 sc1
    v_cvt_pk_bf16_f32 v76, v108, v109
    v_cvt_pk_bf16_f32 v77, v110, v111
    v_cvt_pk_bf16_f32 v78, v124, v125
    v_cvt_pk_bf16_f32 v79, v126, v127
    buffer_store_dwordx4 v[76:79], v1, s[48:51], s74 offen offset:3072 sc1
    s_add_u32 s74, s74, 16384
    s_add_u32 s66, s66, 1
    s_waitcnt vmcnt(0)
    s_barrier
    s_cmp_lg_u32 s64, 1
    s_cbranch_scc1 L_fs_128
    v_mov_b32 v84, s66
    v_mov_b32 v85, 0
    s_mov_b64 exec, 1
    buffer_store_dword v84, v85, s[48:51], s80 offen sc1
    s_mov_b64 exec, -1
L_fs_128:
    s_mov_b32 s12, 63
L_g_res_126:
    s_add_u32 s78, s78, 40960
    s_mul_i32 s79, s64, 10240
    s_add_u32 s79, s79, 40960
    ds_read_b128 v[40:43], v2 offset:0
    ds_read_b128 v[44:47], v2 offset:20480
    ds_read_b128 v[48:51], v2 offset:1024
    ds_read_b128 v[52:55], v2 offset:21504
    ds_read_b128 v[56:59], v2 offset:2048
    ds_read_b128 v[60:63], v2 offset:22528
    s_waitcnt lgkmcnt(4)
    v_mfma_f32_16x16x32_bf16 v[8:11], v[40:43], a[0:3], 0
    v_mfma_f32_16x16x32_bf16 v[12:15], v[40:43], a[80:83], 0
    v_mfma_f32_16x16x32_bf16 v[16:19], v[40:43], a[160:163], 0
    v_mfma_f32_16x16x32_bf16 v[20:23], v[40:43], a[240:243], 0
    v_mfma_f32_16x16x32_bf16 v[24:27], v[44:47], a[0:3], 0
    v_mfma_f32_16x16x32_bf16 v[28:31], v[44:47], a[80:83], 0
    v_mfma_f32_16x16x32_bf16 v[32:35], v[44:47], a[160:163], 0
    v_mfma_f32_16x16x32_bf16 v[36:39], v[44:47], a[240:243], 0
    ds_read_b128 v[40:43], v2 offset:3072
    ds_read_b128 v[44:47], v2 offset:23552
    s_waitcnt lgkmcnt(4)
    v_mfma_f32_16x16x32_bf16 v[8:11], v[48:51], a[4:7], v[8:11]
    v_mfma_f32_16x16x32_bf16 v[12:15], v[48:51], a[84:87], v[12:15]
    v_mfma_f32_16x16x32_bf16 v[16:19], v[48:51], a[164:167], v[16:19]
    v_mfma_f32_16x16x32_bf16 v[20:23], v[48:51], a[244:247], v[20:23]
    v_mfma_f32_16x16x32_bf16 v[24:27], v[52:55], a[4:7], v[24:27]
    v_mfma_f32_16x16x32_bf16 v[28:31], v[52:55], a[84:87], v[28:31]
    v_mfma_f32_16x16x32_bf16 v[32:35], v[52:55], a[164:167], v[32:35]
    v_mfma_f32_16x16x32_bf16 v[36:39], v[52:55], a[244:247], v[36:39]
    ds_read_b128 v[48:51], v2 offset:4096
    ds_read_b128 v[52:55], v2 offset:24576
    s_waitcnt lgkmcnt(4)
    v_mfma_f32_16x16x32_bf16 v[8:11], v[56:59], a[8:11], v[8:11]
    v_mfma_f32_16x16x32_bf16 v[12:15], v[56:59], a[88:91], v[12:15]
    v_mfma_f32_16x16x32_bf16 v[16:19], v[56:59], a[168:171], v[16:19]
    v_mfma_f32_16x16x32_bf16 v[20:23], v[56:59], a[248:251], v[20:23]
    v_mfma_f32_16x16x32_bf16 v[24:27], v[60:63], a[8:11], v[24:27]
    v_mfma_f32_16x16x32_bf16 v[28:31], v[60:63], a[88:91], v[28:31]
    v_mfma_f32_16x16x32_bf16 v[32:35], v[60:63], a[168:171], v[32:35]
    v_mfma_f32_16x16x32_bf16 v[36:39], v[60:63], a[248:251], v[36:39]
    ds_read_b128 v[56:59], v2 offset:5120
    ds_read_b128 v[60:63], v2 offset:25600
    s_waitcnt lgkmcnt(4)
    v_mfma_f32_16x16x32_bf16 v[8:11], v[40:43], a[12:15], v[8:11]
    v_mfma_f32_16x16x32_bf16 v[12:15], v[40:43], a[92:95], v[12:15]
    v_mfma_f32_16x16x32_bf16 v[16:19], v[40:43], a[172:175], v[16:19]
    v_mfma_f32_16x16x32_bf16 v[20:23], v[40:43], a[252:255], v[20:23]
    v_mfma_f32_16x16x32_bf16 v[24:27], v[44:47], a[12:15], v[24:27]
    v_mfma_f32_16x16x32_bf16 v[28:31], v[44:47], a[92:95], v[28:31]
    v_mfma_f32_16x16x32_bf16 v[32:35], v[44:47], a[172:175], v[32:35]
    v_mfma_f32_16x16x32_bf16 v[36:39], v[44:47], a[252:255], v[36:39]
    ds_read_b128 v[40:43], v2 offset:6144
    ds_read_b128 v[44:47], v2 offset:26624
    s_waitcnt lgkmcnt(4)
    v_mfma_f32_16x16x32_bf16 v[8:11], v[48:51], a[16:19], v[8:11]
    v_mfma_f32_16x16x32_bf16 v[12:15], v[48:51], a[96:99], v[12:15]
    v_mfma_f32_16x16x32_bf16 v[16:19], v[48:51], a[176:179], v[16:19]
    v_mfma_f32_16x16x32_bf16 v[20:23], v[48:51], v[192:195], v[20:23]
    v_mfma_f32_16x16x32_bf16 v[24:27], v[52:55], a[16:19], v[24:27]
    v_mfma_f32_16x16x32_bf16 v[28:31], v[52:55], a[96:99], v[28:31]
    v_mfma_f32_16x16x32_bf16 v[32:35], v[52:55], a[176:179], v[32:35]
    v_mfma_f32_16x16x32_bf16 v[36:39], v[52:55], v[192:195], v[36:39]
    ds_read_b128 v[48:51], v2 offset:7168
    ds_read_b128 v[52:55], v2 offset:27648
    s_waitcnt lgkmcnt(4)
    v_mfma_f32_16x16x32_bf16 v[8:11], v[56:59], a[20:23], v[8:11]
    v_mfma_f32_16x16x32_bf16 v[12:15], v[56:59], a[100:103], v[12:15]
    v_mfma_f32_16x16x32_bf16 v[16:19], v[56:59], a[180:183], v[16:19]
    v_mfma_f32_16x16x32_bf16 v[20:23], v[56:59], v[196:199], v[20:23]
    v_mfma_f32_16x16x32_bf16 v[24:27], v[60:63], a[20:23], v[24:27]
    v_mfma_f32_16x16x32_bf16 v[28:31], v[60:63], a[100:103], v[28:31]
    v_mfma_f32_16x16x32_bf16 v[32:35], v[60:63], a[180:183], v[32:35]
    v_mfma_f32_16x16x32_bf16 v[36:39], v[60:63], v[196:199], v[36:39]
    ds_read_b128 v[56:59], v2 offset:8192
    ds_read_b128 v[60:63], v2 offset:28672
    s_waitcnt lgkmcnt(4)
    v_mfma_f32_16x16x32_bf16 v[8:11], v[40:43], a[24:27], v[8:11]
    v_mfma_f32_16x16x32_bf16 v[12:15], v[40:43], a[104:107], v[12:15]
    s_add_u32 m0, s79, 0
    s_add_u32 s85, s78, 0
    buffer_load_dwordx4 v1, s[48:51], s85 offen offset:0 sc1 lds
    v_mfma_f32_16x16x32_bf16 v[16:19], v[40:43], a[184:187], v[16:19]
    v_mfma_f32_16x16x32_bf16 v[20:23], v[40:43], v[200:203], v[20:23]
    v_mfma_f32_16x16x32_bf16 v[24:27], v[44:47], a[24:27], v[24:27]
    v_mfma_f32_16x16x32_bf16 v[28:31], v[44:47], a[104:107], v[28:31]
    v_mfma_f32_16x16x32_bf16 v[32:35], v[44:47], a[184:187], v[32:35]
    v_mfma_f32_16x16x32_bf16 v[36:39], v[44:47], v[200:203], v[36:39]
    ds_read_b128 v[40:43], v2 offset:9216
    ds_read_b128 v[44:47], v2 offset:29696
    s_waitcnt lgkmcnt(4)
    v_mfma_f32_16x16x32_bf16 v[8:11], v[48:51], a[28:31], v[8:11]
    v_mfma_f32_16x16x32_bf16 v[12:15], v[48:51], a[108:111], v[12:15]
    buffer_load_dwordx4 v1, s[48:51], s85 offen offset:1024 sc1 lds
    v_mfma_f32_16x16x32_bf16 v[16:19], v[48:51], a[188:191], v[16:19]
    v_mfma_f32_16x16x32_bf16 v[20:23], v[48:51], v[204:207], v[20:23]
    v_mfma_f32_16x16x32_bf16 v[24:27], v[52:55], a[28:31], v[24:27]
    v_mfma_f32_16x16x32_bf16 v[28:31], v[52:55], a[108:111], v[28:31]
    v_mfma_f32_16x16x32_bf16 v[32:35], v[52:55], a[188:191], v[32:35]
    v_mfma_f32_16x16x32_bf16 v[36:39], v[52:55], v[204:207], v[36:39]
    ds_read_b128 v[48:51], v2 offset:10240
    ds_read_b128 v[52:55], v2 offset:30720
    s_waitcnt lgkmcnt(4)
    v_mfma_f32_16x16x32_bf16 v[8:11], v[56:59], a[32:35], v[8:11]
    v_mfma_f32_16x16x32_bf16 v[12:15], v[56:59], a[112:115], v[12:15]
    buffer_load_dwordx4 v1, s[48:51], s85 offen offset:2048 sc1 lds
    v_mfma_f32_16x16x32_bf16 v[16:19], v[56:59], a[192:195], v[16:19]
    v_mfma_f32_16x16x32_bf16 v[20:23], v[56:59], v[208:211], v[20:23]
    v_mfma_f32_16x16x32_bf16 v[24:27], v[60:63], a[32:35], v[24:27]
    v_mfma_f32_16x16x32_bf16 v[28:31], v[60:63], a[112:115], v[28:31]
    v_mfma_f32_16x16x32_bf16 v[32:35], v[60:63], a[192:195], v[32:35]
    v_mfma_f32_16x16x32_bf16 v[36:39], v[60:63], v[208:211], v[36:39]
    ds_read_b128 v[56:59], v2 offset:11264
    ds_read_b128 v[60:63], v2 offset:31744
    s_waitcnt lgkmcnt(4)
    v_mfma_f32_16x16x32_bf16 v[8:11], v[40:43], a[36:39], v[8:11]
    v_mfma_f32_16x16x32_bf16 v[12:15], v[40:43], a[116:119], v[12:15]
    buffer_load_dwordx4 v1, s[48:51], s85 offen offset:3072 sc1 lds
    v_mfma_f32_16x16x32_bf16 v[16:19], v[40:43], a[196:199], v[16:19]
    v_mfma_f32_16x16x32_bf16 v[20:23], v[40:43], v[212:215], v[20:23]
    v_mfma_f32_16x16x32_bf16 v[24:27], v[44:47], a[36:39], v[24:27]
    v_mfma_f32_16x16x32_bf16 v[28:31], v[44:47], a[116:119], v[28:31]
    v_mfma_f32_16x16x32_bf16 v[32:35], v[44:47], a[196:199], v[32:35]
    v_mfma_f32_16x16x32_bf16 v[36:39], v[44:47], v[212:215], v[36:39]
    ds_read_b128 v[40:43], v2 offset:12288
    ds_read_b128 v[44:47], v2 offset:32768
    s_waitcnt lgkmcnt(4)
    v_mfma_f32_16x16x32_bf16 v[8:11], v[48:51], a[40:43], v[8:11]
    v_mfma_f32_16x16x32_bf16 v[12:15], v[48:51], a[120:123], v[12:15]
    s_add_u32 m0, s79, 4096
    s_add_u32 s85, s78, 4096
    buffer_load_dwordx4 v1, s[48:51], s85 offen offset:0 sc1 lds
    v_mfma_f32_16x16x32_bf16 v[16:19], v[48:51], a[200:203], v[16:19]
    v_mfma_f32_16x16x32_bf16 v[20:23], v[48:51], v[216:219], v[20:23]
    v_mfma_f32_16x16x32_bf16 v[24:27], v[52:55], a[40:43], v[24:27]
    v_mfma_f32_16x16x32_bf16 v[28:31], v[52:55], a[120:123], v[28:31]
    v_mfma_f32_16x16x32_bf16 v[32:35], v[52:55], a[200:203], v[32:35]
    v_mfma_f32_16x16x32_bf16 v[36:39], v[52:55], v[216:219], v[36:39]
    ds_read_b128 v[48:51], v2 offset:13312
    ds_read_b128 v[52:55], v2 offset:33792
    s_waitcnt lgkmcnt(4)
    v_mfma_f32_16x16x32_bf16 v[8:11], v[56:59], a[44:47], v[8:11]
    v_mfma_f32_16x16x32_bf16 v[12:15], v[56:59], a[124:127], v[12:15]
    buffer_load_dwordx4 v1, s[48:51], s85 offen offset:1024 sc1 lds
    v_mfma_f32_16x16x32_bf16 v[16:19], v[56:59], a[204:207], v[16:19]
    v_mfma_f32_16x16x32_bf16 v[20:23], v[56:59], v[220:223], v[20:23]
    v_mfma_f32_16x16x32_bf16 v[24:27], v[60:63], a[44:47], v[24:27]
    v_mfma_f32_16x16x32_bf16 v[28:31], v[60:63], a[124:127], v[28:31]
    v_mfma_f32_16x16x32_bf16 v[32:35], v[60:63], a[204:207], v[32:35]
    v_mfma_f32_16x16x32_bf16 v[36:39], v[60:63], v[220:223], v[36:39]
    ds_read_b128 v[56:59], v2 offset:14336
    ds_read_b128 v[60:63], v2 offset:34816
    s_waitcnt lgkmcnt(4)
    v_mfma_f32_16x16x32_bf16 v[8:11], v[40:43], a[48:51], v[8:11]
    v_mfma_f32_16x16x32_bf16 v[12:15], v[40:43], a[128:131], v[12:15]
    buffer_load_dwordx4 v1, s[48:51], s85 offen offset:2048 sc1 lds
    v_mfma_f32_16x16x32_bf16 v[16:19], v[40:43], a[208:211], v[16:19]
    v_mfma_f32_16x16x32_bf16 v[20:23], v[40:43], v[224:227], v[20:23]
    v_mfma_f32_16x16x32_bf16 v[24:27], v[44:47], a[48:51], v[24:27]
    v_mfma_f32_16x16x32_bf16 v[28:31], v[44:47], a[128:131], v[28:31]
    v_mfma_f32_16x16x32_bf16 v[32:35], v[44:47], a[208:211], v[32:35]
    v_mfma_f32_16x16x32_bf16 v[36:39], v[44:47], v[224:227], v[36:39]
    ds_read_b128 v[40:43], v2 offset:15360
    ds_read_b128 v[44:47], v2 offset:35840
    s_waitcnt lgkmcnt(4)
    v_mfma_f32_16x16x32_bf16 v[8:11], v[48:51], a[52:55], v[8:11]
    v_mfma_f32_16x16x32_bf16 v[12:15], v[48:51], a[132:135], v[12:15]
    buffer_load_dwordx4 v1, s[48:51], s85 offen offset:3072 sc1 lds
    v_mfma_f32_16x16x32_bf16 v[16:19], v[48:51], a[212:215], v[16:19]
    v_mfma_f32_16x16x32_bf16 v[20:23], v[48:51], v[228:231], v[20:23]
    v_mfma_f32_16x16x32_bf16 v[24:27], v[52:55], a[52:55], v[24:27]
    v_mfma_f32_16x16x32_bf16 v[28:31], v[52:55], a[132:135], v[28:31]
    v_mfma_f32_16x16x32_bf16 v[32:35], v[52:55], a[212:215], v[32:35]
    v_mfma_f32_16x16x32_bf16 v[36:39], v[52:55], v[228:231], v[36:39]
    ds_read_b128 v[48:51], v2 offset:16384
    ds_read_b128 v[52:55], v2 offset:36864
    s_waitcnt lgkmcnt(4)
    v_mfma_f32_16x16x32_bf16 v[8:11], v[56:59], a[56:59], v[8:11]
    v_mfma_f32_16x16x32_bf16 v[12:15], v[56:59], a[136:139], v[12:15]
    s_add_u32 m0, s79, 8192
    s_add_u32 s85, s78, 8192
    buffer_load_dwordx4 v1, s[48:51], s85 offen offset:0 sc1 lds
    v_mfma_f32_16x16x32_bf16 v[16:19], v[56:59], a[216:219], v[16:19]
    v_mfma_f32_16x16x32_bf16 v[20:23], v[56:59], v[232:235], v[20:23]
    v_mfma_f32_16x16x32_bf16 v[24:27], v[60:63], a[56:59], v[24:27]
    v_mfma_f32_16x16x32_bf16 v[28:31], v[60:63], a[136:139], v[28:31]
    v_mfma_f32_16x16x32_bf16 v[32:35], v[60:63], a[216:219], v[32:35]
    v_mfma_f32_16x16x32_bf16 v[36:39], v[60:63], v[232:235], v[36:39]
    ds_read_b128 v[56:59], v2 offset:17408
    ds_read_b128 v[60:63], v2 offset:37888
    s_waitcnt lgkmcnt(4)
    v_mfma_f32_16x16x32_bf16 v[8:11], v[40:43], a[60:63], v[8:11]
    v_mfma_f32_16x16x32_bf16 v[12:15], v[40:43], a[140:143], v[12:15]
    buffer_load_dwordx4 v1, s[48:51], s85 offen offset:1024 sc1 lds
    v_mfma_f32_16x16x32_bf16 v[16:19], v[40:43], a[220:223], v[16:19]
    v_mfma_f32_16x16x32_bf16 v[20:23], v[40:43], v[236:239], v[20:23]
    v_mfma_f32_16x16x32_bf16 v[24:27], v[44:47], a[60:63], v[24:27]
    v_mfma_f32_16x16x32_bf16 v[28:31], v[44:47], a[140:143], v[28:31]
    v_mfma_f32_16x16x32_bf16 v[32:35], v[44:47], a[220:223], v[32:35]
    v_mfma_f32_16x16x32_bf16 v[36:39], v[44:47], v[236:239], v[36:39]
    ds_read_b128 v[40:43], v2 offset:18432
    ds_read_b128 v[44:47], v2 offset:38912
    s_waitcnt lgkmcnt(4)
    v_mfma_f32_16x16x32_bf16 v[8:11], v[48:51], a[64:67], v[8:11]
    v_mfma_f32_16x16x32_bf16 v[12:15], v[48:51], a[144:147], v[12:15]
    v_mfma_f32_16x16x32_bf16 v[16:19], v[48:51], a[224:227], v[16:19]
    v_mfma_f32_16x16x32_bf16 v[20:23], v[48:51], v[240:243], v[20:23]
    v_mfma_f32_16x16x32_bf16 v[24:27], v[52:55], a[64:67], v[24:27]
    v_mfma_f32_16x16x32_bf16 v[28:31], v[52:55], a[144:147], v[28:31]
    v_mfma_f32_16x16x32_bf16 v[32:35], v[52:55], a[224:227], v[32:35]
    v_mfma_f32_16x16x32_bf16 v[36:39], v[52:55], v[240:243], v[36:39]
    ds_read_b128 v[48:51], v2 offset:19456
    ds_read_b128 v[52:55], v2 offset:39936
    s_waitcnt lgkmcnt(4)
    v_mfma_f32_16x16x32_bf16 v[8:11], v[56:59], a[68:71], v[8:11]
    v_mfma_f32_16x16x32_bf16 v[12:15], v[56:59], a[148:151], v[12:15]
    v_mfma_f32_16x16x32_bf16 v[16:19], v[56:59], a[228:231], v[16:19]
    v_mfma_f32_16x16x32_bf16 v[20:23], v[56:59], v[244:247], v[20:23]
    v_mfma_f32_16x16x32_bf16 v[24:27], v[60:63], a[68:71], v[24:27]
    v_mfma_f32_16x16x32_bf16 v[28:31], v[60:63], a[148:151], v[28:31]
    v_mfma_f32_16x16x32_bf16 v[32:35], v[60:63], a[228:231], v[32:35]
    v_mfma_f32_16x16x32_bf16 v[36:39], v[60:63], v[244:247], v[36:39]
    s_waitcnt lgkmcnt(2)
    v_mfma_f32_16x16x32_bf16 v[8:11], v[40:43], a[72:75], v[8:11]
    v_mfma_f32_16x16x32_bf16 v[12:15], v[40:43], a[152:155], v[12:15]
    v_mfma_f32_16x16x32_bf16 v[16:19], v[40:43], a[232:235], v[16:19]
    v_mfma_f32_16x16x32_bf16 v[20:23], v[40:43], v[248:251], v[20:23]
    v_mfma_f32_16x16x32_bf16 v[24:27], v[44:47], a[72:75], v[24:27]
    v_mfma_f32_16x16x32_bf16 v[28:31], v[44:47], a[152:155], v[28:31]
    v_mfma_f32_16x16x32_bf16 v[32:35], v[44:47], a[232:235], v[32:35]
    v_mfma_f32_16x16x32_bf16 v[36:39], v[44:47], v[248:251], v[36:39]
    s_waitcnt lgkmcnt(0)
    v_mfma_f32_16x16x32_bf16 v[8:11], v[48:51], a[76:79], v[8:11]
    v_mfma_f32_16x16x32_bf16 v[12:15], v[48:51], a[156:159], v[12:15]
    v_mfma_f32_16x16x32_bf16 v[16:19], v[48:51], a[236:239], v[16:19]
    v_mfma_f32_16x16x32_bf16 v[20:23], v[48:51], v[252:255], v[20:23]
    v_mfma_f32_16x16x32_bf16 v[24:27], v[52:55], a[76:79], v[24:27]
    v_mfma_f32_16x16x32_bf16 v[28:31], v[52:55], a[156:159], v[28:31]
    v_mfma_f32_16x16x32_bf16 v[32:35], v[52:55], a[236:239], v[32:35]
    v_mfma_f32_16x16x32_bf16 v[36:39], v[52:55], v[252:255], v[36:39]
    v_xor_b32 v2, 0xa000, v2
L_g_top_125:
    s_waitcnt vmcnt(0)
    s_barrier
    s_cmp_lg_u32 s64, 1
    s_cbranch_scc1 L_fs_129
    v_mov_b32 v84, s66
    v_mov_b32 v85, 0
    s_mov_b64 exec, 1
    buffer_store_dword v84, v85, s[48:51], s80 offen sc1
    s_mov_b64 exec, -1
L_fs_129:
    s_add_u32 s78, s78, 40960
    s_mul_i32 s79, s64, 10240
    s_add_u32 s79, s79, 0
    ds_read_b128 v[40:43], v2 offset:0
    ds_read_b128 v[44:47], v2 offset:20480
    ds_read_b128 v[48:51], v2 offset:1024
    ds_read_b128 v[52:55], v2 offset:21504
    ds_read_b128 v[56:59], v2 offset:2048
    ds_read_b128 v[60:63], v2 offset:22528
    s_waitcnt lgkmcnt(4)
    v_mfma_f32_16x16x32_bf16 v[96:99], v[40:43], a[0:3], 0
    v_mfma_f32_16x16x32_bf16 v[100:103], v[40:43], a[80:83], 0
    v_mfma_f32_16x16x32_bf16 v[104:107], v[40:43], a[160:163], 0
    v_mfma_f32_16x16x32_bf16 v[108:111], v[40:43], a[240:243], 0
    v_mfma_f32_16x16x32_bf16 v[112:115], v[44:47], a[0:3], 0
    v_mfma_f32_16x16x32_bf16 v[116:119], v[44:47], a[80:83], 0
    v_mfma_f32_16x16x32_bf16 v[120:123], v[44:47], a[160:163], 0
    v_mfma_f32_16x16x32_bf16 v[124:127], v[44:47], a[240:243], 0
    ds_read_b128 v[40:43], v2 offset:3072
    ds_read_b128 v[44:47], v2 offset:23552
    s_waitcnt lgkmcnt(4)
    v_mfma_f32_16x16x32_bf16 v[96:99], v[48:51], a[4:7], v[96:99]
    v_cvt_pk_bf16_f32 v64, v8, v9
    v_mfma_f32_16x16x32_bf16 v[100:103], v[48:51], a[84:87], v[100:103]
    v_cvt_pk_bf16_f32 v65, v10, v11
    v_mfma_f32_16x16x32_bf16 v[104:107], v[48:51], a[164:167], v[104:107]
    v_cvt_pk_bf16_f32 v66, v24, v25
    v_mfma_f32_16x16x32_bf16 v[108:111], v[48:51], a[244:247], v[108:111]
    v_cvt_pk_bf16_f32 v67, v26, v27
    v_mfma_f32_16x16x32_bf16 v[112:115], v[52:55], a[4:7], v[112:115]
    buffer_store_dwordx4 v[64:67], v1, s[48:51], s74 offen offset:0 sc1
    v_mfma_f32_16x16x32_bf16 v[116:119], v[52:55], a[84:87], v[116:119]
    v_cvt_pk_bf16_f32 v68, v12, v13
    v_mfma_f32_16x16x32_bf16 v[120:123], v[52:55], a[164:167], v[120:123]
    v_cvt_pk_bf16_f32 v69, v14, v15
    v_mfma_f32_16x16x32_bf16 v[124:127], v[52:55], a[244:247], v[124:127]
    v_cvt_pk_bf16_f32 v70, v28, v29
    ds_read_b128 v[48:51], v2 offset:4096
    ds_read_b128 v[52:55], v2 offset:24576
    s_waitcnt lgkmcnt(4)
    v_mfma_f32_16x16x32_bf16 v[96:99], v[56:59], a[8:11], v[96:99]
    v_cvt_pk_bf16_f32 v71, v30, v31
    v_mfma_f32_16x16x32_bf16 v[100:103], v[56:59], a[88:91], v[100:103]
    buffer_store_dwordx4 v[68:71], v1, s[48:51], s74 offen offset:1024 sc1
    v_mfma_f32_16x16x32_bf16 v[104:107], v[56:59], a[168:171], v[104:107]
    v_cvt_pk_bf16_f32 v72, v16, v17
    v_mfma_f32_16x16x32_bf16 v[108:111], v[56:59], a[248:251], v[108:111]
    v_cvt_pk_bf16_f32 v73, v18, v19
    v_mfma_f32_16x16x32_bf16 v[112:115], v[60:63], a[8:11], v[112:115]
    v_cvt_pk_bf16_f32 v74, v32, v33
    v_mfma_f32_16x16x32_bf16 v[116:119], v[60:63], a[88:91], v[116:119]
    v_cvt_pk_bf16_f32 v75, v34, v35
    v_mfma_f32_16x16x32_bf16 v[120:123], v[60:63], a[168:171], v[120:123]
    buffer_store_dwordx4 v[72:75], v1, s[48:51], s74 offen offset:2048 sc1
    v_mfma_f32_16x16x32_bf16 v[124:127], v[60:63], a[248:251], v[124:127]
    v_cvt_pk_bf16_f32 v76, v20, v21
    ds_read_b128 v[56:59], v2 offset:5120
    ds_read_b128 v[60:63], v2 offset:25600
    s_waitcnt lgkmcnt(4)
    v_mfma_f32_16x16x32_bf16 v[96:99], v[40:43], a[12:15], v[96:99]
    v_cvt_pk_bf16_f32 v77, v22, v23
    v_mfma_f32_16x16x32_bf16 v[100:103], v[40:43], a[92:95], v[100:103]
    v_cvt_pk_bf16_f32 v78, v36, v37
    v_mfma_f32_16x16x32_bf16 v[104:107], v[40:43], a[172:175], v[104:107]
    v_cvt_pk_bf16_f32 v79, v38, v39
    v_mfma_f32_16x16x32_bf16 v[108:111], v[40:43], a[252:255], v[108:111]
    buffer_store_dwordx4 v[76:79], v1, s[48:51], s74 offen offset:3072 sc1
    s_add_u32 s74, s74, 16384
    v_mfma_f32_16x16x32_bf16 v[112:115], v[44:47], a[12:15], v[112:115]
    v_mfma_f32_16x16x32_bf16 v[116:119], v[44:47], a[92:95], v[116:119]
    v_mfma_f32_16x16x32_bf16 v[120:123], v[44:47], a[172:175], v[120:123]
    v_mfma_f32_16x16x32_bf16 v[124:127], v[44:47], a[252:255], v[124:127]
    ds_read_b128 v[40:43], v2 offset:6144
    ds_read_b128 v[44:47], v2 offset:26624
    s_waitcnt lgkmcnt(4)
    v_mfma_f32_16x16x32_bf16 v[96:99], v[48:51], a[16:19], v[96:99]
    v_mfma_f32_16x16x32_bf16 v[100:103], v[48:51], a[96:99], v[100:103]
    v_mfma_f32_16x16x32_bf16 v[104:107], v[48:51], a[176:179], v[104:107]
    v_mfma_f32_16x16x32_bf16 v[108:111], v[48:51], v[192:195], v[108:111]
    v_mfma_f32_16x16x32_bf16 v[112:115], v[52:55], a[16:19], v[112:115]
    v_mfma_f32_16x16x32_bf16 v[116:119], v[52:55], a[96:99], v[116:119]
    v_mfma_f32_16x16x32_bf16 v[120:123], v[52:55], a[176:179], v[120:123]
    v_mfma_f32_16x16x32_bf16 v[124:127], v[52:55], v[192:195], v[124:127]
    ds_read_b128 v[48:51], v2 offset:7168
    ds_read_b128 v[52:55], v2 offset:27648
    s_waitcnt lgkmcnt(4)
    v_mfma_f32_16x16x32_bf16 v[96:99], v[56:59], a[20:23], v[96:99]
    v_mfma_f32_16x16x32_bf16 v[100:103], v[56:59], a[100:103], v[100:103]
    v_mfma_f32_16x16x32_bf16 v[104:107], v[56:59], a[180:183], v[104:107]
    v_mfma_f32_16x16x32_bf16 v[108:111], v[56:59], v[196:199], v[108:111]
    v_mfma_f32_16x16x32_bf16 v[112:115], v[60:63], a[20:23], v[112:115]
    v_mfma_f32_16x16x32_bf16 v[116:119], v[60:63], a[100:103], v[116:119]
    v_mfma_f32_16x16x32_bf16 v[120:123], v[60:63], a[180:183], v[120:123]
    v_mfma_f32_16x16x32_bf16 v[124:127], v[60:63], v[196:199], v[124:127]
    ds_read_b128 v[56:59], v2 offset:8192
    ds_read_b128 v[60:63], v2 offset:28672
    s_waitcnt lgkmcnt(4)
    v_mfma_f32_16x16x32_bf16 v[96:99], v[40:43], a[24:27], v[96:99]
    v_mfma_f32_16x16x32_bf16 v[100:103], v[40:43], a[104:107], v[100:103]
    s_add_u32 m0, s79, 0
    s_add_u32 s85, s78, 0
    buffer_load_dwordx4 v1, s[48:51], s85 offen offset:0 sc1 lds
    v_mfma_f32_16x16x32_bf16 v[104:107], v[40:43], a[184:187], v[104:107]
    v_mfma_f32_16x16x32_bf16 v[108:111], v[40:43], v[200:203], v[108:111]
    v_mfma_f32_16x16x32_bf16 v[112:115], v[44:47], a[24:27], v[112:115]
    v_mfma_f32_16x16x32_bf16 v[116:119], v[44:47], a[104:107], v[116:119]
    v_mfma_f32_16x16x32_bf16 v[120:123], v[44:47], a[184:187], v[120:123]
    v_mfma_f32_16x16x32_bf16 v[124:127], v[44:47], v[200:203], v[124:127]
    ds_read_b128 v[40:43], v2 offset:9216
    ds_read_b128 v[44:47], v2 offset:29696
    s_waitcnt lgkmcnt(4)
    v_mfma_f32_16x16x32_bf16 v[96:99], v[48:51], a[28:31], v[96:99]
    v_mfma_f32_16x16x32_bf16 v[100:103], v[48:51], a[108:111], v[100:103]
    buffer_load_dwordx4 v1, s[48:51], s85 offen offset:1024 sc1 lds
    v_mfma_f32_16x16x32_bf16 v[104:107], v[48:51], a[188:191], v[104:107]
    v_mfma_f32_16x16x32_bf16 v[108:111], v[48:51], v[204:207], v[108:111]
    v_mfma_f32_16x16x32_bf16 v[112:115], v[52:55], a[28:31], v[112:115]
    v_mfma_f32_16x16x32_bf16 v[116:119], v[52:55], a[108:111], v[116:119]
    v_mfma_f32_16x16x32_bf16 v[120:123], v[52:55], a[188:191], v[120:123]
    v_mfma_f32_16x16x32_bf16 v[124:127], v[52:55], v[204:207], v[124:127]
    ds_read_b128 v[48:51], v2 offset:10240
    ds_read_b128 v[52:55], v2 offset:30720
    s_waitcnt lgkmcnt(4)
    v_mfma_f32_16x16x32_bf16 v[96:99], v[56:59], a[32:35], v[96:99]
    v_mfma_f32_16x16x32_bf16 v[100:103], v[56:59], a[112:115], v[100:103]
    buffer_load_dwordx4 v1, s[48:51], s85 offen offset:2048 sc1 lds
    v_mfma_f32_16x16x32_bf16 v[104:107], v[56:59], a[192:195], v[104:107]
    v_mfma_f32_16x16x32_bf16 v[108:111], v[56:59], v[208:211], v[108:111]
    v_mfma_f32_16x16x32_bf16 v[112:115], v[60:63], a[32:35], v[112:115]
    v_mfma_f32_16x16x32_bf16 v[116:119], v[60:63], a[112:115], v[116:119]
    v_mfma_f32_16x16x32_bf16 v[120:123], v[60:63], a[192:195], v[120:123]
    v_mfma_f32_16x16x32_bf16 v[124:127], v[60:63], v[208:211], v[124:127]
    ds_read_b128 v[56:59], v2 offset:11264
    ds_read_b128 v[60:63], v2 offset:31744
    s_waitcnt lgkmcnt(4)
    v_mfma_f32_16x16x32_bf16 v[96:99], v[40:43], a[36:39], v[96:99]
    v_mfma_f32_16x16x32_bf16 v[100:103], v[40:43], a[116:119], v[100:103]
    buffer_load_dwordx4 v1, s[48:51], s85 offen offset:3072 sc1 lds
    v_mfma_f32_16x16x32_bf16 v[104:107], v[40:43], a[196:199], v[104:107]
    v_mfma_f32_16x16x32_bf16 v[108:111], v[40:43], v[212:215], v[108:111]
    v_mfma_f32_16x16x32_bf16 v[112:115], v[44:47], a[36:39], v[112:115]
    v_mfma_f32_16x16x32_bf16 v[116:119], v[44:47], a[116:119], v[116:119]
    v_mfma_f32_16x16x32_bf16 v[120:123], v[44:47], a[196:199], v[120:123]
    v_mfma_f32_16x16x32_bf16 v[124:127], v[44:47], v[212:215], v[124:127]
    ds_read_b128 v[40:43], v2 offset:12288
    ds_read_b128 v[44:47], v2 offset:32768
    s_waitcnt lgkmcnt(4)
    v_mfma_f32_16x16x32_bf16 v[96:99], v[48:51], a[40:43], v[96:99]
    v_mfma_f32_16x16x32_bf16 v[100:103], v[48:51], a[120:123], v[100:103]
    s_add_u32 m0, s79, 4096
    s_add_u32 s85, s78, 4096
    buffer_load_dwordx4 v1, s[48:51], s85 offen offset:0 sc1 lds
    v_mfma_f32_16x16x32_bf16 v[104:107], v[48:51], a[200:203], v[104:107]
    v_mfma_f32_16x16x32_bf16 v[108:111], v[48:51], v[216:219], v[108:111]
    v_mfma_f32_16x16x32_bf16 v[112:115], v[52:55], a[40:43], v[112:115]
    v_mfma_f32_16x16x32_bf16 v[116:119], v[52:55], a[120:123], v[116:119]
    v_mfma_f32_16x16x32_bf16 v[120:123], v[52:55], a[200:203], v[120:123]
    v_mfma_f32_16x16x32_bf16 v[124:127], v[52:55], v[216:219], v[124:127]
    ds_read_b128 v[48:51], v2 offset:13312
    ds_read_b128 v[52:55], v2 offset:33792
    s_waitcnt lgkmcnt(4)
    v_mfma_f32_16x16x32_bf16 v[96:99], v[56:59], a[44:47], v[96:99]
    v_mfma_f32_16x16x32_bf16 v[100:103], v[56:59], a[124:127], v[100:103]
    buffer_load_dwordx4 v1, s[48:51], s85 offen offset:1024 sc1 lds
    v_mfma_f32_16x16x32_bf16 v[104:107], v[56:59], a[204:207], v[104:107]
    v_mfma_f32_16x16x32_bf16 v[108:111], v[56:59], v[220:223], v[108:111]
    v_mfma_f32_16x16x32_bf16 v[112:115], v[60:63], a[44:47], v[112:115]
    v_mfma_f32_16x16x32_bf16 v[116:119], v[60:63], a[124:127], v[116:119]
    v_mfma_f32_16x16x32_bf16 v[120:123], v[60:63], a[204:207], v[120:123]
    v_mfma_f32_16x16x32_bf16 v[124:127], v[60:63], v[220:223], v[124:127]
    ds_read_b128 v[56:59], v2 offset:14336
    ds_read_b128 v[60:63], v2 offset:34816
    s_waitcnt lgkmcnt(4)
    v_mfma_f32_16x16x32_bf16 v[96:99], v[40:43], a[48:51], v[96:99]
    v_mfma_f32_16x16x32_bf16 v[100:103], v[40:43], a[128:131], v[100:103]
    buffer_load_dwordx4 v1, s[48:51], s85 offen offset:2048 sc1 lds
    v_mfma_f32_16x16x32_bf16 v[104:107], v[40:43], a[208:211], v[104:107]
    v_mfma_f32_16x16x32_bf16 v[108:111], v[40:43], v[224:227], v[108:111]
    v_mfma_f32_16x16x32_bf16 v[112:115], v[44:47], a[48:51], v[112:115]
    v_mfma_f32_16x16x32_bf16 v[116:119], v[44:47], a[128:131], v[116:119]
    v_mfma_f32_16x16x32_bf16 v[120:123], v[44:47], a[208:211], v[120:123]
    v_mfma_f32_16x16x32_bf16 v[124:127], v[44:47], v[224:227], v[124:127]
    ds_read_b128 v[40:43], v2 offset:15360
    ds_read_b128 v[44:47], v2 offset:35840
    s_waitcnt lgkmcnt(4)
    v_mfma_f32_16x16x32_bf16 v[96:99], v[48:51], a[52:55], v[96:99]
    v_mfma_f32_16x16x32_bf16 v[100:103], v[48:51], a[132:135], v[100:103]
    buffer_load_dwordx4 v1, s[48:51], s85 offen offset:3072 sc1 lds
    v_mfma_f32_16x16x32_bf16 v[104:107], v[48:51], a[212:215], v[104:107]
    v_mfma_f32_16x16x32_bf16 v[108:111], v[48:51], v[228:231], v[108:111]
    v_mfma_f32_16x16x32_bf16 v[112:115], v[52:55], a[52:55], v[112:115]
    v_mfma_f32_16x16x32_bf16 v[116:119], v[52:55], a[132:135], v[116:119]
    v_mfma_f32_16x16x32_bf16 v[120:123], v[52:55], a[212:215], v[120:123]
    v_mfma_f32_16x16x32_bf16 v[124:127], v[52:55], v[228:231], v[124:127]
    ds_read_b128 v[48:51], v2 offset:16384
    ds_read_b128 v[52:55], v2 offset:36864
    s_waitcnt lgkmcnt(4)
    v_mfma_f32_16x16x32_bf16 v[96:99], v[56:59], a[56:59], v[96:99]
    v_mfma_f32_16x16x32_bf16 v[100:103], v[56:59], a[136:139], v[100:103]
    s_add_u32 m0, s79, 8192
    s_add_u32 s85, s78, 8192
    buffer_load_dwordx4 v1, s[48:51], s85 offen offset:0 sc1 lds
    v_mfma_f32_16x16x32_bf16 v[104:107], v[56:59], a[216:219], v[104:107]
    v_mfma_f32_16x16x32_bf16 v[108:111], v[56:59], v[232:235], v[108:111]
    v_mfma_f32_16x16x32_bf16 v[112:115], v[60:63], a[56:59], v[112:115]
    v_mfma_f32_16x16x32_bf16 v[116:119], v[60:63], a[136:139], v[116:119]
    v_mfma_f32_16x16x32_bf16 v[120:123], v[60:63], a[216:219], v[120:123]
    v_mfma_f32_16x16x32_bf16 v[124:127], v[60:63], v[232:235], v[124:127]
    ds_read_b128 v[56:59], v2 offset:17408
    ds_read_b128 v[60:63], v2 offset:37888
    s_waitcnt lgkmcnt(4)
    v_mfma_f32_16x16x32_bf16 v[96:99], v[40:43], a[60:63], v[96:99]
    v_mfma_f32_16x16x32_bf16 v[100:103], v[40:43], a[140:143], v[100:103]
    buffer_load_dwordx4 v1, s[48:51], s85 offen offset:1024 sc1 lds
    v_mfma_f32_16x16x32_bf16 v[104:107], v[40:43], a[220:223], v[104:107]
    v_mfma_f32_16x16x32_bf16 v[108:111], v[40:43], v[236:239], v[108:111]
    v_mfma_f32_16x16x32_bf16 v[112:115], v[44:47], a[60:63], v[112:115]
    v_mfma_f32_16x16x32_bf16 v[116:119], v[44:47], a[140:143], v[116:119]
    v_mfma_f32_16x16x32_bf16 v[120:123], v[44:47], a[220:223], v[120:123]
    v_mfma_f32_16x16x32_bf16 v[124:127], v[44:47], v[236:239], v[124:127]
    ds_read_b128 v[40:43], v2 offset:18432
    ds_read_b128 v[44:47], v2 offset:38912
    s_waitcnt lgkmcnt(4)
    v_mfma_f32_16x16x32_bf16 v[96:99], v[48:51], a[64:67], v[96:99]
    v_mfma_f32_16x16x32_bf16 v[100:103], v[48:51], a[144:147], v[100:103]
    v_mfma_f32_16x16x32_bf16 v[104:107], v[48:51], a[224:227], v[104:107]
    v_mfma_f32_16x16x32_bf16 v[108:111], v[48:51], v[240:243], v[108:111]
    v_mfma_f32_16x16x32_bf16 v[112:115], v[52:55], a[64:67], v[112:115]
    v_mfma_f32_16x16x32_bf16 v[116:119], v[52:55], a[144:147], v[116:119]
    v_mfma_f32_16x16x32_bf16 v[120:123], v[52:55], a[224:227], v[120:123]
    v_mfma_f32_16x16x32_bf16 v[124:127], v[52:55], v[240:243], v[124:127]
    ds_read_b128 v[48:51], v2 offset:19456
    ds_read_b128 v[52:55], v2 offset:39936
    s_waitcnt lgkmcnt(4)
    v_mfma_f32_16x16x32_bf16 v[96:99], v[56:59], a[68:71], v[96:99]
    v_mfma_f32_16x16x32_bf16 v[100:103], v[56:59], a[148:151], v[100:103]
    v_mfma_f32_16x16x32_bf16 v[104:107], v[56:59], a[228:231], v[104:107]
    v_mfma_f32_16x16x32_bf16 v[108:111], v[56:59], v[244:247], v[108:111]
    v_mfma_f32_16x16x32_bf16 v[112:115], v[60:63], a[68:71], v[112:115]
    v_mfma_f32_16x16x32_bf16 v[116:119], v[60:63], a[148:151], v[116:119]
    v_mfma_f32_16x16x32_bf16 v[120:123], v[60:63], a[228:231], v[120:123]
    v_mfma_f32_16x16x32_bf16 v[124:127], v[60:63], v[244:247], v[124:127]
    s_waitcnt lgkmcnt(2)
    v_mfma_f32_16x16x32_bf16 v[96:99], v[40:43], a[72:75], v[96:99]
    v_mfma_f32_16x16x32_bf16 v[100:103], v[40:43], a[152:155], v[100:103]
    v_mfma_f32_16x16x32_bf16 v[104:107], v[40:43], a[232:235], v[104:107]
    v_mfma_f32_16x16x32_bf16 v[108:111], v[40:43], v[248:251], v[108:111]
    v_mfma_f32_16x16x32_bf16 v[112:115], v[44:47], a[72:75], v[112:115]
    v_mfma_f32_16x16x32_bf16 v[116:119], v[44:47], a[152:155], v[116:119]
    v_mfma_f32_16x16x32_bf16 v[120:123], v[44:47], a[232:235], v[120:123]
    v_mfma_f32_16x16x32_bf16 v[124:127], v[44:47], v[248:251], v[124:127]
    s_waitcnt lgkmcnt(0)
    v_mfma_f32_16x16x32_bf16 v[96:99], v[48:51], a[76:79], v[96:99]
    v_mfma_f32_16x16x32_bf16 v[100:103], v[48:51], a[156:159], v[100:103]
    v_mfma_f32_16x16x32_bf16 v[104:107], v[48:51], a[236:239], v[104:107]
    v_mfma_f32_16x16x32_bf16 v[108:111], v[48:51], v[252:255], v[108:111]
    v_mfma_f32_16x16x32_bf16 v[112:115], v[52:55], a[76:79], v[112:115]
    v_mfma_f32_16x16x32_bf16 v[116:119], v[52:55], a[156:159], v[116:119]
    v_mfma_f32_16x16x32_bf16 v[120:123], v[52:55], a[236:239], v[120:123]
    v_mfma_f32_16x16x32_bf16 v[124:127], v[52:55], v[252:255], v[124:127]
    v_xor_b32 v2, 0xa000, v2
    s_add_u32 s66, s66, 1
    s_cmp_eq_u32 s66, s12
    s_cbranch_scc1 L_g_end_130
    s_waitcnt vmcnt(0)
    s_barrier
    s_cmp_lg_u32 s64, 1
    s_cbranch_scc1 L_fs_131
    v_mov_b32 v84, s66
    v_mov_b32 v85, 0
    s_mov_b64 exec, 1
    buffer_store_dword v84, v85, s[48:51], s80 offen sc1
    s_mov_b64 exec, -1
L_fs_131:
    s_add_u32 s78, s78, 40960
    s_mul_i32 s79, s64, 10240
    s_add_u32 s79, s79, 40960
    ds_read_b128 v[40:43], v2 offset:0
    ds_read_b128 v[44:47], v2 offset:20480
    ds_read_b128 v[48:51], v2 offset:1024
    ds_read_b128 v[52:55], v2 offset:21504
    ds_read_b128 v[56:59], v2 offset:2048
    ds_read_b128 v[60:63], v2 offset:22528
    s_waitcnt lgkmcnt(4)
    v_mfma_f32_16x16x32_bf16 v[8:11], v[40:43], a[0:3], 0
    v_mfma_f32_16x16x32_bf16 v[12:15], v[40:43], a[80:83], 0
    v_mfma_f32_16x16x32_bf16 v[16:19], v[40:43], a[160:163], 0
    v_mfma_f32_16x16x32_bf16 v[20:23], v[40:43], a[240:243], 0
    v_mfma_f32_16x16x32_bf16 v[24:27], v[44:47], a[0:3], 0
    v_mfma_f32_16x16x32_bf16 v[28:31], v[44:47], a[80:83], 0
    v_mfma_f32_16x16x32_bf16 v[32:35], v[44:47], a[160:163], 0
    v_mfma_f32_16x16x32_bf16 v[36:39], v[44:47], a[240:243], 0
    ds_read_b128 v[40:43], v2 offset:3072
    ds_read_b128 v[44:47], v2 offset:23552
    s_waitcnt lgkmcnt(4)
    v_mfma_f32_16x16x32_bf16 v[8:11], v[48:51], a[4:7], v[8:11]
    v_cvt_pk_bf16_f32 v64, v96, v97
    v_mfma_f32_16x16x32_bf16 v[12:15], v[48:51], a[84:87], v[12:15]
    v_cvt_pk_bf16_f32 v65, v98, v99
    v_mfma_f32_16x16x32_bf16 v[16:19], v[48:51], a[164:167], v[16:19]
    v_cvt_pk_bf16_f32 v66, v112, v113
    v_mfma_f32_16x16x32_bf16 v[20:23], v[48:51], a[244:247], v[20:23]
    v_cvt_pk_bf16_f32 v67, v114, v115
    v_mfma_f32_16x16x32_bf16 v[24:27], v[52:55], a[4:7], v[24:27]
    buffer_store_dwordx4 v[64:67], v1, s[48:51], s74 offen offset:0 sc1
    v_mfma_f32_16x16x32_bf16 v[28:31], v[52:55], a[84:87], v[28:31]
    v_cvt_pk_bf16_f32 v68, v100, v101
    v_mfma_f32_16x16x32_bf16 v[32:35], v[52:55], a[164:167], v[32:35]
    v_cvt_pk_bf16_f32 v69, v102, v103
    v_mfma_f32_16x16x32_bf16 v[36:39], v[52:55], a[244:247], v[36:39]
    v_cvt_pk_bf16_f32 v70, v116, v117
    ds_read_b128 v[48:51], v2 offset:4096
    ds_read_b128 v[52:55], v2 offset:24576
    s_waitcnt lgkmcnt(4)
    v_mfma_f32_16x16x32_bf16 v[8:11], v[56:59], a[8:11], v[8:11]
    v_cvt_pk_bf16_f32 v71, v118, v119
    v_mfma_f32_16x16x32_bf16 v[12:15], v[56:59], a[88:91], v[12:15]
    buffer_store_dwordx4 v[68:71], v1, s[48:51], s74 offen offset:1024 sc1
    v_mfma_f32_16x16x32_bf16 v[16:19], v[56:59], a[168:171], v[16:19]
    v_cvt_pk_bf16_f32 v72, v104, v105
    v_mfma_f32_16x16x32_bf16 v[20:23], v[56:59], a[248:251], v[20:23]
    v_cvt_pk_bf16_f32 v73, v106, v107
    v_mfma_f32_16x16x32_bf16 v[24:27], v[60:63], a[8:11], v[24:27]
    v_cvt_pk_bf16_f32 v74, v120, v121
    v_mfma_f32_16x16x32_bf16 v[28:31], v[60:63], a[88:91], v[28:31]
    v_cvt_pk_bf16_f32 v75, v122, v123
    v_mfma_f32_16x16x32_bf16 v[32:35], v[60:63], a[168:171], v[32:35]
    buffer_store_dwordx4 v[72:75], v1, s[48:51], s74 offen offset:2048 sc1
    v_mfma_f32_16x16x32_bf16 v[36:39], v[60:63], a[248:251], v[36:39]
    v_cvt_pk_bf16_f32 v76, v108, v109
    ds_read_b128 v[56:59], v2 offset:5120
    ds_read_b128 v[60:63], v2 offset:25600
    s_waitcnt lgkmcnt(4)
    v_mfma_f32_16x16x32_bf16 v[8:11], v[40:43], a[12:15], v[8:11]
    v_cvt_pk_bf16_f32 v77, v110, v111
    v_mfma_f32_16x16x32_bf16 v[12:15], v[40:43], a[92:95], v[12:15]
    v_cvt_pk_bf16_f32 v78, v124, v125
    v_mfma_f32_16x16x32_bf16 v[16:19], v[40:43], a[172:175], v[16:19]
    v_cvt_pk_bf16_f32 v79, v126, v127
    v_mfma_f32_16x16x32_bf16 v[20:23], v[40:43], a[252:255], v[20:23]
    buffer_store_dwordx4 v[76:79], v1, s[48:51], s74 offen offset:3072 sc1
    s_add_u32 s74, s74, 16384
    v_mfma_f32_16x16x32_bf16 v[24:27], v[44:47], a[12:15], v[24:27]
    v_mfma_f32_16x16x32_bf16 v[28:31], v[44:47], a[92:95], v[28:31]
    v_mfma_f32_16x16x32_bf16 v[32:35], v[44:47], a[172:175], v[32:35]
    v_mfma_f32_16x16x32_bf16 v[36:39], v[44:47], a[252:255], v[36:39]
    ds_read_b128 v[40:43], v2 offset:6144
    ds_read_b128 v[44:47], v2 offset:26624
    s_waitcnt lgkmcnt(4)
    v_mfma_f32_16x16x32_bf16 v[8:11], v[48:51], a[16:19], v[8:11]
    v_mfma_f32_16x16x32_bf16 v[12:15], v[48:51], a[96:99], v[12:15]
    v_mfma_f32_16x16x32_bf16 v[16:19], v[48:51], a[176:179], v[16:19]
    v_mfma_f32_16x16x32_bf16 v[20:23], v[48:51], v[192:195], v[20:23]
    v_mfma_f32_16x16x32_bf16 v[24:27], v[52:55], a[16:19], v[24:27]
    v_mfma_f32_16x16x32_bf16 v[28:31], v[52:55], a[96:99], v[28:31]
    v_mfma_f32_16x16x32_bf16 v[32:35], v[52:55], a[176:179], v[32:35]
    v_mfma_f32_16x16x32_bf16 v[36:39], v[52:55], v[192:195], v[36:39]
    ds_read_b128 v[48:51], v2 offset:7168
    ds_read_b128 v[52:55], v2 offset:27648
    s_waitcnt lgkmcnt(4)
    v_mfma_f32_16x16x32_bf16 v[8:11], v[56:59], a[20:23], v[8:11]
    v_mfma_f32_16x16x32_bf16 v[12:15], v[56:59], a[100:103], v[12:15]
    v_mfma_f32_16x16x32_bf16 v[16:19], v[56:59], a[180:183], v[16:19]
    v_mfma_f32_16x16x32_bf16 v[20:23], v[56:59], v[196:199], v[20:23]
    v_mfma_f32_16x16x32_bf16 v[24:27], v[60:63], a[20:23], v[24:27]
    v_mfma_f32_16x16x32_bf16 v[28:31], v[60:63], a[100:103], v[28:31]
    v_mfma_f32_16x16x32_bf16 v[32:35], v[60:63], a[180:183], v[32:35]
    v_mfma_f32_16x16x32_bf16 v[36:39], v[60:63], v[196:199], v[36:39]
    ds_read_b128 v[56:59], v2 offset:8192
    ds_read_b128 v[60:63], v2 offset:28672
    s_waitcnt lgkmcnt(4)
    v_mfma_f32_16x16x32_bf16 v[8:11], v[40:43], a[24:27], v[8:11]
    v_mfma_f32_16x16x32_bf16 v[12:15], v[40:43], a[104:107], v[12:15]
    s_add_u32 m0, s79, 0
    s_add_u32 s85, s78, 0
    buffer_load_dwordx4 v1, s[48:51], s85 offen offset:0 sc1 lds
    v_mfma_f32_16x16x32_bf16 v[16:19], v[40:43], a[184:187], v[16:19]
    v_mfma_f32_16x16x32_bf16 v[20:23], v[40:43], v[200:203], v[20:23]
    v_mfma_f32_16x16x32_bf16 v[24:27], v[44:47], a[24:27], v[24:27]
    v_mfma_f32_16x16x32_bf16 v[28:31], v[44:47], a[104:107], v[28:31]
    v_mfma_f32_16x16x32_bf16 v[32:35], v[44:47], a[184:187], v[32:35]
    v_mfma_f32_16x16x32_bf16 v[36:39], v[44:47], v[200:203], v[36:39]
    ds_read_b128 v[40:43], v2 offset:9216
    ds_read_b128 v[44:47], v2 offset:29696
    s_waitcnt lgkmcnt(4)
    v_mfma_f32_16x16x32_bf16 v[8:11], v[48:51], a[28:31], v[8:11]
    v_mfma_f32_16x16x32_bf16 v[12:15], v[48:51], a[108:111], v[12:15]
    buffer_load_dwordx4 v1, s[48:51], s85 offen offset:1024 sc1 lds
    v_mfma_f32_16x16x32_bf16 v[16:19], v[48:51], a[188:191], v[16:19]
    v_mfma_f32_16x16x32_bf16 v[20:23], v[48:51], v[204:207], v[20:23]
    v_mfma_f32_16x16x32_bf16 v[24:27], v[52:55], a[28:31], v[24:27]
    v_mfma_f32_16x16x32_bf16 v[28:31], v[52:55], a[108:111], v[28:31]
    v_mfma_f32_16x16x32_bf16 v[32:35], v[52:55], a[188:191], v[32:35]
    v_mfma_f32_16x16x32_bf16 v[36:39], v[52:55], v[204:207], v[36:39]
    ds_read_b128 v[48:51], v2 offset:10240
    ds_read_b128 v[52:55], v2 offset:30720
    s_waitcnt lgkmcnt(4)
    v_mfma_f32_16x16x32_bf16 v[8:11], v[56:59], a[32:35], v[8:11]
    v_mfma_f32_16x16x32_bf16 v[12:15], v[56:59], a[112:115], v[12:15]
    buffer_load_dwordx4 v1, s[48:51], s85 offen offset:2048 sc1 lds
    v_mfma_f32_16x16x32_bf16 v[16:19], v[56:59], a[192:195], v[16:19]
    v_mfma_f32_16x16x32_bf16 v[20:23], v[56:59], v[208:211], v[20:23]
    v_mfma_f32_16x16x32_bf16 v[24:27], v[60:63], a[32:35], v[24:27]
    v_mfma_f32_16x16x32_bf16 v[28:31], v[60:63], a[112:115], v[28:31]
    v_mfma_f32_16x16x32_bf16 v[32:35], v[60:63], a[192:195], v[32:35]
    v_mfma_f32_16x16x32_bf16 v[36:39], v[60:63], v[208:211], v[36:39]
    ds_read_b128 v[56:59], v2 offset:11264
    ds_read_b128 v[60:63], v2 offset:31744
    s_waitcnt lgkmcnt(4)
    v_mfma_f32_16x16x32_bf16 v[8:11], v[40:43], a[36:39], v[8:11]
    v_mfma_f32_16x16x32_bf16 v[12:15], v[40:43], a[116:119], v[12:15]
    buffer_load_dwordx4 v1, s[48:51], s85 offen offset:3072 sc1 lds
    v_mfma_f32_16x16x32_bf16 v[16:19], v[40:43], a[196:199], v[16:19]
    v_mfma_f32_16x16x32_bf16 v[20:23], v[40:43], v[212:215], v[20:23]
    v_mfma_f32_16x16x32_bf16 v[24:27], v[44:47], a[36:39], v[24:27]
    v_mfma_f32_16x16x32_bf16 v[28:31], v[44:47], a[116:119], v[28:31]
    v_mfma_f32_16x16x32_bf16 v[32:35], v[44:47], a[196:199], v[32:35]
    v_mfma_f32_16x16x32_bf16 v[36:39], v[44:47], v[212:215], v[36:39]
    ds_read_b128 v[40:43], v2 offset:12288
    ds_read_b128 v[44:47], v2 offset:32768
    s_waitcnt lgkmcnt(4)
    v_mfma_f32_16x16x32_bf16 v[8:11], v[48:51], a[40:43], v[8:11]
    v_mfma_f32_16x16x32_bf16 v[12:15], v[48:51], a[120:123], v[12:15]
    s_add_u32 m0, s79, 4096
    s_add_u32 s85, s78, 4096
    buffer_load_dwordx4 v1, s[48:51], s85 offen offset:0 sc1 lds
    v_mfma_f32_16x16x32_bf16 v[16:19], v[48:51], a[200:203], v[16:19]
    v_mfma_f32_16x16x32_bf16 v[20:23], v[48:51], v[216:219], v[20:23]
    v_mfma_f32_16x16x32_bf16 v[24:27], v[52:55], a[40:43], v[24:27]
    v_mfma_f32_16x16x32_bf16 v[28:31], v[52:55], a[120:123], v[28:31]
    v_mfma_f32_16x16x32_bf16 v[32:35], v[52:55], a[200:203], v[32:35]
    v_mfma_f32_16x16x32_bf16 v[36:39], v[52:55], v[216:219], v[36:39]
    ds_read_b128 v[48:51], v2 offset:13312
    ds_read_b128 v[52:55], v2 offset:33792
    s_waitcnt lgkmcnt(4)
    v_mfma_f32_16x16x32_bf16 v[8:11], v[56:59], a[44:47], v[8:11]
    v_mfma_f32_16x16x32_bf16 v[12:15], v[56:59], a[124:127], v[12:15]
    buffer_load_dwordx4 v1, s[48:51], s85 offen offset:1024 sc1 lds
    v_mfma_f32_16x16x32_bf16 v[16:19], v[56:59], a[204:207], v[16:19]
    v_mfma_f32_16x16x32_bf16 v[20:23], v[56:59], v[220:223], v[20:23]
    v_mfma_f32_16x16x32_bf16 v[24:27], v[60:63], a[44:47], v[24:27]
    v_mfma_f32_16x16x32_bf16 v[28:31], v[60:63], a[124:127], v[28:31]
    v_mfma_f32_16x16x32_bf16 v[32:35], v[60:63], a[204:207], v[32:35]
    v_mfma_f32_16x16x32_bf16 v[36:39], v[60:63], v[220:223], v[36:39]
    ds_read_b128 v[56:59], v2 offset:14336
    ds_read_b128 v[60:63], v2 offset:34816
    s_waitcnt lgkmcnt(4)
    v_mfma_f32_16x16x32_bf16 v[8:11], v[40:43], a[48:51], v[8:11]
    v_mfma_f32_16x16x32_bf16 v[12:15], v[40:43], a[128:131], v[12:15]
    buffer_load_dwordx4 v1, s[48:51], s85 offen offset:2048 sc1 lds
    v_mfma_f32_16x16x32_bf16 v[16:19], v[40:43], a[208:211], v[16:19]
    v_mfma_f32_16x16x32_bf16 v[20:23], v[40:43], v[224:227], v[20:23]
    v_mfma_f32_16x16x32_bf16 v[24:27], v[44:47], a[48:51], v[24:27]
    v_mfma_f32_16x16x32_bf16 v[28:31], v[44:47], a[128:131], v[28:31]
    v_mfma_f32_16x16x32_bf16 v[32:35], v[44:47], a[208:211], v[32:35]
    v_mfma_f32_16x16x32_bf16 v[36:39], v[44:47], v[224:227], v[36:39]
    ds_read_b128 v[40:43], v2 offset:15360
    ds_read_b128 v[44:47], v2 offset:35840
    s_waitcnt lgkmcnt(4)
    v_mfma_f32_16x16x32_bf16 v[8:11], v[48:51], a[52:55], v[8:11]
    v_mfma_f32_16x16x32_bf16 v[12:15], v[48:51], a[132:135], v[12:15]
    buffer_load_dwordx4 v1, s[48:51], s85 offen offset:3072 sc1 lds
    v_mfma_f32_16x16x32_bf16 v[16:19], v[48:51], a[212:215], v[16:19]
    v_mfma_f32_16x16x32_bf16 v[20:23], v[48:51], v[228:231], v[20:23]
    v_mfma_f32_16x16x32_bf16 v[24:27], v[52:55], a[52:55], v[24:27]
    v_mfma_f32_16x16x32_bf16 v[28:31], v[52:55], a[132:135], v[28:31]
    v_mfma_f32_16x16x32_bf16 v[32:35], v[52:55], a[212:215], v[32:35]
    v_mfma_f32_16x16x32_bf16 v[36:39], v[52:55], v[228:231], v[36:39]
    ds_read_b128 v[48:51], v2 offset:16384
    ds_read_b128 v[52:55], v2 offset:36864
    s_waitcnt lgkmcnt(4)
    v_mfma_f32_16x16x32_bf16 v[8:11], v[56:59], a[56:59], v[8:11]
    v_mfma_f32_16x16x32_bf16 v[12:15], v[56:59], a[136:139], v[12:15]
    s_add_u32 m0, s79, 8192
    s_add_u32 s85, s78, 8192
    buffer_load_dwordx4 v1, s[48:51], s85 offen offset:0 sc1 lds
    v_mfma_f32_16x16x32_bf16 v[16:19], v[56:59], a[216:219], v[16:19]
    v_mfma_f32_16x16x32_bf16 v[20:23], v[56:59], v[232:235], v[20:23]
    v_mfma_f32_16x16x32_bf16 v[24:27], v[60:63], a[56:59], v[24:27]
    v_mfma_f32_16x16x32_bf16 v[28:31], v[60:63], a[136:139], v[28:31]
    v_mfma_f32_16x16x32_bf16 v[32:35], v[60:63], a[216:219], v[32:35]
    v_mfma_f32_16x16x32_bf16 v[36:39], v[60:63], v[232:235], v[36:39]
    ds_read_b128 v[56:59], v2 offset:17408
    ds_read_b128 v[60:63], v2 offset:37888
    s_waitcnt lgkmcnt(4)
    v_mfma_f32_16x16x32_bf16 v[8:11], v[40:43], a[60:63], v[8:11]
    v_mfma_f32_16x16x32_bf16 v[12:15], v[40:43], a[140:143], v[12:15]
    buffer_load_dwordx4 v1, s[48:51], s85 offen offset:1024 sc1 lds
    v_mfma_f32_16x16x32_bf16 v[16:19], v[40:43], a[220:223], v[16:19]
    v_mfma_f32_16x16x32_bf16 v[20:23], v[40:43], v[236:239], v[20:23]
    v_mfma_f32_16x16x32_bf16 v[24:27], v[44:47], a[60:63], v[24:27]
    v_mfma_f32_16x16x32_bf16 v[28:31], v[44:47], a[140:143], v[28:31]
    v_mfma_f32_16x16x32_bf16 v[32:35], v[44:47], a[220:223], v[32:35]
    v_mfma_f32_16x16x32_bf16 v[36:39], v[44:47], v[236:239], v[36:39]
    ds_read_b128 v[40:43], v2 offset:18432
    ds_read_b128 v[44:47], v2 offset:38912
    s_waitcnt lgkmcnt(4)
    v_mfma_f32_16x16x32_bf16 v[8:11], v[48:51], a[64:67], v[8:11]
    v_mfma_f32_16x16x32_bf16 v[12:15], v[48:51], a[144:147], v[12:15]
    v_mfma_f32_16x16x32_bf16 v[16:19], v[48:51], a[224:227], v[16:19]
    v_mfma_f32_16x16x32_bf16 v[20:23], v[48:51], v[240:243], v[20:23]
    v_mfma_f32_16x16x32_bf16 v[24:27], v[52:55], a[64:67], v[24:27]
    v_mfma_f32_16x16x32_bf16 v[28:31], v[52:55], a[144:147], v[28:31]
    v_mfma_f32_16x16x32_bf16 v[32:35], v[52:55], a[224:227], v[32:35]
    v_mfma_f32_16x16x32_bf16 v[36:39], v[52:55], v[240:243], v[36:39]
    ds_read_b128 v[48:51], v2 offset:19456
    ds_read_b128 v[52:55], v2 offset:39936
    s_waitcnt lgkmcnt(4)
    v_mfma_f32_16x16x32_bf16 v[8:11], v[56:59], a[68:71], v[8:11]
    v_mfma_f32_16x16x32_bf16 v[12:15], v[56:59], a[148:151], v[12:15]
    v_mfma_f32_16x16x32_bf16 v[16:19], v[56:59], a[228:231], v[16:19]
    v_mfma_f32_16x16x32_bf16 v[20:23], v[56:59], v[244:247], v[20:23]
    v_mfma_f32_16x16x32_bf16 v[24:27], v[60:63], a[68:71], v[24:27]
    v_mfma_f32_16x16x32_bf16 v[28:31], v[60:63], a[148:151], v[28:31]
    v_mfma_f32_16x16x32_bf16 v[32:35], v[60:63], a[228:231], v[32:35]
    v_mfma_f32_16x16x32_bf16 v[36:39], v[60:63], v[244:247], v[36:39]
    s_waitcnt lgkmcnt(2)
    v_mfma_f32_16x16x32_bf16 v[8:11], v[40:43], a[72:75], v[8:11]
    v_mfma_f32_16x16x32_bf16 v[12:15], v[40:43], a[152:155], v[12:15]
    v_mfma_f32_16x16x32_bf16 v[16:19], v[40:43], a[232:235], v[16:19]
    v_mfma_f32_16x16x32_bf16 v[20:23], v[40:43], v[248:251], v[20:23]
    v_mfma_f32_16x16x32_bf16 v[24:27], v[44:47], a[72:75], v[24:27]
    v_mfma_f32_16x16x32_bf16 v[28:31], v[44:47], a[152:155], v[28:31]
    v_mfma_f32_16x16x32_bf16 v[32:35], v[44:47], a[232:235], v[32:35]
    v_mfma_f32_16x16x32_bf16 v[36:39], v[44:47], v[248:251], v[36:39]
    s_waitcnt lgkmcnt(0)
    v_mfma_f32_16x16x32_bf16 v[8:11], v[48:51], a[76:79], v[8:11]
    v_mfma_f32_16x16x32_bf16 v[12:15], v[48:51], a[156:159], v[12:15]
    v_mfma_f32_16x16x32_bf16 v[16:19], v[48:51], a[236:239], v[16:19]
    v_mfma_f32_16x16x32_bf16 v[20:23], v[48:51], v[252:255], v[20:23]
    v_mfma_f32_16x16x32_bf16 v[24:27], v[52:55], a[76:79], v[24:27]
    v_mfma_f32_16x16x32_bf16 v[28:31], v[52:55], a[156:159], v[28:31]
    v_mfma_f32_16x16x32_bf16 v[32:35], v[52:55], a[236:239], v[32:35]
    v_mfma_f32_16x16x32_bf16 v[36:39], v[52:55], v[252:255], v[36:39]
    v_xor_b32 v2, 0xa000, v2
    s_add_u32 s66, s66, 1
    s_branch L_g_top_125
L_g_end_130:
    s_nop 7
    v_cvt_pk_bf16_f32 v64, v96, v97
    v_cvt_pk_bf16_f32 v65, v98, v99
    v_cvt_pk_bf16_f32 v66, v112, v113
    v_cvt_pk_bf16_f32 v67, v114, v115
    buffer_store_dwordx4 v[64:67], v1, s[48:51], s74 offen offset:0 sc1
    v_cvt_pk_bf16_f32 v68, v100, v101
    v_cvt_pk_bf16_f32 v69, v102, v103
    v_cvt_pk_bf16_f32 v70, v116, v117
    v_cvt_pk_bf16_f32 v71, v118, v119
    buffer_store_dwordx4 v[68:71], v1, s[48:51], s74 offen offset:1024 sc1
    v_cvt_pk_bf16_f32 v72, v104, v105
    v_cvt_pk_bf16_f32 v73, v106, v107
    v_cvt_pk_bf16_f32 v74, v120, v121
    v_cvt_pk_bf16_f32 v75, v122, v123
    buffer_store_dwordx4 v[72:75], v1, s[48:51], s74 offen offset:2048 sc1
    v_cvt_pk_bf16_f32 v76, v108, v109
    v_cvt_pk_bf16_f32 v77, v110, v111
    v_cvt_pk_bf16_f32 v78, v124, v125
    v_cvt_pk_bf16_f32 v79, v126, v127
    buffer_store_dwordx4 v[76:79], v1, s[48:51], s74 offen offset:3072 sc1
    s_add_u32 s74, s74, 16384
    s_add_u32 s66, s66, 1
    s_waitcnt vmcnt(0)
    s_barrier
    s_cmp_lg_u32 s64, 1
    s_cbranch_scc1 L_fs_132
    v_mov_b32 v84, s66
    v_mov_b32 v85, 0
    s_mov_b64 exec, 1
    buffer_store_dword v84, v85, s[48:51], s80 offen sc1
    s_mov_b64 exec, -1
L_fs_132:
    s_and_b32 s84, s72, 15
    s_mul_i32 s84, s84, 5
    s_lshr_b32 s83, s72, 4
    s_add_u32 s83, s83, 34
    s_mov_b32 s10, 5
    s_mov_b32 s11, 58
    s_movk_i32 s12, 999
    s_branch K2_PR5
K2_PR1:
    s_sub_u32 s72, s65, 112
    s_mov_b32 s83, 61
    s_waitcnt vmcnt(0)
    s_barrier
    s_mov_b32 s52, s16
    s_mov_b32 s53, s17
    s_mov_b32 s54, 0x280000
    s_mov_b32 s55, 0x20000
    s_mov_b32 s56, s42
    s_mov_b32 s57, s43
    s_mov_b32 s58, 0x280000
    s_mov_b32 s59, 0x20000
    s_cmp_lg_u32 s64, 1
    s_cbranch_scc1 L_waok_134
    v_min_u32 v9, 19, v0
    v_lshlrev_b32 v9, 2, v9
    v_add_u32 v9, 0x603e00, v9
L_wa_133:
    buffer_load_dword v8, v9, s[48:51], 0 offen sc1
    s_waitcnt vmcnt(0)
    v_cmp_gt_u32 vcc, 1, v8
    s_cbranch_vccz L_waok_134
    s_sleep 12
    s_sub_u32 s67, s67, 1
    s_cbranch_scc1 K2_DONE
    s_branch L_wa_133
L_waok_134:
    s_barrier
    s_mov_b32 s82, s83
    s_mov_b32 s80, 0x607200
    v_and_b32 v8, 7, v0
    v_lshlrev_b32 v8, 2, v8
    buffer_load_dword v9, v8, s[48:51], s80 offen sc1
    s_waitcnt vmcnt(0)
    v_readlane_b32 s20, v9, 0
    v_readlane_b32 s21, v9, 1
    v_readlane_b32 s22, v9, 2
    v_readlane_b32 s23, v9, 3
    v_readlane_b32 s24, v9, 4
    v_readlane_b32 s25, v9, 5
    v_readlane_b32 s26, v9, 6
    v_readlane_b32 s27, v9, 7
    v_and_b32 v8, 7, v0
    v_bfe_u32 v9, v0, 3, 1
    v_lshrrev_b32 v10, 4, v0
    v_mul_u32_u24 v11, 640, v9
    v_lshl_add_u32 v12, v8, 4, v11
    v_lshl_add_u32 v2, v10, 7, v12
    v_lshrrev_b32 v12, 1, v10
    v_mul_u32_u24 v12, 1280, v12
    v_add3_u32 v12, v12, v11, 0
    v_lshl_add_u32 v12, v8, 4, v12
    v_and_b32 v13, 1, v10
    v_lshl_add_u32 v12, v13, 3, v12
    v_add_u32 v3, 512, v12
    v_lshlrev_b32 v13, 2, v13
    v_add_u32 v13, s64, v13
    v_xor_b32 v13, v13, v8
    v_lshl_add_u32 v13, v8, 3, v13
    v_lshlrev_b32 v13, 4, v13
    v_lshl_add_u32 v13, v9, 10, v13
    v_add_u32 v4, 81920, v13
    v_lshrrev_b32 v8, 3, v0
    v_xor_b32 v5, v8, v0
    v_lshlrev_b32 v5, 4, v5
    v_add_u32 v5, 81920, v5
    s_lshl_b32 s80, s64, 11
    v_add_u32 v5, s80, v5
    v_mul_u32_u24 v10, 1280, v8
    v_bfe_u32 v9, v0, 2, 1
    v_lshl_add_u32 v6, v9, 3, v10
    v_lshlrev_b32 v7, 2, v8
    v_and_b32 v8, 7, v0
    v_min_u32 v8, 0, v8
    v_add_u32 v8, s72, v8
    v_lshlrev_b32 v8, 7, v8
    v_add_u32 v9, 0x604000, v8
    v_add_u32 v8, 0x601000, v8
    v_cmp_gt_u32 vcc, 48, v0
    v_lshlrev_b32 v10, 2, v0
    v_add_u32 v10, 0x607000, v10
    v_cndmask_b32 v8, v8, v9, vcc
    v_cmp_gt_u32 vcc, 32, v0
    s_mov_b32 s78, 0
    s_mov_b64 s[8:9], 0
    v_cndmask_b32 v203, v8, v10, vcc
    v_mov_b32 v216, v8
    s_mov_b32 s4, 0xff00ff
    s_mov_b32 s5, 0xff00ff00
    s_mov_b32 s6, 0x1010101
    s_mov_b32 s7, 0x1010101
    s_add_u32 s32, s65, 0
    s_and_b32 s32, s32, 3
    s_lshl_b32 s32, s32, 11
    s_add_u32 s33, s65, 1
    s_and_b32 s33, s33, 3
    s_lshl_b32 s33, s33, 11
    s_add_u32 s34, s65, 2
    s_and_b32 s34, s34, 3
    s_lshl_b32 s34, s34, 11
    s_add_u32 s35, s65, 3
    s_and_b32 s35, s35, 3
    s_lshl_b32 s35, s35, 11
    s_waitcnt lgkmcnt(0)
    s_lshr_b32 s80, s20, 5
    s_bitset1_b64 s[8:9], s80
    s_lshr_b32 s80, s21, 5
    s_bitset1_b64 s[8:9], s80
    s_lshr_b32 s80, s22, 5
    s_bitset1_b64 s[8:9], s80
    s_lshr_b32 s80, s23, 5
    s_bitset1_b64 s[8:9], s80
    s_lshr_b32 s80, s24, 5
    s_bitset1_b64 s[8:9], s80
    s_lshr_b32 s80, s25, 5
    s_bitset1_b64 s[8:9], s80
    s_lshr_b32 s80, s26, 5
    s_bitset1_b64 s[8:9], s80
    s_lshr_b32 s80, s27, 5
    s_bitset1_b64 s[8:9], s80
    s_cmp_ge_u32 s82, 64
    s_cbranch_scc1 K2_DONE
    s_mul_i32 s73, s72, 0x101000
    s_lshl_b32 s80, s82, 2
    s_add_u32 s80, s80, s64
    s_lshl_b32 s81, s80, 12
    s_add_u32 s73, s73, s81
    s_add_u32 s73, s73, 0x8100000
    s_mul_i32 s74, s72, 0x41000
    s_lshl_b32 s81, s80, 10
    s_add_u32 s74, s74, s81
    s_add_u32 s74, s74, 0x3a00000
    s_mul_i32 s76, s80, 10240
    s_lshl_b32 s81, s72, 4
    s_add_u32 s76, s76, s81
    s_lshl_b32 s77, s80, 5
    s_add_u32 s77, s77, 0x60a000
    s_mul_i32 s75, s82, 81920
    s_mul_i32 s81, s64, 5120
    s_add_u32 s75, s75, s81
    s_add_u32 s75, s75, 0xa00000
    s_add_u32 s79, s82, 1
    s_min_u32 s79, s79, 63
    s_mov_b32 s30, 0
    v_mov_b32 v217, v216
    buffer_load_dwordx2 v[204:205], v6, s[52:55], s76 offen offset:0
    buffer_load_dword v214, v7, s[48:51], s77 offen sc1
    s_add_u32 s81, s73, 0x0
    buffer_load_dwordx4 a[0:3], v1, s[48:51], s81 offen offset:0 sc1
    buffer_load_dwordx4 a[4:7], v1, s[48:51], s81 offen offset:1024 sc1
    buffer_load_dwordx4 a[8:11], v1, s[48:51], s81 offen offset:2048 sc1
    buffer_load_dwordx4 a[12:15], v1, s[48:51], s81 offen offset:3072 sc1
    s_cmp_lg_u32 s64, 1
    s_cbranch_scc1 L_pr_ok_140
    s_cmp_ge_u32 s78, s79
    s_cbranch_scc1 L_pr_hit_142
L_pr_fp_139:
    buffer_load_dword v12, v217, s[48:51], 0 offen sc1
    s_waitcnt vmcnt(0)
    s_nop 1
    v_min_u32_dpp v12, v12, v12 quad_perm:[1,0,3,2] row_mask:0xf bank_mask:0xf
    s_nop 1
    v_min_u32_dpp v12, v12, v12 quad_perm:[2,3,0,1] row_mask:0xf bank_mask:0xf
    s_nop 1
    v_min_u32_dpp v12, v12, v12 row_half_mirror row_mask:0xf bank_mask:0xf
    s_nop 1
    v_min_u32_dpp v12, v12, v12 row_mirror row_mask:0xf bank_mask:0xf
    s_nop 0
    v_readlane_b32 s78, v12, 0
    v_readlane_b32 s80, v12, 16
    v_readlane_b32 s81, v12, 32
    v_readlane_b32 s31, v12, 48
    s_min_u32 s78, s78, s80
    s_min_u32 s81, s81, s31
    s_min_u32 s78, s78, s81
    s_cmp_ge_u32 s78, s79
    s_cbranch_scc1 L_pr_hit_142
    s_sleep 4
    s_add_u32 s80, s78, 1
    s_cmp_ge_u32 s80, s79
    s_cbranch_scc1 L_pr_far_141
    s_sleep 64
L_pr_far_141:
    s_sub_u32 s67, s67, 1
    s_cbranch_scc1 K2_DONE
    s_branch L_pr_fp_139
L_pr_hit_142:
    s_cmp_lt_u32 s82, 62
    s_cbranch_scc1 L_pr_ok_140
    s_cmp_lg_u32 s30, 0
    s_cbranch_scc1 L_pr_ok_140
    s_mov_b32 s30, 1
    s_add_u32 s79, s82, 1
    v_mov_b32 v217, v203
    s_branch L_pr_fp_139
L_pr_ok_140:
    s_barrier
    s_mul_i32 s81, s32, 10
    s_add_u32 s81, s81, s75
    buffer_load_dwordx4 v[32:35], v2, s[48:51], s81 offen offset:0 sc1
    buffer_load_dwordx4 v[36:39], v2, s[48:51], s81 offen offset:1280 sc1
    buffer_load_dwordx4 v[40:43], v2, s[48:51], s81 offen offset:2560 sc1
    buffer_load_dwordx4 v[44:47], v2, s[48:51], s81 offen offset:3840 sc1
    buffer_load_dwordx2 v[48:49], v3, s[48:51], s81 offen sc1
    buffer_load_dwordx2 v[50:51], v3, s[48:51], s81 offen offset:2560 sc1
    s_mul_i32 s81, s33, 10
    s_add_u32 s81, s81, s75
    buffer_load_dwordx4 v[52:55], v2, s[48:51], s81 offen offset:0 sc1
    buffer_load_dwordx4 v[56:59], v2, s[48:51], s81 offen offset:1280 sc1
    buffer_load_dwordx4 v[60:63], v2, s[48:51], s81 offen offset:2560 sc1
    buffer_load_dwordx4 v[64:67], v2, s[48:51], s81 offen offset:3840 sc1
    buffer_load_dwordx2 v[68:69], v3, s[48:51], s81 offen sc1
    buffer_load_dwordx2 v[70:71], v3, s[48:51], s81 offen offset:2560 sc1
    s_mul_i32 s81, s34, 10
    s_add_u32 s81, s81, s75
    buffer_load_dwordx4 v[72:75], v2, s[48:51], s81 offen offset:0 sc1
    buffer_load_dwordx4 v[76:79], v2, s[48:51], s81 offen offset:1280 sc1
    buffer_load_dwordx4 v[80:83], v2, s[48:51], s81 offen offset:2560 sc1
    buffer_load_dwordx4 v[84:87], v2, s[48:51], s81 offen offset:3840 sc1
    buffer_load_dwordx2 v[88:89], v3, s[48:51], s81 offen sc1
    buffer_load_dwordx2 v[90:91], v3, s[48:51], s81 offen offset:2560 sc1
    s_mul_i32 s81, s35, 10
    s_add_u32 s81, s81, s75
    buffer_load_dwordx4 v[92:95], v2, s[48:51], s81 offen offset:0 sc1
    buffer_load_dwordx4 v[96:99], v2, s[48:51], s81 offen offset:1280 sc1
    buffer_load_dwordx4 v[100:103], v2, s[48:51], s81 offen offset:2560 sc1
    buffer_load_dwordx4 v[104:107], v2, s[48:51], s81 offen offset:3840 sc1
    buffer_load_dwordx2 v[108:109], v3, s[48:51], s81 offen sc1
    buffer_load_dwordx2 v[110:111], v3, s[48:51], s81 offen offset:2560 sc1
    s_add_u32 s81, s74, 0x0
    buffer_load_dwordx4 a[16:19], v1, s[48:51], s81 offen sc1
    buffer_load_dword v215, v7, s[48:51], s77 offen
L_pr_top_135:
    v_add_u32 v8, s32, v4
    v_add_u32 v9, s33, v4
    v_add_u32 v10, s34, v4
    v_add_u32 v11, s35, v4
    s_waitcnt vmcnt(1)
    v_mov_b32 v192, v204
    v_mov_b32 v193, v205
    v_mov_b32 v202, v214
    s_mov_b32 s86, s76
    s_mov_b32 s87, s82
    s_add_u32 s82, s82, 1
    v_mfma_f32_16x16x32_bf16 v[112:115], a[0:3], v[32:35], 0
    v_mfma_f32_16x16x32_bf16 v[116:119], a[0:3], v[52:55], 0
    v_mfma_f32_16x16x32_bf16 v[120:123], a[0:3], v[72:75], 0
    v_mfma_f32_16x16x32_bf16 v[124:127], a[0:3], v[92:95], 0
    v_mfma_f32_16x16x32_bf16 v[112:115], a[4:7], v[36:39], v[112:115]
    v_mfma_f32_16x16x32_bf16 v[116:119], a[4:7], v[56:59], v[116:119]
    v_mfma_f32_16x16x32_bf16 v[120:123], a[4:7], v[76:79], v[120:123]
    v_mfma_f32_16x16x32_bf16 v[124:127], a[4:7], v[96:99], v[124:127]
    v_mfma_f32_16x16x32_bf16 v[112:115], a[8:11], v[40:43], v[112:115]
    v_mfma_f32_16x16x32_bf16 v[116:119], a[8:11], v[60:63], v[116:119]
    v_mfma_f32_16x16x32_bf16 v[120:123], a[8:11], v[80:83], v[120:123]
    v_mfma_f32_16x16x32_bf16 v[124:127], a[8:11], v[100:103], v[124:127]
    v_mfma_f32_16x16x32_bf16 v[112:115], a[12:15], v[44:47], v[112:115]
    v_mfma_f32_16x16x32_bf16 v[116:119], a[12:15], v[64:67], v[116:119]
    v_mfma_f32_16x16x32_bf16 v[120:123], a[12:15], v[84:87], v[120:123]
    v_mfma_f32_16x16x32_bf16 v[124:127], a[12:15], v[104:107], v[124:127]
    v_mfma_f32_16x16x32_bf16 v[112:115], a[16:19], v[48:51], v[112:115]
    v_mfma_f32_16x16x32_bf16 v[116:119], a[16:19], v[68:71], v[116:119]
    v_mfma_f32_16x16x32_bf16 v[120:123], a[16:19], v[88:91], v[120:123]
    v_mfma_f32_16x16x32_bf16 v[124:127], a[16:19], v[108:111], v[124:127]
    s_barrier
    s_mov_b64 exec, s[4:5]
    s_nop 2
    ds_write_b128 v8, v[112:115] offset:0
    ds_write_b128 v9, v[116:119] offset:0
    ds_write_b128 v10, v[120:123] offset:0
    ds_write_b128 v11, v[124:127] offset:0
    s_mov_b64 exec, -1
    s_bitcmp1_b64 s[8:9], s87
    s_cbranch_scc0 L_pr_nosel_136
    s_lshl_b32 s80, s87, 2
    s_add_u32 s80, s80, s64
    s_lshl_b32 s80, s80, 3
    v_lshrrev_b32 v12, 3, v0
    v_add_u32 v12, s80, v12
    v_mov_b32 v13, -1
    v_cmp_eq_u32 vcc, s20, v12
    v_mov_b32 v14, 0
    s_nop 0
    v_cndmask_b32 v13, v13, v14, vcc
    v_cmp_eq_u32 vcc, s21, v12
    v_mov_b32 v14, 1280
    s_nop 0
    v_cndmask_b32 v13, v13, v14, vcc
    v_cmp_eq_u32 vcc, s22, v12
    v_mov_b32 v14, 2560
    s_nop 0
    v_cndmask_b32 v13, v13, v14, vcc
    v_cmp_eq_u32 vcc, s23, v12
    v_mov_b32 v14, 3840
    s_nop 0
    v_cndmask_b32 v13, v13, v14, vcc
    v_cmp_eq_u32 vcc, s24, v12
    v_mov_b32 v14, 5120
    s_nop 0
    v_cndmask_b32 v13, v13, v14, vcc
    v_cmp_eq_u32 vcc, s25, v12
    v_mov_b32 v14, 6400
    s_nop 0
    v_cndmask_b32 v13, v13, v14, vcc
    v_cmp_eq_u32 vcc, s26, v12
    v_mov_b32 v14, 7680
    s_nop 0
    v_cndmask_b32 v13, v13, v14, vcc
    v_cmp_eq_u32 vcc, s27, v12
    v_mov_b32 v14, 8960
    s_nop 0
    v_cndmask_b32 v13, v13, v14, vcc
    v_cmp_ne_u32 vcc, -1, v13
    v_bfe_u32 v14, v0, 2, 1
    v_lshl_add_u32 v13, v14, 3, v13
    s_lshl_b32 s80, s72, 4
    s_add_u32 s80, s80, 0x612000
    s_and_saveexec_b64 s[28:29], vcc
    s_cbranch_execz L_pr_sk_137
    buffer_load_dwordx2 v[192:193], v13, s[48:51], s80 offen offset:0 sc1
    s_waitcnt vmcnt(0)
L_pr_sk_137:
    s_mov_b64 exec, -1
L_pr_nosel_136:
    s_cmp_ge_u32 s82, 64
    s_cbranch_scc1 L_pr_nonext_138
    s_mul_i32 s73, s72, 0x101000
    s_lshl_b32 s80, s82, 2
    s_add_u32 s80, s80, s64
    s_lshl_b32 s81, s80, 12
    s_add_u32 s73, s73, s81
    s_add_u32 s73, s73, 0x8100000
    s_mul_i32 s74, s72, 0x41000
    s_lshl_b32 s81, s80, 10
    s_add_u32 s74, s74, s81
    s_add_u32 s74, s74, 0x3a00000
    s_mul_i32 s76, s80, 10240
    s_lshl_b32 s81, s72, 4
    s_add_u32 s76, s76, s81
    s_lshl_b32 s77, s80, 5
    s_add_u32 s77, s77, 0x60a000
    s_mul_i32 s75, s82, 81920
    s_mul_i32 s81, s64, 5120
    s_add_u32 s75, s75, s81
    s_add_u32 s75, s75, 0xa00000
    s_add_u32 s79, s82, 1
    s_min_u32 s79, s79, 63
    s_mov_b32 s30, 0
    v_mov_b32 v217, v216
    buffer_load_dwordx2 v[204:205], v6, s[52:55], s76 offen offset:0
    buffer_load_dword v214, v7, s[48:51], s77 offen sc1
    s_add_u32 s81, s73, 0x0
    buffer_load_dwordx4 a[0:3], v1, s[48:51], s81 offen offset:0 sc1
    buffer_load_dwordx4 a[4:7], v1, s[48:51], s81 offen offset:1024 sc1
    buffer_load_dwordx4 a[8:11], v1, s[48:51], s81 offen offset:2048 sc1
    buffer_load_dwordx4 a[12:15], v1, s[48:51], s81 offen offset:3072 sc1
    s_cmp_lg_u32 s64, 1
    s_cbranch_scc1 L_pr_ok_144
    s_cmp_ge_u32 s78, s79
    s_cbranch_scc1 L_pr_hit_146
L_pr_fp_143:
    buffer_load_dword v12, v217, s[48:51], 0 offen sc1
    s_waitcnt vmcnt(0)
    s_nop 1
    v_min_u32_dpp v12, v12, v12 quad_perm:[1,0,3,2] row_mask:0xf bank_mask:0xf
    s_nop 1
    v_min_u32_dpp v12, v12, v12 quad_perm:[2,3,0,1] row_mask:0xf bank_mask:0xf
    s_nop 1
    v_min_u32_dpp v12, v12, v12 row_half_mirror row_mask:0xf bank_mask:0xf
    s_nop 1
    v_min_u32_dpp v12, v12, v12 row_mirror row_mask:0xf bank_mask:0xf
    s_nop 0
    v_readlane_b32 s78, v12, 0
    v_readlane_b32 s80, v12, 16
    v_readlane_b32 s81, v12, 32
    v_readlane_b32 s31, v12, 48
    s_min_u32 s78, s78, s80
    s_min_u32 s81, s81, s31
    s_min_u32 s78, s78, s81
    s_cmp_ge_u32 s78, s79
    s_cbranch_scc1 L_pr_hit_146
    s_sleep 4
    s_add_u32 s80, s78, 1
    s_cmp_ge_u32 s80, s79
    s_cbranch_scc1 L_pr_far_145
    s_sleep 64
L_pr_far_145:
    s_sub_u32 s67, s67, 1
    s_cbranch_scc1 K2_DONE
    s_branch L_pr_fp_143
L_pr_hit_146:
    s_cmp_lt_u32 s82, 62
    s_cbranch_scc1 L_pr_ok_144
    s_cmp_lg_u32 s30, 0
    s_cbranch_scc1 L_pr_ok_144
    s_mov_b32 s30, 1
    s_add_u32 s79, s82, 1
    v_mov_b32 v217, v203
    s_branch L_pr_fp_143
L_pr_ok_144:
    s_barrier
    s_mul_i32 s81, s32, 10
    s_add_u32 s81, s81, s75
    buffer_load_dwordx4 v[32:35], v2, s[48:51], s81 offen offset:0 sc1
    buffer_load_dwordx4 v[36:39], v2, s[48:51], s81 offen offset:1280 sc1
    buffer_load_dwordx4 v[40:43], v2, s[48:51], s81 offen offset:2560 sc1
    buffer_load_dwordx4 v[44:47], v2, s[48:51], s81 offen offset:3840 sc1
    buffer_load_dwordx2 v[48:49], v3, s[48:51], s81 offen sc1
    buffer_load_dwordx2 v[50:51], v3, s[48:51], s81 offen offset:2560 sc1
    s_mul_i32 s81, s33, 10
    s_add_u32 s81, s81, s75
    buffer_load_dwordx4 v[52:55], v2, s[48:51], s81 offen offset:0 sc1
    buffer_load_dwordx4 v[56:59], v2, s[48:51], s81 offen offset:1280 sc1
    buffer_load_dwordx4 v[60:63], v2, s[48:51], s81 offen offset:2560 sc1
    buffer_load_dwordx4 v[64:67], v2, s[48:51], s81 offen offset:3840 sc1
    buffer_load_dwordx2 v[68:69], v3, s[48:51], s81 offen sc1
    buffer_load_dwordx2 v[70:71], v3, s[48:51], s81 offen offset:2560 sc1
    s_mul_i32 s81, s34, 10
    s_add_u32 s81, s81, s75
    buffer_load_dwordx4 v[72:75], v2, s[48:51], s81 offen offset:0 sc1
    buffer_load_dwordx4 v[76:79], v2, s[48:51], s81 offen offset:1280 sc1
    buffer_load_dwordx4 v[80:83], v2, s[48:51], s81 offen offset:2560 sc1
    buffer_load_dwordx4 v[84:87], v2, s[48:51], s81 offen offset:3840 sc1
    buffer_load_dwordx2 v[88:89], v3, s[48:51], s81 offen sc1
    buffer_load_dwordx2 v[90:91], v3, s[48:51], s81 offen offset:2560 sc1
    s_mul_i32 s81, s35, 10
    s_add_u32 s81, s81, s75
    buffer_load_dwordx4 v[92:95], v2, s[48:51], s81 offen offset:0 sc1
    buffer_load_dwordx4 v[96:99], v2, s[48:51], s81 offen offset:1280 sc1
    buffer_load_dwordx4 v[100:103], v2, s[48:51], s81 offen offset:2560 sc1
    buffer_load_dwordx4 v[104:107], v2, s[48:51], s81 offen offset:3840 sc1
    buffer_load_dwordx2 v[108:109], v3, s[48:51], s81 offen sc1
    buffer_load_dwordx2 v[110:111], v3, s[48:51], s81 offen offset:2560 sc1
    s_add_u32 s81, s74, 0x0
    buffer_load_dwordx4 a[16:19], v1, s[48:51], s81 offen sc1
L_pr_nonext_138:
    v_sub_f32 v28, 1.0, v202
    v_cvt_pk_bf16_f32 v28, v28, v28
    v_and_b32 v28, 0xffff0000, v28
    s_waitcnt lgkmcnt(0)
    s_barrier
    ds_read_b128 v[8:11], v5 offset:0
    ds_read_b128 v[12:15], v5 offset:1024
    s_waitcnt lgkmcnt(0)
    v_pk_add_f32 v[8:9], v[8:9], v[12:13]
    v_pk_add_f32 v[10:11], v[10:11], v[14:15]
    s_nop 0
    v_add_f32_dpp v8, v8, v8 quad_perm:[1,0,3,2] row_mask:0xf bank_mask:0xf
    v_add_f32_dpp v9, v9, v9 quad_perm:[1,0,3,2] row_mask:0xf bank_mask:0xf
    v_add_f32_dpp v10, v10, v10 quad_perm:[1,0,3,2] row_mask:0xf bank_mask:0xf
    v_add_f32_dpp v11, v11, v11 quad_perm:[1,0,3,2] row_mask:0xf bank_mask:0xf
    v_add_f32_dpp v8, v8, v8 quad_perm:[2,3,0,1] row_mask:0xf bank_mask:0xf
    v_add_f32_dpp v9, v9, v9 quad_perm:[2,3,0,1] row_mask:0xf bank_mask:0xf
    v_add_f32_dpp v10, v10, v10 quad_perm:[2,3,0,1] row_mask:0xf bank_mask:0xf
    v_add_f32_dpp v11, v11, v11 quad_perm:[2,3,0,1] row_mask:0xf bank_mask:0xf
    v_cvt_pk_bf16_f32 v12, v8, v9
    v_cvt_pk_bf16_f32 v13, v10, v11
    v_lshlrev_b32 v16, 16, v12
    v_and_b32 v17, 0xffff0000, v12
    v_lshlrev_b32 v18, 16, v192
    v_and_b32 v19, 0xffff0000, v192
    v_mul_f32 v16, v16, v202
    v_mul_f32 v17, v17, v202
    v_mul_f32 v18, v18, v28
    v_mul_f32 v19, v19, v28
    v_cvt_pk_bf16_f32 v16, v16, v17
    v_cvt_pk_bf16_f32 v18, v18, v19
    v_lshlrev_b32 v20, 16, v16
    v_and_b32 v21, 0xffff0000, v16
    v_lshlrev_b32 v22, 16, v18
    v_and_b32 v23, 0xffff0000, v18
    v_add_f32 v20, v20, v22
    v_add_f32 v21, v21, v23
    v_cvt_pk_bf16_f32 v112, v20, v21
    v_lshlrev_b32 v16, 16, v13
    v_and_b32 v17, 0xffff0000, v13
    v_lshlrev_b32 v18, 16, v193
    v_and_b32 v19, 0xffff0000, v193
    v_mul_f32 v16, v16, v202
    v_mul_f32 v17, v17, v202
    v_mul_f32 v18, v18, v28
    v_mul_f32 v19, v19, v28
    v_cvt_pk_bf16_f32 v16, v16, v17
    v_cvt_pk_bf16_f32 v18, v18, v19
    v_lshlrev_b32 v20, 16, v16
    v_and_b32 v21, 0xffff0000, v16
    v_lshlrev_b32 v22, 16, v18
    v_and_b32 v23, 0xffff0000, v18
    v_add_f32 v20, v20, v22
    v_add_f32 v21, v21, v23
    v_cvt_pk_bf16_f32 v113, v20, v21
    s_nop 1
    v_mov_b32_dpp v114, v112 row_shl:4 row_mask:0xf bank_mask:0xf
    v_mov_b32_dpp v115, v113 row_shl:4 row_mask:0xf bank_mask:0xf
    s_mov_b64 exec, s[6:7]
    buffer_store_dwordx4 v[112:115], v6, s[56:59], s86 offen offset:0
    s_mov_b64 exec, -1
    s_cmp_ge_u32 s82, 64
    s_cbranch_scc1 K2_DONE
    s_branch L_pr_top_135
K2_DONE:
K2_EXIT:
    s_endpgm
.section .rodata,"a"
.p2align 6
.amdhsa_kernel gated_mix__memory_aug_recurrent_mem_tr__moe_arch_mod__prompt_kernel
  .amdhsa_next_free_vgpr 512
  .amdhsa_next_free_sgpr 102
  .amdhsa_accum_offset 256
  .amdhsa_group_segment_fixed_size 0
  .amdhsa_kernarg_size 128
  .amdhsa_user_sgpr_count 2
  .amdhsa_user_sgpr_kernarg_segment_ptr 1
  .amdhsa_system_sgpr_workgroup_id_x 1
  .amdhsa_float_denorm_mode_32 3
.end_amdhsa_kernel
```
